```python
import torch

def _softmax(x, axis=-1):
    return torch.softmax(x, dim=axis)

def _gelu(x):
    return torch.nn.functional.gelu(x, approximate='tanh')

def _silu(x):
    return torch.nn.functional.silu(x)

def _sigmoid(x):
    return torch.sigmoid(x)

def _layernorm(x, axis=-1, eps=1e-05):
    m = x.mean(dim=axis, keepdim=True)
    v = x.var(dim=axis, keepdim=True, unbiased=False)
    return (x - m) / torch.sqrt(v + eps)

def _scatter_add(tgt, idx, src, axis=0):
    return tgt.clone().index_add_(axis, idx, src)

def _segment_sum(src, seg, n):
    out = torch.zeros((n,) + src.shape[1:], dtype=src.dtype)
    return out.index_add_(0, seg, src)

def _pad(x, pw):
    flat = tuple((v for pair in reversed(pw) for v in pair))
    return torch.nn.functional.pad(x, flat)
kernel_name = 'adaLN_cond__gqa_block_cached__dense_activation_silu__prompt'

def setup_inputs():

    _w = lambda a: (lambda t: t.to(torch.bfloat16) if t.is_floating_point() else t)(torch.as_tensor(a))

    def _A_setup():
        B, Sq, D = (1, 2048, 512)
        Hq, Hkv, Sk, Dh = (32, 32, 2048, 128)
        assert Hq % Hkv == 0, (Hq, Hkv)
        return {'x': _w((lambda *s: torch.randn(*s, dtype=torch.bfloat16) * 0.1)(B, Sq, D)), 'k_cache': _w((lambda *s: torch.randn(*s, dtype=torch.bfloat16) * 0.8)(B, Hkv, Sk, Dh)), 'v_cache': _w((lambda *s: torch.randn(*s, dtype=torch.bfloat16) * 3.2)(B, Hkv, Sk, Dh)), 'wq': _w((lambda *s: torch.randn(*s, dtype=torch.bfloat16) * 0.8)(D, Hq * Dh) * D ** (-0.5)), 'wo': _w((lambda *s: torch.randn(*s, dtype=torch.bfloat16) * 3.2)(Hq * Dh, D) * (Hq * Dh) ** (-0.5))}
    _A_in = _A_setup()

    def _B_setup():
        B, S, D, F = (1, 2048, 512, 1376)
        return {'x': _w((lambda *s: torch.randn(*s, dtype=torch.bfloat16) * 0.1)(B, S, D)), 'w1': _w((lambda *s: torch.randn(*s, dtype=torch.bfloat16) * 3.2)(D, F) * D ** (-0.5)), 'w2': _w((lambda *s: torch.randn(*s, dtype=torch.bfloat16) * 3.2)(F, D) * F ** (-0.5))}
    _B_in = _B_setup()
    return {'A_x': _A_in['x'], 'A_k_cache': _A_in['k_cache'], 'A_v_cache': _A_in['v_cache'], 'A_wq': _A_in['wq'], 'A_wo': _A_in['wo'], 'B_x': _B_in['x'], 'B_w1': _B_in['w1'], 'B_w2': _B_in['w2'], 'c': _w((lambda *s: torch.randn(*s, dtype=torch.bfloat16) * 0.2)(1, 512) * 8.0), 'w_mod': _w((lambda *s: torch.randn(*s, dtype=torch.bfloat16) * 0.2)(512, 6 * 512) * 512 ** (-0.5) * 8.0)}

def reference(A_x, A_k_cache, A_v_cache, A_wq, A_wo, B_x, B_w1, B_w2, c, w_mod):

    def _A_ref(x, k_cache, v_cache, wq, wo):
        B, Sq, D = x.shape
        Hq, Dh = (32, 128)
        Hkv = k_cache.shape[1]
        rep = Hq // Hkv
        q = (lambda x, *d: x.permute(*d))((x @ wq).reshape(B, Sq, Hq, Dh), 0, 2, 1, 3)
        k = (lambda x, n, axis: torch.repeat_interleave(x, n, dim=axis))(k_cache, rep, axis=1)
        v = (lambda x, n, axis: torch.repeat_interleave(x, n, dim=axis))(v_cache, rep, axis=1)
        scores = torch.einsum('bhqd,bhkd->bhqk', q, k) * Dh ** (-0.5)
        p = _softmax(scores, axis=-1)
        o = torch.einsum('bhqk,bhkd->bhqd', p, v)
        return (lambda x, *d: x.permute(*d))(o, 0, 2, 1, 3).reshape(B, Sq, Hq * Dh) @ wo

    def _B_ref(x, w1, w2):
        h = torch.einsum('bsd,df->bsf', x, w1)
        h = _silu(h)
        out = torch.einsum('bsf,fd->bsd', h, w2)
        return out
    x = A_x
    mod = (_silu(c) @ w_mod).reshape(c.shape[0], 6, 1, -1)
    sa, ca, ga, sb, cb, gb = (mod[:, 0].clone(), mod[:, 1].clone(), mod[:, 2].clone(), mod[:, 3].clone(), mod[:, 4].clone(), mod[:, 5].clone())
    h = _layernorm(x, axis=-1) * (1 + ca) + sa
    x = x + ga * _A_ref(h, A_k_cache, A_v_cache, A_wq, A_wo)
    h = _layernorm(x, axis=-1) * (1 + cb) + sb
    x = x + gb * _B_ref(h, B_w1, B_w2)
    return x
```

```asm
; @launch grid=(256,1,1) block=(256,1,1) lds=163840
.amdgcn_target "amdgcn-amd-amdhsa--gfx950"
.text
.p2align 8
.globl adaLN_cond__gqa_block_cached__dense_activation_silu__prompt_kernel
.type adaLN_cond__gqa_block_cached__dense_activation_silu__prompt_kernel,@function
adaLN_cond__gqa_block_cached__dense_activation_silu__prompt_kernel:
  s_cmp_ge_u32 s2, 256
  s_cbranch_scc1 L_attn_end
  s_load_dwordx4 s[36:39], s[0:1], 64
  s_load_dwordx2 s[48:49], s[0:1], 0
  s_load_dwordx2 s[46:47], s[0:1], 96
  s_load_dwordx2 s[34:35], s[0:1], 88
  s_load_dwordx2 s[12:13], s[0:1], 24
  s_load_dwordx2 s[4:5], s[0:1], 8
  s_load_dwordx2 s[8:9], s[0:1], 16
  s_load_dwordx2 s[52:53], s[0:1], 32
  s_load_dwordx2 s[56:57], s[0:1], 48
  s_load_dwordx2 s[60:61], s[0:1], 56
  s_load_dwordx2 s[50:51], s[0:1], 80
  v_lshrrev_b32 v2, 6, v0
  v_and_b32 v1, 63, v0
  v_readfirstlane_b32 s24, v2
  s_getpc_b64 s[40:41]
L_pc_a:
  s_add_u32 s40, s40, L_attn_body-L_pc_a
  s_addc_u32 s41, s41, 0
  s_lshr_b32 s42, s2, 3
  s_lshl_b32 s42, s42, 2
  s_add_u32 s42, s42, s24
  s_mul_i32 s42, s42, 5
  v_min_u32 v10, 4, v1
  v_add_lshl_u32 v10, v10, s42, 7
  v_min_u32 v10, L_attn_end-L_attn_body, v10
  v_mov_b32 v9, s41
  v_add_co_u32 v8, s[42:43], s40, v10
  s_nop 1
  v_addc_co_u32 v9, s[42:43], v9, 0, s[42:43]
  global_load_dword v23, v[8:9], off
  v_mov_b32 v131, 0
  v_mov_b32 v132, 0
  v_mov_b32 v3, 0
  v_mov_b32 v20, 0
  v_mov_b32 v21, 0
  v_mov_b32 v22, 0
  v_mov_b32 v24, 0
  v_mov_b32 v25, 0
  v_mov_b32 v26, 0
  v_mov_b32 v27, 0
  v_mov_b32 v31, 0
  v_mov_b32 v13, 0
  v_mov_b32 v14, 0
  v_mov_b32 v15, 0
  v_mov_b32 v16, 0
  v_mov_b32 v17, 0
  v_mov_b32 v18, 0
  v_mov_b32 v19, 0
  v_mov_b32 v28, 0
  v_mov_b32 v48, 0
  v_mov_b32 v49, 0
  v_mov_b32 v51, 0
  v_mov_b32 v133, 0
  v_mov_b32 v134, 0
  v_mov_b32 v96, 0
  v_mov_b32 v97, 0
  v_mov_b32 v98, 0
  v_mov_b32 v99, 0
  v_mov_b32 v100, 0
  v_mov_b32 v101, 0
  v_mov_b32 v102, 0
  v_mov_b32 v103, 0
  v_mov_b32 v232, 0
  v_mov_b32 v233, 0
  v_mov_b32 v234, 0
  v_mov_b32 v235, 0
  v_mov_b32 v248, 0
  s_mov_b32 s6, 0
  s_mov_b32 s7, 0x20000
  s_mov_b32 s10, 0
  s_mov_b32 s11, 0x20000
  s_mov_b32 s14, 0
  s_mov_b32 s15, 0x20000
  s_mov_b32 s18, 0
  s_mov_b32 s19, 0x20000
  s_mov_b32 s22, 0
  s_mov_b32 s23, 0x20000
  s_mov_b32 s54, 0
  s_mov_b32 s55, 0x20000
  s_mov_b32 s58, 0
  s_mov_b32 s59, 0x20000
  s_mov_b32 s62, 0
  s_mov_b32 s63, 0x20000
  s_mov_b32 s66, 0
  s_mov_b32 s67, 0x20000
  s_mov_b32 s74, 0
  s_mov_b32 s75, 0x20000
  s_cmp_lt_u32 s2, 32
  s_cbranch_scc1 L_rb_idle
  s_cmp_lt_u32 s2, 128
  s_cbranch_scc1 L_rb_crit
  s_and_b32 s30, s2, 1
  s_lshl_b32 s30, s30, 6
  s_bfe_u32 s31, s2, 0x20001
  s_lshl_b32 s31, s31, 4
  s_add_u32 s30, s30, s31
  s_bfe_u32 s31, s2, 0x40003
  s_add_u32 s30, s30, s31
  s_lshl_b32 s30, s30, 14
  v_and_b32 v129, 15, v0
  v_bfe_u32 v130, v0, 4, 2
  v_lshlrev_b32 v132, 10, v129
  v_lshl_add_u32 v132, v2, 8, v132
  v_lshl_add_u32 v132, v130, 5, v132
  s_waitcnt lgkmcnt(0)
  s_mov_b32 s16, s48
  s_mov_b32 s17, s49
  s_mov_b32 s18, 2097152
  s_mov_b32 s19, 0x20000
  s_add_u32 s20, s46, 1048576
  s_addc_u32 s21, s47, 0
  s_mov_b32 s22, 2097152
  s_mov_b32 s23, 0x20000
  buffer_load_dwordx4 v[144:147], v132, s[16:19], s30 offen offset:0
  buffer_load_dwordx4 v[148:151], v132, s[16:19], s30 offen offset:16
  buffer_load_dwordx4 v[152:155], v132, s[16:19], s30 offen offset:128
  buffer_load_dwordx4 v[156:159], v132, s[16:19], s30 offen offset:144
L_rb_done:
  s_mov_b64 s[64:65], s[46:47]
  s_mov_b64 s[72:73], s[46:47]
  s_mov_b64 vcc, -1
  s_cmp_eq_u32 s24, 0
  s_cbranch_scc1 L_attn_st0
  s_cmp_eq_u32 s24, 1
  s_cbranch_scc1 L_attn_st100
  s_cmp_eq_u32 s24, 2
  s_cbranch_scc1 L_attn_st101
  s_cmp_eq_u32 s24, 3
  s_cbranch_scc1 L_attn_st1
L_attn_walkdone0:
  s_mov_b64 vcc, 0
  s_branch L_attn_body
L_rb_crit:
  v_lshrrev_b32 v129, 4, v0
  v_and_b32 v130, 15, v0
  v_mul_u32_u24 v131, 49152, v129
  v_lshl_add_u32 v131, v130, 4, v131
  v_lshlrev_b32 v132, 4, v129
  s_bfe_u32 s30, s2, 0x20003
  s_mul_i32 s31, s30, 786432
  s_lshr_b32 s32, s2, 5
  s_sub_u32 s32, s32, 1
  s_lshl_b32 s32, s32, 3
  s_and_b32 s33, s2, 7
  s_add_u32 s32, s32, s33
  s_lshl_b32 s32, s32, 8
  s_add_u32 s31, s31, s32
  s_lshl_b32 s33, s30, 8
  s_mul_i32 s30, s30, 12288
  s_lshl_b32 s32, s32, 1
  s_add_u32 s30, s30, s32
  s_waitcnt lgkmcnt(0)
  s_mov_b32 s16, s38
  s_mov_b32 s17, s39
  s_mov_b32 s18, 3145728
  s_mov_b32 s19, 0x20000
  s_mov_b32 s20, s36
  s_mov_b32 s21, s37
  s_mov_b32 s22, 1024
  s_mov_b32 s23, 0x20000
  buffer_load_dwordx4 v[188:191], v132, s[20:23], s33 offen
  buffer_load_dwordx4 v[144:147], v131, s[16:19], s31 offen
  s_add_u32 s31, s31, 6144
  buffer_load_dwordx4 v[148:151], v131, s[16:19], s31 offen
  s_add_u32 s31, s31, 6144
  buffer_load_dwordx4 v[152:155], v131, s[16:19], s31 offen
  s_add_u32 s31, s31, 6144
  buffer_load_dwordx4 v[156:159], v131, s[16:19], s31 offen
  s_add_u32 s31, s31, 6144
  buffer_load_dwordx4 v[160:163], v131, s[16:19], s31 offen
  s_add_u32 s31, s31, 6144
  buffer_load_dwordx4 v[164:167], v131, s[16:19], s31 offen
  s_add_u32 s31, s31, 6144
  buffer_load_dwordx4 v[168:171], v131, s[16:19], s31 offen
  s_add_u32 s31, s31, 6144
  buffer_load_dwordx4 v[172:175], v131, s[16:19], s31 offen
  s_branch L_rb_done
L_rb_idle:
  s_waitcnt lgkmcnt(0)
  s_mov_b64 s[36:37], s[4:5]
  s_mov_b64 s[38:39], s[8:9]
  s_mov_b32 s16, s34
  s_mov_b32 s17, s35
  s_mov_b32 s18, 256
  s_mov_b32 s19, 0x20000
  s_add_u32 s20, s46, 360448
  s_addc_u32 s21, s47, 0
  s_mov_b32 s22, 128
  s_mov_b32 s23, 0x20000
  v_mov_b32 v129, 0
  s_cmp_lg_u32 s2, 0
  s_cbranch_scc1 L_rb_touch
  s_cmp_lg_u32 s24, 3
  s_cbranch_scc1 L_rb_done
  s_mov_b64 exec, 1
  buffer_load_dword v130, v129, s[20:23], 0 offen sc1
  s_waitcnt vmcnt(0)
  v_add_u32 v130, 0x1e3779b1, v130
  v_or_b32 v130, 0x80000000, v130
  buffer_store_dword v130, v129, s[16:19], 0 offen sc1
  buffer_store_dword v130, v129, s[20:23], 0 offen sc1
  s_mov_b64 exec, -1
  s_branch L_rb_done
L_rb_touch:
  s_branch L_rb_done
  s_branch L_attn_body
.p2align 12
L_attn_body:
L_attn_st0:
  s_cbranch_vccnz L_attn_walkdone0
  s_bfe_u32 s40, s2, 0x20001
  s_lshl_b32 s40, s40, 3
  s_bfe_u32 s41, s2, 0x30003
  s_add_u32 s40, s40, s41
  s_and_b32 s41, s2, 1
  s_lshl_b32 s41, s41, 2
  s_lshr_b32 s42, s2, 6
  s_add_u32 s41, s41, s42
  v_lshrrev_b32 v2, 4, v1
  v_and_b32 v3, 15, v1
  v_lshlrev_b32 v19, 4, v1
  v_lshlrev_b32 v28, 2, v2
  v_xor_b32 v28, v28, v3
  s_lshl_b32 s43, s24, 12
  v_lshl_add_u32 v29, v2, 8, s43
  v_lshlrev_b32 v30, 5, v29
  v_lshl_add_u32 v18, v28, 4, v30
  s_lshl_b32 s42, s41, 4
  s_lshl_b32 s44, s24, 2
  s_add_u32 s44, s44, s42
  s_lshl_b32 s42, s40, 8
  s_add_u32 s12, s12, s42
  s_addc_u32 s13, s13, 0
  s_mov_b32 s14, 0
  s_mov_b32 s15, 0x20000
  s_sub_u32 s14, 4194304, s42
  s_getreg_b32 s25, hwreg(HW_REG_XCC_ID)
  s_add_u32 s26, s43, 65536
  s_add_u32 s64, s46, 131072
  s_addc_u32 s65, s47, 0
  s_mov_b32 s66, 229376
  s_mov_b32 s67, 0x20000
  s_mov_b32 s68, 0
  s_mul_i32 s3, s41, 0
  s_and_b32 s3, s3, 7
  s_lshl_b32 s0, s3, 19
  s_sub_u32 s0, s0, 0x80000
  s_lshl_b32 s1, s3, 11
  s_sub_u32 s1, s1, 1024
  s_add_u32 s0, s0, 0x80000
  s_and_b32 s0, s0, 0x3fffff
  s_add_u32 m0, s26, 0
  s_add_u32 s42, s0, 0
  buffer_load_dwordx4 v18, s[12:15], s42 offen offset:0 lds
  s_add_u32 s42, s0, 31744
  buffer_load_dwordx4 v18, s[12:15], s42 offen offset:1024 lds
  s_add_u32 s42, s0, 63488
  buffer_load_dwordx4 v18, s[12:15], s42 offen offset:2048 lds
  s_add_u32 s42, s0, 95232
  buffer_load_dwordx4 v18, s[12:15], s42 offen offset:3072 lds
  s_lshl_b32 s42, s40, 19
  s_add_u32 s4, s4, s42
  s_addc_u32 s5, s5, 0
  s_mov_b32 s6, 524288
  s_mov_b32 s7, 0x20000
  s_add_u32 s8, s8, s42
  s_addc_u32 s9, s9, 0
  s_mov_b32 s10, 524288
  s_mov_b32 s11, 0x20000
  s_mov_b32 s54, 4194304
  s_mov_b32 s55, 0x20000
  s_mov_b32 s58, 1409024
  s_mov_b32 s59, 0x20000
  s_mov_b32 s62, 1409024
  s_mov_b32 s63, 0x20000
  s_mov_b32 s29, 0
  s_lshl_b32 s42, s24, 2
  v_or_b32 v28, s42, v2
  v_xor_b32 v28, v28, v3
  v_lshl_add_u32 v16, v28, 4, v29
  s_and_b32 s42, s24, 1
  s_lshl_b32 s42, s42, 2
  v_or_b32 v28, s42, v2
  v_lshlrev_b32 v28, 1, v28
  v_xor_b32 v28, v28, v3
  v_lshl_add_u32 v17, v28, 4, v29
  v_lshrrev_b32 v28, 2, v3
  v_lshl_add_u32 v28, v2, 4, v28
  v_lshlrev_b32 v28, 8, v28
  v_lshl_add_u32 v28, v3, 4, v28
  v_add_u32 v8, 65536, v28
  v_xor_b32 v9, 64, v8
  v_xor_b32 v10, 128, v8
  v_xor_b32 v11, 192, v8
  v_lshlrev_b32 v12, 6, v2
  v_add_u32 v12, 131072, v12
  v_lshrrev_b32 v28, 2, v3
  v_lshlrev_b32 v28, 12, v28
  v_and_b32 v29, 3, v3
  v_lshl_add_u32 v28, v29, 8, v28
  v_xor_b32 v29, v2, v3
  v_lshl_add_u32 v4, v29, 4, v28
  v_xor_b32 v5, 64, v4
  v_xor_b32 v6, 128, v4
  v_xor_b32 v7, 192, v4
  v_add_u32 v28, -32, v1
  v_cmp_gt_u32 s[32:33], 48, v1
  s_lshr_b32 s42, s41, 2
  s_and_b32 s45, s41, 3
  v_cndmask_b32 v28, v28, v1, s[32:33]
  s_lshl_b32 s45, s45, 1
  s_or_b32 s42, s42, s45
  s_add_u32 s42, s42, 128
  v_lshl_add_u32 v29, v28, 3, s42
  v_add_u32 v30, -16, v28
  s_and_b32 s45, s2, 7
  s_add_u32 s45, s45, 256
  v_lshl_add_u32 v30, v30, 3, s45
  v_cmp_gt_u32 s[32:33], 16, v28
  s_lshl_b32 s42, s2, 7
  v_mov_b32 v14, s42
  v_cndmask_b32 v29, v30, v29, s[32:33]
  v_lshlrev_b32 v13, 7, v29
  s_sub_u32 s45, s2, 32
  s_lshl_b32 s45, s45, 3
  s_add_u32 s45, s45, 256
  v_add_lshl_u32 v15, s45, v1, 7
  s_lshr_b32 s45, s2, 5
  s_cmp_eq_u32 s45, 1
  s_cselect_b64 s[32:33], -1, 0
  s_cselect_b32 s69, 0xff, 1
  v_cndmask_b32 v14, v14, v15, s[32:33]
  v_and_b32 v28, 7, v1
  s_and_b32 s45, s2, 0xc7
  v_lshl_or_b32 v28, v28, 3, s45
  s_and_b32 s45, s2, 0x87
  v_lshl_or_b32 v29, v3, 3, s45
  v_cmp_gt_u32 s[32:33], 16, v1
  s_lshl_b32 s45, s2, 7
  v_mov_b32 v22, s45
  v_cndmask_b32 v15, v29, v28, s[32:33]
  v_lshlrev_b32 v15, 7, v15
  s_add_u32 s0, s0, 0x80000
  s_and_b32 s0, s0, 0x3fffff
  s_add_u32 m0, s26, 16384
  s_add_u32 s42, s0, 0
  buffer_load_dwordx4 v18, s[12:15], s42 offen offset:0 lds
  s_add_u32 s42, s0, 31744
  buffer_load_dwordx4 v18, s[12:15], s42 offen offset:1024 lds
  s_add_u32 s42, s0, 63488
  buffer_load_dwordx4 v18, s[12:15], s42 offen offset:2048 lds
  s_add_u32 s42, s0, 95232
  buffer_load_dwordx4 v18, s[12:15], s42 offen offset:3072 lds
  s_add_u32 s0, s0, 0x80000
  s_and_b32 s0, s0, 0x3fffff
  s_add_u32 m0, s26, 32768
  s_add_u32 s42, s0, 0
  buffer_load_dwordx4 v18, s[12:15], s42 offen offset:0 lds
  s_add_u32 s42, s0, 31744
  buffer_load_dwordx4 v18, s[12:15], s42 offen offset:1024 lds
  s_add_u32 s42, s0, 63488
  buffer_load_dwordx4 v18, s[12:15], s42 offen offset:2048 lds
  s_add_u32 s42, s0, 95232
  buffer_load_dwordx4 v18, s[12:15], s42 offen offset:3072 lds
  s_cmp_ge_u32 s2, 128
  s_cbranch_scc1 L_rd_ln
  s_cmp_lt_u32 s2, 32
  s_cbranch_scc1 L_rd_idle
  v_mov_b32 v176, 0
  v_mov_b32 v177, 0
  v_mov_b32 v178, 0
  v_mov_b32 v179, 0
  v_mov_b32 v180, 0
  v_mov_b32 v181, 0
  v_mov_b32 v182, 0
  v_mov_b32 v183, 0
  s_waitcnt vmcnt(20)
  v_lshlrev_b32 v136, 16, v188
  v_and_b32 v137, 0xffff0000, v188
  v_lshlrev_b32 v138, 16, v189
  v_and_b32 v139, 0xffff0000, v189
  v_lshlrev_b32 v140, 16, v190
  v_and_b32 v141, 0xffff0000, v190
  v_lshlrev_b32 v142, 16, v191
  v_and_b32 v143, 0xffff0000, v191
  v_mul_f32 v184, 0xbfb8aa3b, v136
  v_mul_f32 v185, 0xbfb8aa3b, v137
  v_mul_f32 v186, 0xbfb8aa3b, v138
  v_mul_f32 v187, 0xbfb8aa3b, v139
  v_mul_f32 v188, 0xbfb8aa3b, v140
  v_mul_f32 v189, 0xbfb8aa3b, v141
  v_mul_f32 v190, 0xbfb8aa3b, v142
  v_mul_f32 v191, 0xbfb8aa3b, v143
  v_exp_f32 v184, v184
  v_exp_f32 v185, v185
  v_exp_f32 v186, v186
  v_exp_f32 v187, v187
  v_exp_f32 v188, v188
  v_exp_f32 v189, v189
  v_exp_f32 v190, v190
  v_exp_f32 v191, v191
  v_add_f32 v184, 1.0, v184
  v_add_f32 v185, 1.0, v185
  v_add_f32 v186, 1.0, v186
  v_add_f32 v187, 1.0, v187
  v_add_f32 v188, 1.0, v188
  v_add_f32 v189, 1.0, v189
  v_add_f32 v190, 1.0, v190
  v_add_f32 v191, 1.0, v191
  v_rcp_f32 v184, v184
  v_rcp_f32 v185, v185
  v_rcp_f32 v186, v186
  v_rcp_f32 v187, v187
  v_rcp_f32 v188, v188
  v_rcp_f32 v189, v189
  v_rcp_f32 v190, v190
  v_rcp_f32 v191, v191
  v_mul_f32 v136, v136, v184
  v_mul_f32 v137, v137, v185
  v_mul_f32 v138, v138, v186
  v_mul_f32 v139, v139, v187
  v_mul_f32 v140, v140, v188
  v_mul_f32 v141, v141, v189
  v_mul_f32 v142, v142, v190
  v_mul_f32 v143, v143, v191
  v_cvt_pk_bf16_f32 v136, v136, v136
  v_and_b32 v136, 0xffff0000, v136
  v_cvt_pk_bf16_f32 v137, v137, v137
  v_and_b32 v137, 0xffff0000, v137
  v_cvt_pk_bf16_f32 v138, v138, v138
  v_and_b32 v138, 0xffff0000, v138
  v_cvt_pk_bf16_f32 v139, v139, v139
  v_and_b32 v139, 0xffff0000, v139
  v_cvt_pk_bf16_f32 v140, v140, v140
  v_and_b32 v140, 0xffff0000, v140
  v_cvt_pk_bf16_f32 v141, v141, v141
  v_and_b32 v141, 0xffff0000, v141
  v_cvt_pk_bf16_f32 v142, v142, v142
  v_and_b32 v142, 0xffff0000, v142
  v_cvt_pk_bf16_f32 v143, v143, v143
  v_and_b32 v143, 0xffff0000, v143
  s_waitcnt vmcnt(19)
  v_lshlrev_b32 v184, 16, v144
  v_and_b32 v185, 0xffff0000, v144
  v_pk_fma_f32 v[176:177], v[184:185], v[136:137], v[176:177] op_sel:[0,0,0] op_sel_hi:[1,0,1]
  v_lshlrev_b32 v186, 16, v145
  v_and_b32 v187, 0xffff0000, v145
  v_pk_fma_f32 v[178:179], v[186:187], v[136:137], v[178:179] op_sel:[0,0,0] op_sel_hi:[1,0,1]
  v_lshlrev_b32 v184, 16, v146
  v_and_b32 v185, 0xffff0000, v146
  v_pk_fma_f32 v[180:181], v[184:185], v[136:137], v[180:181] op_sel:[0,0,0] op_sel_hi:[1,0,1]
  v_lshlrev_b32 v186, 16, v147
  v_and_b32 v187, 0xffff0000, v147
  v_pk_fma_f32 v[182:183], v[186:187], v[136:137], v[182:183] op_sel:[0,0,0] op_sel_hi:[1,0,1]
  s_waitcnt vmcnt(18)
  v_lshlrev_b32 v184, 16, v148
  v_and_b32 v185, 0xffff0000, v148
  v_pk_fma_f32 v[176:177], v[184:185], v[136:137], v[176:177] op_sel:[0,1,0] op_sel_hi:[1,1,1]
  v_lshlrev_b32 v186, 16, v149
  v_and_b32 v187, 0xffff0000, v149
  v_pk_fma_f32 v[178:179], v[186:187], v[136:137], v[178:179] op_sel:[0,1,0] op_sel_hi:[1,1,1]
  v_lshlrev_b32 v184, 16, v150
  v_and_b32 v185, 0xffff0000, v150
  v_pk_fma_f32 v[180:181], v[184:185], v[136:137], v[180:181] op_sel:[0,1,0] op_sel_hi:[1,1,1]
  v_lshlrev_b32 v186, 16, v151
  v_and_b32 v187, 0xffff0000, v151
  v_pk_fma_f32 v[182:183], v[186:187], v[136:137], v[182:183] op_sel:[0,1,0] op_sel_hi:[1,1,1]
  s_waitcnt vmcnt(17)
  v_lshlrev_b32 v184, 16, v152
  v_and_b32 v185, 0xffff0000, v152
  v_pk_fma_f32 v[176:177], v[184:185], v[138:139], v[176:177] op_sel:[0,0,0] op_sel_hi:[1,0,1]
  v_lshlrev_b32 v186, 16, v153
  v_and_b32 v187, 0xffff0000, v153
  v_pk_fma_f32 v[178:179], v[186:187], v[138:139], v[178:179] op_sel:[0,0,0] op_sel_hi:[1,0,1]
  v_lshlrev_b32 v184, 16, v154
  v_and_b32 v185, 0xffff0000, v154
  v_pk_fma_f32 v[180:181], v[184:185], v[138:139], v[180:181] op_sel:[0,0,0] op_sel_hi:[1,0,1]
  v_lshlrev_b32 v186, 16, v155
  v_and_b32 v187, 0xffff0000, v155
  v_pk_fma_f32 v[182:183], v[186:187], v[138:139], v[182:183] op_sel:[0,0,0] op_sel_hi:[1,0,1]
  s_waitcnt vmcnt(16)
  v_lshlrev_b32 v184, 16, v156
  v_and_b32 v185, 0xffff0000, v156
  v_pk_fma_f32 v[176:177], v[184:185], v[138:139], v[176:177] op_sel:[0,1,0] op_sel_hi:[1,1,1]
  v_lshlrev_b32 v186, 16, v157
  v_and_b32 v187, 0xffff0000, v157
  v_pk_fma_f32 v[178:179], v[186:187], v[138:139], v[178:179] op_sel:[0,1,0] op_sel_hi:[1,1,1]
  v_lshlrev_b32 v184, 16, v158
  v_and_b32 v185, 0xffff0000, v158
  v_pk_fma_f32 v[180:181], v[184:185], v[138:139], v[180:181] op_sel:[0,1,0] op_sel_hi:[1,1,1]
  v_lshlrev_b32 v186, 16, v159
  v_and_b32 v187, 0xffff0000, v159
  v_pk_fma_f32 v[182:183], v[186:187], v[138:139], v[182:183] op_sel:[0,1,0] op_sel_hi:[1,1,1]
  s_waitcnt vmcnt(15)
  v_lshlrev_b32 v184, 16, v160
  v_and_b32 v185, 0xffff0000, v160
  v_pk_fma_f32 v[176:177], v[184:185], v[140:141], v[176:177] op_sel:[0,0,0] op_sel_hi:[1,0,1]
  v_lshlrev_b32 v186, 16, v161
  v_and_b32 v187, 0xffff0000, v161
  v_pk_fma_f32 v[178:179], v[186:187], v[140:141], v[178:179] op_sel:[0,0,0] op_sel_hi:[1,0,1]
  v_lshlrev_b32 v184, 16, v162
  v_and_b32 v185, 0xffff0000, v162
  v_pk_fma_f32 v[180:181], v[184:185], v[140:141], v[180:181] op_sel:[0,0,0] op_sel_hi:[1,0,1]
  v_lshlrev_b32 v186, 16, v163
  v_and_b32 v187, 0xffff0000, v163
  v_pk_fma_f32 v[182:183], v[186:187], v[140:141], v[182:183] op_sel:[0,0,0] op_sel_hi:[1,0,1]
  s_waitcnt vmcnt(14)
  v_lshlrev_b32 v184, 16, v164
  v_and_b32 v185, 0xffff0000, v164
  v_pk_fma_f32 v[176:177], v[184:185], v[140:141], v[176:177] op_sel:[0,1,0] op_sel_hi:[1,1,1]
  v_lshlrev_b32 v186, 16, v165
  v_and_b32 v187, 0xffff0000, v165
  v_pk_fma_f32 v[178:179], v[186:187], v[140:141], v[178:179] op_sel:[0,1,0] op_sel_hi:[1,1,1]
  v_lshlrev_b32 v184, 16, v166
  v_and_b32 v185, 0xffff0000, v166
  v_pk_fma_f32 v[180:181], v[184:185], v[140:141], v[180:181] op_sel:[0,1,0] op_sel_hi:[1,1,1]
  v_lshlrev_b32 v186, 16, v167
  v_and_b32 v187, 0xffff0000, v167
  v_pk_fma_f32 v[182:183], v[186:187], v[140:141], v[182:183] op_sel:[0,1,0] op_sel_hi:[1,1,1]
  s_waitcnt vmcnt(13)
  v_lshlrev_b32 v184, 16, v168
  v_and_b32 v185, 0xffff0000, v168
  v_pk_fma_f32 v[176:177], v[184:185], v[142:143], v[176:177] op_sel:[0,0,0] op_sel_hi:[1,0,1]
  v_lshlrev_b32 v186, 16, v169
  v_and_b32 v187, 0xffff0000, v169
  v_pk_fma_f32 v[178:179], v[186:187], v[142:143], v[178:179] op_sel:[0,0,0] op_sel_hi:[1,0,1]
  v_lshlrev_b32 v184, 16, v170
  v_and_b32 v185, 0xffff0000, v170
  v_pk_fma_f32 v[180:181], v[184:185], v[142:143], v[180:181] op_sel:[0,0,0] op_sel_hi:[1,0,1]
  v_lshlrev_b32 v186, 16, v171
  v_and_b32 v187, 0xffff0000, v171
  v_pk_fma_f32 v[182:183], v[186:187], v[142:143], v[182:183] op_sel:[0,0,0] op_sel_hi:[1,0,1]
  s_waitcnt vmcnt(12)
  v_lshlrev_b32 v184, 16, v172
  v_and_b32 v185, 0xffff0000, v172
  v_pk_fma_f32 v[176:177], v[184:185], v[142:143], v[176:177] op_sel:[0,1,0] op_sel_hi:[1,1,1]
  v_lshlrev_b32 v186, 16, v173
  v_and_b32 v187, 0xffff0000, v173
  v_pk_fma_f32 v[178:179], v[186:187], v[142:143], v[178:179] op_sel:[0,1,0] op_sel_hi:[1,1,1]
  v_lshlrev_b32 v184, 16, v174
  v_and_b32 v185, 0xffff0000, v174
  v_pk_fma_f32 v[180:181], v[184:185], v[142:143], v[180:181] op_sel:[0,1,0] op_sel_hi:[1,1,1]
  v_lshlrev_b32 v186, 16, v175
  v_and_b32 v187, 0xffff0000, v175
  v_pk_fma_f32 v[182:183], v[186:187], v[142:143], v[182:183] op_sel:[0,1,0] op_sel_hi:[1,1,1]
  v_lshlrev_b32 v133, 5, v0
  v_add_u32 v133, 147456, v133
  ds_write_b128 v133, v[176:179]
  ds_write_b128 v133, v[180:183] offset:16
  v_lshlrev_b32 v134, 3, v1
  v_add_u32 v133, 147456, v134
  s_add_u32 s16, s46, 32768
  s_addc_u32 s17, s47, 0
  s_mov_b32 s18, 49152
  s_mov_b32 s19, 0x20000
  s_waitcnt lgkmcnt(0)
  s_barrier
  s_cmp_lg_u32 s24, 3
  s_cbranch_scc1 L_rd_done
  ds_read_b64 v[144:145], v133 offset:0
  ds_read_b64 v[146:147], v133 offset:512
  ds_read_b64 v[148:149], v133 offset:1024
  ds_read_b64 v[150:151], v133 offset:1536
  ds_read_b64 v[152:153], v133 offset:2048
  ds_read_b64 v[154:155], v133 offset:2560
  ds_read_b64 v[156:157], v133 offset:3072
  ds_read_b64 v[158:159], v133 offset:3584
  ds_read_b64 v[160:161], v133 offset:4096
  ds_read_b64 v[162:163], v133 offset:4608
  ds_read_b64 v[164:165], v133 offset:5120
  ds_read_b64 v[166:167], v133 offset:5632
  ds_read_b64 v[168:169], v133 offset:6144
  ds_read_b64 v[170:171], v133 offset:6656
  ds_read_b64 v[172:173], v133 offset:7168
  ds_read_b64 v[174:175], v133 offset:7680
  s_waitcnt lgkmcnt(0)
  v_pk_add_f32 v[144:145], v[144:145], v[160:161]
  v_pk_add_f32 v[146:147], v[146:147], v[162:163]
  v_pk_add_f32 v[148:149], v[148:149], v[164:165]
  v_pk_add_f32 v[150:151], v[150:151], v[166:167]
  v_pk_add_f32 v[152:153], v[152:153], v[168:169]
  v_pk_add_f32 v[154:155], v[154:155], v[170:171]
  v_pk_add_f32 v[156:157], v[156:157], v[172:173]
  v_pk_add_f32 v[158:159], v[158:159], v[174:175]
  v_pk_add_f32 v[144:145], v[144:145], v[152:153]
  v_pk_add_f32 v[146:147], v[146:147], v[154:155]
  v_pk_add_f32 v[148:149], v[148:149], v[156:157]
  v_pk_add_f32 v[150:151], v[150:151], v[158:159]
  v_pk_add_f32 v[144:145], v[144:145], v[148:149]
  v_pk_add_f32 v[146:147], v[146:147], v[150:151]
  v_pk_add_f32 v[144:145], v[144:145], v[146:147]
  buffer_store_dwordx2 v[144:145], v134, s[16:19], s30 offen sc1
  s_branch L_rd_done
L_rd_idle:
  s_branch L_rd_done
L_rd_ln:
L_attn_st100:
  s_cbranch_vccnz L_attn_walkdone0
  v_add_u32 v134, s43, v19
  v_lshlrev_b32 v136, 4, v129
  v_add_u32 v136, 147456, v136
  s_lshl_b32 s31, s24, 2
  v_add_u32 v135, s31, v136
  s_waitcnt vmcnt(12)
  v_lshlrev_b32 v160, 16, v144
  v_and_b32 v161, 0xffff0000, v144
  v_lshlrev_b32 v162, 16, v145
  v_and_b32 v163, 0xffff0000, v145
  v_lshlrev_b32 v164, 16, v146
  v_and_b32 v165, 0xffff0000, v146
  v_lshlrev_b32 v166, 16, v147
  v_and_b32 v167, 0xffff0000, v147
  v_lshlrev_b32 v168, 16, v148
  v_and_b32 v169, 0xffff0000, v148
  v_lshlrev_b32 v170, 16, v149
  v_and_b32 v171, 0xffff0000, v149
  v_lshlrev_b32 v172, 16, v150
  v_and_b32 v173, 0xffff0000, v150
  v_lshlrev_b32 v174, 16, v151
  v_and_b32 v175, 0xffff0000, v151
  v_lshlrev_b32 v176, 16, v152
  v_and_b32 v177, 0xffff0000, v152
  v_lshlrev_b32 v178, 16, v153
  v_and_b32 v179, 0xffff0000, v153
  v_lshlrev_b32 v180, 16, v154
  v_and_b32 v181, 0xffff0000, v154
  v_lshlrev_b32 v182, 16, v155
  v_and_b32 v183, 0xffff0000, v155
  v_lshlrev_b32 v184, 16, v156
  v_and_b32 v185, 0xffff0000, v156
  v_lshlrev_b32 v186, 16, v157
  v_and_b32 v187, 0xffff0000, v157
  v_lshlrev_b32 v188, 16, v158
  v_and_b32 v189, 0xffff0000, v158
  v_lshlrev_b32 v190, 16, v159
  v_and_b32 v191, 0xffff0000, v159
  v_pk_add_f32 v[144:145], v[160:161], v[162:163]
  v_pk_add_f32 v[144:145], v[144:145], v[164:165]
  v_pk_add_f32 v[144:145], v[144:145], v[166:167]
  v_pk_add_f32 v[144:145], v[144:145], v[168:169]
  v_pk_add_f32 v[144:145], v[144:145], v[170:171]
  v_pk_add_f32 v[144:145], v[144:145], v[172:173]
  v_pk_add_f32 v[144:145], v[144:145], v[174:175]
  v_pk_add_f32 v[144:145], v[144:145], v[176:177]
  v_pk_add_f32 v[144:145], v[144:145], v[178:179]
  v_pk_add_f32 v[144:145], v[144:145], v[180:181]
  v_pk_add_f32 v[144:145], v[144:145], v[182:183]
  v_pk_add_f32 v[144:145], v[144:145], v[184:185]
  v_pk_add_f32 v[144:145], v[144:145], v[186:187]
  v_pk_add_f32 v[144:145], v[144:145], v[188:189]
  v_pk_add_f32 v[144:145], v[144:145], v[190:191]
  v_add_f32 v144, v144, v145
  v_mov_b32 v145, v144
  s_nop 1
  v_permlane32_swap_b32 v144, v145
  v_add_f32 v144, v144, v145
  v_mov_b32 v145, v144
  s_nop 1
  v_permlane16_swap_b32 v144, v145
  v_add_f32 v144, v144, v145
  v_mul_f32 v138, 0x3c000000, v144
  ds_write_b32 v135, v138
  v_pk_add_f32 v[160:161], v[160:161], v[138:139] op_sel_hi:[1,0] neg_lo:[0,1] neg_hi:[0,1]
  v_pk_add_f32 v[162:163], v[162:163], v[138:139] op_sel_hi:[1,0] neg_lo:[0,1] neg_hi:[0,1]
  v_pk_add_f32 v[164:165], v[164:165], v[138:139] op_sel_hi:[1,0] neg_lo:[0,1] neg_hi:[0,1]
  v_pk_add_f32 v[166:167], v[166:167], v[138:139] op_sel_hi:[1,0] neg_lo:[0,1] neg_hi:[0,1]
  v_pk_add_f32 v[168:169], v[168:169], v[138:139] op_sel_hi:[1,0] neg_lo:[0,1] neg_hi:[0,1]
  v_pk_add_f32 v[170:171], v[170:171], v[138:139] op_sel_hi:[1,0] neg_lo:[0,1] neg_hi:[0,1]
  v_pk_add_f32 v[172:173], v[172:173], v[138:139] op_sel_hi:[1,0] neg_lo:[0,1] neg_hi:[0,1]
  v_pk_add_f32 v[174:175], v[174:175], v[138:139] op_sel_hi:[1,0] neg_lo:[0,1] neg_hi:[0,1]
  v_pk_add_f32 v[176:177], v[176:177], v[138:139] op_sel_hi:[1,0] neg_lo:[0,1] neg_hi:[0,1]
  v_pk_add_f32 v[178:179], v[178:179], v[138:139] op_sel_hi:[1,0] neg_lo:[0,1] neg_hi:[0,1]
  v_pk_add_f32 v[180:181], v[180:181], v[138:139] op_sel_hi:[1,0] neg_lo:[0,1] neg_hi:[0,1]
  v_pk_add_f32 v[182:183], v[182:183], v[138:139] op_sel_hi:[1,0] neg_lo:[0,1] neg_hi:[0,1]
  v_pk_add_f32 v[184:185], v[184:185], v[138:139] op_sel_hi:[1,0] neg_lo:[0,1] neg_hi:[0,1]
  v_pk_add_f32 v[186:187], v[186:187], v[138:139] op_sel_hi:[1,0] neg_lo:[0,1] neg_hi:[0,1]
  v_pk_add_f32 v[188:189], v[188:189], v[138:139] op_sel_hi:[1,0] neg_lo:[0,1] neg_hi:[0,1]
  v_pk_add_f32 v[190:191], v[190:191], v[138:139] op_sel_hi:[1,0] neg_lo:[0,1] neg_hi:[0,1]
  v_pk_mul_f32 v[144:145], v[160:161], v[160:161]
  v_pk_fma_f32 v[144:145], v[162:163], v[162:163], v[144:145]
  v_pk_fma_f32 v[144:145], v[164:165], v[164:165], v[144:145]
  v_pk_fma_f32 v[144:145], v[166:167], v[166:167], v[144:145]
  v_pk_fma_f32 v[144:145], v[168:169], v[168:169], v[144:145]
  v_pk_fma_f32 v[144:145], v[170:171], v[170:171], v[144:145]
  v_pk_fma_f32 v[144:145], v[172:173], v[172:173], v[144:145]
  v_pk_fma_f32 v[144:145], v[174:175], v[174:175], v[144:145]
  v_pk_fma_f32 v[144:145], v[176:177], v[176:177], v[144:145]
  v_pk_fma_f32 v[144:145], v[178:179], v[178:179], v[144:145]
  v_pk_fma_f32 v[144:145], v[180:181], v[180:181], v[144:145]
  v_pk_fma_f32 v[144:145], v[182:183], v[182:183], v[144:145]
  v_pk_fma_f32 v[144:145], v[184:185], v[184:185], v[144:145]
  v_pk_fma_f32 v[144:145], v[186:187], v[186:187], v[144:145]
  v_pk_fma_f32 v[144:145], v[188:189], v[188:189], v[144:145]
  v_pk_fma_f32 v[144:145], v[190:191], v[190:191], v[144:145]
  v_add_f32 v144, v144, v145
  v_mov_b32 v145, v144
  s_nop 1
  v_permlane32_swap_b32 v144, v145
  v_add_f32 v144, v144, v145
  v_mov_b32 v145, v144
  s_nop 1
  v_permlane16_swap_b32 v144, v145
  v_add_f32 v144, v144, v145
  ds_write_b32 v135, v144 offset:256
  s_waitcnt lgkmcnt(0)
  s_barrier
  ds_read_b128 v[148:151], v136
  ds_read_b128 v[152:155], v136 offset:256
  s_waitcnt lgkmcnt(1)
  v_pk_add_f32 v[144:145], v[148:149], v[150:151]
  v_add_f32 v144, v144, v145
  v_mul_f32 v144, 0x3e800000, v144
  v_pk_add_f32 v[148:149], v[148:149], v[144:145] op_sel_hi:[1,0] neg_lo:[0,1] neg_hi:[0,1]
  v_pk_add_f32 v[150:151], v[150:151], v[144:145] op_sel_hi:[1,0] neg_lo:[0,1] neg_hi:[0,1]
  v_pk_mul_f32 v[148:149], v[148:149], v[148:149]
  v_pk_fma_f32 v[148:149], v[150:151], v[150:151], v[148:149]
  v_cvt_pk_bf16_f32 v146, v144, v144
  v_and_b32 v146, 0xffff0000, v146
  v_add_f32 v148, v148, v149
  v_sub_f32 v146, v138, v146
  s_waitcnt lgkmcnt(0)
  v_pk_add_f32 v[152:153], v[152:153], v[154:155]
  v_mul_f32 v148, 0x3e800000, v148
  v_add_f32 v152, v152, v153
  v_fmac_f32 v148, 0x3b000000, v152
  v_cvt_pk_bf16_f32 v148, v148, v148
  v_and_b32 v148, 0xffff0000, v148
  v_add_f32 v148, 0x3727c5ac, v148
  v_cvt_pk_bf16_f32 v148, v148, v148
  v_and_b32 v148, 0xffff0000, v148
  v_sqrt_f32 v148, v148
  s_nop 0
  v_cvt_pk_bf16_f32 v148, v148, v148
  v_and_b32 v148, 0xffff0000, v148
  v_rcp_f32 v138, v148
  s_nop 0
  v_mul_f32 v139, v146, v138
  v_pk_fma_f32 v[160:161], v[160:161], v[138:139], v[138:139] op_sel:[0,0,1] op_sel_hi:[1,0,1]
  v_pk_fma_f32 v[162:163], v[162:163], v[138:139], v[138:139] op_sel:[0,0,1] op_sel_hi:[1,0,1]
  v_pk_fma_f32 v[164:165], v[164:165], v[138:139], v[138:139] op_sel:[0,0,1] op_sel_hi:[1,0,1]
  v_pk_fma_f32 v[166:167], v[166:167], v[138:139], v[138:139] op_sel:[0,0,1] op_sel_hi:[1,0,1]
  v_pk_fma_f32 v[168:169], v[168:169], v[138:139], v[138:139] op_sel:[0,0,1] op_sel_hi:[1,0,1]
  v_pk_fma_f32 v[170:171], v[170:171], v[138:139], v[138:139] op_sel:[0,0,1] op_sel_hi:[1,0,1]
  v_pk_fma_f32 v[172:173], v[172:173], v[138:139], v[138:139] op_sel:[0,0,1] op_sel_hi:[1,0,1]
  v_pk_fma_f32 v[174:175], v[174:175], v[138:139], v[138:139] op_sel:[0,0,1] op_sel_hi:[1,0,1]
  v_pk_fma_f32 v[176:177], v[176:177], v[138:139], v[138:139] op_sel:[0,0,1] op_sel_hi:[1,0,1]
  v_pk_fma_f32 v[178:179], v[178:179], v[138:139], v[138:139] op_sel:[0,0,1] op_sel_hi:[1,0,1]
  v_pk_fma_f32 v[180:181], v[180:181], v[138:139], v[138:139] op_sel:[0,0,1] op_sel_hi:[1,0,1]
  v_pk_fma_f32 v[182:183], v[182:183], v[138:139], v[138:139] op_sel:[0,0,1] op_sel_hi:[1,0,1]
  v_pk_fma_f32 v[184:185], v[184:185], v[138:139], v[138:139] op_sel:[0,0,1] op_sel_hi:[1,0,1]
  v_pk_fma_f32 v[186:187], v[186:187], v[138:139], v[138:139] op_sel:[0,0,1] op_sel_hi:[1,0,1]
  v_pk_fma_f32 v[188:189], v[188:189], v[138:139], v[138:139] op_sel:[0,0,1] op_sel_hi:[1,0,1]
  v_pk_fma_f32 v[190:191], v[190:191], v[138:139], v[138:139] op_sel:[0,0,1] op_sel_hi:[1,0,1]
  v_cvt_pk_f16_f32 v144, v160, v161
  v_cvt_pk_f16_f32 v145, v162, v163
  v_cvt_pk_f16_f32 v146, v164, v165
  v_cvt_pk_f16_f32 v147, v166, v167
  v_cvt_pk_f16_f32 v148, v168, v169
  v_cvt_pk_f16_f32 v149, v170, v171
  v_cvt_pk_f16_f32 v150, v172, v173
  v_cvt_pk_f16_f32 v151, v174, v175
  v_cvt_pk_f16_f32 v152, v176, v177
  v_cvt_pk_f16_f32 v153, v178, v179
  v_cvt_pk_f16_f32 v154, v180, v181
  v_cvt_pk_f16_f32 v155, v182, v183
  v_cvt_pk_f16_f32 v156, v184, v185
  v_cvt_pk_f16_f32 v157, v186, v187
  v_cvt_pk_f16_f32 v158, v188, v189
  v_cvt_pk_f16_f32 v159, v190, v191
  buffer_store_dwordx4 v[144:147], v134, s[20:23], s30 offen offset:0 sc1
  buffer_store_dwordx4 v[148:151], v134, s[20:23], s30 offen offset:1024 sc1
  buffer_store_dwordx4 v[152:155], v134, s[20:23], s30 offen offset:2048 sc1
  buffer_store_dwordx4 v[156:159], v134, s[20:23], s30 offen offset:3072 sc1
L_rd_done:
L_attn_st101:
  s_cbranch_vccnz L_attn_walkdone0
  s_cmp_eq_u32 s24, 3
  s_cbranch_scc1 L_e3
  s_waitcnt vmcnt(0)
  s_branch L_ej
L_e3:
  s_mov_b32 s16, s34
  s_mov_b32 s17, s35
  s_mov_b32 s18, 256
  s_mov_b32 s19, 0x20000
  s_mov_b32 s31, 0
  v_mov_b32 v28, 0
L_e3_tag:
  buffer_load_dword v29, v28, s[16:19], 0 offen sc1
  s_add_u32 s31, s31, 1
  s_waitcnt vmcnt(0)
  v_readfirstlane_b32 s68, v29
  s_cmp_gt_u32 s31, 2097152
  s_cbranch_scc1 L_e3_got
  s_cmp_eq_u32 s68, 0
  s_cbranch_scc1 L_e3_tag
L_e3_got:
  v_mov_b32 v28, 155648
  ds_write_b32 v28, v29
  v_mov_b32 v20, s68
  v_mov_b32 v21, s25
  s_mov_b32 s31, 196608
  s_mov_b64 exec, 1
  buffer_store_dwordx2 v[20:21], v22, s[64:67], s31 offen sc1
  s_mov_b64 exec, -1
  s_waitcnt lgkmcnt(0)
L_ej:
  s_barrier
  s_cmp_lg_u32 s24, 3
  s_cbranch_scc1 L_sync0_a
  v_mov_b32 v28, s68
  s_mov_b64 exec, 1
  s_mov_b32 exec_lo, s69
  s_mov_b32 s30, 131072
  buffer_store_dword v28, v14, s[64:67], s30 offen sc1
  s_mov_b64 exec, -1
L_sync0_a:
  s_lshl_b32 s42, s44, 14
  s_add_u32 s42, s42, 1048576
  s_add_u32 s16, s46, s42
  s_addc_u32 s17, s47, 0
  s_mov_b32 s18, 65536
  s_mov_b32 s19, 0x20000
  s_add_u32 s20, s46, 32768
  s_addc_u32 s21, s47, 0
  s_mov_b32 s22, 49152
  s_mov_b32 s23, 0x20000
  s_cmp_ge_u32 s24, 2
  s_cselect_b32 s42, 1.0, 0
  s_bfe_u32 s1, s2, 0x10005
  s_lshl_b32 s1, s1, 15
  s_lshl_b32 s45, s24, 10
  v_add_u32 v31, s45, v19
  s_lshl_b32 s3, s3, 8
  v_subrev_u32 v30, s3, v31
  v_and_b32 v30, 0x7ff, v30
  v_and_b32 v31, 0x800, v31
  v_add_u32 v31, 131072, v31
  v_add_u32 v31, v30, v31
  v_mov_b32 v30, 155648
  ds_read_b32 v30, v30
  v_accvgpr_write_b32 a0, 0
  v_accvgpr_write_b32 a1, 0
  v_accvgpr_write_b32 a2, 0
  v_accvgpr_write_b32 a3, 0
  v_accvgpr_write_b32 a4, 0
  v_accvgpr_write_b32 a5, 0
  v_accvgpr_write_b32 a6, 0
  v_accvgpr_write_b32 a7, 0
  v_accvgpr_write_b32 a8, 0
  v_accvgpr_write_b32 a9, 0
  v_accvgpr_write_b32 a10, 0
  v_accvgpr_write_b32 a11, 0
  v_accvgpr_write_b32 a12, 0
  v_accvgpr_write_b32 a13, 0
  v_accvgpr_write_b32 a14, 0
  v_accvgpr_write_b32 a15, 0
  v_accvgpr_write_b32 a16, 0
  v_accvgpr_write_b32 a17, 0
  v_accvgpr_write_b32 a18, 0
  v_accvgpr_write_b32 a19, 0
  v_accvgpr_write_b32 a20, 0
  v_accvgpr_write_b32 a21, 0
L_attn_st1:
  s_cbranch_vccnz L_attn_walkdone0
  v_accvgpr_write_b32 a22, 0
  v_accvgpr_write_b32 a23, 0
  v_accvgpr_write_b32 a24, 0
  v_accvgpr_write_b32 a25, 0
  v_accvgpr_write_b32 a26, 0
  v_accvgpr_write_b32 a27, 0
  v_accvgpr_write_b32 a28, 0
  v_accvgpr_write_b32 a29, 0
  v_accvgpr_write_b32 a30, 0
  v_accvgpr_write_b32 a31, 0
  v_accvgpr_write_b32 a32, 0
  v_accvgpr_write_b32 a33, 0
  v_accvgpr_write_b32 a34, 0
  v_accvgpr_write_b32 a35, 0
  v_accvgpr_write_b32 a36, 0
  v_accvgpr_write_b32 a37, 0
  v_accvgpr_write_b32 a38, 0
  v_accvgpr_write_b32 a39, 0
  v_accvgpr_write_b32 a40, 0
  v_accvgpr_write_b32 a41, 0
  v_accvgpr_write_b32 a42, 0
  v_accvgpr_write_b32 a43, 0
  v_accvgpr_write_b32 a44, 0
  v_accvgpr_write_b32 a45, 0
  v_accvgpr_write_b32 a46, 0
  v_accvgpr_write_b32 a47, 0
  v_accvgpr_write_b32 a48, 0
  v_accvgpr_write_b32 a49, 0
  v_accvgpr_write_b32 a50, 0
  v_accvgpr_write_b32 a51, 0
  v_accvgpr_write_b32 a52, 0
  v_accvgpr_write_b32 a53, 0
  v_accvgpr_write_b32 a54, 0
  v_accvgpr_write_b32 a55, 0
  v_accvgpr_write_b32 a56, 0
  v_accvgpr_write_b32 a57, 0
  v_accvgpr_write_b32 a58, 0
  v_accvgpr_write_b32 a59, 0
  v_accvgpr_write_b32 a60, 0
  v_accvgpr_write_b32 a61, 0
  v_accvgpr_write_b32 a62, 0
  v_accvgpr_write_b32 a63, 0
  v_accvgpr_write_b32 a64, 0
  v_accvgpr_write_b32 a65, 0
  v_accvgpr_write_b32 a66, 0
  v_accvgpr_write_b32 a67, 0
  v_accvgpr_write_b32 a68, 0
  v_accvgpr_write_b32 a69, 0
  v_accvgpr_write_b32 a70, 0
  v_accvgpr_write_b32 a71, 0
  v_accvgpr_write_b32 a72, 0
  v_accvgpr_write_b32 a73, 0
  v_accvgpr_write_b32 a74, 0
  v_accvgpr_write_b32 a75, 0
  v_accvgpr_write_b32 a76, 0
  v_accvgpr_write_b32 a77, 0
  v_accvgpr_write_b32 a78, 0
  v_accvgpr_write_b32 a79, 0
  v_accvgpr_write_b32 a80, 0
  v_accvgpr_write_b32 a81, 0
  v_accvgpr_write_b32 a82, 0
  v_accvgpr_write_b32 a83, 0
  v_accvgpr_write_b32 a84, 0
  v_accvgpr_write_b32 a85, 0
  v_accvgpr_write_b32 a86, 0
  v_accvgpr_write_b32 a87, 0
  v_accvgpr_write_b32 a88, 0
  v_accvgpr_write_b32 a89, 0
  v_accvgpr_write_b32 a90, 0
  v_accvgpr_write_b32 a91, 0
  v_accvgpr_write_b32 a92, 0
  v_accvgpr_write_b32 a93, 0
  v_accvgpr_write_b32 a94, 0
  v_accvgpr_write_b32 a95, 0
  v_accvgpr_write_b32 a96, 0
  v_accvgpr_write_b32 a97, 0
  v_accvgpr_write_b32 a98, 0
  v_accvgpr_write_b32 a99, 0
  v_accvgpr_write_b32 a100, 0
  v_accvgpr_write_b32 a101, 0
  v_accvgpr_write_b32 a102, 0
  v_accvgpr_write_b32 a103, 0
  v_accvgpr_write_b32 a104, 0
  v_accvgpr_write_b32 a105, 0
  v_accvgpr_write_b32 a106, 0
  v_accvgpr_write_b32 a107, 0
  v_accvgpr_write_b32 a108, 0
  v_accvgpr_write_b32 a109, 0
  v_accvgpr_write_b32 a110, 0
  v_accvgpr_write_b32 a111, 0
  v_accvgpr_write_b32 a112, 0
  v_accvgpr_write_b32 a113, 0
  v_accvgpr_write_b32 a114, 0
  v_accvgpr_write_b32 a115, 0
  v_accvgpr_write_b32 a116, 0
  v_accvgpr_write_b32 a117, 0
  v_accvgpr_write_b32 a118, 0
  v_accvgpr_write_b32 a119, 0
  v_accvgpr_write_b32 a120, 0
  v_accvgpr_write_b32 a121, 0
  v_accvgpr_write_b32 a122, 0
  v_accvgpr_write_b32 a123, 0
  v_accvgpr_write_b32 a124, 0
  v_accvgpr_write_b32 a125, 0
  v_accvgpr_write_b32 a126, 0
  v_accvgpr_write_b32 a127, 0
  s_waitcnt lgkmcnt(0)
  v_readfirstlane_b32 s68, v30
  s_mov_b64 vcc, -1
  s_cmp_eq_u32 s24, 0
  s_cbranch_scc1 L_attn_st2
  s_cmp_eq_u32 s24, 1
  s_cbranch_scc1 L_attn_st3
  s_cmp_eq_u32 s24, 2
  s_cbranch_scc1 L_attn_st4
L_attn_walkdone2:
  s_mov_b64 vcc, 0
  s_cmp_lg_u32 s24, 3
  s_cbranch_scc1 L_sync0_b
  s_mov_b32 s31, 0
  s_mov_b32 s30, 131072
L_sync0_poll:
  buffer_load_dword v29, v13, s[64:67], s30 offen sc1
  s_add_u32 s31, s31, 1
  s_waitcnt vmcnt(0)
  v_cmp_eq_u32 s[32:33], s68, v29
  s_cmp_gt_u32 s31, 2097152
  s_cbranch_scc1 L_sync0_x
  s_cmp_eq_u64 s[32:33], -1
  s_cbranch_scc0 L_sync0_poll
L_sync0_x:
L_sync0_b:
  s_barrier
  buffer_load_dwordx4 v[96:99], v19, s[20:23], s45 offen sc1
  s_add_u32 s45, s45, 12288
  buffer_load_dwordx4 v[100:103], v19, s[20:23], s45 offen sc1
  s_add_u32 s45, s45, 12288
  buffer_load_dwordx4 v[104:107], v19, s[20:23], s45 offen sc1
  s_add_u32 s45, s45, 12288
  buffer_load_dwordx4 v[108:111], v19, s[20:23], s45 offen sc1
  s_xor_b32 s34, s1, 0
  buffer_load_dwordx4 v[48:51], v19, s[16:19], s34 offen sc1
  s_xor_b32 s35, s1, 16384
  buffer_load_dwordx4 v[52:55], v19, s[16:19], s35 offen sc1
  s_xor_b32 s36, s1, 32768
  buffer_load_dwordx4 v[56:59], v19, s[16:19], s36 offen sc1
  s_xor_b32 s37, s1, 49152
  buffer_load_dwordx4 v[60:63], v19, s[16:19], s37 offen sc1
  s_xor_b32 s34, s1, 1024
  buffer_load_dwordx4 v[64:67], v19, s[16:19], s34 offen sc1
  s_xor_b32 s35, s1, 17408
  buffer_load_dwordx4 v[68:71], v19, s[16:19], s35 offen sc1
  v_mov_b32 v28, s42
  v_mov_b32 v29, 0x3e0293ee
  s_lshl_b32 s42, s44, 15
  s_and_b32 s45, s40, 7
  s_lshl_b32 s45, s45, 12
  s_add_u32 s42, s42, s45
  s_lshr_b32 s45, s40, 3
  s_lshl_b32 s45, s45, 22
  s_add_u32 s42, s42, s45
  s_add_u32 s42, s42, 4194304
  s_add_u32 s20, s46, s42
  s_addc_u32 s21, s47, 0
  s_mov_b32 s22, 102400
  s_mov_b32 s23, 0x20000
  ds_read_b64_tr_b16 a[192:193], v8 offset:0
  ds_read_b64_tr_b16 a[194:195], v8 offset:1024
  ds_read_b64_tr_b16 a[196:197], v8 offset:8
  ds_read_b64_tr_b16 a[198:199], v8 offset:1032
  ds_read_b64_tr_b16 a[200:201], v9 offset:0
  ds_read_b64_tr_b16 a[202:203], v9 offset:1024
  ds_read_b64_tr_b16 a[204:205], v9 offset:8
  ds_read_b64_tr_b16 a[206:207], v9 offset:1032
  ds_read_b64_tr_b16 a[208:209], v10 offset:0
  ds_read_b64_tr_b16 a[210:211], v10 offset:1024
  ds_read_b64_tr_b16 a[212:213], v10 offset:8
  ds_read_b64_tr_b16 a[214:215], v10 offset:1032
  ds_read_b64_tr_b16 a[216:217], v11 offset:0
  ds_read_b64_tr_b16 a[218:219], v11 offset:1024
  ds_read_b64_tr_b16 a[220:221], v11 offset:8
  ds_read_b64_tr_b16 a[222:223], v11 offset:1032
  s_waitcnt vmcnt(6)
  v_pk_add_f32 v[96:97], v[96:97], v[100:101]
  v_pk_add_f32 v[98:99], v[98:99], v[102:103]
  v_pk_add_f32 v[96:97], v[96:97], v[104:105]
  v_pk_add_f32 v[98:99], v[98:99], v[106:107]
  v_pk_add_f32 v[96:97], v[96:97], v[108:109]
  v_pk_add_f32 v[98:99], v[98:99], v[110:111]
  v_cvt_pk_bf16_f32 v100, v96, v97
  v_cvt_pk_bf16_f32 v101, v98, v99
  v_lshlrev_b32 v96, 16, v100
  v_and_b32 v97, 0xffff0000, v100
  v_lshlrev_b32 v98, 16, v101
  v_and_b32 v99, 0xffff0000, v101
  v_pk_add_f32 v[96:97], v[96:97], v[28:29] op_sel_hi:[1,0]
  v_pk_add_f32 v[98:99], v[98:99], v[28:29] op_sel_hi:[1,0]
  v_cvt_pk_bf16_f32 v100, v96, v97
  v_cvt_pk_bf16_f32 v101, v98, v99
  v_lshlrev_b32 v96, 16, v100
  v_and_b32 v97, 0xffff0000, v100
  v_lshlrev_b32 v98, 16, v101
  v_and_b32 v99, 0xffff0000, v101
  v_pk_mul_f32 v[24:25], v[96:97], v[28:29] op_sel:[0,1] op_sel_hi:[1,1]
  v_pk_mul_f32 v[26:27], v[98:99], v[28:29] op_sel:[0,1] op_sel_hi:[1,1]
  ds_write_b128 v31, v[24:27]
  s_waitcnt lgkmcnt(0)
  s_barrier
  ds_read_b128 v[96:99], v12 offset:2048
  ds_read_b128 v[100:103], v12 offset:2064
  ds_read_b128 v[104:107], v12 offset:0
  ds_read_b128 v[108:111], v12 offset:16
  ds_read_b128 v[112:115], v12 offset:2080
  ds_read_b128 v[116:119], v12 offset:2096
  ds_read_b128 v[120:123], v12 offset:32
  ds_read_b128 v[124:127], v12 offset:48
  s_xor_b32 s36, s1, 33792
  buffer_load_dwordx4 v[72:75], v19, s[16:19], s36 offen sc1
  s_xor_b32 s37, s1, 50176
  buffer_load_dwordx4 v[76:79], v19, s[16:19], s37 offen sc1
  s_waitcnt vmcnt(4) lgkmcnt(4)
  v_fma_mix_f32 v24, v48, v96, v104 op_sel:[0,0,0] op_sel_hi:[1,0,0]
  v_fma_mix_f32 v25, v48, v97, v105 op_sel:[1,0,0] op_sel_hi:[1,0,0]
  v_fma_mix_f32 v26, v49, v98, v106 op_sel:[0,0,0] op_sel_hi:[1,0,0]
  v_fma_mix_f32 v27, v49, v99, v107 op_sel:[1,0,0] op_sel_hi:[1,0,0]
  v_cvt_pk_bf16_f32 v48, v24, v25
  v_cvt_pk_bf16_f32 v49, v26, v27
  v_fma_mix_f32 v28, v50, v100, v108 op_sel:[0,0,0] op_sel_hi:[1,0,0]
  v_fma_mix_f32 v29, v50, v101, v109 op_sel:[1,0,0] op_sel_hi:[1,0,0]
  s_xor_b32 s34, s1, 2048
  buffer_load_dwordx4 v[80:83], v19, s[16:19], s34 offen sc1
  v_fma_mix_f32 v30, v51, v102, v110 op_sel:[0,0,0] op_sel_hi:[1,0,0]
  v_fma_mix_f32 v31, v51, v103, v111 op_sel:[1,0,0] op_sel_hi:[1,0,0]
  v_cvt_pk_bf16_f32 v50, v28, v29
  v_cvt_pk_bf16_f32 v51, v30, v31
  v_fma_mix_f32 v24, v52, v96, v104 op_sel:[0,0,0] op_sel_hi:[1,0,0]
  v_fma_mix_f32 v25, v52, v97, v105 op_sel:[1,0,0] op_sel_hi:[1,0,0]
  v_fma_mix_f32 v26, v53, v98, v106 op_sel:[0,0,0] op_sel_hi:[1,0,0]
  v_fma_mix_f32 v27, v53, v99, v107 op_sel:[1,0,0] op_sel_hi:[1,0,0]
  s_xor_b32 s35, s1, 18432
  buffer_load_dwordx4 v[84:87], v19, s[16:19], s35 offen sc1
  v_cvt_pk_bf16_f32 v52, v24, v25
  v_cvt_pk_bf16_f32 v53, v26, v27
  v_fma_mix_f32 v28, v54, v100, v108 op_sel:[0,0,0] op_sel_hi:[1,0,0]
  v_fma_mix_f32 v29, v54, v101, v109 op_sel:[1,0,0] op_sel_hi:[1,0,0]
  v_fma_mix_f32 v30, v55, v102, v110 op_sel:[0,0,0] op_sel_hi:[1,0,0]
  v_fma_mix_f32 v31, v55, v103, v111 op_sel:[1,0,0] op_sel_hi:[1,0,0]
  v_cvt_pk_bf16_f32 v54, v28, v29
  v_cvt_pk_bf16_f32 v55, v30, v31
  s_xor_b32 s36, s1, 34816
  buffer_load_dwordx4 v[88:91], v19, s[16:19], s36 offen sc1
  v_fma_mix_f32 v24, v56, v96, v104 op_sel:[0,0,0] op_sel_hi:[1,0,0]
  v_fma_mix_f32 v25, v56, v97, v105 op_sel:[1,0,0] op_sel_hi:[1,0,0]
  v_fma_mix_f32 v26, v57, v98, v106 op_sel:[0,0,0] op_sel_hi:[1,0,0]
  v_fma_mix_f32 v27, v57, v99, v107 op_sel:[1,0,0] op_sel_hi:[1,0,0]
  v_cvt_pk_bf16_f32 v56, v24, v25
  v_cvt_pk_bf16_f32 v57, v26, v27
  v_fma_mix_f32 v28, v58, v100, v108 op_sel:[0,0,0] op_sel_hi:[1,0,0]
  v_fma_mix_f32 v29, v58, v101, v109 op_sel:[1,0,0] op_sel_hi:[1,0,0]
  s_xor_b32 s37, s1, 51200
  buffer_load_dwordx4 v[92:95], v19, s[16:19], s37 offen sc1
  v_fma_mix_f32 v30, v59, v102, v110 op_sel:[0,0,0] op_sel_hi:[1,0,0]
  v_fma_mix_f32 v31, v59, v103, v111 op_sel:[1,0,0] op_sel_hi:[1,0,0]
  v_cvt_pk_bf16_f32 v58, v28, v29
  v_cvt_pk_bf16_f32 v59, v30, v31
  v_fma_mix_f32 v24, v60, v96, v104 op_sel:[0,0,0] op_sel_hi:[1,0,0]
  v_fma_mix_f32 v25, v60, v97, v105 op_sel:[1,0,0] op_sel_hi:[1,0,0]
  v_fma_mix_f32 v26, v61, v98, v106 op_sel:[0,0,0] op_sel_hi:[1,0,0]
  v_fma_mix_f32 v27, v61, v99, v107 op_sel:[1,0,0] op_sel_hi:[1,0,0]
  v_cvt_pk_bf16_f32 v60, v24, v25
  v_cvt_pk_bf16_f32 v61, v26, v27
  v_fma_mix_f32 v28, v62, v100, v108 op_sel:[0,0,0] op_sel_hi:[1,0,0]
  v_fma_mix_f32 v29, v62, v101, v109 op_sel:[1,0,0] op_sel_hi:[1,0,0]
  v_fma_mix_f32 v30, v63, v102, v110 op_sel:[0,0,0] op_sel_hi:[1,0,0]
  v_fma_mix_f32 v31, v63, v103, v111 op_sel:[1,0,0] op_sel_hi:[1,0,0]
  v_cvt_pk_bf16_f32 v62, v28, v29
  v_cvt_pk_bf16_f32 v63, v30, v31
  s_waitcnt vmcnt(7)
  s_waitcnt lgkmcnt(0)
  v_mfma_f32_16x16x32_bf16 v[128:131], a[192:195], v[48:51], 0
  ds_read_b64_tr_b16 a[224:225], v8 offset:2048
  v_fma_mix_f32 v24, v64, v112, v120 op_sel:[0,0,0] op_sel_hi:[1,0,0]
  v_mfma_f32_16x16x32_bf16 v[132:135], a[192:195], v[52:55], 0
  s_xor_b32 s34, s1, 3072
  ds_read_b64_tr_b16 a[226:227], v8 offset:3072
  v_fma_mix_f32 v25, v64, v113, v121 op_sel:[1,0,0] op_sel_hi:[1,0,0]
  v_fma_mix_f32 v26, v65, v114, v122 op_sel:[0,0,0] op_sel_hi:[1,0,0]
  v_mfma_f32_16x16x32_bf16 v[136:139], a[192:195], v[56:59], 0
  buffer_load_dwordx4 v[32:35], v19, s[16:19], s34 offen sc1
  v_mfma_f32_16x16x32_bf16 v[140:143], a[192:195], v[60:63], 0
  ds_read_b64_tr_b16 a[228:229], v8 offset:2056
  v_fma_mix_f32 v27, v65, v115, v123 op_sel:[1,0,0] op_sel_hi:[1,0,0]
  v_cvt_pk_bf16_f32 v64, v24, v25
  v_mfma_f32_16x16x32_bf16 v[156:159], a[196:199], v[60:63], 0
  ds_read_b64_tr_b16 a[230:231], v8 offset:3080
  v_cvt_pk_bf16_f32 v65, v26, v27
  v_mfma_f32_16x16x32_bf16 v[152:155], a[196:199], v[56:59], 0
  s_xor_b32 s35, s1, 19456
  ds_read_b64_tr_b16 a[232:233], v9 offset:2048
  v_fma_mix_f32 v28, v66, v116, v124 op_sel:[0,0,0] op_sel_hi:[1,0,0]
  v_fma_mix_f32 v29, v66, v117, v125 op_sel:[1,0,0] op_sel_hi:[1,0,0]
  v_mfma_f32_16x16x32_bf16 v[148:151], a[196:199], v[52:55], 0
  buffer_load_dwordx4 v[36:39], v19, s[16:19], s35 offen sc1
  v_mfma_f32_16x16x32_bf16 v[144:147], a[196:199], v[48:51], 0
  v_fma_mix_f32 v30, v67, v118, v126 op_sel:[0,0,0] op_sel_hi:[1,0,0]
  v_fma_mix_f32 v31, v67, v119, v127 op_sel:[1,0,0] op_sel_hi:[1,0,0]
  v_cvt_pk_bf16_f32 v66, v28, v29
  v_mfma_f32_16x16x32_bf16 v[160:163], a[200:203], v[48:51], 0
  ds_read_b128 v[96:99], v12 offset:2304
  v_cvt_pk_bf16_f32 v67, v30, v31
  v_mfma_f32_16x16x32_bf16 v[164:167], a[200:203], v[52:55], 0
  s_waitcnt vmcnt(8)
  ds_read_b64_tr_b16 a[234:235], v9 offset:3072
  v_fma_mix_f32 v24, v68, v112, v120 op_sel:[0,0,0] op_sel_hi:[1,0,0]
  v_fma_mix_f32 v25, v68, v113, v121 op_sel:[1,0,0] op_sel_hi:[1,0,0]
  v_mfma_f32_16x16x32_bf16 v[168:171], a[200:203], v[56:59], 0
  s_xor_b32 s36, s1, 35840
  ds_read_b64_tr_b16 a[236:237], v9 offset:2056
  v_fma_mix_f32 v26, v69, v114, v122 op_sel:[0,0,0] op_sel_hi:[1,0,0]
  v_mfma_f32_16x16x32_bf16 v[172:175], a[200:203], v[60:63], 0
  buffer_load_dwordx4 v[40:43], v19, s[16:19], s36 offen sc1
  v_fma_mix_f32 v27, v69, v115, v123 op_sel:[1,0,0] op_sel_hi:[1,0,0]
  v_mfma_f32_16x16x32_bf16 v[188:191], a[204:207], v[60:63], 0
  ds_read_b128 v[100:103], v12 offset:2320
  v_cvt_pk_bf16_f32 v68, v24, v25
  v_mfma_f32_16x16x32_bf16 v[184:187], a[204:207], v[56:59], 0
  ds_read_b64_tr_b16 a[238:239], v9 offset:3080
  v_cvt_pk_bf16_f32 v69, v26, v27
  v_fma_mix_f32 v28, v70, v116, v124 op_sel:[0,0,0] op_sel_hi:[1,0,0]
  v_mfma_f32_16x16x32_bf16 v[180:183], a[204:207], v[52:55], 0
  v_fma_mix_f32 v29, v70, v117, v125 op_sel:[1,0,0] op_sel_hi:[1,0,0]
  v_fma_mix_f32 v30, v71, v118, v126 op_sel:[0,0,0] op_sel_hi:[1,0,0]
  v_mfma_f32_16x16x32_bf16 v[176:179], a[204:207], v[48:51], 0
  ds_read_b64_tr_b16 a[240:241], v10 offset:2048
  v_fma_mix_f32 v31, v71, v119, v127 op_sel:[1,0,0] op_sel_hi:[1,0,0]
  v_cvt_pk_bf16_f32 v70, v28, v29
  v_mfma_f32_16x16x32_bf16 v[192:195], a[208:211], v[48:51], 0
  s_xor_b32 s37, s1, 52224
  ds_read_b128 v[104:107], v12 offset:256
  v_cvt_pk_bf16_f32 v71, v30, v31
  v_mfma_f32_16x16x32_bf16 v[196:199], a[208:211], v[52:55], 0
  s_waitcnt vmcnt(8)
  buffer_load_dwordx4 v[44:47], v19, s[16:19], s37 offen sc1
  v_fma_mix_f32 v24, v72, v112, v120 op_sel:[0,0,0] op_sel_hi:[1,0,0]
  v_mfma_f32_16x16x32_bf16 v[200:203], a[208:211], v[56:59], 0
  ds_read_b64_tr_b16 a[242:243], v10 offset:3072
  v_fma_mix_f32 v25, v72, v113, v121 op_sel:[1,0,0] op_sel_hi:[1,0,0]
  v_mfma_f32_16x16x32_bf16 v[204:207], a[208:211], v[60:63], 0
  s_mov_b32 s30, 1572864
  ds_read_b64_tr_b16 a[244:245], v10 offset:2056
  v_fma_mix_f32 v26, v73, v114, v122 op_sel:[0,0,0] op_sel_hi:[1,0,0]
  v_fma_mix_f32 v27, v73, v115, v123 op_sel:[1,0,0] op_sel_hi:[1,0,0]
  v_mfma_f32_16x16x32_bf16 v[220:223], a[212:215], v[60:63], 0
  s_add_u32 m0, s26, 49152
  ds_read_b128 v[108:111], v12 offset:272
  v_cvt_pk_bf16_f32 v72, v24, v25
  v_mfma_f32_16x16x32_bf16 v[216:219], a[212:215], v[56:59], 0
  buffer_load_dwordx4 v18, s[12:15], s30 offen offset:0 lds
  v_cvt_pk_bf16_f32 v73, v26, v27
  v_mfma_f32_16x16x32_bf16 v[212:215], a[212:215], v[52:55], 0
  v_fma_mix_f32 v28, v74, v116, v124 op_sel:[0,0,0] op_sel_hi:[1,0,0]
  v_fma_mix_f32 v29, v74, v117, v125 op_sel:[1,0,0] op_sel_hi:[1,0,0]
  v_mfma_f32_16x16x32_bf16 v[208:211], a[212:215], v[48:51], 0
  ds_read_b64_tr_b16 a[246:247], v10 offset:3080
  v_fma_mix_f32 v30, v75, v118, v126 op_sel:[0,0,0] op_sel_hi:[1,0,0]
  v_fma_mix_f32 v31, v75, v119, v127 op_sel:[1,0,0] op_sel_hi:[1,0,0]
  v_mfma_f32_16x16x32_bf16 v[224:227], a[216:219], v[48:51], 0
  s_waitcnt vmcnt(9)
  ds_read_b64_tr_b16 a[248:249], v11 offset:2048
  v_cvt_pk_bf16_f32 v74, v28, v29
  v_mfma_f32_16x16x32_bf16 v[228:231], a[216:219], v[52:55], 0
  s_mov_b32 s31, 1604608
  ds_read_b64_tr_b16 a[250:251], v11 offset:3072
  v_cvt_pk_bf16_f32 v75, v30, v31
  v_fma_mix_f32 v24, v76, v112, v120 op_sel:[0,0,0] op_sel_hi:[1,0,0]
  v_mfma_f32_16x16x32_bf16 v[232:235], a[216:219], v[56:59], 0
  buffer_load_dwordx4 v18, s[12:15], s31 offen offset:1024 lds
  v_mfma_f32_16x16x32_bf16 v[236:239], a[216:219], v[60:63], 0
  ds_read_b64_tr_b16 a[252:253], v11 offset:2056
  v_fma_mix_f32 v25, v76, v113, v121 op_sel:[1,0,0] op_sel_hi:[1,0,0]
  v_fma_mix_f32 v26, v77, v114, v122 op_sel:[0,0,0] op_sel_hi:[1,0,0]
  v_mfma_f32_16x16x32_bf16 v[252:255], a[220:223], v[60:63], 0
  ds_read_b64_tr_b16 a[254:255], v11 offset:3080
  v_fma_mix_f32 v27, v77, v115, v123 op_sel:[1,0,0] op_sel_hi:[1,0,0]
  v_mfma_f32_16x16x32_bf16 v[248:251], a[220:223], v[56:59], 0
  v_cvt_pk_bf16_f32 v76, v24, v25
  v_cvt_pk_bf16_f32 v77, v26, v27
  v_fma_mix_f32 v28, v78, v116, v124 op_sel:[0,0,0] op_sel_hi:[1,0,0]
  v_mfma_f32_16x16x32_bf16 v[244:247], a[220:223], v[52:55], 0
  v_fma_mix_f32 v29, v78, v117, v125 op_sel:[1,0,0] op_sel_hi:[1,0,0]
  v_fma_mix_f32 v30, v79, v118, v126 op_sel:[0,0,0] op_sel_hi:[1,0,0]
  v_mfma_f32_16x16x32_bf16 v[240:243], a[220:223], v[48:51], 0
  s_waitcnt vmcnt(9) lgkmcnt(5)
  v_fma_mix_f32 v31, v79, v119, v127 op_sel:[1,0,0] op_sel_hi:[1,0,0]
  v_cvt_pk_bf16_f32 v78, v28, v29
  v_cvt_pk_bf16_f32 v79, v30, v31
  v_mfma_f32_16x16x32_bf16 v[128:131], a[224:227], v[64:67], v[128:131]
  s_waitcnt vmcnt(26)
  s_barrier
  ds_read_b64_tr_b16 a[192:193], v8 offset:16384
  v_fma_mix_f32 v24, v80, v96, v104 op_sel:[0,0,0] op_sel_hi:[1,0,0]
  v_mfma_f32_16x16x32_bf16 v[132:135], a[224:227], v[68:71], v[132:135]
  s_xor_b32 s34, s1, 4096
  ds_read_b64_tr_b16 a[194:195], v8 offset:17408
  v_fma_mix_f32 v25, v80, v97, v105 op_sel:[1,0,0] op_sel_hi:[1,0,0]
  v_fma_mix_f32 v26, v81, v98, v106 op_sel:[0,0,0] op_sel_hi:[1,0,0]
  v_mfma_f32_16x16x32_bf16 v[136:139], a[224:227], v[72:75], v[136:139]
  buffer_load_dwordx4 v[48:51], v19, s[16:19], s34 offen sc1
  v_mfma_f32_16x16x32_bf16 v[140:143], a[224:227], v[76:79], v[140:143]
  ds_read_b64_tr_b16 a[196:197], v8 offset:16392
  v_fma_mix_f32 v27, v81, v99, v107 op_sel:[1,0,0] op_sel_hi:[1,0,0]
  v_cvt_pk_bf16_f32 v80, v24, v25
  v_mfma_f32_16x16x32_bf16 v[156:159], a[228:231], v[76:79], v[156:159]
  ds_read_b64_tr_b16 a[198:199], v8 offset:17416
  v_cvt_pk_bf16_f32 v81, v26, v27
  v_mfma_f32_16x16x32_bf16 v[152:155], a[228:231], v[72:75], v[152:155]
  s_xor_b32 s35, s1, 20480
  ds_read_b64_tr_b16 a[200:201], v9 offset:16384
  v_fma_mix_f32 v28, v82, v100, v108 op_sel:[0,0,0] op_sel_hi:[1,0,0]
  v_fma_mix_f32 v29, v82, v101, v109 op_sel:[1,0,0] op_sel_hi:[1,0,0]
  v_mfma_f32_16x16x32_bf16 v[148:151], a[228:231], v[68:71], v[148:151]
  buffer_load_dwordx4 v[52:55], v19, s[16:19], s35 offen sc1
  v_mfma_f32_16x16x32_bf16 v[144:147], a[228:231], v[64:67], v[144:147]
  s_waitcnt lgkmcnt(15)
  v_fma_mix_f32 v30, v83, v102, v110 op_sel:[0,0,0] op_sel_hi:[1,0,0]
  v_fma_mix_f32 v31, v83, v103, v111 op_sel:[1,0,0] op_sel_hi:[1,0,0]
  v_cvt_pk_bf16_f32 v82, v28, v29
  v_mfma_f32_16x16x32_bf16 v[160:163], a[232:235], v[64:67], v[160:163]
  ds_read_b128 v[112:115], v12 offset:2336
  v_cvt_pk_bf16_f32 v83, v30, v31
  v_mfma_f32_16x16x32_bf16 v[164:167], a[232:235], v[68:71], v[164:167]
  s_waitcnt vmcnt(10)
  ds_read_b64_tr_b16 a[202:203], v9 offset:17408
  v_fma_mix_f32 v24, v84, v96, v104 op_sel:[0,0,0] op_sel_hi:[1,0,0]
  v_fma_mix_f32 v25, v84, v97, v105 op_sel:[1,0,0] op_sel_hi:[1,0,0]
  v_mfma_f32_16x16x32_bf16 v[168:171], a[232:235], v[72:75], v[168:171]
  s_xor_b32 s36, s1, 36864
  ds_read_b64_tr_b16 a[204:205], v9 offset:16392
  v_fma_mix_f32 v26, v85, v98, v106 op_sel:[0,0,0] op_sel_hi:[1,0,0]
  v_mfma_f32_16x16x32_bf16 v[172:175], a[232:235], v[76:79], v[172:175]
  buffer_load_dwordx4 v[56:59], v19, s[16:19], s36 offen sc1
  v_fma_mix_f32 v27, v85, v99, v107 op_sel:[1,0,0] op_sel_hi:[1,0,0]
  v_mfma_f32_16x16x32_bf16 v[188:191], a[236:239], v[76:79], v[188:191]
  ds_read_b128 v[116:119], v12 offset:2352
  v_cvt_pk_bf16_f32 v84, v24, v25
  v_mfma_f32_16x16x32_bf16 v[184:187], a[236:239], v[72:75], v[184:187]
  ds_read_b64_tr_b16 a[206:207], v9 offset:17416
  v_cvt_pk_bf16_f32 v85, v26, v27
  v_fma_mix_f32 v28, v86, v100, v108 op_sel:[0,0,0] op_sel_hi:[1,0,0]
  v_mfma_f32_16x16x32_bf16 v[180:183], a[236:239], v[68:71], v[180:183]
  v_fma_mix_f32 v29, v86, v101, v109 op_sel:[1,0,0] op_sel_hi:[1,0,0]
  v_fma_mix_f32 v30, v87, v102, v110 op_sel:[0,0,0] op_sel_hi:[1,0,0]
  v_mfma_f32_16x16x32_bf16 v[176:179], a[236:239], v[64:67], v[176:179]
  s_waitcnt lgkmcnt(14)
  ds_read_b64_tr_b16 a[208:209], v10 offset:16384
  v_fma_mix_f32 v31, v87, v103, v111 op_sel:[1,0,0] op_sel_hi:[1,0,0]
  v_cvt_pk_bf16_f32 v86, v28, v29
  v_mfma_f32_16x16x32_bf16 v[192:195], a[240:243], v[64:67], v[192:195]
  s_xor_b32 s37, s1, 53248
  ds_read_b128 v[120:123], v12 offset:288
  v_cvt_pk_bf16_f32 v87, v30, v31
  v_mfma_f32_16x16x32_bf16 v[196:199], a[240:243], v[68:71], v[196:199]
  s_waitcnt vmcnt(10)
  buffer_load_dwordx4 v[60:63], v19, s[16:19], s37 offen sc1
  v_fma_mix_f32 v24, v88, v96, v104 op_sel:[0,0,0] op_sel_hi:[1,0,0]
  v_mfma_f32_16x16x32_bf16 v[200:203], a[240:243], v[72:75], v[200:203]
  ds_read_b64_tr_b16 a[210:211], v10 offset:17408
  v_fma_mix_f32 v25, v88, v97, v105 op_sel:[1,0,0] op_sel_hi:[1,0,0]
  v_mfma_f32_16x16x32_bf16 v[204:207], a[240:243], v[76:79], v[204:207]
  s_mov_b32 s32, 1636352
  ds_read_b64_tr_b16 a[212:213], v10 offset:16392
  v_fma_mix_f32 v26, v89, v98, v106 op_sel:[0,0,0] op_sel_hi:[1,0,0]
  v_fma_mix_f32 v27, v89, v99, v107 op_sel:[1,0,0] op_sel_hi:[1,0,0]
  v_mfma_f32_16x16x32_bf16 v[220:223], a[244:247], v[76:79], v[220:223]
  s_add_u32 m0, s26, 49152
  ds_read_b128 v[124:127], v12 offset:304
  v_cvt_pk_bf16_f32 v88, v24, v25
  v_mfma_f32_16x16x32_bf16 v[216:219], a[244:247], v[72:75], v[216:219]
  buffer_load_dwordx4 v18, s[12:15], s32 offen offset:2048 lds
  v_cvt_pk_bf16_f32 v89, v26, v27
  v_mfma_f32_16x16x32_bf16 v[212:215], a[244:247], v[68:71], v[212:215]
  v_fma_mix_f32 v28, v90, v100, v108 op_sel:[0,0,0] op_sel_hi:[1,0,0]
  v_fma_mix_f32 v29, v90, v101, v109 op_sel:[1,0,0] op_sel_hi:[1,0,0]
  v_mfma_f32_16x16x32_bf16 v[208:211], a[244:247], v[64:67], v[208:211]
  s_waitcnt lgkmcnt(15)
  ds_read_b64_tr_b16 a[214:215], v10 offset:17416
  v_fma_mix_f32 v30, v91, v102, v110 op_sel:[0,0,0] op_sel_hi:[1,0,0]
  v_fma_mix_f32 v31, v91, v103, v111 op_sel:[1,0,0] op_sel_hi:[1,0,0]
  v_mfma_f32_16x16x32_bf16 v[224:227], a[248:251], v[64:67], v[224:227]
  s_waitcnt vmcnt(11)
  ds_read_b64_tr_b16 a[216:217], v11 offset:16384
  v_cvt_pk_bf16_f32 v90, v28, v29
  v_mfma_f32_16x16x32_bf16 v[228:231], a[248:251], v[68:71], v[228:231]
  s_mov_b32 s33, 1668096
  ds_read_b64_tr_b16 a[218:219], v11 offset:17408
  v_cvt_pk_bf16_f32 v91, v30, v31
  v_fma_mix_f32 v24, v92, v96, v104 op_sel:[0,0,0] op_sel_hi:[1,0,0]
  v_mfma_f32_16x16x32_bf16 v[232:235], a[248:251], v[72:75], v[232:235]
  buffer_load_dwordx4 v18, s[12:15], s33 offen offset:3072 lds
  v_mfma_f32_16x16x32_bf16 v[236:239], a[248:251], v[76:79], v[236:239]
  ds_read_b64_tr_b16 a[220:221], v11 offset:16392
  v_fma_mix_f32 v25, v92, v97, v105 op_sel:[1,0,0] op_sel_hi:[1,0,0]
  v_fma_mix_f32 v26, v93, v98, v106 op_sel:[0,0,0] op_sel_hi:[1,0,0]
  v_mfma_f32_16x16x32_bf16 v[252:255], a[252:255], v[76:79], v[252:255]
  ds_read_b64_tr_b16 a[222:223], v11 offset:17416
  v_fma_mix_f32 v27, v93, v99, v107 op_sel:[1,0,0] op_sel_hi:[1,0,0]
  v_mfma_f32_16x16x32_bf16 v[248:251], a[252:255], v[72:75], v[248:251]
  v_cvt_pk_bf16_f32 v92, v24, v25
  v_cvt_pk_bf16_f32 v93, v26, v27
  v_fma_mix_f32 v28, v94, v100, v108 op_sel:[0,0,0] op_sel_hi:[1,0,0]
  v_mfma_f32_16x16x32_bf16 v[244:247], a[252:255], v[68:71], v[244:247]
  v_fma_mix_f32 v29, v94, v101, v109 op_sel:[1,0,0] op_sel_hi:[1,0,0]
  v_fma_mix_f32 v30, v95, v102, v110 op_sel:[0,0,0] op_sel_hi:[1,0,0]
  v_mfma_f32_16x16x32_bf16 v[240:243], a[252:255], v[64:67], v[240:243]
  s_waitcnt vmcnt(11) lgkmcnt(5)
  v_fma_mix_f32 v31, v95, v103, v111 op_sel:[1,0,0] op_sel_hi:[1,0,0]
  v_cvt_pk_bf16_f32 v94, v28, v29
  v_cvt_pk_bf16_f32 v95, v30, v31
  v_mfma_f32_16x16x32_bf16 v[128:131], a[192:195], v[80:83], v[128:131]
  ds_read_b64_tr_b16 a[224:225], v8 offset:18432
  v_fma_mix_f32 v24, v32, v112, v120 op_sel:[0,0,0] op_sel_hi:[1,0,0]
  v_mfma_f32_16x16x32_bf16 v[132:135], a[192:195], v[84:87], v[132:135]
  s_xor_b32 s34, s1, 5120
  ds_read_b64_tr_b16 a[226:227], v8 offset:19456
  v_fma_mix_f32 v25, v32, v113, v121 op_sel:[1,0,0] op_sel_hi:[1,0,0]
  v_fma_mix_f32 v26, v33, v114, v122 op_sel:[0,0,0] op_sel_hi:[1,0,0]
  v_mfma_f32_16x16x32_bf16 v[136:139], a[192:195], v[88:91], v[136:139]
  buffer_load_dwordx4 v[64:67], v19, s[16:19], s34 offen sc1
  v_mfma_f32_16x16x32_bf16 v[140:143], a[192:195], v[92:95], v[140:143]
  ds_read_b64_tr_b16 a[228:229], v8 offset:18440
  v_fma_mix_f32 v27, v33, v115, v123 op_sel:[1,0,0] op_sel_hi:[1,0,0]
  v_cvt_pk_bf16_f32 v32, v24, v25
  v_mfma_f32_16x16x32_bf16 v[156:159], a[196:199], v[92:95], v[156:159]
  ds_read_b64_tr_b16 a[230:231], v8 offset:19464
  v_cvt_pk_bf16_f32 v33, v26, v27
  v_mfma_f32_16x16x32_bf16 v[152:155], a[196:199], v[88:91], v[152:155]
  s_xor_b32 s35, s1, 21504
  ds_read_b64_tr_b16 a[232:233], v9 offset:18432
  v_fma_mix_f32 v28, v34, v116, v124 op_sel:[0,0,0] op_sel_hi:[1,0,0]
  v_fma_mix_f32 v29, v34, v117, v125 op_sel:[1,0,0] op_sel_hi:[1,0,0]
  v_mfma_f32_16x16x32_bf16 v[148:151], a[196:199], v[84:87], v[148:151]
  buffer_load_dwordx4 v[68:71], v19, s[16:19], s35 offen sc1
  v_mfma_f32_16x16x32_bf16 v[144:147], a[196:199], v[80:83], v[144:147]
  s_waitcnt lgkmcnt(15)
  v_fma_mix_f32 v30, v35, v118, v126 op_sel:[0,0,0] op_sel_hi:[1,0,0]
  v_fma_mix_f32 v31, v35, v119, v127 op_sel:[1,0,0] op_sel_hi:[1,0,0]
  v_cvt_pk_bf16_f32 v34, v28, v29
  v_mfma_f32_16x16x32_bf16 v[160:163], a[200:203], v[80:83], v[160:163]
L_attn_st2:
  s_cbranch_vccnz L_attn_st5
  ds_read_b128 v[96:99], v12 offset:2560
  v_cvt_pk_bf16_f32 v35, v30, v31
  v_mfma_f32_16x16x32_bf16 v[164:167], a[200:203], v[84:87], v[164:167]
  s_waitcnt vmcnt(12)
  ds_read_b64_tr_b16 a[234:235], v9 offset:19456
  v_fma_mix_f32 v24, v36, v112, v120 op_sel:[0,0,0] op_sel_hi:[1,0,0]
  v_fma_mix_f32 v25, v36, v113, v121 op_sel:[1,0,0] op_sel_hi:[1,0,0]
  v_mfma_f32_16x16x32_bf16 v[168:171], a[200:203], v[88:91], v[168:171]
  s_xor_b32 s36, s1, 37888
  ds_read_b64_tr_b16 a[236:237], v9 offset:18440
  v_fma_mix_f32 v26, v37, v114, v122 op_sel:[0,0,0] op_sel_hi:[1,0,0]
  v_mfma_f32_16x16x32_bf16 v[172:175], a[200:203], v[92:95], v[172:175]
  buffer_load_dwordx4 v[72:75], v19, s[16:19], s36 offen sc1
  v_fma_mix_f32 v27, v37, v115, v123 op_sel:[1,0,0] op_sel_hi:[1,0,0]
  v_mfma_f32_16x16x32_bf16 v[188:191], a[204:207], v[92:95], v[188:191]
  ds_read_b128 v[100:103], v12 offset:2576
  v_cvt_pk_bf16_f32 v36, v24, v25
  v_mfma_f32_16x16x32_bf16 v[184:187], a[204:207], v[88:91], v[184:187]
  ds_read_b64_tr_b16 a[238:239], v9 offset:19464
  v_cvt_pk_bf16_f32 v37, v26, v27
  v_fma_mix_f32 v28, v38, v116, v124 op_sel:[0,0,0] op_sel_hi:[1,0,0]
  v_mfma_f32_16x16x32_bf16 v[180:183], a[204:207], v[84:87], v[180:183]
  v_fma_mix_f32 v29, v38, v117, v125 op_sel:[1,0,0] op_sel_hi:[1,0,0]
  v_fma_mix_f32 v30, v39, v118, v126 op_sel:[0,0,0] op_sel_hi:[1,0,0]
  v_mfma_f32_16x16x32_bf16 v[176:179], a[204:207], v[80:83], v[176:179]
  s_waitcnt lgkmcnt(14)
  ds_read_b64_tr_b16 a[240:241], v10 offset:18432
  v_fma_mix_f32 v31, v39, v119, v127 op_sel:[1,0,0] op_sel_hi:[1,0,0]
  v_cvt_pk_bf16_f32 v38, v28, v29
  v_mfma_f32_16x16x32_bf16 v[192:195], a[208:211], v[80:83], v[192:195]
  s_xor_b32 s37, s1, 54272
  ds_read_b128 v[104:107], v12 offset:512
  v_cvt_pk_bf16_f32 v39, v30, v31
  v_mfma_f32_16x16x32_bf16 v[196:199], a[208:211], v[84:87], v[196:199]
  s_waitcnt vmcnt(12)
  buffer_load_dwordx4 v[76:79], v19, s[16:19], s37 offen sc1
  v_fma_mix_f32 v24, v40, v112, v120 op_sel:[0,0,0] op_sel_hi:[1,0,0]
  v_mfma_f32_16x16x32_bf16 v[200:203], a[208:211], v[88:91], v[200:203]
  ds_read_b64_tr_b16 a[242:243], v10 offset:19456
  v_fma_mix_f32 v25, v40, v113, v121 op_sel:[1,0,0] op_sel_hi:[1,0,0]
  v_mfma_f32_16x16x32_bf16 v[204:207], a[208:211], v[92:95], v[204:207]
  s_mov_b32 s30, 2097152
  ds_read_b64_tr_b16 a[244:245], v10 offset:18440
  v_fma_mix_f32 v26, v41, v114, v122 op_sel:[0,0,0] op_sel_hi:[1,0,0]
  v_fma_mix_f32 v27, v41, v115, v123 op_sel:[1,0,0] op_sel_hi:[1,0,0]
  v_mfma_f32_16x16x32_bf16 v[220:223], a[212:215], v[92:95], v[220:223]
  s_add_u32 m0, s26, 0
  ds_read_b128 v[108:111], v12 offset:528
  v_cvt_pk_bf16_f32 v40, v24, v25
  v_mfma_f32_16x16x32_bf16 v[216:219], a[212:215], v[88:91], v[216:219]
  buffer_load_dwordx4 v18, s[12:15], s30 offen offset:0 lds
  v_cvt_pk_bf16_f32 v41, v26, v27
  v_mfma_f32_16x16x32_bf16 v[212:215], a[212:215], v[84:87], v[212:215]
  v_fma_mix_f32 v28, v42, v116, v124 op_sel:[0,0,0] op_sel_hi:[1,0,0]
  v_fma_mix_f32 v29, v42, v117, v125 op_sel:[1,0,0] op_sel_hi:[1,0,0]
  v_mfma_f32_16x16x32_bf16 v[208:211], a[212:215], v[80:83], v[208:211]
  s_waitcnt lgkmcnt(15)
  ds_read_b64_tr_b16 a[246:247], v10 offset:19464
  v_fma_mix_f32 v30, v43, v118, v126 op_sel:[0,0,0] op_sel_hi:[1,0,0]
  v_fma_mix_f32 v31, v43, v119, v127 op_sel:[1,0,0] op_sel_hi:[1,0,0]
  v_mfma_f32_16x16x32_bf16 v[224:227], a[216:219], v[80:83], v[224:227]
  s_waitcnt vmcnt(13)
  ds_read_b64_tr_b16 a[248:249], v11 offset:18432
  v_cvt_pk_bf16_f32 v42, v28, v29
  v_mfma_f32_16x16x32_bf16 v[228:231], a[216:219], v[84:87], v[228:231]
  s_mov_b32 s31, 2128896
  ds_read_b64_tr_b16 a[250:251], v11 offset:19456
  v_cvt_pk_bf16_f32 v43, v30, v31
  v_fma_mix_f32 v24, v44, v112, v120 op_sel:[0,0,0] op_sel_hi:[1,0,0]
  v_mfma_f32_16x16x32_bf16 v[232:235], a[216:219], v[88:91], v[232:235]
  buffer_load_dwordx4 v18, s[12:15], s31 offen offset:1024 lds
  v_mfma_f32_16x16x32_bf16 v[236:239], a[216:219], v[92:95], v[236:239]
  ds_read_b64_tr_b16 a[252:253], v11 offset:18440
  v_fma_mix_f32 v25, v44, v113, v121 op_sel:[1,0,0] op_sel_hi:[1,0,0]
  v_fma_mix_f32 v26, v45, v114, v122 op_sel:[0,0,0] op_sel_hi:[1,0,0]
  v_mfma_f32_16x16x32_bf16 v[252:255], a[220:223], v[92:95], v[252:255]
  ds_read_b64_tr_b16 a[254:255], v11 offset:19464
  v_fma_mix_f32 v27, v45, v115, v123 op_sel:[1,0,0] op_sel_hi:[1,0,0]
  v_mfma_f32_16x16x32_bf16 v[248:251], a[220:223], v[88:91], v[248:251]
  v_cvt_pk_bf16_f32 v44, v24, v25
  v_cvt_pk_bf16_f32 v45, v26, v27
  v_fma_mix_f32 v28, v46, v116, v124 op_sel:[0,0,0] op_sel_hi:[1,0,0]
  v_mfma_f32_16x16x32_bf16 v[244:247], a[220:223], v[84:87], v[244:247]
  v_fma_mix_f32 v29, v46, v117, v125 op_sel:[1,0,0] op_sel_hi:[1,0,0]
  v_fma_mix_f32 v30, v47, v118, v126 op_sel:[0,0,0] op_sel_hi:[1,0,0]
  v_mfma_f32_16x16x32_bf16 v[240:243], a[220:223], v[80:83], v[240:243]
  s_waitcnt vmcnt(11) lgkmcnt(5)
  v_fma_mix_f32 v31, v47, v119, v127 op_sel:[1,0,0] op_sel_hi:[1,0,0]
  v_cvt_pk_bf16_f32 v46, v28, v29
  v_cvt_pk_bf16_f32 v47, v30, v31
  v_mfma_f32_16x16x32_bf16 v[128:131], a[224:227], v[32:35], v[128:131]
  s_waitcnt vmcnt(34)
  s_barrier
  ds_read_b64_tr_b16 a[192:193], v8 offset:32768
  v_fma_mix_f32 v24, v48, v96, v104 op_sel:[0,0,0] op_sel_hi:[1,0,0]
  v_mfma_f32_16x16x32_bf16 v[132:135], a[224:227], v[36:39], v[132:135]
  s_xor_b32 s34, s1, 6144
  ds_read_b64_tr_b16 a[194:195], v8 offset:33792
  v_fma_mix_f32 v25, v48, v97, v105 op_sel:[1,0,0] op_sel_hi:[1,0,0]
  v_fma_mix_f32 v26, v49, v98, v106 op_sel:[0,0,0] op_sel_hi:[1,0,0]
  v_mfma_f32_16x16x32_bf16 v[136:139], a[224:227], v[40:43], v[136:139]
  buffer_load_dwordx4 v[80:83], v19, s[16:19], s34 offen sc1
  v_mfma_f32_16x16x32_bf16 v[140:143], a[224:227], v[44:47], v[140:143]
  ds_read_b64_tr_b16 a[196:197], v8 offset:32776
  v_fma_mix_f32 v27, v49, v99, v107 op_sel:[1,0,0] op_sel_hi:[1,0,0]
  v_cvt_pk_bf16_f32 v48, v24, v25
  v_mfma_f32_16x16x32_bf16 v[156:159], a[228:231], v[44:47], v[156:159]
  ds_read_b64_tr_b16 a[198:199], v8 offset:33800
  v_cvt_pk_bf16_f32 v49, v26, v27
  v_mfma_f32_16x16x32_bf16 v[152:155], a[228:231], v[40:43], v[152:155]
  s_xor_b32 s35, s1, 22528
  ds_read_b64_tr_b16 a[200:201], v9 offset:32768
  v_fma_mix_f32 v28, v50, v100, v108 op_sel:[0,0,0] op_sel_hi:[1,0,0]
  v_fma_mix_f32 v29, v50, v101, v109 op_sel:[1,0,0] op_sel_hi:[1,0,0]
  v_mfma_f32_16x16x32_bf16 v[148:151], a[228:231], v[36:39], v[148:151]
  buffer_load_dwordx4 v[84:87], v19, s[16:19], s35 offen sc1
  v_mfma_f32_16x16x32_bf16 v[144:147], a[228:231], v[32:35], v[144:147]
  s_waitcnt lgkmcnt(15)
  v_fma_mix_f32 v30, v51, v102, v110 op_sel:[0,0,0] op_sel_hi:[1,0,0]
  v_fma_mix_f32 v31, v51, v103, v111 op_sel:[1,0,0] op_sel_hi:[1,0,0]
  v_cvt_pk_bf16_f32 v50, v28, v29
  v_mfma_f32_16x16x32_bf16 v[160:163], a[232:235], v[32:35], v[160:163]
  ds_read_b128 v[112:115], v12 offset:2592
  v_cvt_pk_bf16_f32 v51, v30, v31
  v_mfma_f32_16x16x32_bf16 v[164:167], a[232:235], v[36:39], v[164:167]
  s_waitcnt vmcnt(12)
  ds_read_b64_tr_b16 a[202:203], v9 offset:33792
  v_fma_mix_f32 v24, v52, v96, v104 op_sel:[0,0,0] op_sel_hi:[1,0,0]
  v_fma_mix_f32 v25, v52, v97, v105 op_sel:[1,0,0] op_sel_hi:[1,0,0]
  v_mfma_f32_16x16x32_bf16 v[168:171], a[232:235], v[40:43], v[168:171]
  s_xor_b32 s36, s1, 38912
  ds_read_b64_tr_b16 a[204:205], v9 offset:32776
  v_fma_mix_f32 v26, v53, v98, v106 op_sel:[0,0,0] op_sel_hi:[1,0,0]
  v_mfma_f32_16x16x32_bf16 v[172:175], a[232:235], v[44:47], v[172:175]
  buffer_load_dwordx4 v[88:91], v19, s[16:19], s36 offen sc1
  v_fma_mix_f32 v27, v53, v99, v107 op_sel:[1,0,0] op_sel_hi:[1,0,0]
  v_mfma_f32_16x16x32_bf16 v[188:191], a[236:239], v[44:47], v[188:191]
  ds_read_b128 v[116:119], v12 offset:2608
  v_cvt_pk_bf16_f32 v52, v24, v25
  v_mfma_f32_16x16x32_bf16 v[184:187], a[236:239], v[40:43], v[184:187]
  ds_read_b64_tr_b16 a[206:207], v9 offset:33800
  v_cvt_pk_bf16_f32 v53, v26, v27
  v_fma_mix_f32 v28, v54, v100, v108 op_sel:[0,0,0] op_sel_hi:[1,0,0]
  v_mfma_f32_16x16x32_bf16 v[180:183], a[236:239], v[36:39], v[180:183]
  v_fma_mix_f32 v29, v54, v101, v109 op_sel:[1,0,0] op_sel_hi:[1,0,0]
  v_fma_mix_f32 v30, v55, v102, v110 op_sel:[0,0,0] op_sel_hi:[1,0,0]
  v_mfma_f32_16x16x32_bf16 v[176:179], a[236:239], v[32:35], v[176:179]
  s_waitcnt lgkmcnt(14)
  ds_read_b64_tr_b16 a[208:209], v10 offset:32768
  v_fma_mix_f32 v31, v55, v103, v111 op_sel:[1,0,0] op_sel_hi:[1,0,0]
  v_cvt_pk_bf16_f32 v54, v28, v29
  v_mfma_f32_16x16x32_bf16 v[192:195], a[240:243], v[32:35], v[192:195]
  s_xor_b32 s37, s1, 55296
  ds_read_b128 v[120:123], v12 offset:544
  v_cvt_pk_bf16_f32 v55, v30, v31
  v_mfma_f32_16x16x32_bf16 v[196:199], a[240:243], v[36:39], v[196:199]
  s_waitcnt vmcnt(12)
  buffer_load_dwordx4 v[92:95], v19, s[16:19], s37 offen sc1
  v_fma_mix_f32 v24, v56, v96, v104 op_sel:[0,0,0] op_sel_hi:[1,0,0]
  v_mfma_f32_16x16x32_bf16 v[200:203], a[240:243], v[40:43], v[200:203]
  ds_read_b64_tr_b16 a[210:211], v10 offset:33792
  v_fma_mix_f32 v25, v56, v97, v105 op_sel:[1,0,0] op_sel_hi:[1,0,0]
  v_mfma_f32_16x16x32_bf16 v[204:207], a[240:243], v[44:47], v[204:207]
  s_mov_b32 s32, 2160640
  ds_read_b64_tr_b16 a[212:213], v10 offset:32776
  v_fma_mix_f32 v26, v57, v98, v106 op_sel:[0,0,0] op_sel_hi:[1,0,0]
  v_fma_mix_f32 v27, v57, v99, v107 op_sel:[1,0,0] op_sel_hi:[1,0,0]
  v_mfma_f32_16x16x32_bf16 v[220:223], a[244:247], v[44:47], v[220:223]
  s_add_u32 m0, s26, 0
  ds_read_b128 v[124:127], v12 offset:560
  v_cvt_pk_bf16_f32 v56, v24, v25
  v_mfma_f32_16x16x32_bf16 v[216:219], a[244:247], v[40:43], v[216:219]
  buffer_load_dwordx4 v18, s[12:15], s32 offen offset:2048 lds
  v_cvt_pk_bf16_f32 v57, v26, v27
  v_mfma_f32_16x16x32_bf16 v[212:215], a[244:247], v[36:39], v[212:215]
  v_fma_mix_f32 v28, v58, v100, v108 op_sel:[0,0,0] op_sel_hi:[1,0,0]
  v_fma_mix_f32 v29, v58, v101, v109 op_sel:[1,0,0] op_sel_hi:[1,0,0]
  v_mfma_f32_16x16x32_bf16 v[208:211], a[244:247], v[32:35], v[208:211]
  s_waitcnt lgkmcnt(15)
  ds_read_b64_tr_b16 a[214:215], v10 offset:33800
  v_fma_mix_f32 v30, v59, v102, v110 op_sel:[0,0,0] op_sel_hi:[1,0,0]
  v_fma_mix_f32 v31, v59, v103, v111 op_sel:[1,0,0] op_sel_hi:[1,0,0]
  v_mfma_f32_16x16x32_bf16 v[224:227], a[248:251], v[32:35], v[224:227]
  s_waitcnt vmcnt(13)
  ds_read_b64_tr_b16 a[216:217], v11 offset:32768
  v_cvt_pk_bf16_f32 v58, v28, v29
  v_mfma_f32_16x16x32_bf16 v[228:231], a[248:251], v[36:39], v[228:231]
  s_mov_b32 s33, 2192384
  ds_read_b64_tr_b16 a[218:219], v11 offset:33792
  v_cvt_pk_bf16_f32 v59, v30, v31
  v_fma_mix_f32 v24, v60, v96, v104 op_sel:[0,0,0] op_sel_hi:[1,0,0]
  v_mfma_f32_16x16x32_bf16 v[232:235], a[248:251], v[40:43], v[232:235]
  buffer_load_dwordx4 v18, s[12:15], s33 offen offset:3072 lds
  v_mfma_f32_16x16x32_bf16 v[236:239], a[248:251], v[44:47], v[236:239]
  ds_read_b64_tr_b16 a[220:221], v11 offset:32776
  v_fma_mix_f32 v25, v60, v97, v105 op_sel:[1,0,0] op_sel_hi:[1,0,0]
  v_fma_mix_f32 v26, v61, v98, v106 op_sel:[0,0,0] op_sel_hi:[1,0,0]
  v_mfma_f32_16x16x32_bf16 v[252:255], a[252:255], v[44:47], v[252:255]
  ds_read_b64_tr_b16 a[222:223], v11 offset:33800
  v_fma_mix_f32 v27, v61, v99, v107 op_sel:[1,0,0] op_sel_hi:[1,0,0]
  v_mfma_f32_16x16x32_bf16 v[248:251], a[252:255], v[40:43], v[248:251]
  v_cvt_pk_bf16_f32 v60, v24, v25
  v_cvt_pk_bf16_f32 v61, v26, v27
  v_fma_mix_f32 v28, v62, v100, v108 op_sel:[0,0,0] op_sel_hi:[1,0,0]
  v_mfma_f32_16x16x32_bf16 v[244:247], a[252:255], v[36:39], v[244:247]
  v_fma_mix_f32 v29, v62, v101, v109 op_sel:[1,0,0] op_sel_hi:[1,0,0]
  v_fma_mix_f32 v30, v63, v102, v110 op_sel:[0,0,0] op_sel_hi:[1,0,0]
  v_mfma_f32_16x16x32_bf16 v[240:243], a[252:255], v[32:35], v[240:243]
  s_waitcnt vmcnt(11) lgkmcnt(5)
  v_fma_mix_f32 v31, v63, v103, v111 op_sel:[1,0,0] op_sel_hi:[1,0,0]
  v_cvt_pk_bf16_f32 v62, v28, v29
  v_cvt_pk_bf16_f32 v63, v30, v31
  v_mfma_f32_16x16x32_bf16 v[128:131], a[192:195], v[48:51], v[128:131]
  ds_read_b64_tr_b16 a[224:225], v8 offset:34816
  v_fma_mix_f32 v24, v64, v112, v120 op_sel:[0,0,0] op_sel_hi:[1,0,0]
  v_mfma_f32_16x16x32_bf16 v[132:135], a[192:195], v[52:55], v[132:135]
  s_xor_b32 s34, s1, 7168
  ds_read_b64_tr_b16 a[226:227], v8 offset:35840
  v_fma_mix_f32 v25, v64, v113, v121 op_sel:[1,0,0] op_sel_hi:[1,0,0]
  v_fma_mix_f32 v26, v65, v114, v122 op_sel:[0,0,0] op_sel_hi:[1,0,0]
  v_mfma_f32_16x16x32_bf16 v[136:139], a[192:195], v[56:59], v[136:139]
  buffer_load_dwordx4 v[32:35], v19, s[16:19], s34 offen sc1
  v_mfma_f32_16x16x32_bf16 v[140:143], a[192:195], v[60:63], v[140:143]
  ds_read_b64_tr_b16 a[228:229], v8 offset:34824
  v_fma_mix_f32 v27, v65, v115, v123 op_sel:[1,0,0] op_sel_hi:[1,0,0]
  v_cvt_pk_bf16_f32 v64, v24, v25
  v_mfma_f32_16x16x32_bf16 v[156:159], a[196:199], v[60:63], v[156:159]
  ds_read_b64_tr_b16 a[230:231], v8 offset:35848
  v_cvt_pk_bf16_f32 v65, v26, v27
  v_mfma_f32_16x16x32_bf16 v[152:155], a[196:199], v[56:59], v[152:155]
  s_xor_b32 s35, s1, 23552
  ds_read_b64_tr_b16 a[232:233], v9 offset:34816
  v_fma_mix_f32 v28, v66, v116, v124 op_sel:[0,0,0] op_sel_hi:[1,0,0]
  v_fma_mix_f32 v29, v66, v117, v125 op_sel:[1,0,0] op_sel_hi:[1,0,0]
  v_mfma_f32_16x16x32_bf16 v[148:151], a[196:199], v[52:55], v[148:151]
  buffer_load_dwordx4 v[36:39], v19, s[16:19], s35 offen sc1
  v_mfma_f32_16x16x32_bf16 v[144:147], a[196:199], v[48:51], v[144:147]
  s_waitcnt lgkmcnt(15)
  v_fma_mix_f32 v30, v67, v118, v126 op_sel:[0,0,0] op_sel_hi:[1,0,0]
  v_fma_mix_f32 v31, v67, v119, v127 op_sel:[1,0,0] op_sel_hi:[1,0,0]
  v_cvt_pk_bf16_f32 v66, v28, v29
  v_mfma_f32_16x16x32_bf16 v[160:163], a[200:203], v[48:51], v[160:163]
  ds_read_b128 v[96:99], v12 offset:2816
  v_cvt_pk_bf16_f32 v67, v30, v31
  v_mfma_f32_16x16x32_bf16 v[164:167], a[200:203], v[52:55], v[164:167]
  s_waitcnt vmcnt(12)
  ds_read_b64_tr_b16 a[234:235], v9 offset:35840
  v_fma_mix_f32 v24, v68, v112, v120 op_sel:[0,0,0] op_sel_hi:[1,0,0]
  v_fma_mix_f32 v25, v68, v113, v121 op_sel:[1,0,0] op_sel_hi:[1,0,0]
  v_mfma_f32_16x16x32_bf16 v[168:171], a[200:203], v[56:59], v[168:171]
  s_xor_b32 s36, s1, 39936
  ds_read_b64_tr_b16 a[236:237], v9 offset:34824
  v_fma_mix_f32 v26, v69, v114, v122 op_sel:[0,0,0] op_sel_hi:[1,0,0]
  v_mfma_f32_16x16x32_bf16 v[172:175], a[200:203], v[60:63], v[172:175]
  buffer_load_dwordx4 v[40:43], v19, s[16:19], s36 offen sc1
  v_fma_mix_f32 v27, v69, v115, v123 op_sel:[1,0,0] op_sel_hi:[1,0,0]
  v_mfma_f32_16x16x32_bf16 v[188:191], a[204:207], v[60:63], v[188:191]
  ds_read_b128 v[100:103], v12 offset:2832
  v_cvt_pk_bf16_f32 v68, v24, v25
  v_mfma_f32_16x16x32_bf16 v[184:187], a[204:207], v[56:59], v[184:187]
  ds_read_b64_tr_b16 a[238:239], v9 offset:35848
  v_cvt_pk_bf16_f32 v69, v26, v27
  v_fma_mix_f32 v28, v70, v116, v124 op_sel:[0,0,0] op_sel_hi:[1,0,0]
  v_mfma_f32_16x16x32_bf16 v[180:183], a[204:207], v[52:55], v[180:183]
  v_fma_mix_f32 v29, v70, v117, v125 op_sel:[1,0,0] op_sel_hi:[1,0,0]
  v_fma_mix_f32 v30, v71, v118, v126 op_sel:[0,0,0] op_sel_hi:[1,0,0]
  v_mfma_f32_16x16x32_bf16 v[176:179], a[204:207], v[48:51], v[176:179]
  s_waitcnt lgkmcnt(14)
  ds_read_b64_tr_b16 a[240:241], v10 offset:34816
  v_fma_mix_f32 v31, v71, v119, v127 op_sel:[1,0,0] op_sel_hi:[1,0,0]
  v_cvt_pk_bf16_f32 v70, v28, v29
  v_mfma_f32_16x16x32_bf16 v[192:195], a[208:211], v[48:51], v[192:195]
  s_xor_b32 s37, s1, 56320
  ds_read_b128 v[104:107], v12 offset:768
  v_cvt_pk_bf16_f32 v71, v30, v31
  v_mfma_f32_16x16x32_bf16 v[196:199], a[208:211], v[52:55], v[196:199]
  s_waitcnt vmcnt(12)
  buffer_load_dwordx4 v[44:47], v19, s[16:19], s37 offen sc1
  v_fma_mix_f32 v24, v72, v112, v120 op_sel:[0,0,0] op_sel_hi:[1,0,0]
  v_mfma_f32_16x16x32_bf16 v[200:203], a[208:211], v[56:59], v[200:203]
  ds_read_b64_tr_b16 a[242:243], v10 offset:35840
  v_fma_mix_f32 v25, v72, v113, v121 op_sel:[1,0,0] op_sel_hi:[1,0,0]
  v_mfma_f32_16x16x32_bf16 v[204:207], a[208:211], v[60:63], v[204:207]
  s_mov_b32 s30, 2621440
  ds_read_b64_tr_b16 a[244:245], v10 offset:34824
  v_fma_mix_f32 v26, v73, v114, v122 op_sel:[0,0,0] op_sel_hi:[1,0,0]
  v_fma_mix_f32 v27, v73, v115, v123 op_sel:[1,0,0] op_sel_hi:[1,0,0]
  v_mfma_f32_16x16x32_bf16 v[220:223], a[212:215], v[60:63], v[220:223]
  s_add_u32 m0, s26, 16384
  ds_read_b128 v[108:111], v12 offset:784
  v_cvt_pk_bf16_f32 v72, v24, v25
  v_mfma_f32_16x16x32_bf16 v[216:219], a[212:215], v[56:59], v[216:219]
  buffer_load_dwordx4 v18, s[12:15], s30 offen offset:0 lds
  v_cvt_pk_bf16_f32 v73, v26, v27
  v_mfma_f32_16x16x32_bf16 v[212:215], a[212:215], v[52:55], v[212:215]
  v_fma_mix_f32 v28, v74, v116, v124 op_sel:[0,0,0] op_sel_hi:[1,0,0]
  v_fma_mix_f32 v29, v74, v117, v125 op_sel:[1,0,0] op_sel_hi:[1,0,0]
  v_mfma_f32_16x16x32_bf16 v[208:211], a[212:215], v[48:51], v[208:211]
  s_waitcnt lgkmcnt(15)
  ds_read_b64_tr_b16 a[246:247], v10 offset:35848
  v_fma_mix_f32 v30, v75, v118, v126 op_sel:[0,0,0] op_sel_hi:[1,0,0]
  v_fma_mix_f32 v31, v75, v119, v127 op_sel:[1,0,0] op_sel_hi:[1,0,0]
  v_mfma_f32_16x16x32_bf16 v[224:227], a[216:219], v[48:51], v[224:227]
  s_waitcnt vmcnt(13)
  ds_read_b64_tr_b16 a[248:249], v11 offset:34816
  v_cvt_pk_bf16_f32 v74, v28, v29
  v_mfma_f32_16x16x32_bf16 v[228:231], a[216:219], v[52:55], v[228:231]
  s_mov_b32 s31, 2653184
  ds_read_b64_tr_b16 a[250:251], v11 offset:35840
  v_cvt_pk_bf16_f32 v75, v30, v31
  v_fma_mix_f32 v24, v76, v112, v120 op_sel:[0,0,0] op_sel_hi:[1,0,0]
  v_mfma_f32_16x16x32_bf16 v[232:235], a[216:219], v[56:59], v[232:235]
  buffer_load_dwordx4 v18, s[12:15], s31 offen offset:1024 lds
  v_mfma_f32_16x16x32_bf16 v[236:239], a[216:219], v[60:63], v[236:239]
  ds_read_b64_tr_b16 a[252:253], v11 offset:34824
  v_fma_mix_f32 v25, v76, v113, v121 op_sel:[1,0,0] op_sel_hi:[1,0,0]
  v_fma_mix_f32 v26, v77, v114, v122 op_sel:[0,0,0] op_sel_hi:[1,0,0]
  v_mfma_f32_16x16x32_bf16 v[252:255], a[220:223], v[60:63], v[252:255]
  ds_read_b64_tr_b16 a[254:255], v11 offset:35848
  v_fma_mix_f32 v27, v77, v115, v123 op_sel:[1,0,0] op_sel_hi:[1,0,0]
  v_mfma_f32_16x16x32_bf16 v[248:251], a[220:223], v[56:59], v[248:251]
  v_cvt_pk_bf16_f32 v76, v24, v25
  v_cvt_pk_bf16_f32 v77, v26, v27
  v_fma_mix_f32 v28, v78, v116, v124 op_sel:[0,0,0] op_sel_hi:[1,0,0]
  v_mfma_f32_16x16x32_bf16 v[244:247], a[220:223], v[52:55], v[244:247]
  v_fma_mix_f32 v29, v78, v117, v125 op_sel:[1,0,0] op_sel_hi:[1,0,0]
  v_fma_mix_f32 v30, v79, v118, v126 op_sel:[0,0,0] op_sel_hi:[1,0,0]
  v_mfma_f32_16x16x32_bf16 v[240:243], a[220:223], v[48:51], v[240:243]
  s_waitcnt vmcnt(11) lgkmcnt(5)
  v_fma_mix_f32 v31, v79, v119, v127 op_sel:[1,0,0] op_sel_hi:[1,0,0]
  v_cvt_pk_bf16_f32 v78, v28, v29
  v_cvt_pk_bf16_f32 v79, v30, v31
  v_mfma_f32_16x16x32_bf16 v[128:131], a[224:227], v[64:67], v[128:131]
  s_waitcnt vmcnt(18)
  s_barrier
  ds_read_b64_tr_b16 a[192:193], v8 offset:49152
  v_fma_mix_f32 v24, v80, v96, v104 op_sel:[0,0,0] op_sel_hi:[1,0,0]
  v_mfma_f32_16x16x32_bf16 v[132:135], a[224:227], v[68:71], v[132:135]
  s_xor_b32 s34, s1, 8192
  ds_read_b64_tr_b16 a[194:195], v8 offset:50176
  v_fma_mix_f32 v25, v80, v97, v105 op_sel:[1,0,0] op_sel_hi:[1,0,0]
  v_fma_mix_f32 v26, v81, v98, v106 op_sel:[0,0,0] op_sel_hi:[1,0,0]
  v_mfma_f32_16x16x32_bf16 v[136:139], a[224:227], v[72:75], v[136:139]
  buffer_load_dwordx4 v[48:51], v19, s[16:19], s34 offen sc1
  v_mfma_f32_16x16x32_bf16 v[140:143], a[224:227], v[76:79], v[140:143]
  ds_read_b64_tr_b16 a[196:197], v8 offset:49160
  v_fma_mix_f32 v27, v81, v99, v107 op_sel:[1,0,0] op_sel_hi:[1,0,0]
  v_cvt_pk_bf16_f32 v80, v24, v25
  v_mfma_f32_16x16x32_bf16 v[156:159], a[228:231], v[76:79], v[156:159]
  ds_read_b64_tr_b16 a[198:199], v8 offset:50184
  v_cvt_pk_bf16_f32 v81, v26, v27
  v_mfma_f32_16x16x32_bf16 v[152:155], a[228:231], v[72:75], v[152:155]
  s_xor_b32 s35, s1, 24576
  ds_read_b64_tr_b16 a[200:201], v9 offset:49152
  v_fma_mix_f32 v28, v82, v100, v108 op_sel:[0,0,0] op_sel_hi:[1,0,0]
  v_fma_mix_f32 v29, v82, v101, v109 op_sel:[1,0,0] op_sel_hi:[1,0,0]
  v_mfma_f32_16x16x32_bf16 v[148:151], a[228:231], v[68:71], v[148:151]
  buffer_load_dwordx4 v[52:55], v19, s[16:19], s35 offen sc1
  v_mfma_f32_16x16x32_bf16 v[144:147], a[228:231], v[64:67], v[144:147]
  s_waitcnt lgkmcnt(15)
  v_fma_mix_f32 v30, v83, v102, v110 op_sel:[0,0,0] op_sel_hi:[1,0,0]
  v_fma_mix_f32 v31, v83, v103, v111 op_sel:[1,0,0] op_sel_hi:[1,0,0]
  v_cvt_pk_bf16_f32 v82, v28, v29
  v_mfma_f32_16x16x32_bf16 v[160:163], a[232:235], v[64:67], v[160:163]
  ds_read_b128 v[112:115], v12 offset:2848
  v_cvt_pk_bf16_f32 v83, v30, v31
  v_mfma_f32_16x16x32_bf16 v[164:167], a[232:235], v[68:71], v[164:167]
  s_waitcnt vmcnt(12)
  ds_read_b64_tr_b16 a[202:203], v9 offset:50176
  v_fma_mix_f32 v24, v84, v96, v104 op_sel:[0,0,0] op_sel_hi:[1,0,0]
  v_fma_mix_f32 v25, v84, v97, v105 op_sel:[1,0,0] op_sel_hi:[1,0,0]
  v_mfma_f32_16x16x32_bf16 v[168:171], a[232:235], v[72:75], v[168:171]
  s_xor_b32 s36, s1, 40960
  ds_read_b64_tr_b16 a[204:205], v9 offset:49160
  v_fma_mix_f32 v26, v85, v98, v106 op_sel:[0,0,0] op_sel_hi:[1,0,0]
  v_mfma_f32_16x16x32_bf16 v[172:175], a[232:235], v[76:79], v[172:175]
  buffer_load_dwordx4 v[56:59], v19, s[16:19], s36 offen sc1
  v_fma_mix_f32 v27, v85, v99, v107 op_sel:[1,0,0] op_sel_hi:[1,0,0]
  v_mfma_f32_16x16x32_bf16 v[188:191], a[236:239], v[76:79], v[188:191]
  ds_read_b128 v[116:119], v12 offset:2864
  v_cvt_pk_bf16_f32 v84, v24, v25
  v_mfma_f32_16x16x32_bf16 v[184:187], a[236:239], v[72:75], v[184:187]
  ds_read_b64_tr_b16 a[206:207], v9 offset:50184
  v_cvt_pk_bf16_f32 v85, v26, v27
  v_fma_mix_f32 v28, v86, v100, v108 op_sel:[0,0,0] op_sel_hi:[1,0,0]
  v_mfma_f32_16x16x32_bf16 v[180:183], a[236:239], v[68:71], v[180:183]
  v_fma_mix_f32 v29, v86, v101, v109 op_sel:[1,0,0] op_sel_hi:[1,0,0]
  v_fma_mix_f32 v30, v87, v102, v110 op_sel:[0,0,0] op_sel_hi:[1,0,0]
  v_mfma_f32_16x16x32_bf16 v[176:179], a[236:239], v[64:67], v[176:179]
  s_waitcnt lgkmcnt(14)
  ds_read_b64_tr_b16 a[208:209], v10 offset:49152
  v_fma_mix_f32 v31, v87, v103, v111 op_sel:[1,0,0] op_sel_hi:[1,0,0]
  v_cvt_pk_bf16_f32 v86, v28, v29
  v_mfma_f32_16x16x32_bf16 v[192:195], a[240:243], v[64:67], v[192:195]
  s_xor_b32 s37, s1, 57344
  ds_read_b128 v[120:123], v12 offset:800
  v_cvt_pk_bf16_f32 v87, v30, v31
  v_mfma_f32_16x16x32_bf16 v[196:199], a[240:243], v[68:71], v[196:199]
  s_waitcnt vmcnt(12)
  buffer_load_dwordx4 v[60:63], v19, s[16:19], s37 offen sc1
  v_fma_mix_f32 v24, v88, v96, v104 op_sel:[0,0,0] op_sel_hi:[1,0,0]
  v_mfma_f32_16x16x32_bf16 v[200:203], a[240:243], v[72:75], v[200:203]
  ds_read_b64_tr_b16 a[210:211], v10 offset:50176
  v_fma_mix_f32 v25, v88, v97, v105 op_sel:[1,0,0] op_sel_hi:[1,0,0]
  v_mfma_f32_16x16x32_bf16 v[204:207], a[240:243], v[76:79], v[204:207]
  s_mov_b32 s32, 2684928
  ds_read_b64_tr_b16 a[212:213], v10 offset:49160
  v_fma_mix_f32 v26, v89, v98, v106 op_sel:[0,0,0] op_sel_hi:[1,0,0]
  v_fma_mix_f32 v27, v89, v99, v107 op_sel:[1,0,0] op_sel_hi:[1,0,0]
  v_mfma_f32_16x16x32_bf16 v[220:223], a[244:247], v[76:79], v[220:223]
  s_add_u32 m0, s26, 16384
  ds_read_b128 v[124:127], v12 offset:816
  v_cvt_pk_bf16_f32 v88, v24, v25
  v_mfma_f32_16x16x32_bf16 v[216:219], a[244:247], v[72:75], v[216:219]
  buffer_load_dwordx4 v18, s[12:15], s32 offen offset:2048 lds
  v_cvt_pk_bf16_f32 v89, v26, v27
  v_mfma_f32_16x16x32_bf16 v[212:215], a[244:247], v[68:71], v[212:215]
  v_fma_mix_f32 v28, v90, v100, v108 op_sel:[0,0,0] op_sel_hi:[1,0,0]
  v_fma_mix_f32 v29, v90, v101, v109 op_sel:[1,0,0] op_sel_hi:[1,0,0]
  v_mfma_f32_16x16x32_bf16 v[208:211], a[244:247], v[64:67], v[208:211]
  s_waitcnt lgkmcnt(15)
  ds_read_b64_tr_b16 a[214:215], v10 offset:50184
  v_fma_mix_f32 v30, v91, v102, v110 op_sel:[0,0,0] op_sel_hi:[1,0,0]
  v_fma_mix_f32 v31, v91, v103, v111 op_sel:[1,0,0] op_sel_hi:[1,0,0]
  v_mfma_f32_16x16x32_bf16 v[224:227], a[248:251], v[64:67], v[224:227]
  s_waitcnt vmcnt(13)
  ds_read_b64_tr_b16 a[216:217], v11 offset:49152
  v_cvt_pk_bf16_f32 v90, v28, v29
  v_mfma_f32_16x16x32_bf16 v[228:231], a[248:251], v[68:71], v[228:231]
  s_mov_b32 s33, 2716672
  ds_read_b64_tr_b16 a[218:219], v11 offset:50176
  v_cvt_pk_bf16_f32 v91, v30, v31
  v_fma_mix_f32 v24, v92, v96, v104 op_sel:[0,0,0] op_sel_hi:[1,0,0]
  v_mfma_f32_16x16x32_bf16 v[232:235], a[248:251], v[72:75], v[232:235]
  buffer_load_dwordx4 v18, s[12:15], s33 offen offset:3072 lds
  v_mfma_f32_16x16x32_bf16 v[236:239], a[248:251], v[76:79], v[236:239]
  ds_read_b64_tr_b16 a[220:221], v11 offset:49160
  v_fma_mix_f32 v25, v92, v97, v105 op_sel:[1,0,0] op_sel_hi:[1,0,0]
  v_fma_mix_f32 v26, v93, v98, v106 op_sel:[0,0,0] op_sel_hi:[1,0,0]
  v_mfma_f32_16x16x32_bf16 v[252:255], a[252:255], v[76:79], v[252:255]
  ds_read_b64_tr_b16 a[222:223], v11 offset:50184
  v_fma_mix_f32 v27, v93, v99, v107 op_sel:[1,0,0] op_sel_hi:[1,0,0]
  v_mfma_f32_16x16x32_bf16 v[248:251], a[252:255], v[72:75], v[248:251]
  v_cvt_pk_bf16_f32 v92, v24, v25
  v_cvt_pk_bf16_f32 v93, v26, v27
  v_fma_mix_f32 v28, v94, v100, v108 op_sel:[0,0,0] op_sel_hi:[1,0,0]
  v_mfma_f32_16x16x32_bf16 v[244:247], a[252:255], v[68:71], v[244:247]
  v_fma_mix_f32 v29, v94, v101, v109 op_sel:[1,0,0] op_sel_hi:[1,0,0]
  v_fma_mix_f32 v30, v95, v102, v110 op_sel:[0,0,0] op_sel_hi:[1,0,0]
  v_mfma_f32_16x16x32_bf16 v[240:243], a[252:255], v[64:67], v[240:243]
  s_waitcnt vmcnt(11) lgkmcnt(5)
  v_fma_mix_f32 v31, v95, v103, v111 op_sel:[1,0,0] op_sel_hi:[1,0,0]
  v_cvt_pk_bf16_f32 v94, v28, v29
  v_cvt_pk_bf16_f32 v95, v30, v31
  v_mfma_f32_16x16x32_bf16 v[128:131], a[192:195], v[80:83], v[128:131]
  ds_read_b64_tr_b16 a[224:225], v8 offset:51200
  v_fma_mix_f32 v24, v32, v112, v120 op_sel:[0,0,0] op_sel_hi:[1,0,0]
  v_mfma_f32_16x16x32_bf16 v[132:135], a[192:195], v[84:87], v[132:135]
  s_xor_b32 s34, s1, 9216
  ds_read_b64_tr_b16 a[226:227], v8 offset:52224
  v_fma_mix_f32 v25, v32, v113, v121 op_sel:[1,0,0] op_sel_hi:[1,0,0]
  v_fma_mix_f32 v26, v33, v114, v122 op_sel:[0,0,0] op_sel_hi:[1,0,0]
  v_mfma_f32_16x16x32_bf16 v[136:139], a[192:195], v[88:91], v[136:139]
  buffer_load_dwordx4 v[64:67], v19, s[16:19], s34 offen sc1
  v_mfma_f32_16x16x32_bf16 v[140:143], a[192:195], v[92:95], v[140:143]
  ds_read_b64_tr_b16 a[228:229], v8 offset:51208
  v_fma_mix_f32 v27, v33, v115, v123 op_sel:[1,0,0] op_sel_hi:[1,0,0]
  v_cvt_pk_bf16_f32 v32, v24, v25
  v_mfma_f32_16x16x32_bf16 v[156:159], a[196:199], v[92:95], v[156:159]
  ds_read_b64_tr_b16 a[230:231], v8 offset:52232
  v_cvt_pk_bf16_f32 v33, v26, v27
  v_mfma_f32_16x16x32_bf16 v[152:155], a[196:199], v[88:91], v[152:155]
  s_xor_b32 s35, s1, 25600
  ds_read_b64_tr_b16 a[232:233], v9 offset:51200
  v_fma_mix_f32 v28, v34, v116, v124 op_sel:[0,0,0] op_sel_hi:[1,0,0]
  v_fma_mix_f32 v29, v34, v117, v125 op_sel:[1,0,0] op_sel_hi:[1,0,0]
  v_mfma_f32_16x16x32_bf16 v[148:151], a[196:199], v[84:87], v[148:151]
  buffer_load_dwordx4 v[68:71], v19, s[16:19], s35 offen sc1
  v_mfma_f32_16x16x32_bf16 v[144:147], a[196:199], v[80:83], v[144:147]
  s_waitcnt lgkmcnt(15)
  v_fma_mix_f32 v30, v35, v118, v126 op_sel:[0,0,0] op_sel_hi:[1,0,0]
  v_fma_mix_f32 v31, v35, v119, v127 op_sel:[1,0,0] op_sel_hi:[1,0,0]
  v_cvt_pk_bf16_f32 v34, v28, v29
  v_mfma_f32_16x16x32_bf16 v[160:163], a[200:203], v[80:83], v[160:163]
  ds_read_b128 v[96:99], v12 offset:3072
  v_cvt_pk_bf16_f32 v35, v30, v31
  v_mfma_f32_16x16x32_bf16 v[164:167], a[200:203], v[84:87], v[164:167]
  s_waitcnt vmcnt(12)
  ds_read_b64_tr_b16 a[234:235], v9 offset:52224
  v_fma_mix_f32 v24, v36, v112, v120 op_sel:[0,0,0] op_sel_hi:[1,0,0]
  v_fma_mix_f32 v25, v36, v113, v121 op_sel:[1,0,0] op_sel_hi:[1,0,0]
  v_mfma_f32_16x16x32_bf16 v[168:171], a[200:203], v[88:91], v[168:171]
  s_xor_b32 s36, s1, 41984
  ds_read_b64_tr_b16 a[236:237], v9 offset:51208
  v_fma_mix_f32 v26, v37, v114, v122 op_sel:[0,0,0] op_sel_hi:[1,0,0]
  v_mfma_f32_16x16x32_bf16 v[172:175], a[200:203], v[92:95], v[172:175]
  buffer_load_dwordx4 v[72:75], v19, s[16:19], s36 offen sc1
  v_fma_mix_f32 v27, v37, v115, v123 op_sel:[1,0,0] op_sel_hi:[1,0,0]
  v_mfma_f32_16x16x32_bf16 v[188:191], a[204:207], v[92:95], v[188:191]
  ds_read_b128 v[100:103], v12 offset:3088
  v_cvt_pk_bf16_f32 v36, v24, v25
  v_mfma_f32_16x16x32_bf16 v[184:187], a[204:207], v[88:91], v[184:187]
  ds_read_b64_tr_b16 a[238:239], v9 offset:52232
  v_cvt_pk_bf16_f32 v37, v26, v27
  v_fma_mix_f32 v28, v38, v116, v124 op_sel:[0,0,0] op_sel_hi:[1,0,0]
  v_mfma_f32_16x16x32_bf16 v[180:183], a[204:207], v[84:87], v[180:183]
  v_fma_mix_f32 v29, v38, v117, v125 op_sel:[1,0,0] op_sel_hi:[1,0,0]
  v_fma_mix_f32 v30, v39, v118, v126 op_sel:[0,0,0] op_sel_hi:[1,0,0]
  v_mfma_f32_16x16x32_bf16 v[176:179], a[204:207], v[80:83], v[176:179]
  s_waitcnt lgkmcnt(14)
  ds_read_b64_tr_b16 a[240:241], v10 offset:51200
  v_fma_mix_f32 v31, v39, v119, v127 op_sel:[1,0,0] op_sel_hi:[1,0,0]
  v_cvt_pk_bf16_f32 v38, v28, v29
  v_mfma_f32_16x16x32_bf16 v[192:195], a[208:211], v[80:83], v[192:195]
  s_xor_b32 s37, s1, 58368
  ds_read_b128 v[104:107], v12 offset:1024
  v_cvt_pk_bf16_f32 v39, v30, v31
  v_mfma_f32_16x16x32_bf16 v[196:199], a[208:211], v[84:87], v[196:199]
  s_waitcnt vmcnt(12)
  buffer_load_dwordx4 v[76:79], v19, s[16:19], s37 offen sc1
  v_fma_mix_f32 v24, v40, v112, v120 op_sel:[0,0,0] op_sel_hi:[1,0,0]
  v_mfma_f32_16x16x32_bf16 v[200:203], a[208:211], v[88:91], v[200:203]
  ds_read_b64_tr_b16 a[242:243], v10 offset:52224
  v_fma_mix_f32 v25, v40, v113, v121 op_sel:[1,0,0] op_sel_hi:[1,0,0]
  v_mfma_f32_16x16x32_bf16 v[204:207], a[208:211], v[92:95], v[204:207]
  s_mov_b32 s30, 3145728
  ds_read_b64_tr_b16 a[244:245], v10 offset:51208
  v_fma_mix_f32 v26, v41, v114, v122 op_sel:[0,0,0] op_sel_hi:[1,0,0]
  v_fma_mix_f32 v27, v41, v115, v123 op_sel:[1,0,0] op_sel_hi:[1,0,0]
  v_mfma_f32_16x16x32_bf16 v[220:223], a[212:215], v[92:95], v[220:223]
L_attn_st3:
  s_cbranch_vccnz L_attn_st6
  s_add_u32 m0, s26, 32768
  ds_read_b128 v[108:111], v12 offset:1040
  v_cvt_pk_bf16_f32 v40, v24, v25
  v_mfma_f32_16x16x32_bf16 v[216:219], a[212:215], v[88:91], v[216:219]
  buffer_load_dwordx4 v18, s[12:15], s30 offen offset:0 lds
  v_cvt_pk_bf16_f32 v41, v26, v27
  v_mfma_f32_16x16x32_bf16 v[212:215], a[212:215], v[84:87], v[212:215]
  v_fma_mix_f32 v28, v42, v116, v124 op_sel:[0,0,0] op_sel_hi:[1,0,0]
  v_fma_mix_f32 v29, v42, v117, v125 op_sel:[1,0,0] op_sel_hi:[1,0,0]
  v_mfma_f32_16x16x32_bf16 v[208:211], a[212:215], v[80:83], v[208:211]
  s_waitcnt lgkmcnt(15)
  ds_read_b64_tr_b16 a[246:247], v10 offset:52232
  v_fma_mix_f32 v30, v43, v118, v126 op_sel:[0,0,0] op_sel_hi:[1,0,0]
  v_fma_mix_f32 v31, v43, v119, v127 op_sel:[1,0,0] op_sel_hi:[1,0,0]
  v_mfma_f32_16x16x32_bf16 v[224:227], a[216:219], v[80:83], v[224:227]
  s_waitcnt vmcnt(13)
  ds_read_b64_tr_b16 a[248:249], v11 offset:51200
  v_cvt_pk_bf16_f32 v42, v28, v29
  v_mfma_f32_16x16x32_bf16 v[228:231], a[216:219], v[84:87], v[228:231]
  s_mov_b32 s31, 3177472
  ds_read_b64_tr_b16 a[250:251], v11 offset:52224
  v_cvt_pk_bf16_f32 v43, v30, v31
  v_fma_mix_f32 v24, v44, v112, v120 op_sel:[0,0,0] op_sel_hi:[1,0,0]
  v_mfma_f32_16x16x32_bf16 v[232:235], a[216:219], v[88:91], v[232:235]
  buffer_load_dwordx4 v18, s[12:15], s31 offen offset:1024 lds
  v_mfma_f32_16x16x32_bf16 v[236:239], a[216:219], v[92:95], v[236:239]
  ds_read_b64_tr_b16 a[252:253], v11 offset:51208
  v_fma_mix_f32 v25, v44, v113, v121 op_sel:[1,0,0] op_sel_hi:[1,0,0]
  v_fma_mix_f32 v26, v45, v114, v122 op_sel:[0,0,0] op_sel_hi:[1,0,0]
  v_mfma_f32_16x16x32_bf16 v[252:255], a[220:223], v[92:95], v[252:255]
  ds_read_b64_tr_b16 a[254:255], v11 offset:52232
  v_fma_mix_f32 v27, v45, v115, v123 op_sel:[1,0,0] op_sel_hi:[1,0,0]
  v_mfma_f32_16x16x32_bf16 v[248:251], a[220:223], v[88:91], v[248:251]
  v_cvt_pk_bf16_f32 v44, v24, v25
  v_cvt_pk_bf16_f32 v45, v26, v27
  v_fma_mix_f32 v28, v46, v116, v124 op_sel:[0,0,0] op_sel_hi:[1,0,0]
  v_mfma_f32_16x16x32_bf16 v[244:247], a[220:223], v[84:87], v[244:247]
  v_fma_mix_f32 v29, v46, v117, v125 op_sel:[1,0,0] op_sel_hi:[1,0,0]
  v_fma_mix_f32 v30, v47, v118, v126 op_sel:[0,0,0] op_sel_hi:[1,0,0]
  v_mfma_f32_16x16x32_bf16 v[240:243], a[220:223], v[80:83], v[240:243]
  s_waitcnt vmcnt(11) lgkmcnt(5)
  v_fma_mix_f32 v31, v47, v119, v127 op_sel:[1,0,0] op_sel_hi:[1,0,0]
  v_cvt_pk_bf16_f32 v46, v28, v29
  v_cvt_pk_bf16_f32 v47, v30, v31
  v_mfma_f32_16x16x32_bf16 v[128:131], a[224:227], v[32:35], v[128:131]
  s_waitcnt vmcnt(18)
  s_barrier
  ds_read_b64_tr_b16 a[192:193], v8 offset:0
  v_fma_mix_f32 v24, v48, v96, v104 op_sel:[0,0,0] op_sel_hi:[1,0,0]
  v_mfma_f32_16x16x32_bf16 v[132:135], a[224:227], v[36:39], v[132:135]
  s_xor_b32 s34, s1, 10240
  ds_read_b64_tr_b16 a[194:195], v8 offset:1024
  v_fma_mix_f32 v25, v48, v97, v105 op_sel:[1,0,0] op_sel_hi:[1,0,0]
  v_fma_mix_f32 v26, v49, v98, v106 op_sel:[0,0,0] op_sel_hi:[1,0,0]
  v_mfma_f32_16x16x32_bf16 v[136:139], a[224:227], v[40:43], v[136:139]
  buffer_load_dwordx4 v[80:83], v19, s[16:19], s34 offen sc1
  v_mfma_f32_16x16x32_bf16 v[140:143], a[224:227], v[44:47], v[140:143]
  ds_read_b64_tr_b16 a[196:197], v8 offset:8
  v_fma_mix_f32 v27, v49, v99, v107 op_sel:[1,0,0] op_sel_hi:[1,0,0]
  v_cvt_pk_bf16_f32 v48, v24, v25
  v_mfma_f32_16x16x32_bf16 v[156:159], a[228:231], v[44:47], v[156:159]
  ds_read_b64_tr_b16 a[198:199], v8 offset:1032
  v_cvt_pk_bf16_f32 v49, v26, v27
  v_mfma_f32_16x16x32_bf16 v[152:155], a[228:231], v[40:43], v[152:155]
  s_xor_b32 s35, s1, 26624
  ds_read_b64_tr_b16 a[200:201], v9 offset:0
  v_fma_mix_f32 v28, v50, v100, v108 op_sel:[0,0,0] op_sel_hi:[1,0,0]
  v_fma_mix_f32 v29, v50, v101, v109 op_sel:[1,0,0] op_sel_hi:[1,0,0]
  v_mfma_f32_16x16x32_bf16 v[148:151], a[228:231], v[36:39], v[148:151]
  buffer_load_dwordx4 v[84:87], v19, s[16:19], s35 offen sc1
  v_mfma_f32_16x16x32_bf16 v[144:147], a[228:231], v[32:35], v[144:147]
  s_waitcnt lgkmcnt(15)
  v_fma_mix_f32 v30, v51, v102, v110 op_sel:[0,0,0] op_sel_hi:[1,0,0]
  v_fma_mix_f32 v31, v51, v103, v111 op_sel:[1,0,0] op_sel_hi:[1,0,0]
  v_cvt_pk_bf16_f32 v50, v28, v29
  v_mfma_f32_16x16x32_bf16 v[160:163], a[232:235], v[32:35], v[160:163]
  ds_read_b128 v[112:115], v12 offset:3104
  v_cvt_pk_bf16_f32 v51, v30, v31
  v_mfma_f32_16x16x32_bf16 v[164:167], a[232:235], v[36:39], v[164:167]
  s_waitcnt vmcnt(12)
  ds_read_b64_tr_b16 a[202:203], v9 offset:1024
  v_fma_mix_f32 v24, v52, v96, v104 op_sel:[0,0,0] op_sel_hi:[1,0,0]
  v_fma_mix_f32 v25, v52, v97, v105 op_sel:[1,0,0] op_sel_hi:[1,0,0]
  v_mfma_f32_16x16x32_bf16 v[168:171], a[232:235], v[40:43], v[168:171]
  s_xor_b32 s36, s1, 43008
  ds_read_b64_tr_b16 a[204:205], v9 offset:8
  v_fma_mix_f32 v26, v53, v98, v106 op_sel:[0,0,0] op_sel_hi:[1,0,0]
  v_mfma_f32_16x16x32_bf16 v[172:175], a[232:235], v[44:47], v[172:175]
  buffer_load_dwordx4 v[88:91], v19, s[16:19], s36 offen sc1
  v_fma_mix_f32 v27, v53, v99, v107 op_sel:[1,0,0] op_sel_hi:[1,0,0]
  v_mfma_f32_16x16x32_bf16 v[188:191], a[236:239], v[44:47], v[188:191]
  ds_read_b128 v[116:119], v12 offset:3120
  v_cvt_pk_bf16_f32 v52, v24, v25
  v_mfma_f32_16x16x32_bf16 v[184:187], a[236:239], v[40:43], v[184:187]
  ds_read_b64_tr_b16 a[206:207], v9 offset:1032
  v_cvt_pk_bf16_f32 v53, v26, v27
  v_fma_mix_f32 v28, v54, v100, v108 op_sel:[0,0,0] op_sel_hi:[1,0,0]
  v_mfma_f32_16x16x32_bf16 v[180:183], a[236:239], v[36:39], v[180:183]
  v_fma_mix_f32 v29, v54, v101, v109 op_sel:[1,0,0] op_sel_hi:[1,0,0]
  v_fma_mix_f32 v30, v55, v102, v110 op_sel:[0,0,0] op_sel_hi:[1,0,0]
  v_mfma_f32_16x16x32_bf16 v[176:179], a[236:239], v[32:35], v[176:179]
  s_waitcnt lgkmcnt(14)
  ds_read_b64_tr_b16 a[208:209], v10 offset:0
  v_fma_mix_f32 v31, v55, v103, v111 op_sel:[1,0,0] op_sel_hi:[1,0,0]
  v_cvt_pk_bf16_f32 v54, v28, v29
  v_mfma_f32_16x16x32_bf16 v[192:195], a[240:243], v[32:35], v[192:195]
  s_xor_b32 s37, s1, 59392
  ds_read_b128 v[120:123], v12 offset:1056
  v_cvt_pk_bf16_f32 v55, v30, v31
  v_mfma_f32_16x16x32_bf16 v[196:199], a[240:243], v[36:39], v[196:199]
  s_waitcnt vmcnt(12)
  buffer_load_dwordx4 v[92:95], v19, s[16:19], s37 offen sc1
  v_fma_mix_f32 v24, v56, v96, v104 op_sel:[0,0,0] op_sel_hi:[1,0,0]
  v_mfma_f32_16x16x32_bf16 v[200:203], a[240:243], v[40:43], v[200:203]
  ds_read_b64_tr_b16 a[210:211], v10 offset:1024
  v_fma_mix_f32 v25, v56, v97, v105 op_sel:[1,0,0] op_sel_hi:[1,0,0]
  v_mfma_f32_16x16x32_bf16 v[204:207], a[240:243], v[44:47], v[204:207]
  s_mov_b32 s32, 3209216
  ds_read_b64_tr_b16 a[212:213], v10 offset:8
  v_fma_mix_f32 v26, v57, v98, v106 op_sel:[0,0,0] op_sel_hi:[1,0,0]
  v_fma_mix_f32 v27, v57, v99, v107 op_sel:[1,0,0] op_sel_hi:[1,0,0]
  v_mfma_f32_16x16x32_bf16 v[220:223], a[244:247], v[44:47], v[220:223]
  s_add_u32 m0, s26, 32768
  ds_read_b128 v[124:127], v12 offset:1072
  v_cvt_pk_bf16_f32 v56, v24, v25
  v_mfma_f32_16x16x32_bf16 v[216:219], a[244:247], v[40:43], v[216:219]
  buffer_load_dwordx4 v18, s[12:15], s32 offen offset:2048 lds
  v_cvt_pk_bf16_f32 v57, v26, v27
  v_mfma_f32_16x16x32_bf16 v[212:215], a[244:247], v[36:39], v[212:215]
  v_fma_mix_f32 v28, v58, v100, v108 op_sel:[0,0,0] op_sel_hi:[1,0,0]
  v_fma_mix_f32 v29, v58, v101, v109 op_sel:[1,0,0] op_sel_hi:[1,0,0]
  v_mfma_f32_16x16x32_bf16 v[208:211], a[244:247], v[32:35], v[208:211]
  s_waitcnt lgkmcnt(15)
  ds_read_b64_tr_b16 a[214:215], v10 offset:1032
  v_fma_mix_f32 v30, v59, v102, v110 op_sel:[0,0,0] op_sel_hi:[1,0,0]
  v_fma_mix_f32 v31, v59, v103, v111 op_sel:[1,0,0] op_sel_hi:[1,0,0]
  v_mfma_f32_16x16x32_bf16 v[224:227], a[248:251], v[32:35], v[224:227]
  s_waitcnt vmcnt(13)
  ds_read_b64_tr_b16 a[216:217], v11 offset:0
  v_cvt_pk_bf16_f32 v58, v28, v29
  v_mfma_f32_16x16x32_bf16 v[228:231], a[248:251], v[36:39], v[228:231]
  s_mov_b32 s33, 3240960
  ds_read_b64_tr_b16 a[218:219], v11 offset:1024
  v_cvt_pk_bf16_f32 v59, v30, v31
  v_fma_mix_f32 v24, v60, v96, v104 op_sel:[0,0,0] op_sel_hi:[1,0,0]
  v_mfma_f32_16x16x32_bf16 v[232:235], a[248:251], v[40:43], v[232:235]
  buffer_load_dwordx4 v18, s[12:15], s33 offen offset:3072 lds
  v_mfma_f32_16x16x32_bf16 v[236:239], a[248:251], v[44:47], v[236:239]
  ds_read_b64_tr_b16 a[220:221], v11 offset:8
  v_fma_mix_f32 v25, v60, v97, v105 op_sel:[1,0,0] op_sel_hi:[1,0,0]
  v_fma_mix_f32 v26, v61, v98, v106 op_sel:[0,0,0] op_sel_hi:[1,0,0]
  v_mfma_f32_16x16x32_bf16 v[252:255], a[252:255], v[44:47], v[252:255]
  ds_read_b64_tr_b16 a[222:223], v11 offset:1032
  v_fma_mix_f32 v27, v61, v99, v107 op_sel:[1,0,0] op_sel_hi:[1,0,0]
  v_mfma_f32_16x16x32_bf16 v[248:251], a[252:255], v[40:43], v[248:251]
  v_cvt_pk_bf16_f32 v60, v24, v25
  v_cvt_pk_bf16_f32 v61, v26, v27
  v_fma_mix_f32 v28, v62, v100, v108 op_sel:[0,0,0] op_sel_hi:[1,0,0]
  v_mfma_f32_16x16x32_bf16 v[244:247], a[252:255], v[36:39], v[244:247]
  v_fma_mix_f32 v29, v62, v101, v109 op_sel:[1,0,0] op_sel_hi:[1,0,0]
  v_fma_mix_f32 v30, v63, v102, v110 op_sel:[0,0,0] op_sel_hi:[1,0,0]
  v_mfma_f32_16x16x32_bf16 v[240:243], a[252:255], v[32:35], v[240:243]
  s_waitcnt vmcnt(11) lgkmcnt(5)
  v_fma_mix_f32 v31, v63, v103, v111 op_sel:[1,0,0] op_sel_hi:[1,0,0]
  v_cvt_pk_bf16_f32 v62, v28, v29
  v_cvt_pk_bf16_f32 v63, v30, v31
  v_mfma_f32_16x16x32_bf16 v[128:131], a[192:195], v[48:51], v[128:131]
  ds_read_b64_tr_b16 a[224:225], v8 offset:2048
  v_fma_mix_f32 v24, v64, v112, v120 op_sel:[0,0,0] op_sel_hi:[1,0,0]
  v_mfma_f32_16x16x32_bf16 v[132:135], a[192:195], v[52:55], v[132:135]
  s_xor_b32 s34, s1, 11264
  ds_read_b64_tr_b16 a[226:227], v8 offset:3072
  v_fma_mix_f32 v25, v64, v113, v121 op_sel:[1,0,0] op_sel_hi:[1,0,0]
  v_fma_mix_f32 v26, v65, v114, v122 op_sel:[0,0,0] op_sel_hi:[1,0,0]
  v_mfma_f32_16x16x32_bf16 v[136:139], a[192:195], v[56:59], v[136:139]
  buffer_load_dwordx4 v[32:35], v19, s[16:19], s34 offen sc1
  v_mfma_f32_16x16x32_bf16 v[140:143], a[192:195], v[60:63], v[140:143]
  ds_read_b64_tr_b16 a[228:229], v8 offset:2056
  v_fma_mix_f32 v27, v65, v115, v123 op_sel:[1,0,0] op_sel_hi:[1,0,0]
  v_cvt_pk_bf16_f32 v64, v24, v25
  v_mfma_f32_16x16x32_bf16 v[156:159], a[196:199], v[60:63], v[156:159]
  ds_read_b64_tr_b16 a[230:231], v8 offset:3080
  v_cvt_pk_bf16_f32 v65, v26, v27
  v_mfma_f32_16x16x32_bf16 v[152:155], a[196:199], v[56:59], v[152:155]
  s_xor_b32 s35, s1, 27648
  ds_read_b64_tr_b16 a[232:233], v9 offset:2048
  v_fma_mix_f32 v28, v66, v116, v124 op_sel:[0,0,0] op_sel_hi:[1,0,0]
  v_fma_mix_f32 v29, v66, v117, v125 op_sel:[1,0,0] op_sel_hi:[1,0,0]
  v_mfma_f32_16x16x32_bf16 v[148:151], a[196:199], v[52:55], v[148:151]
  buffer_load_dwordx4 v[36:39], v19, s[16:19], s35 offen sc1
  v_mfma_f32_16x16x32_bf16 v[144:147], a[196:199], v[48:51], v[144:147]
  s_waitcnt lgkmcnt(15)
  v_fma_mix_f32 v30, v67, v118, v126 op_sel:[0,0,0] op_sel_hi:[1,0,0]
  v_fma_mix_f32 v31, v67, v119, v127 op_sel:[1,0,0] op_sel_hi:[1,0,0]
  v_cvt_pk_bf16_f32 v66, v28, v29
  v_mfma_f32_16x16x32_bf16 v[160:163], a[200:203], v[48:51], v[160:163]
  ds_read_b128 v[96:99], v12 offset:3328
  v_cvt_pk_bf16_f32 v67, v30, v31
  v_mfma_f32_16x16x32_bf16 v[164:167], a[200:203], v[52:55], v[164:167]
  s_waitcnt vmcnt(12)
  ds_read_b64_tr_b16 a[234:235], v9 offset:3072
  v_fma_mix_f32 v24, v68, v112, v120 op_sel:[0,0,0] op_sel_hi:[1,0,0]
  v_fma_mix_f32 v25, v68, v113, v121 op_sel:[1,0,0] op_sel_hi:[1,0,0]
  v_mfma_f32_16x16x32_bf16 v[168:171], a[200:203], v[56:59], v[168:171]
  s_xor_b32 s36, s1, 44032
  ds_read_b64_tr_b16 a[236:237], v9 offset:2056
  v_fma_mix_f32 v26, v69, v114, v122 op_sel:[0,0,0] op_sel_hi:[1,0,0]
  v_mfma_f32_16x16x32_bf16 v[172:175], a[200:203], v[60:63], v[172:175]
  buffer_load_dwordx4 v[40:43], v19, s[16:19], s36 offen sc1
  v_fma_mix_f32 v27, v69, v115, v123 op_sel:[1,0,0] op_sel_hi:[1,0,0]
  v_mfma_f32_16x16x32_bf16 v[188:191], a[204:207], v[60:63], v[188:191]
  ds_read_b128 v[100:103], v12 offset:3344
  v_cvt_pk_bf16_f32 v68, v24, v25
  v_mfma_f32_16x16x32_bf16 v[184:187], a[204:207], v[56:59], v[184:187]
  ds_read_b64_tr_b16 a[238:239], v9 offset:3080
  v_cvt_pk_bf16_f32 v69, v26, v27
  v_fma_mix_f32 v28, v70, v116, v124 op_sel:[0,0,0] op_sel_hi:[1,0,0]
  v_mfma_f32_16x16x32_bf16 v[180:183], a[204:207], v[52:55], v[180:183]
  v_fma_mix_f32 v29, v70, v117, v125 op_sel:[1,0,0] op_sel_hi:[1,0,0]
  v_fma_mix_f32 v30, v71, v118, v126 op_sel:[0,0,0] op_sel_hi:[1,0,0]
  v_mfma_f32_16x16x32_bf16 v[176:179], a[204:207], v[48:51], v[176:179]
  s_waitcnt lgkmcnt(14)
  ds_read_b64_tr_b16 a[240:241], v10 offset:2048
  v_fma_mix_f32 v31, v71, v119, v127 op_sel:[1,0,0] op_sel_hi:[1,0,0]
  v_cvt_pk_bf16_f32 v70, v28, v29
  v_mfma_f32_16x16x32_bf16 v[192:195], a[208:211], v[48:51], v[192:195]
  s_xor_b32 s37, s1, 60416
  ds_read_b128 v[104:107], v12 offset:1280
  v_cvt_pk_bf16_f32 v71, v30, v31
  v_mfma_f32_16x16x32_bf16 v[196:199], a[208:211], v[52:55], v[196:199]
  s_waitcnt vmcnt(12)
  buffer_load_dwordx4 v[44:47], v19, s[16:19], s37 offen sc1
  v_fma_mix_f32 v24, v72, v112, v120 op_sel:[0,0,0] op_sel_hi:[1,0,0]
  v_mfma_f32_16x16x32_bf16 v[200:203], a[208:211], v[56:59], v[200:203]
  ds_read_b64_tr_b16 a[242:243], v10 offset:3072
  v_fma_mix_f32 v25, v72, v113, v121 op_sel:[1,0,0] op_sel_hi:[1,0,0]
  v_mfma_f32_16x16x32_bf16 v[204:207], a[208:211], v[60:63], v[204:207]
  s_mov_b32 s30, 3670016
  ds_read_b64_tr_b16 a[244:245], v10 offset:2056
  v_fma_mix_f32 v26, v73, v114, v122 op_sel:[0,0,0] op_sel_hi:[1,0,0]
  v_fma_mix_f32 v27, v73, v115, v123 op_sel:[1,0,0] op_sel_hi:[1,0,0]
  v_mfma_f32_16x16x32_bf16 v[220:223], a[212:215], v[60:63], v[220:223]
  s_add_u32 m0, s26, 49152
  ds_read_b128 v[108:111], v12 offset:1296
  v_cvt_pk_bf16_f32 v72, v24, v25
  v_mfma_f32_16x16x32_bf16 v[216:219], a[212:215], v[56:59], v[216:219]
  buffer_load_dwordx4 v18, s[12:15], s30 offen offset:0 lds
  v_cvt_pk_bf16_f32 v73, v26, v27
  v_mfma_f32_16x16x32_bf16 v[212:215], a[212:215], v[52:55], v[212:215]
  v_fma_mix_f32 v28, v74, v116, v124 op_sel:[0,0,0] op_sel_hi:[1,0,0]
  v_fma_mix_f32 v29, v74, v117, v125 op_sel:[1,0,0] op_sel_hi:[1,0,0]
  v_mfma_f32_16x16x32_bf16 v[208:211], a[212:215], v[48:51], v[208:211]
  s_waitcnt lgkmcnt(15)
  ds_read_b64_tr_b16 a[246:247], v10 offset:3080
  v_fma_mix_f32 v30, v75, v118, v126 op_sel:[0,0,0] op_sel_hi:[1,0,0]
  v_fma_mix_f32 v31, v75, v119, v127 op_sel:[1,0,0] op_sel_hi:[1,0,0]
  v_mfma_f32_16x16x32_bf16 v[224:227], a[216:219], v[48:51], v[224:227]
  s_waitcnt vmcnt(13)
  ds_read_b64_tr_b16 a[248:249], v11 offset:2048
  v_cvt_pk_bf16_f32 v74, v28, v29
  v_mfma_f32_16x16x32_bf16 v[228:231], a[216:219], v[52:55], v[228:231]
  s_mov_b32 s31, 3701760
  ds_read_b64_tr_b16 a[250:251], v11 offset:3072
  v_cvt_pk_bf16_f32 v75, v30, v31
  v_fma_mix_f32 v24, v76, v112, v120 op_sel:[0,0,0] op_sel_hi:[1,0,0]
  v_mfma_f32_16x16x32_bf16 v[232:235], a[216:219], v[56:59], v[232:235]
  buffer_load_dwordx4 v18, s[12:15], s31 offen offset:1024 lds
  v_mfma_f32_16x16x32_bf16 v[236:239], a[216:219], v[60:63], v[236:239]
  ds_read_b64_tr_b16 a[252:253], v11 offset:2056
  v_fma_mix_f32 v25, v76, v113, v121 op_sel:[1,0,0] op_sel_hi:[1,0,0]
  v_fma_mix_f32 v26, v77, v114, v122 op_sel:[0,0,0] op_sel_hi:[1,0,0]
  v_mfma_f32_16x16x32_bf16 v[252:255], a[220:223], v[60:63], v[252:255]
  ds_read_b64_tr_b16 a[254:255], v11 offset:3080
  v_fma_mix_f32 v27, v77, v115, v123 op_sel:[1,0,0] op_sel_hi:[1,0,0]
  v_mfma_f32_16x16x32_bf16 v[248:251], a[220:223], v[56:59], v[248:251]
  v_cvt_pk_bf16_f32 v76, v24, v25
  v_cvt_pk_bf16_f32 v77, v26, v27
  v_fma_mix_f32 v28, v78, v116, v124 op_sel:[0,0,0] op_sel_hi:[1,0,0]
  v_mfma_f32_16x16x32_bf16 v[244:247], a[220:223], v[52:55], v[244:247]
  v_fma_mix_f32 v29, v78, v117, v125 op_sel:[1,0,0] op_sel_hi:[1,0,0]
  v_fma_mix_f32 v30, v79, v118, v126 op_sel:[0,0,0] op_sel_hi:[1,0,0]
  v_mfma_f32_16x16x32_bf16 v[240:243], a[220:223], v[48:51], v[240:243]
  s_waitcnt vmcnt(11) lgkmcnt(5)
  v_fma_mix_f32 v31, v79, v119, v127 op_sel:[1,0,0] op_sel_hi:[1,0,0]
  v_cvt_pk_bf16_f32 v78, v28, v29
  v_cvt_pk_bf16_f32 v79, v30, v31
  v_mfma_f32_16x16x32_bf16 v[128:131], a[224:227], v[64:67], v[128:131]
  s_waitcnt vmcnt(18)
  s_barrier
  ds_read_b64_tr_b16 a[192:193], v8 offset:16384
  v_fma_mix_f32 v24, v80, v96, v104 op_sel:[0,0,0] op_sel_hi:[1,0,0]
  v_mfma_f32_16x16x32_bf16 v[132:135], a[224:227], v[68:71], v[132:135]
  s_xor_b32 s34, s1, 12288
  ds_read_b64_tr_b16 a[194:195], v8 offset:17408
  v_fma_mix_f32 v25, v80, v97, v105 op_sel:[1,0,0] op_sel_hi:[1,0,0]
  v_fma_mix_f32 v26, v81, v98, v106 op_sel:[0,0,0] op_sel_hi:[1,0,0]
  v_mfma_f32_16x16x32_bf16 v[136:139], a[224:227], v[72:75], v[136:139]
  buffer_load_dwordx4 v[48:51], v19, s[16:19], s34 offen sc1
  v_mfma_f32_16x16x32_bf16 v[140:143], a[224:227], v[76:79], v[140:143]
  ds_read_b64_tr_b16 a[196:197], v8 offset:16392
  v_fma_mix_f32 v27, v81, v99, v107 op_sel:[1,0,0] op_sel_hi:[1,0,0]
  v_cvt_pk_bf16_f32 v80, v24, v25
  v_mfma_f32_16x16x32_bf16 v[156:159], a[228:231], v[76:79], v[156:159]
  ds_read_b64_tr_b16 a[198:199], v8 offset:17416
  v_cvt_pk_bf16_f32 v81, v26, v27
  v_mfma_f32_16x16x32_bf16 v[152:155], a[228:231], v[72:75], v[152:155]
  s_xor_b32 s35, s1, 28672
  ds_read_b64_tr_b16 a[200:201], v9 offset:16384
  v_fma_mix_f32 v28, v82, v100, v108 op_sel:[0,0,0] op_sel_hi:[1,0,0]
  v_fma_mix_f32 v29, v82, v101, v109 op_sel:[1,0,0] op_sel_hi:[1,0,0]
  v_mfma_f32_16x16x32_bf16 v[148:151], a[228:231], v[68:71], v[148:151]
  buffer_load_dwordx4 v[52:55], v19, s[16:19], s35 offen sc1
  v_mfma_f32_16x16x32_bf16 v[144:147], a[228:231], v[64:67], v[144:147]
  s_waitcnt lgkmcnt(15)
  v_fma_mix_f32 v30, v83, v102, v110 op_sel:[0,0,0] op_sel_hi:[1,0,0]
  v_fma_mix_f32 v31, v83, v103, v111 op_sel:[1,0,0] op_sel_hi:[1,0,0]
  v_cvt_pk_bf16_f32 v82, v28, v29
  v_mfma_f32_16x16x32_bf16 v[160:163], a[232:235], v[64:67], v[160:163]
  ds_read_b128 v[112:115], v12 offset:3360
  v_cvt_pk_bf16_f32 v83, v30, v31
  v_mfma_f32_16x16x32_bf16 v[164:167], a[232:235], v[68:71], v[164:167]
  s_waitcnt vmcnt(12)
  ds_read_b64_tr_b16 a[202:203], v9 offset:17408
  v_fma_mix_f32 v24, v84, v96, v104 op_sel:[0,0,0] op_sel_hi:[1,0,0]
  v_fma_mix_f32 v25, v84, v97, v105 op_sel:[1,0,0] op_sel_hi:[1,0,0]
  v_mfma_f32_16x16x32_bf16 v[168:171], a[232:235], v[72:75], v[168:171]
  s_xor_b32 s36, s1, 45056
  ds_read_b64_tr_b16 a[204:205], v9 offset:16392
  v_fma_mix_f32 v26, v85, v98, v106 op_sel:[0,0,0] op_sel_hi:[1,0,0]
  v_mfma_f32_16x16x32_bf16 v[172:175], a[232:235], v[76:79], v[172:175]
  buffer_load_dwordx4 v[56:59], v19, s[16:19], s36 offen sc1
  v_fma_mix_f32 v27, v85, v99, v107 op_sel:[1,0,0] op_sel_hi:[1,0,0]
  v_mfma_f32_16x16x32_bf16 v[188:191], a[236:239], v[76:79], v[188:191]
  ds_read_b128 v[116:119], v12 offset:3376
  v_cvt_pk_bf16_f32 v84, v24, v25
  v_mfma_f32_16x16x32_bf16 v[184:187], a[236:239], v[72:75], v[184:187]
  ds_read_b64_tr_b16 a[206:207], v9 offset:17416
  v_cvt_pk_bf16_f32 v85, v26, v27
  v_fma_mix_f32 v28, v86, v100, v108 op_sel:[0,0,0] op_sel_hi:[1,0,0]
  v_mfma_f32_16x16x32_bf16 v[180:183], a[236:239], v[68:71], v[180:183]
  v_fma_mix_f32 v29, v86, v101, v109 op_sel:[1,0,0] op_sel_hi:[1,0,0]
  v_fma_mix_f32 v30, v87, v102, v110 op_sel:[0,0,0] op_sel_hi:[1,0,0]
  v_mfma_f32_16x16x32_bf16 v[176:179], a[236:239], v[64:67], v[176:179]
  s_waitcnt lgkmcnt(14)
  ds_read_b64_tr_b16 a[208:209], v10 offset:16384
  v_fma_mix_f32 v31, v87, v103, v111 op_sel:[1,0,0] op_sel_hi:[1,0,0]
  v_cvt_pk_bf16_f32 v86, v28, v29
  v_mfma_f32_16x16x32_bf16 v[192:195], a[240:243], v[64:67], v[192:195]
  s_xor_b32 s37, s1, 61440
  ds_read_b128 v[120:123], v12 offset:1312
  v_cvt_pk_bf16_f32 v87, v30, v31
  v_mfma_f32_16x16x32_bf16 v[196:199], a[240:243], v[68:71], v[196:199]
  s_waitcnt vmcnt(12)
  buffer_load_dwordx4 v[60:63], v19, s[16:19], s37 offen sc1
  v_fma_mix_f32 v24, v88, v96, v104 op_sel:[0,0,0] op_sel_hi:[1,0,0]
  v_mfma_f32_16x16x32_bf16 v[200:203], a[240:243], v[72:75], v[200:203]
  ds_read_b64_tr_b16 a[210:211], v10 offset:17408
  v_fma_mix_f32 v25, v88, v97, v105 op_sel:[1,0,0] op_sel_hi:[1,0,0]
  v_mfma_f32_16x16x32_bf16 v[204:207], a[240:243], v[76:79], v[204:207]
  s_mov_b32 s32, 3733504
  ds_read_b64_tr_b16 a[212:213], v10 offset:16392
  v_fma_mix_f32 v26, v89, v98, v106 op_sel:[0,0,0] op_sel_hi:[1,0,0]
  v_fma_mix_f32 v27, v89, v99, v107 op_sel:[1,0,0] op_sel_hi:[1,0,0]
  v_mfma_f32_16x16x32_bf16 v[220:223], a[244:247], v[76:79], v[220:223]
  s_add_u32 m0, s26, 49152
  ds_read_b128 v[124:127], v12 offset:1328
  v_cvt_pk_bf16_f32 v88, v24, v25
  v_mfma_f32_16x16x32_bf16 v[216:219], a[244:247], v[72:75], v[216:219]
  buffer_load_dwordx4 v18, s[12:15], s32 offen offset:2048 lds
  v_cvt_pk_bf16_f32 v89, v26, v27
  v_mfma_f32_16x16x32_bf16 v[212:215], a[244:247], v[68:71], v[212:215]
  v_fma_mix_f32 v28, v90, v100, v108 op_sel:[0,0,0] op_sel_hi:[1,0,0]
  v_fma_mix_f32 v29, v90, v101, v109 op_sel:[1,0,0] op_sel_hi:[1,0,0]
  v_mfma_f32_16x16x32_bf16 v[208:211], a[244:247], v[64:67], v[208:211]
  s_waitcnt lgkmcnt(15)
  ds_read_b64_tr_b16 a[214:215], v10 offset:17416
  v_fma_mix_f32 v30, v91, v102, v110 op_sel:[0,0,0] op_sel_hi:[1,0,0]
  v_fma_mix_f32 v31, v91, v103, v111 op_sel:[1,0,0] op_sel_hi:[1,0,0]
  v_mfma_f32_16x16x32_bf16 v[224:227], a[248:251], v[64:67], v[224:227]
  s_waitcnt vmcnt(13)
  ds_read_b64_tr_b16 a[216:217], v11 offset:16384
  v_cvt_pk_bf16_f32 v90, v28, v29
  v_mfma_f32_16x16x32_bf16 v[228:231], a[248:251], v[68:71], v[228:231]
  s_mov_b32 s33, 3765248
  ds_read_b64_tr_b16 a[218:219], v11 offset:17408
  v_cvt_pk_bf16_f32 v91, v30, v31
  v_fma_mix_f32 v24, v92, v96, v104 op_sel:[0,0,0] op_sel_hi:[1,0,0]
  v_mfma_f32_16x16x32_bf16 v[232:235], a[248:251], v[72:75], v[232:235]
  buffer_load_dwordx4 v18, s[12:15], s33 offen offset:3072 lds
  v_mfma_f32_16x16x32_bf16 v[236:239], a[248:251], v[76:79], v[236:239]
  ds_read_b64_tr_b16 a[220:221], v11 offset:16392
  v_fma_mix_f32 v25, v92, v97, v105 op_sel:[1,0,0] op_sel_hi:[1,0,0]
  v_fma_mix_f32 v26, v93, v98, v106 op_sel:[0,0,0] op_sel_hi:[1,0,0]
  v_mfma_f32_16x16x32_bf16 v[252:255], a[252:255], v[76:79], v[252:255]
  ds_read_b64_tr_b16 a[222:223], v11 offset:17416
  v_fma_mix_f32 v27, v93, v99, v107 op_sel:[1,0,0] op_sel_hi:[1,0,0]
  v_mfma_f32_16x16x32_bf16 v[248:251], a[252:255], v[72:75], v[248:251]
  v_cvt_pk_bf16_f32 v92, v24, v25
  v_cvt_pk_bf16_f32 v93, v26, v27
  v_fma_mix_f32 v28, v94, v100, v108 op_sel:[0,0,0] op_sel_hi:[1,0,0]
  v_mfma_f32_16x16x32_bf16 v[244:247], a[252:255], v[68:71], v[244:247]
  v_fma_mix_f32 v29, v94, v101, v109 op_sel:[1,0,0] op_sel_hi:[1,0,0]
  v_fma_mix_f32 v30, v95, v102, v110 op_sel:[0,0,0] op_sel_hi:[1,0,0]
  v_mfma_f32_16x16x32_bf16 v[240:243], a[252:255], v[64:67], v[240:243]
  s_waitcnt vmcnt(11) lgkmcnt(5)
  v_fma_mix_f32 v31, v95, v103, v111 op_sel:[1,0,0] op_sel_hi:[1,0,0]
  v_cvt_pk_bf16_f32 v94, v28, v29
  v_cvt_pk_bf16_f32 v95, v30, v31
  v_mfma_f32_16x16x32_bf16 v[128:131], a[192:195], v[80:83], v[128:131]
  ds_read_b64_tr_b16 a[224:225], v8 offset:18432
  v_fma_mix_f32 v24, v32, v112, v120 op_sel:[0,0,0] op_sel_hi:[1,0,0]
  v_mfma_f32_16x16x32_bf16 v[132:135], a[192:195], v[84:87], v[132:135]
  s_xor_b32 s34, s1, 13312
  ds_read_b64_tr_b16 a[226:227], v8 offset:19456
  v_fma_mix_f32 v25, v32, v113, v121 op_sel:[1,0,0] op_sel_hi:[1,0,0]
  v_mfma_f32_16x16x32_bf16 v[136:139], a[192:195], v[88:91], v[136:139]
  buffer_load_dwordx4 v[64:67], v19, s[16:19], s34 offen sc1
  v_fma_mix_f32 v26, v33, v114, v122 op_sel:[0,0,0] op_sel_hi:[1,0,0]
  v_mfma_f32_16x16x32_bf16 v[140:143], a[192:195], v[92:95], v[140:143]
  ds_read_b64_tr_b16 a[228:229], v8 offset:18440
  v_fma_mix_f32 v27, v33, v115, v123 op_sel:[1,0,0] op_sel_hi:[1,0,0]
  v_mfma_f32_16x16x32_bf16 v[156:159], a[196:199], v[92:95], v[156:159]
  v_cvt_pk_bf16_f32 v32, v24, v25
  v_cvt_pk_bf16_f32 v33, v26, v27
  v_mfma_f32_16x16x32_bf16 v[152:155], a[196:199], v[88:91], v[152:155]
  ds_read_b64_tr_b16 a[230:231], v8 offset:19464
  v_fma_mix_f32 v28, v34, v116, v124 op_sel:[0,0,0] op_sel_hi:[1,0,0]
  v_fma_mix_f32 v29, v34, v117, v125 op_sel:[1,0,0] op_sel_hi:[1,0,0]
  v_mfma_f32_16x16x32_bf16 v[148:151], a[196:199], v[84:87], v[148:151]
  ds_read_b64_tr_b16 a[232:233], v9 offset:18432
  v_fma_mix_f32 v30, v35, v118, v126 op_sel:[0,0,0] op_sel_hi:[1,0,0]
  v_mfma_f32_16x16x32_bf16 v[144:147], a[196:199], v[80:83], v[144:147]
  s_waitcnt lgkmcnt(15)
  ds_read_b128 v[96:99], v12 offset:3584
  v_fma_mix_f32 v31, v35, v119, v127 op_sel:[1,0,0] op_sel_hi:[1,0,0]
  v_cvt_pk_bf16_f32 v34, v28, v29
  v_mfma_f32_16x16x32_bf16 v[160:163], a[200:203], v[80:83], v[160:163]
  s_waitcnt vmcnt(11)
  ds_read_b64_tr_b16 a[234:235], v9 offset:19456
  v_cvt_pk_bf16_f32 v35, v30, v31
  v_mfma_f32_16x16x32_bf16 v[164:167], a[200:203], v[84:87], v[164:167]
  s_xor_b32 s35, s1, 29696
  v_fma_mix_f32 v24, v36, v112, v120 op_sel:[0,0,0] op_sel_hi:[1,0,0]
  v_fma_mix_f32 v25, v36, v113, v121 op_sel:[1,0,0] op_sel_hi:[1,0,0]
  v_mfma_f32_16x16x32_bf16 v[168:171], a[200:203], v[88:91], v[168:171]
  buffer_load_dwordx4 v[68:71], v19, s[16:19], s35 offen sc1
  v_fma_mix_f32 v26, v37, v114, v122 op_sel:[0,0,0] op_sel_hi:[1,0,0]
  v_mfma_f32_16x16x32_bf16 v[172:175], a[200:203], v[92:95], v[172:175]
  ds_read_b64_tr_b16 a[236:237], v9 offset:18440
  v_fma_mix_f32 v27, v37, v115, v123 op_sel:[1,0,0] op_sel_hi:[1,0,0]
  v_mfma_f32_16x16x32_bf16 v[188:191], a[204:207], v[92:95], v[188:191]
  ds_read_b128 v[100:103], v12 offset:3600
  v_cvt_pk_bf16_f32 v36, v24, v25
  v_mfma_f32_16x16x32_bf16 v[184:187], a[204:207], v[88:91], v[184:187]
  ds_read_b64_tr_b16 a[238:239], v9 offset:19464
  v_cvt_pk_bf16_f32 v37, v26, v27
  v_fma_mix_f32 v28, v38, v116, v124 op_sel:[0,0,0] op_sel_hi:[1,0,0]
  v_mfma_f32_16x16x32_bf16 v[180:183], a[204:207], v[84:87], v[180:183]
  v_fma_mix_f32 v29, v38, v117, v125 op_sel:[1,0,0] op_sel_hi:[1,0,0]
  v_fma_mix_f32 v30, v39, v118, v126 op_sel:[0,0,0] op_sel_hi:[1,0,0]
  v_mfma_f32_16x16x32_bf16 v[176:179], a[204:207], v[80:83], v[176:179]
  s_waitcnt lgkmcnt(14)
  ds_read_b64_tr_b16 a[240:241], v10 offset:18432
  v_fma_mix_f32 v31, v39, v119, v127 op_sel:[1,0,0] op_sel_hi:[1,0,0]
  v_cvt_pk_bf16_f32 v38, v28, v29
  v_mfma_f32_16x16x32_bf16 v[192:195], a[208:211], v[80:83], v[192:195]
  s_xor_b32 s36, s1, 46080
  ds_read_b128 v[104:107], v12 offset:1536
  v_cvt_pk_bf16_f32 v39, v30, v31
  v_mfma_f32_16x16x32_bf16 v[196:199], a[208:211], v[84:87], v[196:199]
  buffer_load_dwordx4 v[72:75], v19, s[16:19], s36 offen sc1
  v_mfma_f32_16x16x32_bf16 v[200:203], a[208:211], v[88:91], v[200:203]
  s_waitcnt vmcnt(12)
  ds_read_b64_tr_b16 a[242:243], v10 offset:19456
  v_fma_mix_f32 v24, v40, v112, v120 op_sel:[0,0,0] op_sel_hi:[1,0,0]
  v_fma_mix_f32 v25, v40, v113, v121 op_sel:[1,0,0] op_sel_hi:[1,0,0]
  v_mfma_f32_16x16x32_bf16 v[204:207], a[208:211], v[92:95], v[204:207]
  v_fma_mix_f32 v26, v41, v114, v122 op_sel:[0,0,0] op_sel_hi:[1,0,0]
  v_fma_mix_f32 v27, v41, v115, v123 op_sel:[1,0,0] op_sel_hi:[1,0,0]
  v_mfma_f32_16x16x32_bf16 v[220:223], a[212:215], v[92:95], v[220:223]
  ds_read_b64_tr_b16 a[244:245], v10 offset:18440
  v_cvt_pk_bf16_f32 v40, v24, v25
  v_mfma_f32_16x16x32_bf16 v[216:219], a[212:215], v[88:91], v[216:219]
  ds_read_b128 v[108:111], v12 offset:1552
  v_cvt_pk_bf16_f32 v41, v26, v27
  v_fma_mix_f32 v28, v42, v116, v124 op_sel:[0,0,0] op_sel_hi:[1,0,0]
  v_mfma_f32_16x16x32_bf16 v[212:215], a[212:215], v[84:87], v[212:215]
  ds_read_b64_tr_b16 a[246:247], v10 offset:19464
  v_fma_mix_f32 v29, v42, v117, v125 op_sel:[1,0,0] op_sel_hi:[1,0,0]
  v_mfma_f32_16x16x32_bf16 v[208:211], a[212:215], v[80:83], v[208:211]
  s_waitcnt lgkmcnt(15)
  ds_read_b64_tr_b16 a[248:249], v11 offset:18432
  v_fma_mix_f32 v30, v43, v118, v126 op_sel:[0,0,0] op_sel_hi:[1,0,0]
  v_fma_mix_f32 v31, v43, v119, v127 op_sel:[1,0,0] op_sel_hi:[1,0,0]
  v_mfma_f32_16x16x32_bf16 v[224:227], a[216:219], v[80:83], v[224:227]
  s_xor_b32 s37, s1, 62464
  v_cvt_pk_bf16_f32 v42, v28, v29
  v_cvt_pk_bf16_f32 v43, v30, v31
  v_mfma_f32_16x16x32_bf16 v[228:231], a[216:219], v[84:87], v[228:231]
  buffer_load_dwordx4 v[76:79], v19, s[16:19], s37 offen sc1
  v_mfma_f32_16x16x32_bf16 v[232:235], a[216:219], v[88:91], v[232:235]
  s_waitcnt vmcnt(12)
  ds_read_b64_tr_b16 a[250:251], v11 offset:19456
  v_fma_mix_f32 v24, v44, v112, v120 op_sel:[0,0,0] op_sel_hi:[1,0,0]
  v_fma_mix_f32 v25, v44, v113, v121 op_sel:[1,0,0] op_sel_hi:[1,0,0]
  v_mfma_f32_16x16x32_bf16 v[236:239], a[216:219], v[92:95], v[236:239]
  ds_read_b64_tr_b16 a[252:253], v11 offset:18440
  v_fma_mix_f32 v26, v45, v114, v122 op_sel:[0,0,0] op_sel_hi:[1,0,0]
  v_mfma_f32_16x16x32_bf16 v[252:255], a[220:223], v[92:95], v[252:255]
  ds_read_b64_tr_b16 a[254:255], v11 offset:19464
  v_fma_mix_f32 v27, v45, v115, v123 op_sel:[1,0,0] op_sel_hi:[1,0,0]
  v_mfma_f32_16x16x32_bf16 v[248:251], a[220:223], v[88:91], v[248:251]
  v_cvt_pk_bf16_f32 v44, v24, v25
  v_cvt_pk_bf16_f32 v45, v26, v27
  v_fma_mix_f32 v28, v46, v116, v124 op_sel:[0,0,0] op_sel_hi:[1,0,0]
  v_mfma_f32_16x16x32_bf16 v[244:247], a[220:223], v[84:87], v[244:247]
  v_fma_mix_f32 v29, v46, v117, v125 op_sel:[1,0,0] op_sel_hi:[1,0,0]
  v_fma_mix_f32 v30, v47, v118, v126 op_sel:[0,0,0] op_sel_hi:[1,0,0]
  v_mfma_f32_16x16x32_bf16 v[240:243], a[220:223], v[80:83], v[240:243]
  s_waitcnt vmcnt(9) lgkmcnt(5)
  v_fma_mix_f32 v31, v47, v119, v127 op_sel:[1,0,0] op_sel_hi:[1,0,0]
  v_cvt_pk_bf16_f32 v46, v28, v29
  v_cvt_pk_bf16_f32 v47, v30, v31
  v_mfma_f32_16x16x32_bf16 v[128:131], a[224:227], v[32:35], v[128:131]
  s_waitcnt vmcnt(16)
  s_barrier
  ds_read_b64_tr_b16 a[192:193], v8 offset:32768
  v_fma_mix_f32 v24, v48, v96, v104 op_sel:[0,0,0] op_sel_hi:[1,0,0]
  v_mfma_f32_16x16x32_bf16 v[132:135], a[224:227], v[36:39], v[132:135]
L_attn_st4:
  s_cbranch_vccnz L_attn_st7
  s_xor_b32 s34, s1, 14336
  ds_read_b64_tr_b16 a[194:195], v8 offset:33792
  v_fma_mix_f32 v25, v48, v97, v105 op_sel:[1,0,0] op_sel_hi:[1,0,0]
  v_mfma_f32_16x16x32_bf16 v[136:139], a[224:227], v[40:43], v[136:139]
  buffer_load_dwordx4 v[80:83], v19, s[16:19], s34 offen sc1
  v_fma_mix_f32 v26, v49, v98, v106 op_sel:[0,0,0] op_sel_hi:[1,0,0]
  v_mfma_f32_16x16x32_bf16 v[140:143], a[224:227], v[44:47], v[140:143]
  ds_read_b64_tr_b16 a[196:197], v8 offset:32776
  v_fma_mix_f32 v27, v49, v99, v107 op_sel:[1,0,0] op_sel_hi:[1,0,0]
  v_mfma_f32_16x16x32_bf16 v[156:159], a[228:231], v[44:47], v[156:159]
  v_cvt_pk_bf16_f32 v48, v24, v25
  v_cvt_pk_bf16_f32 v49, v26, v27
  v_mfma_f32_16x16x32_bf16 v[152:155], a[228:231], v[40:43], v[152:155]
  ds_read_b64_tr_b16 a[198:199], v8 offset:33800
  v_fma_mix_f32 v28, v50, v100, v108 op_sel:[0,0,0] op_sel_hi:[1,0,0]
  v_fma_mix_f32 v29, v50, v101, v109 op_sel:[1,0,0] op_sel_hi:[1,0,0]
  v_mfma_f32_16x16x32_bf16 v[148:151], a[228:231], v[36:39], v[148:151]
  ds_read_b64_tr_b16 a[200:201], v9 offset:32768
  v_fma_mix_f32 v30, v51, v102, v110 op_sel:[0,0,0] op_sel_hi:[1,0,0]
  v_mfma_f32_16x16x32_bf16 v[144:147], a[228:231], v[32:35], v[144:147]
  s_waitcnt lgkmcnt(15)
  ds_read_b128 v[112:115], v12 offset:3616
  v_fma_mix_f32 v31, v51, v103, v111 op_sel:[1,0,0] op_sel_hi:[1,0,0]
  v_cvt_pk_bf16_f32 v50, v28, v29
  v_mfma_f32_16x16x32_bf16 v[160:163], a[232:235], v[32:35], v[160:163]
  s_waitcnt vmcnt(9)
  ds_read_b64_tr_b16 a[202:203], v9 offset:33792
  v_cvt_pk_bf16_f32 v51, v30, v31
  v_mfma_f32_16x16x32_bf16 v[164:167], a[232:235], v[36:39], v[164:167]
  s_xor_b32 s35, s1, 30720
  v_fma_mix_f32 v24, v52, v96, v104 op_sel:[0,0,0] op_sel_hi:[1,0,0]
  v_fma_mix_f32 v25, v52, v97, v105 op_sel:[1,0,0] op_sel_hi:[1,0,0]
  v_mfma_f32_16x16x32_bf16 v[168:171], a[232:235], v[40:43], v[168:171]
  buffer_load_dwordx4 v[84:87], v19, s[16:19], s35 offen sc1
  v_fma_mix_f32 v26, v53, v98, v106 op_sel:[0,0,0] op_sel_hi:[1,0,0]
  v_mfma_f32_16x16x32_bf16 v[172:175], a[232:235], v[44:47], v[172:175]
  ds_read_b64_tr_b16 a[204:205], v9 offset:32776
  v_fma_mix_f32 v27, v53, v99, v107 op_sel:[1,0,0] op_sel_hi:[1,0,0]
  v_mfma_f32_16x16x32_bf16 v[188:191], a[236:239], v[44:47], v[188:191]
  ds_read_b128 v[116:119], v12 offset:3632
  v_cvt_pk_bf16_f32 v52, v24, v25
  v_mfma_f32_16x16x32_bf16 v[184:187], a[236:239], v[40:43], v[184:187]
  ds_read_b64_tr_b16 a[206:207], v9 offset:33800
  v_cvt_pk_bf16_f32 v53, v26, v27
  v_fma_mix_f32 v28, v54, v100, v108 op_sel:[0,0,0] op_sel_hi:[1,0,0]
  v_mfma_f32_16x16x32_bf16 v[180:183], a[236:239], v[36:39], v[180:183]
  v_fma_mix_f32 v29, v54, v101, v109 op_sel:[1,0,0] op_sel_hi:[1,0,0]
  v_fma_mix_f32 v30, v55, v102, v110 op_sel:[0,0,0] op_sel_hi:[1,0,0]
  v_mfma_f32_16x16x32_bf16 v[176:179], a[236:239], v[32:35], v[176:179]
  s_waitcnt lgkmcnt(14)
  ds_read_b64_tr_b16 a[208:209], v10 offset:32768
  v_fma_mix_f32 v31, v55, v103, v111 op_sel:[1,0,0] op_sel_hi:[1,0,0]
  v_cvt_pk_bf16_f32 v54, v28, v29
  v_mfma_f32_16x16x32_bf16 v[192:195], a[240:243], v[32:35], v[192:195]
  s_xor_b32 s36, s1, 47104
  ds_read_b128 v[120:123], v12 offset:1568
  v_cvt_pk_bf16_f32 v55, v30, v31
  v_mfma_f32_16x16x32_bf16 v[196:199], a[240:243], v[36:39], v[196:199]
  buffer_load_dwordx4 v[88:91], v19, s[16:19], s36 offen sc1
  v_mfma_f32_16x16x32_bf16 v[200:203], a[240:243], v[40:43], v[200:203]
  s_waitcnt vmcnt(10)
  ds_read_b64_tr_b16 a[210:211], v10 offset:33792
  v_fma_mix_f32 v24, v56, v96, v104 op_sel:[0,0,0] op_sel_hi:[1,0,0]
  v_fma_mix_f32 v25, v56, v97, v105 op_sel:[1,0,0] op_sel_hi:[1,0,0]
  v_mfma_f32_16x16x32_bf16 v[204:207], a[240:243], v[44:47], v[204:207]
  v_fma_mix_f32 v26, v57, v98, v106 op_sel:[0,0,0] op_sel_hi:[1,0,0]
  v_fma_mix_f32 v27, v57, v99, v107 op_sel:[1,0,0] op_sel_hi:[1,0,0]
  v_mfma_f32_16x16x32_bf16 v[220:223], a[244:247], v[44:47], v[220:223]
  ds_read_b64_tr_b16 a[212:213], v10 offset:32776
  v_cvt_pk_bf16_f32 v56, v24, v25
  v_mfma_f32_16x16x32_bf16 v[216:219], a[244:247], v[40:43], v[216:219]
  ds_read_b128 v[124:127], v12 offset:1584
  v_cvt_pk_bf16_f32 v57, v26, v27
  v_fma_mix_f32 v28, v58, v100, v108 op_sel:[0,0,0] op_sel_hi:[1,0,0]
  v_mfma_f32_16x16x32_bf16 v[212:215], a[244:247], v[36:39], v[212:215]
  ds_read_b64_tr_b16 a[214:215], v10 offset:33800
  v_fma_mix_f32 v29, v58, v101, v109 op_sel:[1,0,0] op_sel_hi:[1,0,0]
  v_mfma_f32_16x16x32_bf16 v[208:211], a[244:247], v[32:35], v[208:211]
  s_waitcnt lgkmcnt(15)
  ds_read_b64_tr_b16 a[216:217], v11 offset:32768
  v_fma_mix_f32 v30, v59, v102, v110 op_sel:[0,0,0] op_sel_hi:[1,0,0]
  v_fma_mix_f32 v31, v59, v103, v111 op_sel:[1,0,0] op_sel_hi:[1,0,0]
  v_mfma_f32_16x16x32_bf16 v[224:227], a[248:251], v[32:35], v[224:227]
  s_xor_b32 s37, s1, 63488
  v_cvt_pk_bf16_f32 v58, v28, v29
  v_cvt_pk_bf16_f32 v59, v30, v31
  v_mfma_f32_16x16x32_bf16 v[228:231], a[248:251], v[36:39], v[228:231]
  buffer_load_dwordx4 v[92:95], v19, s[16:19], s37 offen sc1
  v_mfma_f32_16x16x32_bf16 v[232:235], a[248:251], v[40:43], v[232:235]
  s_waitcnt vmcnt(10)
  ds_read_b64_tr_b16 a[218:219], v11 offset:33792
  v_fma_mix_f32 v24, v60, v96, v104 op_sel:[0,0,0] op_sel_hi:[1,0,0]
  v_fma_mix_f32 v25, v60, v97, v105 op_sel:[1,0,0] op_sel_hi:[1,0,0]
  v_mfma_f32_16x16x32_bf16 v[236:239], a[248:251], v[44:47], v[236:239]
  ds_read_b64_tr_b16 a[220:221], v11 offset:32776
  v_fma_mix_f32 v26, v61, v98, v106 op_sel:[0,0,0] op_sel_hi:[1,0,0]
  v_mfma_f32_16x16x32_bf16 v[252:255], a[252:255], v[44:47], v[252:255]
  ds_read_b64_tr_b16 a[222:223], v11 offset:33800
  v_fma_mix_f32 v27, v61, v99, v107 op_sel:[1,0,0] op_sel_hi:[1,0,0]
  v_mfma_f32_16x16x32_bf16 v[248:251], a[252:255], v[40:43], v[248:251]
  v_cvt_pk_bf16_f32 v60, v24, v25
  v_cvt_pk_bf16_f32 v61, v26, v27
  v_fma_mix_f32 v28, v62, v100, v108 op_sel:[0,0,0] op_sel_hi:[1,0,0]
  v_mfma_f32_16x16x32_bf16 v[244:247], a[252:255], v[36:39], v[244:247]
  v_fma_mix_f32 v29, v62, v101, v109 op_sel:[1,0,0] op_sel_hi:[1,0,0]
  v_fma_mix_f32 v30, v63, v102, v110 op_sel:[0,0,0] op_sel_hi:[1,0,0]
  v_mfma_f32_16x16x32_bf16 v[240:243], a[252:255], v[32:35], v[240:243]
  s_waitcnt vmcnt(7) lgkmcnt(5)
  v_fma_mix_f32 v31, v63, v103, v111 op_sel:[1,0,0] op_sel_hi:[1,0,0]
  v_cvt_pk_bf16_f32 v62, v28, v29
  v_cvt_pk_bf16_f32 v63, v30, v31
  v_mfma_f32_16x16x32_bf16 v[128:131], a[192:195], v[48:51], v[128:131]
  s_xor_b32 s34, s1, 15360
  ds_read_b64_tr_b16 a[224:225], v8 offset:34816
  v_fma_mix_f32 v24, v64, v112, v120 op_sel:[0,0,0] op_sel_hi:[1,0,0]
  v_mfma_f32_16x16x32_bf16 v[132:135], a[192:195], v[52:55], v[132:135]
  buffer_load_dwordx4 v[32:35], v19, s[16:19], s34 offen sc1
  v_fma_mix_f32 v25, v64, v113, v121 op_sel:[1,0,0] op_sel_hi:[1,0,0]
  v_mfma_f32_16x16x32_bf16 v[136:139], a[192:195], v[56:59], v[136:139]
  ds_read_b64_tr_b16 a[226:227], v8 offset:35840
  v_fma_mix_f32 v26, v65, v114, v122 op_sel:[0,0,0] op_sel_hi:[1,0,0]
  v_fma_mix_f32 v27, v65, v115, v123 op_sel:[1,0,0] op_sel_hi:[1,0,0]
  v_mfma_f32_16x16x32_bf16 v[140:143], a[192:195], v[60:63], v[140:143]
  s_xor_b32 s35, s1, 31744
  ds_read_b64_tr_b16 a[228:229], v8 offset:34824
  v_cvt_pk_bf16_f32 v64, v24, v25
  v_mfma_f32_16x16x32_bf16 v[156:159], a[196:199], v[60:63], v[156:159]
  buffer_load_dwordx4 v[36:39], v19, s[16:19], s35 offen sc1
  v_cvt_pk_bf16_f32 v65, v26, v27
  v_mfma_f32_16x16x32_bf16 v[152:155], a[196:199], v[56:59], v[152:155]
  ds_read_b64_tr_b16 a[230:231], v8 offset:35848
  v_fma_mix_f32 v28, v66, v116, v124 op_sel:[0,0,0] op_sel_hi:[1,0,0]
  v_fma_mix_f32 v29, v66, v117, v125 op_sel:[1,0,0] op_sel_hi:[1,0,0]
  v_mfma_f32_16x16x32_bf16 v[148:151], a[196:199], v[52:55], v[148:151]
  s_waitcnt lgkmcnt(14)
  ds_read_b64_tr_b16 a[232:233], v9 offset:34816
  v_fma_mix_f32 v30, v67, v118, v126 op_sel:[0,0,0] op_sel_hi:[1,0,0]
  v_mfma_f32_16x16x32_bf16 v[144:147], a[196:199], v[48:51], v[144:147]
  s_xor_b32 s36, s1, 48128
  ds_read_b128 v[96:99], v12 offset:3840
  v_fma_mix_f32 v31, v67, v119, v127 op_sel:[1,0,0] op_sel_hi:[1,0,0]
  v_cvt_pk_bf16_f32 v66, v28, v29
  v_mfma_f32_16x16x32_bf16 v[160:163], a[200:203], v[48:51], v[160:163]
  buffer_load_dwordx4 v[40:43], v19, s[16:19], s36 offen sc1
  v_cvt_pk_bf16_f32 v67, v30, v31
  v_mfma_f32_16x16x32_bf16 v[164:167], a[200:203], v[52:55], v[164:167]
  s_waitcnt vmcnt(9)
  ds_read_b64_tr_b16 a[234:235], v9 offset:35840
  v_fma_mix_f32 v24, v68, v112, v120 op_sel:[0,0,0] op_sel_hi:[1,0,0]
  v_mfma_f32_16x16x32_bf16 v[168:171], a[200:203], v[56:59], v[168:171]
  s_xor_b32 s37, s1, 64512
  ds_read_b64_tr_b16 a[236:237], v9 offset:34824
  v_fma_mix_f32 v25, v68, v113, v121 op_sel:[1,0,0] op_sel_hi:[1,0,0]
  v_fma_mix_f32 v26, v69, v114, v122 op_sel:[0,0,0] op_sel_hi:[1,0,0]
  v_mfma_f32_16x16x32_bf16 v[172:175], a[200:203], v[60:63], v[172:175]
  buffer_load_dwordx4 v[44:47], v19, s[16:19], s37 offen sc1
  v_fma_mix_f32 v27, v69, v115, v123 op_sel:[1,0,0] op_sel_hi:[1,0,0]
  v_mfma_f32_16x16x32_bf16 v[188:191], a[204:207], v[60:63], v[188:191]
  ds_read_b128 v[100:103], v12 offset:3856
  v_cvt_pk_bf16_f32 v68, v24, v25
  v_mfma_f32_16x16x32_bf16 v[184:187], a[204:207], v[56:59], v[184:187]
  s_mov_b32 s30, 196608
  ds_read_b64_tr_b16 a[238:239], v9 offset:35848
  v_cvt_pk_bf16_f32 v69, v26, v27
  v_fma_mix_f32 v28, v70, v116, v124 op_sel:[0,0,0] op_sel_hi:[1,0,0]
  v_mfma_f32_16x16x32_bf16 v[180:183], a[204:207], v[52:55], v[180:183]
  s_waitcnt lgkmcnt(14)
  buffer_load_dwordx2 v[20:21], v15, s[64:67], s30 offen sc1
  v_fma_mix_f32 v29, v70, v117, v125 op_sel:[1,0,0] op_sel_hi:[1,0,0]
  v_mfma_f32_16x16x32_bf16 v[176:179], a[204:207], v[48:51], v[176:179]
  s_mov_b32 s38, 0
  ds_read_b64_tr_b16 a[240:241], v10 offset:34816
  v_fma_mix_f32 v30, v71, v118, v126 op_sel:[0,0,0] op_sel_hi:[1,0,0]
  v_fma_mix_f32 v31, v71, v119, v127 op_sel:[1,0,0] op_sel_hi:[1,0,0]
  v_mfma_f32_16x16x32_bf16 v[192:195], a[208:211], v[48:51], v[192:195]
  s_add_u32 m0, s43, 0
  ds_read_b128 v[104:107], v12 offset:1792
  v_cvt_pk_bf16_f32 v70, v28, v29
  v_mfma_f32_16x16x32_bf16 v[196:199], a[208:211], v[52:55], v[196:199]
  buffer_load_dwordx4 v16, s[4:7], s38 offen offset:0 lds
  v_cvt_pk_bf16_f32 v71, v30, v31
  v_mfma_f32_16x16x32_bf16 v[200:203], a[208:211], v[56:59], v[200:203]
  s_waitcnt vmcnt(11)
  ds_read_b64_tr_b16 a[242:243], v10 offset:35840
  v_fma_mix_f32 v24, v72, v112, v120 op_sel:[0,0,0] op_sel_hi:[1,0,0]
  v_fma_mix_f32 v25, v72, v113, v121 op_sel:[1,0,0] op_sel_hi:[1,0,0]
  v_mfma_f32_16x16x32_bf16 v[204:207], a[208:211], v[60:63], v[204:207]
  s_mov_b32 s38, 0
  ds_read_b64_tr_b16 a[244:245], v10 offset:34824
  v_fma_mix_f32 v26, v73, v114, v122 op_sel:[0,0,0] op_sel_hi:[1,0,0]
  v_mfma_f32_16x16x32_bf16 v[220:223], a[212:215], v[60:63], v[220:223]
  buffer_load_dwordx4 v16, s[4:7], s38 offen offset:1024 lds
  v_fma_mix_f32 v27, v73, v115, v123 op_sel:[1,0,0] op_sel_hi:[1,0,0]
  v_mfma_f32_16x16x32_bf16 v[216:219], a[212:215], v[56:59], v[216:219]
  ds_read_b128 v[108:111], v12 offset:1808
  v_cvt_pk_bf16_f32 v72, v24, v25
  v_cvt_pk_bf16_f32 v73, v26, v27
  v_mfma_f32_16x16x32_bf16 v[212:215], a[212:215], v[52:55], v[212:215]
  s_waitcnt lgkmcnt(15)
  ds_read_b64_tr_b16 a[246:247], v10 offset:35848
  v_fma_mix_f32 v28, v74, v116, v124 op_sel:[0,0,0] op_sel_hi:[1,0,0]
  v_mfma_f32_16x16x32_bf16 v[208:211], a[212:215], v[48:51], v[208:211]
  s_mov_b32 s38, 0
  ds_read_b64_tr_b16 a[248:249], v11 offset:34816
  v_fma_mix_f32 v29, v74, v117, v125 op_sel:[1,0,0] op_sel_hi:[1,0,0]
  v_fma_mix_f32 v30, v75, v118, v126 op_sel:[0,0,0] op_sel_hi:[1,0,0]
  v_mfma_f32_16x16x32_bf16 v[224:227], a[216:219], v[48:51], v[224:227]
  buffer_load_dwordx4 v16, s[4:7], s38 offen offset:2048 lds
  v_fma_mix_f32 v31, v75, v119, v127 op_sel:[1,0,0] op_sel_hi:[1,0,0]
  v_mfma_f32_16x16x32_bf16 v[228:231], a[216:219], v[52:55], v[228:231]
  s_waitcnt vmcnt(12)
  ds_read_b64_tr_b16 a[250:251], v11 offset:35840
  v_cvt_pk_bf16_f32 v74, v28, v29
  v_mfma_f32_16x16x32_bf16 v[232:235], a[216:219], v[56:59], v[232:235]
  s_mov_b32 s38, 0
  ds_read_b64_tr_b16 a[252:253], v11 offset:34824
  v_cvt_pk_bf16_f32 v75, v30, v31
  v_fma_mix_f32 v24, v76, v112, v120 op_sel:[0,0,0] op_sel_hi:[1,0,0]
  v_mfma_f32_16x16x32_bf16 v[236:239], a[216:219], v[60:63], v[236:239]
  buffer_load_dwordx4 v16, s[4:7], s38 offen offset:3072 lds
  v_fma_mix_f32 v25, v76, v113, v121 op_sel:[1,0,0] op_sel_hi:[1,0,0]
  v_mfma_f32_16x16x32_bf16 v[252:255], a[220:223], v[60:63], v[252:255]
  ds_read_b64_tr_b16 a[254:255], v11 offset:35848
  v_fma_mix_f32 v26, v77, v114, v122 op_sel:[0,0,0] op_sel_hi:[1,0,0]
  v_mfma_f32_16x16x32_bf16 v[248:251], a[220:223], v[56:59], v[248:251]
  v_fma_mix_f32 v27, v77, v115, v123 op_sel:[1,0,0] op_sel_hi:[1,0,0]
  v_cvt_pk_bf16_f32 v76, v24, v25
  v_cvt_pk_bf16_f32 v77, v26, v27
  v_mfma_f32_16x16x32_bf16 v[244:247], a[220:223], v[52:55], v[244:247]
  v_fma_mix_f32 v28, v78, v116, v124 op_sel:[0,0,0] op_sel_hi:[1,0,0]
  v_fma_mix_f32 v29, v78, v117, v125 op_sel:[1,0,0] op_sel_hi:[1,0,0]
  v_fma_mix_f32 v30, v79, v118, v126 op_sel:[0,0,0] op_sel_hi:[1,0,0]
  v_mfma_f32_16x16x32_bf16 v[240:243], a[220:223], v[48:51], v[240:243]
  s_waitcnt vmcnt(12) lgkmcnt(5)
  v_fma_mix_f32 v31, v79, v119, v127 op_sel:[1,0,0] op_sel_hi:[1,0,0]
  v_cvt_pk_bf16_f32 v78, v28, v29
  v_cvt_pk_bf16_f32 v79, v30, v31
  v_mfma_f32_16x16x32_bf16 v[128:131], a[224:227], v[64:67], v[128:131]
  s_waitcnt vmcnt(17)
  s_barrier
  s_mov_b32 s38, 16384
  s_add_u32 m0, s43, 16384
  ds_read_b64_tr_b16 a[192:193], v8 offset:49152
  v_mfma_f32_16x16x32_bf16 v[132:135], a[224:227], v[68:71], v[132:135]
  buffer_load_dwordx4 v16, s[4:7], s38 offen offset:0 lds
  v_mfma_f32_16x16x32_bf16 v[136:139], a[224:227], v[72:75], v[136:139]
  ds_read_b64_tr_b16 a[194:195], v8 offset:50176
  v_fma_mix_f32 v24, v80, v96, v104 op_sel:[0,0,0] op_sel_hi:[1,0,0]
  v_fma_mix_f32 v25, v80, v97, v105 op_sel:[1,0,0] op_sel_hi:[1,0,0]
  v_mfma_f32_16x16x32_bf16 v[140:143], a[224:227], v[76:79], v[140:143]
  ds_read_b64_tr_b16 a[196:197], v8 offset:49160
  v_fma_mix_f32 v26, v81, v98, v106 op_sel:[0,0,0] op_sel_hi:[1,0,0]
  v_mfma_f32_16x16x32_bf16 v[156:159], a[228:231], v[76:79], v[156:159]
  s_mov_b32 s38, 16384
  ds_read_b64_tr_b16 a[198:199], v8 offset:50184
  v_fma_mix_f32 v27, v81, v99, v107 op_sel:[1,0,0] op_sel_hi:[1,0,0]
  v_cvt_pk_bf16_f32 v80, v24, v25
  v_mfma_f32_16x16x32_bf16 v[152:155], a[228:231], v[72:75], v[152:155]
  buffer_load_dwordx4 v16, s[4:7], s38 offen offset:1024 lds
  v_cvt_pk_bf16_f32 v81, v26, v27
  v_mfma_f32_16x16x32_bf16 v[148:151], a[228:231], v[68:71], v[148:151]
  s_waitcnt lgkmcnt(14)
  ds_read_b64_tr_b16 a[200:201], v9 offset:49152
  v_fma_mix_f32 v28, v82, v100, v108 op_sel:[0,0,0] op_sel_hi:[1,0,0]
  v_mfma_f32_16x16x32_bf16 v[144:147], a[228:231], v[64:67], v[144:147]
  s_mov_b32 s38, 16384
  ds_read_b128 v[112:115], v12 offset:3872
  v_fma_mix_f32 v29, v82, v101, v109 op_sel:[1,0,0] op_sel_hi:[1,0,0]
  v_fma_mix_f32 v30, v83, v102, v110 op_sel:[0,0,0] op_sel_hi:[1,0,0]
  v_mfma_f32_16x16x32_bf16 v[160:163], a[232:235], v[64:67], v[160:163]
  buffer_load_dwordx4 v16, s[4:7], s38 offen offset:2048 lds
  v_fma_mix_f32 v31, v83, v103, v111 op_sel:[1,0,0] op_sel_hi:[1,0,0]
  v_mfma_f32_16x16x32_bf16 v[164:167], a[232:235], v[68:71], v[164:167]
  ds_read_b64_tr_b16 a[202:203], v9 offset:50176
  v_cvt_pk_bf16_f32 v82, v28, v29
  v_mfma_f32_16x16x32_bf16 v[168:171], a[232:235], v[72:75], v[168:171]
  s_waitcnt vmcnt(14)
  ds_read_b64_tr_b16 a[204:205], v9 offset:49160
  v_cvt_pk_bf16_f32 v83, v30, v31
  v_fma_mix_f32 v24, v84, v96, v104 op_sel:[0,0,0] op_sel_hi:[1,0,0]
  v_mfma_f32_16x16x32_bf16 v[172:175], a[232:235], v[76:79], v[172:175]
  s_mov_b32 s38, 16384
  ds_read_b128 v[116:119], v12 offset:3888
  v_fma_mix_f32 v25, v84, v97, v105 op_sel:[1,0,0] op_sel_hi:[1,0,0]
  v_fma_mix_f32 v26, v85, v98, v106 op_sel:[0,0,0] op_sel_hi:[1,0,0]
  v_mfma_f32_16x16x32_bf16 v[188:191], a[236:239], v[76:79], v[188:191]
  buffer_load_dwordx4 v16, s[4:7], s38 offen offset:3072 lds
  v_mfma_f32_16x16x32_bf16 v[184:187], a[236:239], v[72:75], v[184:187]
  s_waitcnt lgkmcnt(13)
  ds_read_b64_tr_b16 a[206:207], v9 offset:50184
  v_fma_mix_f32 v27, v85, v99, v107 op_sel:[1,0,0] op_sel_hi:[1,0,0]
  v_cvt_pk_bf16_f32 v84, v24, v25
  v_mfma_f32_16x16x32_bf16 v[180:183], a[236:239], v[68:71], v[180:183]
  s_mov_b32 s38, 0
  v_cvt_pk_bf16_f32 v85, v26, v27
  v_fma_mix_f32 v28, v86, v100, v108 op_sel:[0,0,0] op_sel_hi:[1,0,0]
  v_fma_mix_f32 v29, v86, v101, v109 op_sel:[1,0,0] op_sel_hi:[1,0,0]
  v_mfma_f32_16x16x32_bf16 v[176:179], a[236:239], v[64:67], v[176:179]
  s_add_u32 m0, s26, 0
  ds_read_b64_tr_b16 a[208:209], v10 offset:49152
  v_fma_mix_f32 v30, v87, v102, v110 op_sel:[0,0,0] op_sel_hi:[1,0,0]
  v_fma_mix_f32 v31, v87, v103, v111 op_sel:[1,0,0] op_sel_hi:[1,0,0]
  v_mfma_f32_16x16x32_bf16 v[192:195], a[240:243], v[64:67], v[192:195]
  buffer_load_dwordx4 v17, s[8:11], s38 offen offset:0 lds
  v_mfma_f32_16x16x32_bf16 v[196:199], a[240:243], v[68:71], v[196:199]
  ds_read_b128 v[120:123], v12 offset:1824
  v_cvt_pk_bf16_f32 v86, v28, v29
  v_cvt_pk_bf16_f32 v87, v30, v31
  v_mfma_f32_16x16x32_bf16 v[200:203], a[240:243], v[72:75], v[200:203]
  s_waitcnt vmcnt(15)
  ds_read_b64_tr_b16 a[210:211], v10 offset:50176
  v_fma_mix_f32 v24, v88, v96, v104 op_sel:[0,0,0] op_sel_hi:[1,0,0]
  v_fma_mix_f32 v25, v88, v97, v105 op_sel:[1,0,0] op_sel_hi:[1,0,0]
  v_mfma_f32_16x16x32_bf16 v[204:207], a[240:243], v[76:79], v[204:207]
  s_mov_b32 s38, 0
  ds_read_b64_tr_b16 a[212:213], v10 offset:49160
  v_fma_mix_f32 v26, v89, v98, v106 op_sel:[0,0,0] op_sel_hi:[1,0,0]
  v_mfma_f32_16x16x32_bf16 v[220:223], a[244:247], v[76:79], v[220:223]
  buffer_load_dwordx4 v17, s[8:11], s38 offen offset:1024 lds
  v_fma_mix_f32 v27, v89, v99, v107 op_sel:[1,0,0] op_sel_hi:[1,0,0]
  v_mfma_f32_16x16x32_bf16 v[216:219], a[244:247], v[72:75], v[216:219]
  ds_read_b128 v[124:127], v12 offset:1840
  v_cvt_pk_bf16_f32 v88, v24, v25
  v_cvt_pk_bf16_f32 v89, v26, v27
  v_mfma_f32_16x16x32_bf16 v[212:215], a[244:247], v[68:71], v[212:215]
  s_mov_b32 s38, 0
  ds_read_b64_tr_b16 a[214:215], v10 offset:50184
  v_fma_mix_f32 v28, v90, v100, v108 op_sel:[0,0,0] op_sel_hi:[1,0,0]
  v_mfma_f32_16x16x32_bf16 v[208:211], a[244:247], v[64:67], v[208:211]
  s_waitcnt lgkmcnt(15)
  buffer_load_dwordx4 v17, s[8:11], s38 offen offset:2048 lds
  v_fma_mix_f32 v29, v90, v101, v109 op_sel:[1,0,0] op_sel_hi:[1,0,0]
  v_mfma_f32_16x16x32_bf16 v[224:227], a[248:251], v[64:67], v[224:227]
  ds_read_b64_tr_b16 a[216:217], v11 offset:49152
  v_fma_mix_f32 v30, v91, v102, v110 op_sel:[0,0,0] op_sel_hi:[1,0,0]
  v_fma_mix_f32 v31, v91, v103, v111 op_sel:[1,0,0] op_sel_hi:[1,0,0]
  v_mfma_f32_16x16x32_bf16 v[228:231], a[248:251], v[68:71], v[228:231]
  s_waitcnt vmcnt(16)
  ds_read_b64_tr_b16 a[218:219], v11 offset:50176
  v_cvt_pk_bf16_f32 v90, v28, v29
  v_mfma_f32_16x16x32_bf16 v[232:235], a[248:251], v[72:75], v[232:235]
  s_mov_b32 s38, 0
  ds_read_b64_tr_b16 a[220:221], v11 offset:49160
  v_cvt_pk_bf16_f32 v91, v30, v31
  v_fma_mix_f32 v24, v92, v96, v104 op_sel:[0,0,0] op_sel_hi:[1,0,0]
  v_mfma_f32_16x16x32_bf16 v[236:239], a[248:251], v[76:79], v[236:239]
  buffer_load_dwordx4 v17, s[8:11], s38 offen offset:3072 lds
  v_fma_mix_f32 v25, v92, v97, v105 op_sel:[1,0,0] op_sel_hi:[1,0,0]
  v_mfma_f32_16x16x32_bf16 v[252:255], a[252:255], v[76:79], v[252:255]
  ds_read_b64_tr_b16 a[222:223], v11 offset:50184
  v_fma_mix_f32 v26, v93, v98, v106 op_sel:[0,0,0] op_sel_hi:[1,0,0]
  v_mfma_f32_16x16x32_bf16 v[248:251], a[252:255], v[72:75], v[248:251]
  v_fma_mix_f32 v27, v93, v99, v107 op_sel:[1,0,0] op_sel_hi:[1,0,0]
  v_cvt_pk_bf16_f32 v92, v24, v25
  v_cvt_pk_bf16_f32 v93, v26, v27
  v_mfma_f32_16x16x32_bf16 v[244:247], a[252:255], v[68:71], v[244:247]
  v_fma_mix_f32 v28, v94, v100, v108 op_sel:[0,0,0] op_sel_hi:[1,0,0]
  v_fma_mix_f32 v29, v94, v101, v109 op_sel:[1,0,0] op_sel_hi:[1,0,0]
  v_fma_mix_f32 v30, v95, v102, v110 op_sel:[0,0,0] op_sel_hi:[1,0,0]
  v_mfma_f32_16x16x32_bf16 v[240:243], a[252:255], v[64:67], v[240:243]
  s_waitcnt vmcnt(16) lgkmcnt(5)
  v_fma_mix_f32 v31, v95, v103, v111 op_sel:[1,0,0] op_sel_hi:[1,0,0]
  v_cvt_pk_bf16_f32 v94, v28, v29
  v_cvt_pk_bf16_f32 v95, v30, v31
  v_mfma_f32_16x16x32_bf16 v[128:131], a[192:195], v[80:83], v[128:131]
  s_mov_b32 s38, 32768
  s_add_u32 m0, s43, 32768
  ds_read_b64_tr_b16 a[224:225], v8 offset:51200
  v_mfma_f32_16x16x32_bf16 v[132:135], a[192:195], v[84:87], v[132:135]
  buffer_load_dwordx4 v16, s[4:7], s38 offen offset:0 lds
  v_fma_mix_f32 v24, v32, v112, v120 op_sel:[0,0,0] op_sel_hi:[1,0,0]
  v_mfma_f32_16x16x32_bf16 v[136:139], a[192:195], v[88:91], v[136:139]
  ds_read_b64_tr_b16 a[226:227], v8 offset:52224
  v_fma_mix_f32 v25, v32, v113, v121 op_sel:[1,0,0] op_sel_hi:[1,0,0]
  v_mfma_f32_16x16x32_bf16 v[140:143], a[192:195], v[92:95], v[140:143]
  ds_read_b64_tr_b16 a[228:229], v8 offset:51208
  v_fma_mix_f32 v26, v33, v114, v122 op_sel:[0,0,0] op_sel_hi:[1,0,0]
  v_fma_mix_f32 v27, v33, v115, v123 op_sel:[1,0,0] op_sel_hi:[1,0,0]
  v_mfma_f32_16x16x32_bf16 v[156:159], a[196:199], v[92:95], v[156:159]
  s_mov_b32 s38, 32768
  v_cvt_pk_bf16_f32 v32, v24, v25
  v_cvt_pk_bf16_f32 v33, v26, v27
  v_mfma_f32_16x16x32_bf16 v[152:155], a[196:199], v[88:91], v[152:155]
  buffer_load_dwordx4 v16, s[4:7], s38 offen offset:1024 lds
  v_fma_mix_f32 v28, v34, v116, v124 op_sel:[0,0,0] op_sel_hi:[1,0,0]
  v_mfma_f32_16x16x32_bf16 v[148:151], a[196:199], v[84:87], v[148:151]
  s_waitcnt lgkmcnt(13)
  ds_read_b64_tr_b16 a[230:231], v8 offset:52232
  v_fma_mix_f32 v29, v34, v117, v125 op_sel:[1,0,0] op_sel_hi:[1,0,0]
  v_mfma_f32_16x16x32_bf16 v[144:147], a[196:199], v[80:83], v[144:147]
  s_mov_b32 s38, 32768
  ds_read_b64_tr_b16 a[232:233], v9 offset:51200
  v_fma_mix_f32 v30, v35, v118, v126 op_sel:[0,0,0] op_sel_hi:[1,0,0]
  v_fma_mix_f32 v31, v35, v119, v127 op_sel:[1,0,0] op_sel_hi:[1,0,0]
  v_mfma_f32_16x16x32_bf16 v[160:163], a[200:203], v[80:83], v[160:163]
  buffer_load_dwordx4 v16, s[4:7], s38 offen offset:2048 lds
  v_mfma_f32_16x16x32_bf16 v[164:167], a[200:203], v[84:87], v[164:167]
  s_waitcnt vmcnt(18)
  v_cvt_pk_bf16_f32 v34, v28, v29
  v_cvt_pk_bf16_f32 v35, v30, v31
  v_fma_mix_f32 v24, v36, v112, v120 op_sel:[0,0,0] op_sel_hi:[1,0,0]
  v_mfma_f32_16x16x32_bf16 v[168:171], a[200:203], v[88:91], v[168:171]
  ds_read_b64_tr_b16 a[234:235], v9 offset:52224
  v_fma_mix_f32 v25, v36, v113, v121 op_sel:[1,0,0] op_sel_hi:[1,0,0]
  v_mfma_f32_16x16x32_bf16 v[172:175], a[200:203], v[92:95], v[172:175]
  s_mov_b32 s38, 32768
  ds_read_b64_tr_b16 a[236:237], v9 offset:51208
  v_fma_mix_f32 v26, v37, v114, v122 op_sel:[0,0,0] op_sel_hi:[1,0,0]
  v_fma_mix_f32 v27, v37, v115, v123 op_sel:[1,0,0] op_sel_hi:[1,0,0]
  v_mfma_f32_16x16x32_bf16 v[188:191], a[204:207], v[92:95], v[188:191]
  buffer_load_dwordx4 v16, s[4:7], s38 offen offset:3072 lds
  v_mfma_f32_16x16x32_bf16 v[184:187], a[204:207], v[88:91], v[184:187]
  s_waitcnt lgkmcnt(11)
  ds_read_b64_tr_b16 a[238:239], v9 offset:52232
  v_cvt_pk_bf16_f32 v36, v24, v25
  v_cvt_pk_bf16_f32 v37, v26, v27
  v_mfma_f32_16x16x32_bf16 v[180:183], a[204:207], v[84:87], v[180:183]
  s_mov_b32 s38, 16384
  v_fma_mix_f32 v28, v38, v116, v124 op_sel:[0,0,0] op_sel_hi:[1,0,0]
  v_fma_mix_f32 v29, v38, v117, v125 op_sel:[1,0,0] op_sel_hi:[1,0,0]
  v_mfma_f32_16x16x32_bf16 v[176:179], a[204:207], v[80:83], v[176:179]
  s_add_u32 m0, s26, 16384
  ds_read_b64_tr_b16 a[240:241], v10 offset:51200
  v_fma_mix_f32 v30, v39, v118, v126 op_sel:[0,0,0] op_sel_hi:[1,0,0]
  v_fma_mix_f32 v31, v39, v119, v127 op_sel:[1,0,0] op_sel_hi:[1,0,0]
  v_mfma_f32_16x16x32_bf16 v[192:195], a[208:211], v[80:83], v[192:195]
  buffer_load_dwordx4 v17, s[8:11], s38 offen offset:0 lds
  v_cvt_pk_bf16_f32 v38, v28, v29
  v_mfma_f32_16x16x32_bf16 v[196:199], a[208:211], v[84:87], v[196:199]
  ds_read_b64_tr_b16 a[242:243], v10 offset:52224
  v_cvt_pk_bf16_f32 v39, v30, v31
  v_mfma_f32_16x16x32_bf16 v[200:203], a[208:211], v[88:91], v[200:203]
  s_waitcnt vmcnt(19)
  ds_read_b64_tr_b16 a[244:245], v10 offset:51208
  v_fma_mix_f32 v24, v40, v112, v120 op_sel:[0,0,0] op_sel_hi:[1,0,0]
  v_fma_mix_f32 v25, v40, v113, v121 op_sel:[1,0,0] op_sel_hi:[1,0,0]
  v_mfma_f32_16x16x32_bf16 v[204:207], a[208:211], v[92:95], v[204:207]
  s_mov_b32 s38, 16384
  v_fma_mix_f32 v26, v41, v114, v122 op_sel:[0,0,0] op_sel_hi:[1,0,0]
  v_fma_mix_f32 v27, v41, v115, v123 op_sel:[1,0,0] op_sel_hi:[1,0,0]
  v_mfma_f32_16x16x32_bf16 v[220:223], a[212:215], v[92:95], v[220:223]
  buffer_load_dwordx4 v17, s[8:11], s38 offen offset:1024 lds
  v_cvt_pk_bf16_f32 v40, v24, v25
  v_mfma_f32_16x16x32_bf16 v[216:219], a[212:215], v[88:91], v[216:219]
  ds_read_b64_tr_b16 a[246:247], v10 offset:52232
  v_cvt_pk_bf16_f32 v41, v26, v27
  v_mfma_f32_16x16x32_bf16 v[212:215], a[212:215], v[84:87], v[212:215]
  s_mov_b32 s38, 16384
  ds_read_b64_tr_b16 a[248:249], v11 offset:51200
  v_fma_mix_f32 v28, v42, v116, v124 op_sel:[0,0,0] op_sel_hi:[1,0,0]
  v_fma_mix_f32 v29, v42, v117, v125 op_sel:[1,0,0] op_sel_hi:[1,0,0]
  v_mfma_f32_16x16x32_bf16 v[208:211], a[212:215], v[80:83], v[208:211]
  s_waitcnt lgkmcnt(13)
  buffer_load_dwordx4 v17, s[8:11], s38 offen offset:2048 lds
  v_mfma_f32_16x16x32_bf16 v[224:227], a[216:219], v[80:83], v[224:227]
  v_fma_mix_f32 v30, v43, v118, v126 op_sel:[0,0,0] op_sel_hi:[1,0,0]
  v_fma_mix_f32 v31, v43, v119, v127 op_sel:[1,0,0] op_sel_hi:[1,0,0]
  v_cvt_pk_bf16_f32 v42, v28, v29
  v_mfma_f32_16x16x32_bf16 v[228:231], a[216:219], v[84:87], v[228:231]
  s_waitcnt vmcnt(20)
  ds_read_b64_tr_b16 a[250:251], v11 offset:52224
  v_cvt_pk_bf16_f32 v43, v30, v31
  v_mfma_f32_16x16x32_bf16 v[232:235], a[216:219], v[88:91], v[232:235]
  s_mov_b32 s38, 16384
  ds_read_b64_tr_b16 a[252:253], v11 offset:51208
  v_fma_mix_f32 v24, v44, v112, v120 op_sel:[0,0,0] op_sel_hi:[1,0,0]
  v_fma_mix_f32 v25, v44, v113, v121 op_sel:[1,0,0] op_sel_hi:[1,0,0]
  v_mfma_f32_16x16x32_bf16 v[236:239], a[216:219], v[92:95], v[236:239]
  buffer_load_dwordx4 v17, s[8:11], s38 offen offset:3072 lds
  v_mfma_f32_16x16x32_bf16 v[252:255], a[220:223], v[92:95], v[252:255]
  ds_read_b64_tr_b16 a[254:255], v11 offset:52232
  v_fma_mix_f32 v26, v45, v114, v122 op_sel:[0,0,0] op_sel_hi:[1,0,0]
  v_fma_mix_f32 v27, v45, v115, v123 op_sel:[1,0,0] op_sel_hi:[1,0,0]
  v_mfma_f32_16x16x32_bf16 v[248:251], a[220:223], v[88:91], v[248:251]
  v_cvt_pk_bf16_f32 v44, v24, v25
  v_cvt_pk_bf16_f32 v45, v26, v27
  v_mfma_f32_16x16x32_bf16 v[244:247], a[220:223], v[84:87], v[244:247]
  v_fma_mix_f32 v28, v46, v116, v124 op_sel:[0,0,0] op_sel_hi:[1,0,0]
  v_fma_mix_f32 v29, v46, v117, v125 op_sel:[1,0,0] op_sel_hi:[1,0,0]
  v_fma_mix_f32 v30, v47, v118, v126 op_sel:[0,0,0] op_sel_hi:[1,0,0]
  v_mfma_f32_16x16x32_bf16 v[240:243], a[220:223], v[80:83], v[240:243]
  s_waitcnt lgkmcnt(12)
  v_fma_mix_f32 v31, v47, v119, v127 op_sel:[1,0,0] op_sel_hi:[1,0,0]
  v_cvt_pk_bf16_f32 v46, v28, v29
  v_cvt_pk_bf16_f32 v47, v30, v31
  v_mfma_f32_16x16x32_bf16 v[128:131], a[224:227], v[32:35], v[128:131]
  s_waitcnt vmcnt(16)
  s_barrier
  ds_read_b128 a[128:131], v4 offset:0
  v_mfma_f32_16x16x32_bf16 v[132:135], a[224:227], v[36:39], v[132:135]
  s_mov_b32 s38, 49152
  s_add_u32 m0, s43, 49152
  ds_read_b128 a[132:135], v5 offset:0
  v_lshrrev_b32 v28, 4, v1
  v_mfma_f32_16x16x32_bf16 v[136:139], a[224:227], v[40:43], v[136:139]
  buffer_load_dwordx4 v16, s[4:7], s38 offen offset:0 lds
  s_lshl_b32 s42, s24, 2
  v_add_u32 v28, s42, v28
  v_mfma_f32_16x16x32_bf16 v[140:143], a[224:227], v[44:47], v[140:143]
  v_and_b32 v29, 0xf0, v17
  v_mfma_f32_16x16x32_bf16 v[144:147], a[228:231], v[32:35], v[144:147]
  ds_read_b128 a[136:139], v6 offset:0
  v_lshl_add_u32 v18, v28, 10, v29
  v_mfma_f32_16x16x32_bf16 v[148:151], a[228:231], v[36:39], v[148:151]
  ds_read_b128 a[140:143], v7 offset:0
  v_mul_u32_u24 v28, 2752, v28
  v_mfma_f32_16x16x32_bf16 v[152:155], a[228:231], v[40:43], v[152:155]
  v_add_u32 v28, v28, v29
  v_mfma_f32_16x16x32_bf16 v[156:159], a[228:231], v[44:47], v[156:159]
  s_waitcnt lgkmcnt(12)
  ds_read_b128 a[144:147], v4 offset:1024
  v_mov_b32 v30, 0xc0
  v_mfma_f32_16x16x32_bf16 v[160:163], a[232:235], v[32:35], v[160:163]
  s_mov_b32 s38, 49152
  ds_read_b128 a[148:151], v5 offset:1024
  v_cmp_le_u32 s[32:33], v30, v29
  v_mfma_f32_16x16x32_bf16 v[164:167], a[232:235], v[36:39], v[164:167]
  buffer_load_dwordx4 v16, s[4:7], s38 offen offset:1024 lds
  v_mov_b32 v30, 0x40000000
  v_mfma_f32_16x16x32_bf16 v[168:171], a[232:235], v[40:43], v[168:171]
  s_bfe_u32 s3, s2, 0x40003
  s_mul_i32 s3, s3, 192
  v_cndmask_b32 v51, v28, v30, s[32:33]
  v_mfma_f32_16x16x32_bf16 v[172:175], a[232:235], v[44:47], v[172:175]
  ds_read_b128 a[152:155], v6 offset:1024
  s_bfe_u32 s39, s2, 0x20001
  s_lshl_b32 s39, s39, 20
  s_bfe_u32 s42, s2, 0x20003
  s_lshl_b32 s42, s42, 8
  s_add_u32 s39, s39, s42
  s_bfe_u32 s42, s2, 0x30003
  s_lshl_b32 s79, s42, 17
  s_add_u32 s79, s79, s39
  s_cmp_eq_u32 s42, 0
  s_cselect_b32 s80, 0x20000, 0
  s_add_u32 s80, s80, s39
  s_cmp_le_u32 s42, 1
  s_cselect_b32 s81, 2, 1
  s_lshl_b32 s81, s81, 17
  s_add_u32 s81, s81, s39
  v_mfma_f32_16x16x32_bf16 v[176:179], a[236:239], v[32:35], v[176:179]
L_attn_st5:
  s_cbranch_vccnz L_attn_st8
  ds_read_b128 a[156:159], v7 offset:1024
  v_cvt_pk_bf16_f32 v64, v128, v129
  v_cvt_pk_bf16_f32 v65, v130, v131
  v_mfma_f32_16x16x32_bf16 v[180:183], a[236:239], v[36:39], v[180:183]
  v_cvt_pk_bf16_f32 v66, v144, v145
  v_cvt_pk_bf16_f32 v67, v146, v147
  v_mfma_f32_16x16x32_bf16 v[184:187], a[236:239], v[40:43], v[184:187]
  s_waitcnt lgkmcnt(12)
  ds_read_b128 a[160:163], v4 offset:2048
  v_cvt_pk_bf16_f32 v80, v132, v133
  v_cvt_pk_bf16_f32 v81, v134, v135
  v_mfma_f32_16x16x32_bf16 v[188:191], a[236:239], v[44:47], v[188:191]
  s_mov_b32 s38, 49152
  ds_read_b128 a[164:167], v5 offset:2048
  v_cvt_pk_bf16_f32 v82, v148, v149
  v_cvt_pk_bf16_f32 v83, v150, v151
  v_mfma_f32_16x16x32_bf16 v[192:195], a[240:243], v[32:35], v[192:195]
  buffer_load_dwordx4 v16, s[4:7], s38 offen offset:2048 lds
  v_cvt_pk_bf16_f32 v96, v136, v137
  v_cvt_pk_bf16_f32 v97, v138, v139
  v_mfma_f32_16x16x32_bf16 v[196:199], a[240:243], v[36:39], v[196:199]
  v_cvt_pk_bf16_f32 v98, v152, v153
  v_cvt_pk_bf16_f32 v99, v154, v155
  v_mfma_f32_16x16x32_bf16 v[200:203], a[240:243], v[40:43], v[200:203]
  ds_read_b128 a[168:171], v6 offset:2048
  v_cvt_pk_bf16_f32 v112, v140, v141
  v_cvt_pk_bf16_f32 v113, v142, v143
  v_mfma_f32_16x16x32_bf16 v[204:207], a[240:243], v[44:47], v[204:207]
  ds_read_b128 a[172:175], v7 offset:2048
  v_cvt_pk_bf16_f32 v114, v156, v157
  v_cvt_pk_bf16_f32 v115, v158, v159
  v_mfma_f32_16x16x32_bf16 v[208:211], a[244:247], v[32:35], v[208:211]
  v_cvt_pk_bf16_f32 v68, v160, v161
  v_cvt_pk_bf16_f32 v69, v162, v163
  v_mfma_f32_16x16x32_bf16 v[212:215], a[244:247], v[36:39], v[212:215]
  ds_read_b128 a[176:179], v4 offset:3072
  v_cvt_pk_bf16_f32 v70, v176, v177
  v_cvt_pk_bf16_f32 v71, v178, v179
  v_mfma_f32_16x16x32_bf16 v[216:219], a[244:247], v[40:43], v[216:219]
  s_mov_b32 s38, 49152
  ds_read_b128 a[180:183], v5 offset:3072
  v_cvt_pk_bf16_f32 v84, v164, v165
  v_cvt_pk_bf16_f32 v85, v166, v167
  v_mfma_f32_16x16x32_bf16 v[220:223], a[244:247], v[44:47], v[220:223]
  s_waitcnt lgkmcnt(14)
  buffer_load_dwordx4 v16, s[4:7], s38 offen offset:3072 lds
  v_cvt_pk_bf16_f32 v86, v180, v181
  v_cvt_pk_bf16_f32 v87, v182, v183
  v_mfma_f32_16x16x32_bf16 v[224:227], a[248:251], v[32:35], v[224:227]
  v_cvt_pk_bf16_f32 v100, v168, v169
  v_cvt_pk_bf16_f32 v101, v170, v171
  v_mfma_f32_16x16x32_bf16 v[228:231], a[248:251], v[36:39], v[228:231]
  ds_read_b128 a[184:187], v6 offset:3072
  v_cvt_pk_bf16_f32 v102, v184, v185
  v_cvt_pk_bf16_f32 v103, v186, v187
  v_mfma_f32_16x16x32_bf16 v[232:235], a[248:251], v[40:43], v[232:235]
  ds_read_b128 a[188:191], v7 offset:3072
  v_cvt_pk_bf16_f32 v116, v172, v173
  v_cvt_pk_bf16_f32 v117, v174, v175
  v_mfma_f32_16x16x32_bf16 v[236:239], a[248:251], v[44:47], v[236:239]
  v_cvt_pk_bf16_f32 v118, v188, v189
  v_cvt_pk_bf16_f32 v119, v190, v191
  v_mfma_f32_16x16x32_bf16 v[240:243], a[252:255], v[32:35], v[240:243]
  v_cvt_pk_bf16_f32 v72, v192, v193
  v_cvt_pk_bf16_f32 v73, v194, v195
  v_mfma_f32_16x16x32_bf16 v[244:247], a[252:255], v[36:39], v[244:247]
  v_cvt_pk_bf16_f32 v74, v208, v209
  v_cvt_pk_bf16_f32 v75, v210, v211
  v_mfma_f32_16x16x32_bf16 v[248:251], a[252:255], v[40:43], v[248:251]
  v_cvt_pk_bf16_f32 v88, v196, v197
  v_cvt_pk_bf16_f32 v89, v198, v199
  v_mfma_f32_16x16x32_bf16 v[252:255], a[252:255], v[44:47], v[252:255]
  v_cvt_pk_bf16_f32 v90, v212, v213
  v_cvt_pk_bf16_f32 v91, v214, v215
  v_cvt_pk_bf16_f32 v104, v200, v201
  v_cvt_pk_bf16_f32 v105, v202, v203
  v_cvt_pk_bf16_f32 v106, v216, v217
  v_cvt_pk_bf16_f32 v107, v218, v219
  v_cvt_pk_bf16_f32 v120, v204, v205
  v_cvt_pk_bf16_f32 v121, v206, v207
  v_cvt_pk_bf16_f32 v122, v220, v221
  v_cvt_pk_bf16_f32 v123, v222, v223
  v_cmp_eq_u32 s[30:31], s68, v20
  v_cmp_eq_u32 s[32:33], s25, v21
  v_mov_b32 v24, 0xff7fffff
  v_mov_b32 v25, 0xff7fffff
  v_mov_b32 v26, 0xff7fffff
  v_mov_b32 v27, 0xff7fffff
  s_and_b32 s30, s30, s32
  s_lshr_b32 s31, s30, 16
  s_and_b32 s30, s30, 0xffff
  s_cmp_eq_u32 s30, 0xffff
  s_cselect_b32 s25, 1, 0
  s_cmp_eq_u32 s31, 0xffff
  s_cselect_b32 s31, 2, 0
  s_or_b32 s25, s25, s31
  v_cvt_pk_bf16_f32 v76, v224, v225
  v_cvt_pk_bf16_f32 v77, v226, v227
  v_cvt_pk_bf16_f32 v78, v240, v241
  v_cvt_pk_bf16_f32 v79, v242, v243
  v_cvt_pk_bf16_f32 v92, v228, v229
  v_cvt_pk_bf16_f32 v93, v230, v231
  v_cvt_pk_bf16_f32 v94, v244, v245
  v_cvt_pk_bf16_f32 v95, v246, v247
  v_cvt_pk_bf16_f32 v108, v232, v233
  v_cvt_pk_bf16_f32 v109, v234, v235
  v_cvt_pk_bf16_f32 v110, v248, v249
  v_cvt_pk_bf16_f32 v111, v250, v251
  v_cvt_pk_bf16_f32 v124, v236, v237
  v_cvt_pk_bf16_f32 v125, v238, v239
  v_cvt_pk_bf16_f32 v126, v252, v253
  v_cvt_pk_bf16_f32 v127, v254, v255
L_attn_restart:
  s_waitcnt lgkmcnt(0)
  v_mfma_f32_16x16x32_bf16 v[128:131], a[128:131], v[64:67], 0
  s_lshl_b32 s41, s2, 2
  v_and_b32 v3, 15, v1
  v_lshrrev_b32 v2, 4, v1
  v_mfma_f32_16x16x32_bf16 v[128:131], a[132:135], v[68:71], v[128:131]
  s_add_u32 s41, s41, s24
  v_lshrrev_b32 v28, 2, v3
  v_lshl_add_u32 v29, v2, 4, v28
  v_mfma_f32_16x16x32_bf16 v[128:131], a[136:139], v[72:75], v[128:131]
  s_lshl_b32 s41, s41, 13
  v_lshlrev_b32 v29, 8, v29
  v_and_b32 v30, 1, v2
  v_mfma_f32_16x16x32_bf16 v[128:131], a[140:143], v[76:79], v[128:131]
  s_mov_b32 s27, 65536
  v_lshl_add_u32 v28, v30, 2, v28
  v_lshl_add_u32 v29, v28, 5, v29
  v_mfma_f32_16x16x32_bf16 v[132:135], a[156:159], v[76:79], 0
  s_mov_b32 s28, 0
  v_and_b32 v30, 3, v3
  v_lshl_add_u32 v29, v30, 3, v29
  v_mfma_f32_16x16x32_bf16 v[132:135], a[152:155], v[72:75], v[132:135]
  s_and_b32 s1, s41, 2097151
  v_add_u32 v8, 65536, v29
  v_cmp_gt_u32 s[32:33], 10, v1
  v_mfma_f32_16x16x32_bf16 v[132:135], a[148:151], v[68:71], v[132:135]
  s_mov_b32 s40, 0x40000000
  v_lshlrev_b32 v49, 7, v1
  v_mov_b32 v48, 0x40000000
  v_mfma_f32_16x16x32_bf16 v[132:135], a[144:147], v[64:67], v[132:135]
  s_mov_b32 s44, 0x40000000
  v_xor_b32 v9, 32, v8
  v_xor_b32 v10, 64, v8
  v_mfma_f32_16x16x32_bf16 v[136:139], a[128:131], v[80:83], 0
  s_add_u32 s34, s3, 0
  s_add_u32 m0, s43, 131072
  v_xor_b32 v11, 96, v8
  v_xor_b32 v12, 128, v8
  v_mfma_f32_16x16x32_bf16 v[136:139], a[132:135], v[84:87], v[136:139]
  s_mov_b32 s0, 0x40000000
  buffer_load_dwordx4 v51, s[56:59], s34 offen offset:0 lds
  v_mfma_f32_16x16x32_bf16 v[136:139], a[136:139], v[88:91], v[136:139]
  s_add_u32 s35, s3, 43008
  v_xor_b32 v13, 160, v8
  v_xor_b32 v14, 192, v8
  v_mfma_f32_16x16x32_bf16 v[136:139], a[140:143], v[92:95], v[136:139]
  s_mov_b32 s42, 0x40000000
  buffer_load_dwordx4 v51, s[56:59], s35 offen offset:1024 lds
  v_mfma_f32_16x16x32_bf16 v[140:143], a[156:159], v[92:95], 0
  s_add_u32 s36, s3, 86016
  v_xor_b32 v15, 224, v8
  v_cndmask_b32 v48, v48, v49, s[32:33]
  v_mfma_f32_16x16x32_bf16 v[140:143], a[152:155], v[88:91], v[140:143]
  s_lshl_b32 s38, s41, 1
  buffer_load_dwordx4 v51, s[56:59], s36 offen offset:2048 lds
  v_mfma_f32_16x16x32_bf16 v[140:143], a[148:151], v[84:87], v[140:143]
  s_add_u32 s37, s3, 129024
  v_lshrrev_b32 v2, 5, v1
  v_and_b32 v3, 31, v1
  v_mfma_f32_16x16x32_bf16 v[140:143], a[144:147], v[80:83], v[140:143]
  s_cmp_lt_u32 s41, 6291456
  buffer_load_dwordx4 v51, s[56:59], s37 offen offset:3072 lds
  v_mfma_f32_16x16x32_bf16 v[144:147], a[128:131], v[96:99], 0
  s_cselect_b32 s12, s56, s60
  v_max3_f32 v24, v24, v128, v129
  v_lshlrev_b32 v2, 15, v2
  v_mfma_f32_16x16x32_bf16 v[144:147], a[132:135], v[100:103], v[144:147]
  s_cselect_b32 s13, s57, s61
  v_max3_f32 v24, v24, v130, v131
  v_lshl_add_u32 v2, v3, 7, v2
  v_mfma_f32_16x16x32_bf16 v[144:147], a[136:139], v[104:107], v[144:147]
  s_cselect_b32 s14, s58, s62
  v_max3_f32 v24, v24, v132, v133
  v_cmp_gt_u32 s[32:33], 20, v1
  v_mfma_f32_16x16x32_bf16 v[144:147], a[140:143], v[108:111], v[144:147]
  s_mov_b32 s45, 0x40000000
  v_max3_f32 v24, v24, v134, v135
  v_mov_b32 v3, 0x40000000
  v_mfma_f32_16x16x32_bf16 v[148:151], a[156:159], v[108:111], 0
  s_add_u32 s34, s3, 176128
  s_add_u32 m0, s43, 147456
  v_nop
  v_cndmask_b32 v3, v3, v49, s[32:33]
  v_mfma_f32_16x16x32_bf16 v[148:151], a[152:155], v[104:107], v[148:151]
  s_add_u32 s16, s46, 4194304
  s_addc_u32 s17, s47, 0
  buffer_load_dwordx4 v51, s[56:59], s34 offen offset:0 lds
  v_mfma_f32_16x16x32_bf16 v[148:151], a[148:151], v[100:103], v[148:151]
  s_add_u32 s35, s3, 219136
  v_mov_b32 v224, 0x3f803f80
  v_mov_b32 v225, 0x3f803f80
  v_mfma_f32_16x16x32_bf16 v[148:151], a[144:147], v[96:99], v[148:151]
  s_cmp_lt_u32 s41, 4194304
  buffer_load_dwordx4 v51, s[56:59], s35 offen offset:1024 lds
  v_mfma_f32_16x16x32_bf16 v[152:155], a[128:131], v[112:115], 0
  s_cselect_b32 s12, s52, s12
  v_max3_f32 v25, v25, v136, v137
  v_mov_b32 v226, 0x3f803f80
  v_mfma_f32_16x16x32_bf16 v[152:155], a[132:135], v[116:119], v[152:155]
  s_cselect_b32 s13, s53, s13
  v_max3_f32 v25, v25, v138, v139
  v_mov_b32 v227, 0x3f803f80
  v_mfma_f32_16x16x32_bf16 v[152:155], a[136:139], v[120:123], v[152:155]
  s_cselect_b32 s14, s54, s14
  v_max3_f32 v25, v25, v140, v141
  v_mov_b32 v228, 0
  v_mfma_f32_16x16x32_bf16 v[152:155], a[140:143], v[124:127], v[152:155]
  s_cselect_b32 s1, s41, s1
  v_max3_f32 v25, v25, v142, v143
  v_mov_b32 v229, 0
  v_mfma_f32_16x16x32_bf16 v[156:159], a[156:159], v[124:127], 0
  s_add_u32 s36, s3, 262144
  v_mov_b32 v230, 0
  v_mov_b32 v231, 0
  v_mfma_f32_16x16x32_bf16 v[156:159], a[152:155], v[120:123], v[156:159]
  s_mov_b32 s18, 16777216
  buffer_load_dwordx4 v51, s[56:59], s36 offen offset:2048 lds
  v_mfma_f32_16x16x32_bf16 v[156:159], a[148:151], v[116:119], v[156:159]
  s_add_u32 s37, s3, 305152
  v_mov_b32 v232, 0
  v_mov_b32 v233, 0
  v_mfma_f32_16x16x32_bf16 v[156:159], a[144:147], v[112:115], v[156:159]
  s_mov_b64 s[76:77], 0
  s_mov_b32 s78, 0
  buffer_load_dwordx4 v51, s[56:59], s37 offen offset:3072 lds
  v_mov_b32 v234, 0
  v_mov_b32 v235, 0
  v_mov_b32 v236, 0
  v_mov_b32 v237, 0
  v_mov_b32 v238, 0
  v_mov_b32 v239, 0
  v_mov_b32 v240, 0
  v_mov_b32 v241, 0
  v_mov_b32 v242, 0
  v_mov_b32 v243, 0
  v_max3_f32 v26, v26, v144, v145
  v_max3_f32 v26, v26, v146, v147
  v_max3_f32 v26, v26, v148, v149
  v_max3_f32 v26, v26, v150, v151
  v_max3_f32 v27, v27, v152, v153
  v_max3_f32 v27, v27, v154, v155
  v_max3_f32 v27, v27, v156, v157
  v_max3_f32 v27, v27, v158, v159
  v_mov_b32 v28, v24
  v_mov_b32 v29, v25
  v_mov_b32 v30, v26
  v_mov_b32 v31, v27
  v_permlane32_swap_b32 v24, v28
  v_permlane32_swap_b32 v25, v29
  v_permlane32_swap_b32 v26, v30
  v_permlane32_swap_b32 v27, v31
  v_max_f32 v24, v24, v28
  v_max_f32 v25, v25, v29
  v_max_f32 v26, v26, v30
  v_max_f32 v27, v27, v31
  v_mov_b32 v28, v24
  v_mov_b32 v29, v25
  v_mov_b32 v30, v26
  v_mov_b32 v31, v27
  v_permlane16_swap_b32 v24, v28
  v_permlane16_swap_b32 v25, v29
  v_permlane16_swap_b32 v26, v30
  v_permlane16_swap_b32 v27, v31
  v_max_f32 v24, v24, v28
  v_max_f32 v25, v25, v29
  v_max_f32 v26, v26, v30
  v_max_f32 v27, v27, v31
  v_pk_mul_f32 v[32:33], v[24:25], -1.0 op_sel:[0,0] op_sel_hi:[0,0]
  v_pk_mul_f32 v[34:35], v[24:25], -1.0 op_sel:[0,0] op_sel_hi:[0,0]
  v_pk_mul_f32 v[36:37], v[24:25], -1.0 op_sel:[1,0] op_sel_hi:[1,0]
  v_pk_mul_f32 v[38:39], v[24:25], -1.0 op_sel:[1,0] op_sel_hi:[1,0]
  v_pk_mul_f32 v[40:41], v[26:27], -1.0 op_sel:[0,0] op_sel_hi:[0,0]
  v_pk_mul_f32 v[42:43], v[26:27], -1.0 op_sel:[0,0] op_sel_hi:[0,0]
  v_pk_mul_f32 v[44:45], v[26:27], -1.0 op_sel:[1,0] op_sel_hi:[1,0]
  v_pk_mul_f32 v[46:47], v[26:27], -1.0 op_sel:[1,0] op_sel_hi:[1,0]
  v_pk_add_f32 v[128:129], v[128:129], v[32:33]
  v_pk_add_f32 v[130:131], v[130:131], v[32:33]
  v_pk_add_f32 v[132:133], v[132:133], v[32:33]
  v_pk_add_f32 v[134:135], v[134:135], v[32:33]
  v_pk_add_f32 v[136:137], v[136:137], v[36:37]
  v_pk_add_f32 v[138:139], v[138:139], v[36:37]
  v_pk_add_f32 v[140:141], v[140:141], v[36:37]
  v_pk_add_f32 v[142:143], v[142:143], v[36:37]
  v_pk_add_f32 v[144:145], v[144:145], v[40:41]
  v_pk_add_f32 v[146:147], v[146:147], v[40:41]
  v_pk_add_f32 v[148:149], v[148:149], v[40:41]
  v_pk_add_f32 v[150:151], v[150:151], v[40:41]
  v_pk_add_f32 v[152:153], v[152:153], v[44:45]
  v_pk_add_f32 v[154:155], v[154:155], v[44:45]
  v_pk_add_f32 v[156:157], v[156:157], v[44:45]
  v_pk_add_f32 v[158:159], v[158:159], v[44:45]
  v_mfma_f32_16x16x32_bf16 v[160:163], a[160:163], v[64:67], v[32:35]
  s_waitcnt vmcnt(20)
  s_barrier
  s_sub_u32 s30, s27, 32768
  ds_read_b128 a[128:131], v4 offset:16384
  v_exp_f32 v128, v128
  v_mfma_f32_16x16x32_bf16 v[160:163], a[164:167], v[68:71], v[160:163]
  v_exp_f32 v129, v129
  v_mfma_f32_16x16x32_bf16 v[160:163], a[168:171], v[72:75], v[160:163]
  ds_read_b128 a[132:135], v5 offset:16384
  v_exp_f32 v130, v130
  v_mfma_f32_16x16x32_bf16 v[160:163], a[172:175], v[76:79], v[160:163]
  s_add_u32 m0, s26, 32768
  v_exp_f32 v131, v131
  v_cvt_pk_bf16_f32 v52, v128, v129
  v_mfma_f32_16x16x32_bf16 v[164:167], a[188:191], v[76:79], v[32:35]
  buffer_load_dwordx4 v17, s[8:11], s30 offen offset:0 lds
  v_exp_f32 v132, v132
  v_mfma_f32_16x16x32_bf16 v[164:167], a[184:187], v[72:75], v[164:167]
  v_exp_f32 v133, v133
  v_cvt_pk_bf16_f32 v53, v130, v131
  v_mfma_f32_16x16x32_bf16 v[164:167], a[180:183], v[68:71], v[164:167]
  v_exp_f32 v134, v134
  v_cvt_pk_bf16_f32 v54, v132, v133
  v_mfma_f32_16x16x32_bf16 v[164:167], a[176:179], v[64:67], v[164:167]
  ds_read_b128 a[136:139], v6 offset:16384
  v_exp_f32 v135, v135
  v_mfma_f32_16x16x32_bf16 v[172:175], a[176:179], v[80:83], v[36:39]
  v_exp_f32 v136, v136
  v_cvt_pk_bf16_f32 v55, v134, v135
  v_mfma_f32_16x16x32_bf16 v[172:175], a[180:183], v[84:87], v[172:175]
  ds_read_b128 a[140:143], v7 offset:16384
  v_exp_f32 v137, v137
  v_mfma_f32_16x16x32_bf16 v[172:175], a[184:187], v[88:91], v[172:175]
  v_exp_f32 v138, v138
  v_cvt_pk_bf16_f32 v56, v136, v137
  v_mfma_f32_16x16x32_bf16 v[172:175], a[188:191], v[92:95], v[172:175]
  buffer_load_dwordx4 v17, s[8:11], s30 offen offset:1024 lds
  v_exp_f32 v139, v139
  v_mfma_f32_16x16x32_bf16 v[168:171], a[172:175], v[92:95], v[36:39]
  v_exp_f32 v140, v140
  v_cvt_pk_bf16_f32 v57, v138, v139
  v_mfma_f32_16x16x32_bf16 v[168:171], a[168:171], v[88:91], v[168:171]
  v_exp_f32 v141, v141
  v_mfma_f32_16x16x32_bf16 v[168:171], a[164:167], v[84:87], v[168:171]
  ds_read_b128 a[144:147], v4 offset:17408
  v_exp_f32 v142, v142
  v_mfma_f32_16x16x32_bf16 v[168:171], a[160:163], v[80:83], v[168:171]
  v_exp_f32 v143, v143
  v_cvt_pk_bf16_f32 v58, v140, v141
  v_mfma_f32_16x16x32_bf16 v[176:179], a[160:163], v[96:99], v[40:43]
  ds_read_b128 a[148:151], v5 offset:17408
  v_exp_f32 v144, v144
  v_mfma_f32_16x16x32_bf16 v[176:179], a[164:167], v[100:103], v[176:179]
  v_exp_f32 v145, v145
  v_cvt_pk_bf16_f32 v59, v142, v143
  v_mfma_f32_16x16x32_bf16 v[176:179], a[168:171], v[104:107], v[176:179]
  buffer_load_dwordx4 v17, s[8:11], s30 offen offset:2048 lds
  v_exp_f32 v146, v146
  v_mfma_f32_16x16x32_bf16 v[176:179], a[172:175], v[108:111], v[176:179]
  v_exp_f32 v147, v147
  v_cvt_pk_bf16_f32 v60, v144, v145
  v_mfma_f32_16x16x32_bf16 v[180:183], a[188:191], v[108:111], v[40:43]
  v_exp_f32 v148, v148
  v_cvt_pk_bf16_f32 v61, v146, v147
  v_mfma_f32_16x16x32_bf16 v[180:183], a[184:187], v[104:107], v[180:183]
  ds_read_b128 a[152:155], v6 offset:17408
  v_exp_f32 v149, v149
  v_mfma_f32_16x16x32_bf16 v[180:183], a[180:183], v[100:103], v[180:183]
  v_exp_f32 v150, v150
  v_cvt_pk_bf16_f32 v62, v148, v149
  v_mfma_f32_16x16x32_bf16 v[180:183], a[176:179], v[96:99], v[180:183]
  ds_read_b128 a[156:159], v7 offset:17408
  v_exp_f32 v151, v151
  v_mfma_f32_16x16x32_bf16 v[188:191], a[176:179], v[112:115], v[44:47]
  v_exp_f32 v152, v152
  v_cvt_pk_bf16_f32 v63, v150, v151
  v_mfma_f32_16x16x32_bf16 v[188:191], a[180:183], v[116:119], v[188:191]
  buffer_load_dwordx4 v17, s[8:11], s30 offen offset:3072 lds
  v_exp_f32 v153, v153
  v_mfma_f32_16x16x32_bf16 v[188:191], a[184:187], v[120:123], v[188:191]
  v_exp_f32 v154, v154
  v_cvt_pk_bf16_f32 v244, v152, v153
  v_mfma_f32_16x16x32_bf16 v[188:191], a[188:191], v[124:127], v[188:191]
  v_exp_f32 v155, v155
  v_mfma_f32_16x16x32_bf16 v[184:187], a[172:175], v[124:127], v[44:47]
  v_exp_f32 v156, v156
  v_cvt_pk_bf16_f32 v245, v154, v155
  v_mfma_f32_16x16x32_bf16 v[184:187], a[168:171], v[120:123], v[184:187]
  v_exp_f32 v157, v157
  v_mfma_f32_16x16x32_bf16 v[184:187], a[164:167], v[116:119], v[184:187]
  v_exp_f32 v158, v158
  v_cvt_pk_bf16_f32 v246, v156, v157
  v_mfma_f32_16x16x32_bf16 v[184:187], a[160:163], v[112:115], v[184:187]
  s_waitcnt lgkmcnt(0)
  v_exp_f32 v159, v159
  s_nop 0
  v_cvt_pk_bf16_f32 v247, v158, v159
  v_mfma_f32_16x16x32_bf16 v[128:131], a[128:131], v[64:67], v[32:35]
  ds_read_b128 a[160:163], v4 offset:18432
  v_exp_f32 v160, v160
  v_mfma_f32_16x16x32_bf16 v[128:131], a[132:135], v[68:71], v[128:131]
  s_add_u32 m0, s43, 0
  ds_read_b64_tr_b16 a[224:225], v8 offset:0
  v_exp_f32 v161, v161
  v_mfma_f32_16x16x32_bf16 v[128:131], a[136:139], v[72:75], v[128:131]
  buffer_load_dwordx4 v16, s[4:7], s27 offen offset:0 lds
  v_exp_f32 v162, v162
  v_mfma_f32_16x16x32_bf16 v[128:131], a[140:143], v[76:79], v[128:131]
  ds_read_b128 a[164:167], v5 offset:18432
  v_exp_f32 v163, v163
  v_cvt_pk_bf16_f32 v248, v160, v161
  v_mfma_f32_16x16x32_bf16 v[132:135], a[156:159], v[76:79], v[32:35]
  ds_read_b64_tr_b16 a[226:227], v8 offset:1024
  v_exp_f32 v164, v164
  v_cvt_pk_bf16_f32 v249, v162, v163
  v_mfma_f32_16x16x32_bf16 v[132:135], a[152:155], v[72:75], v[132:135]
  ds_read_b128 a[168:171], v6 offset:18432
  v_exp_f32 v165, v165
  v_mfma_f32_16x16x32_bf16 v[132:135], a[148:151], v[68:71], v[132:135]
  ds_read_b64_tr_b16 a[228:229], v8 offset:2048
  v_exp_f32 v166, v166
  v_cvt_pk_bf16_f32 v250, v164, v165
  v_mfma_f32_16x16x32_bf16 v[132:135], a[144:147], v[64:67], v[132:135]
  ds_read_b128 a[172:175], v7 offset:18432
  v_exp_f32 v167, v167
  v_mfma_f32_16x16x32_bf16 v[140:143], a[144:147], v[80:83], v[36:39]
  ds_read_b64_tr_b16 a[230:231], v8 offset:3072
  v_exp_f32 v168, v168
  v_cvt_pk_bf16_f32 v251, v166, v167
  v_mfma_f32_16x16x32_bf16 v[140:143], a[148:151], v[84:87], v[140:143]
  buffer_load_dwordx4 v16, s[4:7], s27 offen offset:1024 lds
  v_exp_f32 v169, v169
  v_mfma_f32_16x16x32_bf16 v[140:143], a[152:155], v[88:91], v[140:143]
  ds_read_b128 a[176:179], v4 offset:19456
  v_exp_f32 v170, v170
  v_cvt_pk_bf16_f32 v252, v168, v169
  v_mfma_f32_16x16x32_bf16 v[140:143], a[156:159], v[92:95], v[140:143]
  ds_read_b64_tr_b16 a[232:233], v9 offset:0
  v_exp_f32 v171, v171
  v_mfma_f32_16x16x32_bf16 v[136:139], a[140:143], v[92:95], v[36:39]
  ds_read_b128 a[180:183], v5 offset:19456
  v_exp_f32 v172, v172
  v_cvt_pk_bf16_f32 v253, v170, v171
  v_mfma_f32_16x16x32_bf16 v[136:139], a[136:139], v[88:91], v[136:139]
  ds_read_b64_tr_b16 a[234:235], v9 offset:1024
  v_exp_f32 v173, v173
  v_mfma_f32_16x16x32_bf16 v[136:139], a[132:135], v[84:87], v[136:139]
  ds_read_b128 a[184:187], v6 offset:19456
  v_exp_f32 v174, v174
  v_cvt_pk_bf16_f32 v254, v172, v173
  v_mfma_f32_16x16x32_bf16 v[136:139], a[128:131], v[80:83], v[136:139]
  ds_read_b64_tr_b16 a[236:237], v9 offset:2048
  v_exp_f32 v175, v175
  v_mfma_f32_16x16x32_bf16 v[144:147], a[128:131], v[96:99], v[40:43]
  buffer_load_dwordx4 v16, s[4:7], s27 offen offset:2048 lds
  v_exp_f32 v176, v176
  v_mfma_f32_16x16x32_bf16 v[144:147], a[132:135], v[100:103], v[144:147]
  ds_read_b128 a[188:191], v7 offset:19456
  v_exp_f32 v177, v177
  v_cvt_pk_bf16_f32 v255, v174, v175
  v_mfma_f32_16x16x32_bf16 v[144:147], a[136:139], v[104:107], v[144:147]
  ds_read_b64_tr_b16 a[238:239], v9 offset:3072
  v_exp_f32 v178, v178
  v_cvt_pk_bf16_f32 v20, v176, v177
  v_mfma_f32_16x16x32_bf16 v[144:147], a[140:143], v[108:111], v[144:147]
  ds_read_b64_tr_b16 a[240:241], v10 offset:0
  v_exp_f32 v179, v179
  v_mfma_f32_16x16x32_bf16 v[148:151], a[156:159], v[108:111], v[40:43]
  ds_read_b64_tr_b16 a[242:243], v10 offset:1024
  v_exp_f32 v180, v180
  v_cvt_pk_bf16_f32 v21, v178, v179
  v_mfma_f32_16x16x32_bf16 v[148:151], a[152:155], v[104:107], v[148:151]
  ds_read_b64_tr_b16 a[244:245], v10 offset:2048
  v_exp_f32 v181, v181
  v_mfma_f32_16x16x32_bf16 v[148:151], a[148:151], v[100:103], v[148:151]
  ds_read_b64_tr_b16 a[246:247], v10 offset:3072
  v_exp_f32 v182, v182
  v_cvt_pk_bf16_f32 v22, v180, v181
  v_mfma_f32_16x16x32_bf16 v[148:151], a[144:147], v[96:99], v[148:151]
  buffer_load_dwordx4 v16, s[4:7], s27 offen offset:3072 lds
  v_exp_f32 v183, v183
  v_mfma_f32_16x16x32_bf16 v[156:159], a[144:147], v[112:115], v[44:47]
  ds_read_b64_tr_b16 a[248:249], v11 offset:0
  v_exp_f32 v184, v184
  v_mfma_f32_16x16x32_bf16 v[156:159], a[148:151], v[116:119], v[156:159]
  ds_read_b64_tr_b16 a[250:251], v11 offset:1024
  v_exp_f32 v185, v185
  v_mfma_f32_16x16x32_bf16 v[156:159], a[152:155], v[120:123], v[156:159]
  ds_read_b64_tr_b16 a[252:253], v11 offset:2048
  v_exp_f32 v186, v186
  v_mfma_f32_16x16x32_bf16 v[156:159], a[156:159], v[124:127], v[156:159]
  ds_read_b64_tr_b16 a[254:255], v11 offset:3072
  v_exp_f32 v187, v187
  v_mfma_f32_16x16x32_bf16 v[152:155], a[140:143], v[124:127], v[44:47]
  v_exp_f32 v188, v188
  v_cvt_pk_bf16_f32 v23, v182, v183
  v_mfma_f32_16x16x32_bf16 v[152:155], a[136:139], v[120:123], v[152:155]
  v_exp_f32 v189, v189
  v_cvt_pk_bf16_f32 v28, v184, v185
  v_mfma_f32_16x16x32_bf16 v[152:155], a[132:135], v[116:119], v[152:155]
  s_add_u32 s27, s27, 16384
  v_exp_f32 v190, v190
  v_cvt_pk_bf16_f32 v29, v186, v187
  v_mfma_f32_16x16x32_bf16 v[152:155], a[128:131], v[112:115], v[152:155]
  s_waitcnt vmcnt(20) lgkmcnt(0)
  s_barrier
  v_exp_f32 v191, v191
  v_cvt_pk_bf16_f32 v30, v188, v189
  s_nop 0
  v_cvt_pk_bf16_f32 v31, v190, v191
.p2align 6
L_attn_loop:
  v_mfma_f32_16x16x32_bf16 v[160:163], a[160:163], v[64:67], v[32:35]
  s_sub_u32 s30, s27, 32768
  v_exp_f32 v128, v128
  v_mfma_f32_16x16x32_bf16 v[160:163], a[164:167], v[68:71], v[160:163]
  ds_read_b128 a[128:131], v4 offset:32768
  v_mfma_f32_16x16x32_bf16 v[160:163], a[168:171], v[72:75], v[160:163]
  v_exp_f32 v129, v129
  v_mfma_f32_16x16x32_bf16 v[160:163], a[172:175], v[76:79], v[160:163]
  ds_read_b64_tr_b16 a[192:193], v12 offset:0
  v_cvt_pk_bf16_f32 v192, v128, v129
  v_mfma_f32_16x16x32_bf16 v[164:167], a[188:191], v[76:79], v[32:35]
  s_add_u32 m0, s26, 49152
  v_exp_f32 v130, v130
  v_mfma_f32_16x16x32_bf16 v[164:167], a[184:187], v[72:75], v[164:167]
  buffer_load_dwordx4 v17, s[8:11], s30 offen offset:0 lds
  v_mfma_f32_16x16x32_bf16 v[164:167], a[180:183], v[68:71], v[164:167]
  v_exp_f32 v131, v131
  v_mfma_f32_16x16x32_bf16 v[164:167], a[176:179], v[64:67], v[164:167]
  ds_read_b128 a[132:135], v5 offset:32768
  v_cvt_pk_bf16_f32 v193, v130, v131
  v_mfma_f32_16x16x32_bf16 v[172:175], a[176:179], v[80:83], v[36:39]
  v_exp_f32 v132, v132
  v_mfma_f32_16x16x32_bf16 v[172:175], a[180:183], v[84:87], v[172:175]
  ds_read_b64_tr_b16 a[194:195], v12 offset:1024
  v_mfma_f32_16x16x32_bf16 v[172:175], a[184:187], v[88:91], v[172:175]
  v_exp_f32 v133, v133
  v_mfma_f32_16x16x32_bf16 v[172:175], a[188:191], v[92:95], v[172:175]
  ds_read_b128 a[136:139], v6 offset:32768
  v_cvt_pk_bf16_f32 v194, v132, v133
  v_mfma_f32_16x16x32_bf16 v[168:171], a[172:175], v[92:95], v[36:39]
  v_exp_f32 v134, v134
  v_mfma_f32_16x16x32_bf16 v[168:171], a[168:171], v[88:91], v[168:171]
  ds_read_b64_tr_b16 a[196:197], v12 offset:2048
  v_mfma_f32_16x16x32_bf16 v[168:171], a[164:167], v[84:87], v[168:171]
  v_exp_f32 v135, v135
  v_mfma_f32_16x16x32_bf16 v[168:171], a[160:163], v[80:83], v[168:171]
  buffer_load_dwordx4 v17, s[8:11], s30 offen offset:1024 lds
  v_mfma_f32_16x16x32_bf16 v[176:179], a[160:163], v[96:99], v[40:43]
  ds_read_b128 a[140:143], v7 offset:32768
  v_cvt_pk_bf16_f32 v195, v134, v135
  v_mfma_f32_16x16x32_bf16 v[176:179], a[164:167], v[100:103], v[176:179]
  v_exp_f32 v136, v136
  v_mfma_f32_16x16x32_bf16 v[176:179], a[168:171], v[104:107], v[176:179]
  ds_read_b64_tr_b16 a[198:199], v12 offset:3072
  v_mfma_f32_16x16x32_bf16 v[176:179], a[172:175], v[108:111], v[176:179]
  v_exp_f32 v137, v137
  v_mfma_f32_16x16x32_bf16 v[180:183], a[188:191], v[108:111], v[40:43]
  ds_read_b128 a[144:147], v4 offset:33792
  v_cvt_pk_bf16_f32 v196, v136, v137
  v_mfma_f32_16x16x32_bf16 v[180:183], a[184:187], v[104:107], v[180:183]
  v_exp_f32 v138, v138
  v_mfma_f32_16x16x32_bf16 v[180:183], a[180:183], v[100:103], v[180:183]
  ds_read_b64_tr_b16 a[200:201], v13 offset:0
  v_mfma_f32_16x16x32_bf16 v[180:183], a[176:179], v[96:99], v[180:183]
  v_exp_f32 v139, v139
  v_mfma_f32_16x16x32_bf16 v[188:191], a[176:179], v[112:115], v[44:47]
  ds_read_b128 a[148:151], v5 offset:33792
  v_cvt_pk_bf16_f32 v197, v138, v139
  v_mfma_f32_16x16x32_bf16 v[188:191], a[180:183], v[116:119], v[188:191]
  v_exp_f32 v140, v140
  v_mfma_f32_16x16x32_bf16 v[188:191], a[184:187], v[120:123], v[188:191]
  buffer_load_dwordx4 v17, s[8:11], s30 offen offset:2048 lds
  v_mfma_f32_16x16x32_bf16 v[188:191], a[188:191], v[124:127], v[188:191]
  v_exp_f32 v141, v141
  v_mfma_f32_16x16x32_bf16 v[184:187], a[172:175], v[124:127], v[44:47]
  ds_read_b64_tr_b16 a[202:203], v13 offset:1024
  v_cvt_pk_bf16_f32 v198, v140, v141
  v_mfma_f32_16x16x32_bf16 v[184:187], a[168:171], v[120:123], v[184:187]
  v_exp_f32 v142, v142
  v_mfma_f32_16x16x32_bf16 v[184:187], a[164:167], v[116:119], v[184:187]
  v_mfma_f32_16x16x32_bf16 v[184:187], a[160:163], v[112:115], v[184:187]
  v_exp_f32 v143, v143
  v_mfma_f32_16x16x32_bf16 a[0:3], a[224:227], v[52:55], a[0:3]
  ds_read_b128 a[152:155], v6 offset:33792
  v_cvt_pk_bf16_f32 v199, v142, v143
  v_mfma_f32_16x16x32_bf16 a[0:3], a[228:231], v[248:251], a[0:3]
L_attn_st6:
  s_cbranch_vccnz L_attn_st9
  ds_read_b64_tr_b16 a[204:205], v13 offset:2048
  v_mfma_f32_16x16x32_bf16 a[4:7], a[228:231], v[252:255], a[4:7]
  v_exp_f32 v144, v144
  v_mfma_f32_16x16x32_bf16 a[4:7], a[224:227], v[56:59], a[4:7]
  ds_read_b128 a[156:159], v7 offset:33792
  v_mfma_f32_16x16x32_bf16 a[8:11], a[224:227], v[60:63], a[8:11]
  v_exp_f32 v145, v145
  v_mfma_f32_16x16x32_bf16 a[8:11], a[228:231], v[20:23], a[8:11]
  ds_read_b64_tr_b16 a[206:207], v13 offset:3072
  v_cvt_pk_bf16_f32 v200, v144, v145
  v_mfma_f32_16x16x32_bf16 a[12:15], a[228:231], v[28:31], a[12:15]
  v_exp_f32 v146, v146
  v_mfma_f32_16x16x32_bf16 a[12:15], a[224:227], v[244:247], a[12:15]
  buffer_load_dwordx4 v17, s[8:11], s30 offen offset:3072 lds
  v_mfma_f32_16x16x32_bf16 a[28:31], a[232:235], v[244:247], a[28:31]
  v_exp_f32 v147, v147
  v_mfma_f32_16x16x32_bf16 a[28:31], a[236:239], v[28:31], a[28:31]
  ds_read_b64_tr_b16 a[208:209], v14 offset:0
  v_cvt_pk_bf16_f32 v201, v146, v147
  v_mfma_f32_16x16x32_bf16 a[24:27], a[236:239], v[20:23], a[24:27]
  v_exp_f32 v148, v148
  v_mfma_f32_16x16x32_bf16 a[24:27], a[232:235], v[60:63], a[24:27]
  ds_read_b64_tr_b16 a[210:211], v14 offset:1024
  v_mfma_f32_16x16x32_bf16 a[20:23], a[232:235], v[56:59], a[20:23]
  v_exp_f32 v149, v149
  v_mfma_f32_16x16x32_bf16 a[20:23], a[236:239], v[252:255], a[20:23]
  ds_read_b64_tr_b16 a[212:213], v14 offset:2048
  v_cvt_pk_bf16_f32 v202, v148, v149
  v_mfma_f32_16x16x32_bf16 a[16:19], a[236:239], v[248:251], a[16:19]
  v_exp_f32 v150, v150
  v_mfma_f32_16x16x32_bf16 a[16:19], a[232:235], v[52:55], a[16:19]
  ds_read_b64_tr_b16 a[214:215], v14 offset:3072
  v_mfma_f32_16x16x32_bf16 a[32:35], a[240:243], v[52:55], a[32:35]
  v_exp_f32 v151, v151
  v_mfma_f32_16x16x32_bf16 a[32:35], a[244:247], v[248:251], a[32:35]
  ds_read_b64_tr_b16 a[216:217], v15 offset:0
  v_cvt_pk_bf16_f32 v203, v150, v151
  v_mfma_f32_16x16x32_bf16 a[36:39], a[244:247], v[252:255], a[36:39]
  buffer_load_dword v50, v48, s[12:15], s1 offen
  v_mfma_f32_16x16x32_bf16 a[36:39], a[240:243], v[56:59], a[36:39]
  v_exp_f32 v152, v152
  v_mfma_f32_16x16x32_bf16 a[40:43], a[240:243], v[60:63], a[40:43]
  ds_read_b64_tr_b16 a[218:219], v15 offset:1024
  v_mfma_f32_16x16x32_bf16 a[40:43], a[244:247], v[20:23], a[40:43]
  v_exp_f32 v153, v153
  v_mfma_f32_16x16x32_bf16 a[44:47], a[244:247], v[28:31], a[44:47]
  ds_read_b64_tr_b16 a[220:221], v15 offset:2048
  v_cvt_pk_bf16_f32 v204, v152, v153
  v_mfma_f32_16x16x32_bf16 a[44:47], a[240:243], v[244:247], a[44:47]
  v_exp_f32 v154, v154
  v_mfma_f32_16x16x32_bf16 a[60:63], a[248:251], v[244:247], a[60:63]
  ds_read_b64_tr_b16 a[222:223], v15 offset:3072
  v_mfma_f32_16x16x32_bf16 a[60:63], a[252:255], v[28:31], a[60:63]
  v_exp_f32 v155, v155
  v_mfma_f32_16x16x32_bf16 a[56:59], a[252:255], v[20:23], a[56:59]
  v_cvt_pk_bf16_f32 v205, v154, v155
  v_mfma_f32_16x16x32_bf16 a[56:59], a[248:251], v[60:63], a[56:59]
  v_exp_f32 v156, v156
  v_mfma_f32_16x16x32_bf16 a[52:55], a[248:251], v[56:59], a[52:55]
  v_mfma_f32_16x16x32_bf16 a[52:55], a[252:255], v[252:255], a[52:55]
  v_exp_f32 v157, v157
  v_mfma_f32_16x16x32_bf16 a[48:51], a[252:255], v[248:251], a[48:51]
  v_cvt_pk_bf16_f32 v206, v156, v157
  v_mfma_f32_16x16x32_bf16 a[48:51], a[248:251], v[52:55], a[48:51]
  v_exp_f32 v158, v158
  v_mfma_f32_16x16x32_bf16 v[228:231], v[224:227], v[52:55], v[228:231]
  v_mfma_f32_16x16x32_bf16 v[228:231], v[224:227], v[248:251], v[228:231]
  v_exp_f32 v159, v159
  v_mfma_f32_16x16x32_bf16 v[232:235], v[224:227], v[56:59], v[232:235]
  v_cvt_pk_bf16_f32 v207, v158, v159
  v_mfma_f32_16x16x32_bf16 v[232:235], v[224:227], v[252:255], v[232:235]
  s_waitcnt lgkmcnt(0)
  v_mfma_f32_16x16x32_bf16 v[128:131], a[128:131], v[64:67], v[32:35]
  v_exp_f32 v160, v160
  v_mfma_f32_16x16x32_bf16 v[128:131], a[132:135], v[68:71], v[128:131]
  ds_read_b128 a[160:163], v4 offset:34816
  v_mfma_f32_16x16x32_bf16 v[128:131], a[136:139], v[72:75], v[128:131]
  v_exp_f32 v161, v161
  v_mfma_f32_16x16x32_bf16 v[128:131], a[140:143], v[76:79], v[128:131]
  ds_read_b64_tr_b16 a[224:225], v8 offset:16384
  v_cvt_pk_bf16_f32 v208, v160, v161
  v_mfma_f32_16x16x32_bf16 v[132:135], a[156:159], v[76:79], v[32:35]
  s_add_u32 m0, s43, 16384
  v_exp_f32 v162, v162
  v_mfma_f32_16x16x32_bf16 v[132:135], a[152:155], v[72:75], v[132:135]
  buffer_load_dwordx4 v16, s[4:7], s27 offen offset:0 lds
  v_mfma_f32_16x16x32_bf16 v[132:135], a[148:151], v[68:71], v[132:135]
  v_exp_f32 v163, v163
  v_mfma_f32_16x16x32_bf16 v[132:135], a[144:147], v[64:67], v[132:135]
  ds_read_b128 a[164:167], v5 offset:34816
  v_cvt_pk_bf16_f32 v209, v162, v163
  v_mfma_f32_16x16x32_bf16 v[140:143], a[144:147], v[80:83], v[36:39]
  v_exp_f32 v164, v164
  v_mfma_f32_16x16x32_bf16 v[140:143], a[148:151], v[84:87], v[140:143]
  ds_read_b64_tr_b16 a[226:227], v8 offset:17408
  v_mfma_f32_16x16x32_bf16 v[140:143], a[152:155], v[88:91], v[140:143]
  v_exp_f32 v165, v165
  v_mfma_f32_16x16x32_bf16 v[140:143], a[156:159], v[92:95], v[140:143]
  ds_read_b128 a[168:171], v6 offset:34816
  v_cvt_pk_bf16_f32 v210, v164, v165
  v_mfma_f32_16x16x32_bf16 v[136:139], a[140:143], v[92:95], v[36:39]
  v_exp_f32 v166, v166
  v_mfma_f32_16x16x32_bf16 v[136:139], a[136:139], v[88:91], v[136:139]
  ds_read_b64_tr_b16 a[228:229], v8 offset:18432
  v_mfma_f32_16x16x32_bf16 v[136:139], a[132:135], v[84:87], v[136:139]
  v_exp_f32 v167, v167
  v_mfma_f32_16x16x32_bf16 v[136:139], a[128:131], v[80:83], v[136:139]
  buffer_load_dwordx4 v16, s[4:7], s27 offen offset:1024 lds
  v_mfma_f32_16x16x32_bf16 v[144:147], a[128:131], v[96:99], v[40:43]
  ds_read_b128 a[172:175], v7 offset:34816
  v_cvt_pk_bf16_f32 v211, v166, v167
  v_mfma_f32_16x16x32_bf16 v[144:147], a[132:135], v[100:103], v[144:147]
  v_exp_f32 v168, v168
  v_mfma_f32_16x16x32_bf16 v[144:147], a[136:139], v[104:107], v[144:147]
  ds_read_b64_tr_b16 a[230:231], v8 offset:19456
  v_mfma_f32_16x16x32_bf16 v[144:147], a[140:143], v[108:111], v[144:147]
  v_exp_f32 v169, v169
  v_mfma_f32_16x16x32_bf16 v[148:151], a[156:159], v[108:111], v[40:43]
  ds_read_b128 a[176:179], v4 offset:35840
  v_cvt_pk_bf16_f32 v212, v168, v169
  v_mfma_f32_16x16x32_bf16 v[148:151], a[152:155], v[104:107], v[148:151]
  v_exp_f32 v170, v170
  v_mfma_f32_16x16x32_bf16 v[148:151], a[148:151], v[100:103], v[148:151]
  ds_read_b64_tr_b16 a[232:233], v9 offset:16384
  v_mfma_f32_16x16x32_bf16 v[148:151], a[144:147], v[96:99], v[148:151]
  v_exp_f32 v171, v171
  v_mfma_f32_16x16x32_bf16 v[156:159], a[144:147], v[112:115], v[44:47]
  ds_read_b128 a[180:183], v5 offset:35840
  v_cvt_pk_bf16_f32 v213, v170, v171
  v_mfma_f32_16x16x32_bf16 v[156:159], a[148:151], v[116:119], v[156:159]
  v_exp_f32 v172, v172
  v_mfma_f32_16x16x32_bf16 v[156:159], a[152:155], v[120:123], v[156:159]
  buffer_load_dwordx4 v16, s[4:7], s27 offen offset:2048 lds
  v_mfma_f32_16x16x32_bf16 v[156:159], a[156:159], v[124:127], v[156:159]
  v_exp_f32 v173, v173
  v_mfma_f32_16x16x32_bf16 v[152:155], a[140:143], v[124:127], v[44:47]
  ds_read_b64_tr_b16 a[234:235], v9 offset:17408
  v_cvt_pk_bf16_f32 v214, v172, v173
  v_mfma_f32_16x16x32_bf16 v[152:155], a[136:139], v[120:123], v[152:155]
  v_exp_f32 v174, v174
  v_mfma_f32_16x16x32_bf16 v[152:155], a[132:135], v[116:119], v[152:155]
  v_mfma_f32_16x16x32_bf16 v[152:155], a[128:131], v[112:115], v[152:155]
  v_exp_f32 v175, v175
  v_mfma_f32_16x16x32_bf16 a[64:67], a[192:195], v[52:55], a[64:67]
  ds_read_b128 a[184:187], v6 offset:35840
  v_cvt_pk_bf16_f32 v215, v174, v175
  v_mfma_f32_16x16x32_bf16 a[64:67], a[196:199], v[248:251], a[64:67]
  ds_read_b64_tr_b16 a[236:237], v9 offset:18432
  v_mfma_f32_16x16x32_bf16 a[68:71], a[196:199], v[252:255], a[68:71]
  v_exp_f32 v176, v176
  v_mfma_f32_16x16x32_bf16 a[68:71], a[192:195], v[56:59], a[68:71]
  ds_read_b128 a[188:191], v7 offset:35840
  v_mfma_f32_16x16x32_bf16 a[72:75], a[192:195], v[60:63], a[72:75]
  v_exp_f32 v177, v177
  v_mfma_f32_16x16x32_bf16 a[72:75], a[196:199], v[20:23], a[72:75]
  ds_read_b64_tr_b16 a[238:239], v9 offset:19456
  v_cvt_pk_bf16_f32 v216, v176, v177
  v_mfma_f32_16x16x32_bf16 a[76:79], a[196:199], v[28:31], a[76:79]
  v_exp_f32 v178, v178
  v_mfma_f32_16x16x32_bf16 a[76:79], a[192:195], v[244:247], a[76:79]
  buffer_load_dwordx4 v16, s[4:7], s27 offen offset:3072 lds
  v_mfma_f32_16x16x32_bf16 a[92:95], a[200:203], v[244:247], a[92:95]
  v_exp_f32 v179, v179
  v_mfma_f32_16x16x32_bf16 a[92:95], a[204:207], v[28:31], a[92:95]
  ds_read_b64_tr_b16 a[240:241], v10 offset:16384
  v_cvt_pk_bf16_f32 v217, v178, v179
  v_mfma_f32_16x16x32_bf16 a[88:91], a[204:207], v[20:23], a[88:91]
  v_exp_f32 v180, v180
  v_mfma_f32_16x16x32_bf16 a[88:91], a[200:203], v[60:63], a[88:91]
  ds_read_b64_tr_b16 a[242:243], v10 offset:17408
  v_mfma_f32_16x16x32_bf16 a[84:87], a[200:203], v[56:59], a[84:87]
  v_exp_f32 v181, v181
  v_mfma_f32_16x16x32_bf16 a[84:87], a[204:207], v[252:255], a[84:87]
  ds_read_b64_tr_b16 a[244:245], v10 offset:18432
  v_cvt_pk_bf16_f32 v218, v180, v181
  v_mfma_f32_16x16x32_bf16 a[80:83], a[204:207], v[248:251], a[80:83]
  v_exp_f32 v182, v182
  v_mfma_f32_16x16x32_bf16 a[80:83], a[200:203], v[52:55], a[80:83]
  ds_read_b64_tr_b16 a[246:247], v10 offset:19456
  v_mfma_f32_16x16x32_bf16 a[96:99], a[208:211], v[52:55], a[96:99]
  v_exp_f32 v183, v183
  v_mfma_f32_16x16x32_bf16 a[96:99], a[212:215], v[248:251], a[96:99]
  ds_read_b64_tr_b16 a[248:249], v11 offset:16384
  v_cvt_pk_bf16_f32 v219, v182, v183
  v_mfma_f32_16x16x32_bf16 a[100:103], a[212:215], v[252:255], a[100:103]
  buffer_load_dword v50, v3, s[16:19], s38 offen
  v_mfma_f32_16x16x32_bf16 a[100:103], a[208:211], v[56:59], a[100:103]
  v_exp_f32 v184, v184
  v_mfma_f32_16x16x32_bf16 a[104:107], a[208:211], v[60:63], a[104:107]
  ds_read_b64_tr_b16 a[250:251], v11 offset:17408
  v_mfma_f32_16x16x32_bf16 a[104:107], a[212:215], v[20:23], a[104:107]
  v_exp_f32 v185, v185
  v_mfma_f32_16x16x32_bf16 a[108:111], a[212:215], v[28:31], a[108:111]
  ds_read_b64_tr_b16 a[252:253], v11 offset:18432
  v_cvt_pk_bf16_f32 v220, v184, v185
  v_mfma_f32_16x16x32_bf16 a[108:111], a[208:211], v[244:247], a[108:111]
  v_exp_f32 v186, v186
  v_mfma_f32_16x16x32_bf16 a[124:127], a[216:219], v[244:247], a[124:127]
  ds_read_b64_tr_b16 a[254:255], v11 offset:19456
  v_mfma_f32_16x16x32_bf16 a[124:127], a[220:223], v[28:31], a[124:127]
  v_exp_f32 v187, v187
  v_mfma_f32_16x16x32_bf16 a[120:123], a[220:223], v[20:23], a[120:123]
  v_cvt_pk_bf16_f32 v221, v186, v187
  v_mfma_f32_16x16x32_bf16 a[120:123], a[216:219], v[60:63], a[120:123]
  v_exp_f32 v188, v188
  v_mfma_f32_16x16x32_bf16 a[116:119], a[216:219], v[56:59], a[116:119]
  v_mfma_f32_16x16x32_bf16 a[116:119], a[220:223], v[252:255], a[116:119]
  v_exp_f32 v189, v189
  v_mfma_f32_16x16x32_bf16 a[112:115], a[220:223], v[248:251], a[112:115]
  v_cvt_pk_bf16_f32 v222, v188, v189
  v_mfma_f32_16x16x32_bf16 a[112:115], a[216:219], v[52:55], a[112:115]
  v_exp_f32 v190, v190
  v_mfma_f32_16x16x32_bf16 v[236:239], v[224:227], v[60:63], v[236:239]
  v_mfma_f32_16x16x32_bf16 v[236:239], v[224:227], v[20:23], v[236:239]
  v_exp_f32 v191, v191
  v_mfma_f32_16x16x32_bf16 v[240:243], v[224:227], v[244:247], v[240:243]
  s_add_u32 s27, s27, 16384
  v_cvt_pk_bf16_f32 v223, v190, v191
  v_mfma_f32_16x16x32_bf16 v[240:243], v[224:227], v[28:31], v[240:243]
  s_waitcnt vmcnt(14) lgkmcnt(0)
  s_barrier
  v_mfma_f32_16x16x32_bf16 v[160:163], a[160:163], v[64:67], v[32:35]
  s_sub_u32 s30, s27, 32768
  v_exp_f32 v128, v128
  v_mfma_f32_16x16x32_bf16 v[160:163], a[164:167], v[68:71], v[160:163]
  ds_read_b128 a[128:131], v4 offset:49152
  v_mfma_f32_16x16x32_bf16 v[160:163], a[168:171], v[72:75], v[160:163]
  v_exp_f32 v129, v129
  v_mfma_f32_16x16x32_bf16 v[160:163], a[172:175], v[76:79], v[160:163]
  ds_read_b64_tr_b16 a[192:193], v12 offset:16384
  v_cvt_pk_bf16_f32 v52, v128, v129
  v_mfma_f32_16x16x32_bf16 v[164:167], a[188:191], v[76:79], v[32:35]
  s_add_u32 m0, s26, 0
  v_exp_f32 v130, v130
  v_mfma_f32_16x16x32_bf16 v[164:167], a[184:187], v[72:75], v[164:167]
  buffer_load_dwordx4 v17, s[8:11], s30 offen offset:0 lds
  v_mfma_f32_16x16x32_bf16 v[164:167], a[180:183], v[68:71], v[164:167]
  v_exp_f32 v131, v131
  v_mfma_f32_16x16x32_bf16 v[164:167], a[176:179], v[64:67], v[164:167]
  ds_read_b128 a[132:135], v5 offset:49152
  v_cvt_pk_bf16_f32 v53, v130, v131
  v_mfma_f32_16x16x32_bf16 v[172:175], a[176:179], v[80:83], v[36:39]
  v_exp_f32 v132, v132
  v_mfma_f32_16x16x32_bf16 v[172:175], a[180:183], v[84:87], v[172:175]
  ds_read_b64_tr_b16 a[194:195], v12 offset:17408
  v_mfma_f32_16x16x32_bf16 v[172:175], a[184:187], v[88:91], v[172:175]
  v_exp_f32 v133, v133
  v_mfma_f32_16x16x32_bf16 v[172:175], a[188:191], v[92:95], v[172:175]
  ds_read_b128 a[136:139], v6 offset:49152
  v_cvt_pk_bf16_f32 v54, v132, v133
  v_mfma_f32_16x16x32_bf16 v[168:171], a[172:175], v[92:95], v[36:39]
  v_exp_f32 v134, v134
  v_mfma_f32_16x16x32_bf16 v[168:171], a[168:171], v[88:91], v[168:171]
  ds_read_b64_tr_b16 a[196:197], v12 offset:18432
  v_mfma_f32_16x16x32_bf16 v[168:171], a[164:167], v[84:87], v[168:171]
  v_exp_f32 v135, v135
  v_mfma_f32_16x16x32_bf16 v[168:171], a[160:163], v[80:83], v[168:171]
  ds_read_b128 a[140:143], v7 offset:49152
  v_cvt_pk_bf16_f32 v55, v134, v135
  v_mfma_f32_16x16x32_bf16 v[176:179], a[160:163], v[96:99], v[40:43]
  ds_read_b64_tr_b16 a[198:199], v12 offset:19456
  v_mfma_f32_16x16x32_bf16 v[176:179], a[164:167], v[100:103], v[176:179]
  v_exp_f32 v136, v136
  v_mfma_f32_16x16x32_bf16 v[176:179], a[168:171], v[104:107], v[176:179]
  buffer_load_dwordx4 v17, s[8:11], s30 offen offset:1024 lds
  v_mfma_f32_16x16x32_bf16 v[176:179], a[172:175], v[108:111], v[176:179]
  v_exp_f32 v137, v137
  v_mfma_f32_16x16x32_bf16 v[180:183], a[188:191], v[108:111], v[40:43]
  v_cvt_pk_bf16_f32 v56, v136, v137
  v_mfma_f32_16x16x32_bf16 v[180:183], a[184:187], v[104:107], v[180:183]
  v_exp_f32 v138, v138
  v_mfma_f32_16x16x32_bf16 v[180:183], a[180:183], v[100:103], v[180:183]
  ds_read_b128 a[144:147], v4 offset:50176
  v_mfma_f32_16x16x32_bf16 v[180:183], a[176:179], v[96:99], v[180:183]
  v_exp_f32 v139, v139
  v_mfma_f32_16x16x32_bf16 v[188:191], a[176:179], v[112:115], v[44:47]
  ds_read_b64_tr_b16 a[200:201], v13 offset:16384
  v_cvt_pk_bf16_f32 v57, v138, v139
  v_mfma_f32_16x16x32_bf16 v[188:191], a[180:183], v[116:119], v[188:191]
  v_exp_f32 v140, v140
  v_mfma_f32_16x16x32_bf16 v[188:191], a[184:187], v[120:123], v[188:191]
  ds_read_b128 a[148:151], v5 offset:50176
  v_mfma_f32_16x16x32_bf16 v[188:191], a[188:191], v[124:127], v[188:191]
  v_exp_f32 v141, v141
  v_mfma_f32_16x16x32_bf16 v[184:187], a[172:175], v[124:127], v[44:47]
  ds_read_b64_tr_b16 a[202:203], v13 offset:17408
  v_cvt_pk_bf16_f32 v58, v140, v141
  v_mfma_f32_16x16x32_bf16 v[184:187], a[168:171], v[120:123], v[184:187]
  v_exp_f32 v142, v142
  v_mfma_f32_16x16x32_bf16 v[184:187], a[164:167], v[116:119], v[184:187]
  ds_read_b128 a[152:155], v6 offset:50176
  v_mfma_f32_16x16x32_bf16 v[184:187], a[160:163], v[112:115], v[184:187]
  v_exp_f32 v143, v143
  v_mfma_f32_16x16x32_bf16 a[0:3], a[224:227], v[192:195], a[0:3]
  ds_read_b64_tr_b16 a[204:205], v13 offset:18432
  v_cvt_pk_bf16_f32 v59, v142, v143
  v_mfma_f32_16x16x32_bf16 a[0:3], a[228:231], v[208:211], a[0:3]
  buffer_load_dwordx4 v17, s[8:11], s30 offen offset:2048 lds
  v_mfma_f32_16x16x32_bf16 a[4:7], a[228:231], v[212:215], a[4:7]
  v_exp_f32 v144, v144
  v_mfma_f32_16x16x32_bf16 a[4:7], a[224:227], v[196:199], a[4:7]
  ds_read_b128 a[156:159], v7 offset:50176
  v_mfma_f32_16x16x32_bf16 a[8:11], a[224:227], v[200:203], a[8:11]
  v_exp_f32 v145, v145
  v_mfma_f32_16x16x32_bf16 a[8:11], a[228:231], v[216:219], a[8:11]
  ds_read_b64_tr_b16 a[206:207], v13 offset:19456
  v_cvt_pk_bf16_f32 v60, v144, v145
  v_mfma_f32_16x16x32_bf16 a[12:15], a[228:231], v[220:223], a[12:15]
  v_exp_f32 v146, v146
  v_mfma_f32_16x16x32_bf16 a[12:15], a[224:227], v[204:207], a[12:15]
  v_mfma_f32_16x16x32_bf16 a[28:31], a[232:235], v[204:207], a[28:31]
  v_exp_f32 v147, v147
  v_mfma_f32_16x16x32_bf16 a[28:31], a[236:239], v[220:223], a[28:31]
  ds_read_b64_tr_b16 a[208:209], v14 offset:16384
  v_cvt_pk_bf16_f32 v61, v146, v147
  v_mfma_f32_16x16x32_bf16 a[24:27], a[236:239], v[216:219], a[24:27]
  v_exp_f32 v148, v148
  v_mfma_f32_16x16x32_bf16 a[24:27], a[232:235], v[200:203], a[24:27]
  ds_read_b64_tr_b16 a[210:211], v14 offset:17408
  v_mfma_f32_16x16x32_bf16 a[20:23], a[232:235], v[196:199], a[20:23]
  v_exp_f32 v149, v149
  v_mfma_f32_16x16x32_bf16 a[20:23], a[236:239], v[212:215], a[20:23]
  ds_read_b64_tr_b16 a[212:213], v14 offset:18432
  v_cvt_pk_bf16_f32 v62, v148, v149
  v_mfma_f32_16x16x32_bf16 a[16:19], a[236:239], v[208:211], a[16:19]
  v_exp_f32 v150, v150
  v_mfma_f32_16x16x32_bf16 a[16:19], a[232:235], v[192:195], a[16:19]
  ds_read_b64_tr_b16 a[214:215], v14 offset:19456
  v_mfma_f32_16x16x32_bf16 a[32:35], a[240:243], v[192:195], a[32:35]
  v_exp_f32 v151, v151
  v_mfma_f32_16x16x32_bf16 a[32:35], a[244:247], v[208:211], a[32:35]
  buffer_load_dwordx4 v17, s[8:11], s30 offen offset:3072 lds
  v_mfma_f32_16x16x32_bf16 a[36:39], a[244:247], v[212:215], a[36:39]
  ds_read_b64_tr_b16 a[216:217], v15 offset:16384
  v_cvt_pk_bf16_f32 v63, v150, v151
  v_mfma_f32_16x16x32_bf16 a[36:39], a[240:243], v[196:199], a[36:39]
  v_exp_f32 v152, v152
  v_mfma_f32_16x16x32_bf16 a[40:43], a[240:243], v[200:203], a[40:43]
  ds_read_b64_tr_b16 a[218:219], v15 offset:17408
  v_mfma_f32_16x16x32_bf16 a[40:43], a[244:247], v[216:219], a[40:43]
  v_exp_f32 v153, v153
  v_mfma_f32_16x16x32_bf16 a[44:47], a[244:247], v[220:223], a[44:47]
  ds_read_b64_tr_b16 a[220:221], v15 offset:18432
  v_cvt_pk_bf16_f32 v244, v152, v153
  v_mfma_f32_16x16x32_bf16 a[44:47], a[240:243], v[204:207], a[44:47]
  v_exp_f32 v154, v154
  v_mfma_f32_16x16x32_bf16 a[60:63], a[248:251], v[204:207], a[60:63]
  ds_read_b64_tr_b16 a[222:223], v15 offset:19456
  v_mfma_f32_16x16x32_bf16 a[60:63], a[252:255], v[220:223], a[60:63]
  v_exp_f32 v155, v155
  v_mfma_f32_16x16x32_bf16 a[56:59], a[252:255], v[216:219], a[56:59]
  v_cvt_pk_bf16_f32 v245, v154, v155
  v_mfma_f32_16x16x32_bf16 a[56:59], a[248:251], v[200:203], a[56:59]
  v_exp_f32 v156, v156
  v_mfma_f32_16x16x32_bf16 a[52:55], a[248:251], v[196:199], a[52:55]
  v_mfma_f32_16x16x32_bf16 a[52:55], a[252:255], v[212:215], a[52:55]
  v_exp_f32 v157, v157
  v_mfma_f32_16x16x32_bf16 a[48:51], a[252:255], v[208:211], a[48:51]
  v_cvt_pk_bf16_f32 v246, v156, v157
  v_mfma_f32_16x16x32_bf16 a[48:51], a[248:251], v[192:195], a[48:51]
  v_exp_f32 v158, v158
  v_mfma_f32_16x16x32_bf16 v[228:231], v[224:227], v[192:195], v[228:231]
  v_mfma_f32_16x16x32_bf16 v[228:231], v[224:227], v[208:211], v[228:231]
  v_exp_f32 v159, v159
  v_mfma_f32_16x16x32_bf16 v[232:235], v[224:227], v[196:199], v[232:235]
  v_cvt_pk_bf16_f32 v247, v158, v159
  v_mfma_f32_16x16x32_bf16 v[232:235], v[224:227], v[212:215], v[232:235]
  s_waitcnt lgkmcnt(0)
  v_mfma_f32_16x16x32_bf16 v[128:131], a[128:131], v[64:67], v[32:35]
  v_exp_f32 v160, v160
  v_mfma_f32_16x16x32_bf16 v[128:131], a[132:135], v[68:71], v[128:131]
  ds_read_b128 a[160:163], v4 offset:51200
  v_mfma_f32_16x16x32_bf16 v[128:131], a[136:139], v[72:75], v[128:131]
  v_exp_f32 v161, v161
  v_mfma_f32_16x16x32_bf16 v[128:131], a[140:143], v[76:79], v[128:131]
  ds_read_b64_tr_b16 a[224:225], v8 offset:32768
  v_cvt_pk_bf16_f32 v248, v160, v161
  v_mfma_f32_16x16x32_bf16 v[132:135], a[156:159], v[76:79], v[32:35]
  s_add_u32 m0, s43, 32768
  v_exp_f32 v162, v162
  v_mfma_f32_16x16x32_bf16 v[132:135], a[152:155], v[72:75], v[132:135]
  buffer_load_dwordx4 v16, s[4:7], s27 offen offset:0 lds
  v_mfma_f32_16x16x32_bf16 v[132:135], a[148:151], v[68:71], v[132:135]
  v_exp_f32 v163, v163
  v_mfma_f32_16x16x32_bf16 v[132:135], a[144:147], v[64:67], v[132:135]
  ds_read_b128 a[164:167], v5 offset:51200
  v_cvt_pk_bf16_f32 v249, v162, v163
  v_mfma_f32_16x16x32_bf16 v[140:143], a[144:147], v[80:83], v[36:39]
  v_exp_f32 v164, v164
  v_mfma_f32_16x16x32_bf16 v[140:143], a[148:151], v[84:87], v[140:143]
  ds_read_b64_tr_b16 a[226:227], v8 offset:33792
  v_mfma_f32_16x16x32_bf16 v[140:143], a[152:155], v[88:91], v[140:143]
  v_exp_f32 v165, v165
  v_mfma_f32_16x16x32_bf16 v[140:143], a[156:159], v[92:95], v[140:143]
  ds_read_b128 a[168:171], v6 offset:51200
  v_cvt_pk_bf16_f32 v250, v164, v165
  v_mfma_f32_16x16x32_bf16 v[136:139], a[140:143], v[92:95], v[36:39]
  v_exp_f32 v166, v166
  v_mfma_f32_16x16x32_bf16 v[136:139], a[136:139], v[88:91], v[136:139]
  ds_read_b64_tr_b16 a[228:229], v8 offset:34816
  v_mfma_f32_16x16x32_bf16 v[136:139], a[132:135], v[84:87], v[136:139]
  v_exp_f32 v167, v167
  v_mfma_f32_16x16x32_bf16 v[136:139], a[128:131], v[80:83], v[136:139]
  ds_read_b128 a[172:175], v7 offset:51200
  v_cvt_pk_bf16_f32 v251, v166, v167
  v_mfma_f32_16x16x32_bf16 v[144:147], a[128:131], v[96:99], v[40:43]
  ds_read_b64_tr_b16 a[230:231], v8 offset:35840
  v_mfma_f32_16x16x32_bf16 v[144:147], a[132:135], v[100:103], v[144:147]
  v_exp_f32 v168, v168
  v_mfma_f32_16x16x32_bf16 v[144:147], a[136:139], v[104:107], v[144:147]
  buffer_load_dwordx4 v16, s[4:7], s27 offen offset:1024 lds
  v_mfma_f32_16x16x32_bf16 v[144:147], a[140:143], v[108:111], v[144:147]
  v_exp_f32 v169, v169
  v_mfma_f32_16x16x32_bf16 v[148:151], a[156:159], v[108:111], v[40:43]
  v_cvt_pk_bf16_f32 v252, v168, v169
  v_mfma_f32_16x16x32_bf16 v[148:151], a[152:155], v[104:107], v[148:151]
  v_exp_f32 v170, v170
  v_mfma_f32_16x16x32_bf16 v[148:151], a[148:151], v[100:103], v[148:151]
  ds_read_b128 a[176:179], v4 offset:52224
  v_mfma_f32_16x16x32_bf16 v[148:151], a[144:147], v[96:99], v[148:151]
  v_exp_f32 v171, v171
  v_mfma_f32_16x16x32_bf16 v[156:159], a[144:147], v[112:115], v[44:47]
  ds_read_b64_tr_b16 a[232:233], v9 offset:32768
  v_cvt_pk_bf16_f32 v253, v170, v171
  v_mfma_f32_16x16x32_bf16 v[156:159], a[148:151], v[116:119], v[156:159]
  v_exp_f32 v172, v172
  v_mfma_f32_16x16x32_bf16 v[156:159], a[152:155], v[120:123], v[156:159]
  ds_read_b128 a[180:183], v5 offset:52224
  v_mfma_f32_16x16x32_bf16 v[156:159], a[156:159], v[124:127], v[156:159]
  v_exp_f32 v173, v173
  v_mfma_f32_16x16x32_bf16 v[152:155], a[140:143], v[124:127], v[44:47]
  ds_read_b64_tr_b16 a[234:235], v9 offset:33792
  v_cvt_pk_bf16_f32 v254, v172, v173
  v_mfma_f32_16x16x32_bf16 v[152:155], a[136:139], v[120:123], v[152:155]
  v_exp_f32 v174, v174
  v_mfma_f32_16x16x32_bf16 v[152:155], a[132:135], v[116:119], v[152:155]
  ds_read_b128 a[184:187], v6 offset:52224
  v_mfma_f32_16x16x32_bf16 v[152:155], a[128:131], v[112:115], v[152:155]
  v_exp_f32 v175, v175
  v_mfma_f32_16x16x32_bf16 a[64:67], a[192:195], v[192:195], a[64:67]
  ds_read_b64_tr_b16 a[236:237], v9 offset:34816
  v_cvt_pk_bf16_f32 v255, v174, v175
  v_mfma_f32_16x16x32_bf16 a[64:67], a[196:199], v[208:211], a[64:67]
  buffer_load_dwordx4 v16, s[4:7], s27 offen offset:2048 lds
  v_mfma_f32_16x16x32_bf16 a[68:71], a[196:199], v[212:215], a[68:71]
  v_exp_f32 v176, v176
  v_mfma_f32_16x16x32_bf16 a[68:71], a[192:195], v[196:199], a[68:71]
  ds_read_b128 a[188:191], v7 offset:52224
  v_mfma_f32_16x16x32_bf16 a[72:75], a[192:195], v[200:203], a[72:75]
  v_exp_f32 v177, v177
  v_mfma_f32_16x16x32_bf16 a[72:75], a[196:199], v[216:219], a[72:75]
  ds_read_b64_tr_b16 a[238:239], v9 offset:35840
  v_cvt_pk_bf16_f32 v20, v176, v177
  v_mfma_f32_16x16x32_bf16 a[76:79], a[196:199], v[220:223], a[76:79]
  v_exp_f32 v178, v178
  v_mfma_f32_16x16x32_bf16 a[76:79], a[192:195], v[204:207], a[76:79]
  v_mfma_f32_16x16x32_bf16 a[92:95], a[200:203], v[204:207], a[92:95]
  v_exp_f32 v179, v179
  v_mfma_f32_16x16x32_bf16 a[92:95], a[204:207], v[220:223], a[92:95]
  ds_read_b64_tr_b16 a[240:241], v10 offset:32768
  v_cvt_pk_bf16_f32 v21, v178, v179
  v_mfma_f32_16x16x32_bf16 a[88:91], a[204:207], v[216:219], a[88:91]
  v_exp_f32 v180, v180
  v_mfma_f32_16x16x32_bf16 a[88:91], a[200:203], v[200:203], a[88:91]
  ds_read_b64_tr_b16 a[242:243], v10 offset:33792
  v_mfma_f32_16x16x32_bf16 a[84:87], a[200:203], v[196:199], a[84:87]
  v_exp_f32 v181, v181
  v_mfma_f32_16x16x32_bf16 a[84:87], a[204:207], v[212:215], a[84:87]
  ds_read_b64_tr_b16 a[244:245], v10 offset:34816
  v_cvt_pk_bf16_f32 v22, v180, v181
  v_mfma_f32_16x16x32_bf16 a[80:83], a[204:207], v[208:211], a[80:83]
  v_exp_f32 v182, v182
  v_mfma_f32_16x16x32_bf16 a[80:83], a[200:203], v[192:195], a[80:83]
  ds_read_b64_tr_b16 a[246:247], v10 offset:35840
  v_mfma_f32_16x16x32_bf16 a[96:99], a[208:211], v[192:195], a[96:99]
  v_exp_f32 v183, v183
  v_mfma_f32_16x16x32_bf16 a[96:99], a[212:215], v[208:211], a[96:99]
  buffer_load_dwordx4 v16, s[4:7], s27 offen offset:3072 lds
  v_mfma_f32_16x16x32_bf16 a[100:103], a[212:215], v[212:215], a[100:103]
  ds_read_b64_tr_b16 a[248:249], v11 offset:32768
  v_cvt_pk_bf16_f32 v23, v182, v183
  v_mfma_f32_16x16x32_bf16 a[100:103], a[208:211], v[196:199], a[100:103]
  v_exp_f32 v184, v184
  v_mfma_f32_16x16x32_bf16 a[104:107], a[208:211], v[200:203], a[104:107]
  ds_read_b64_tr_b16 a[250:251], v11 offset:33792
  v_mfma_f32_16x16x32_bf16 a[104:107], a[212:215], v[216:219], a[104:107]
  v_exp_f32 v185, v185
  v_mfma_f32_16x16x32_bf16 a[108:111], a[212:215], v[220:223], a[108:111]
  ds_read_b64_tr_b16 a[252:253], v11 offset:34816
  v_cvt_pk_bf16_f32 v28, v184, v185
  v_mfma_f32_16x16x32_bf16 a[108:111], a[208:211], v[204:207], a[108:111]
  v_exp_f32 v186, v186
  v_mfma_f32_16x16x32_bf16 a[124:127], a[216:219], v[204:207], a[124:127]
  ds_read_b64_tr_b16 a[254:255], v11 offset:35840
  v_mfma_f32_16x16x32_bf16 a[124:127], a[220:223], v[220:223], a[124:127]
  v_exp_f32 v187, v187
  v_mfma_f32_16x16x32_bf16 a[120:123], a[220:223], v[216:219], a[120:123]
  v_cvt_pk_bf16_f32 v29, v186, v187
  v_mfma_f32_16x16x32_bf16 a[120:123], a[216:219], v[200:203], a[120:123]
  v_exp_f32 v188, v188
  v_mfma_f32_16x16x32_bf16 a[116:119], a[216:219], v[196:199], a[116:119]
  v_mfma_f32_16x16x32_bf16 a[116:119], a[220:223], v[212:215], a[116:119]
  v_exp_f32 v189, v189
  v_mfma_f32_16x16x32_bf16 a[112:115], a[220:223], v[208:211], a[112:115]
  v_cvt_pk_bf16_f32 v30, v188, v189
  v_mfma_f32_16x16x32_bf16 a[112:115], a[216:219], v[192:195], a[112:115]
  v_exp_f32 v190, v190
  v_mfma_f32_16x16x32_bf16 v[236:239], v[224:227], v[200:203], v[236:239]
  v_mfma_f32_16x16x32_bf16 v[236:239], v[224:227], v[216:219], v[236:239]
  v_exp_f32 v191, v191
  v_mfma_f32_16x16x32_bf16 v[240:243], v[224:227], v[204:207], v[240:243]
  s_add_u32 s27, s27, 16384
  v_cvt_pk_bf16_f32 v31, v190, v191
  v_mfma_f32_16x16x32_bf16 v[240:243], v[224:227], v[220:223], v[240:243]
  s_waitcnt vmcnt(13) lgkmcnt(0)
  s_barrier
  v_mfma_f32_16x16x32_bf16 v[160:163], a[160:163], v[64:67], v[32:35]
  s_sub_u32 s30, s27, 32768
  v_exp_f32 v128, v128
  v_mfma_f32_16x16x32_bf16 v[160:163], a[164:167], v[68:71], v[160:163]
  ds_read_b128 a[128:131], v4 offset:0
  v_mfma_f32_16x16x32_bf16 v[160:163], a[168:171], v[72:75], v[160:163]
  v_exp_f32 v129, v129
  v_mfma_f32_16x16x32_bf16 v[160:163], a[172:175], v[76:79], v[160:163]
  ds_read_b64_tr_b16 a[192:193], v12 offset:32768
  v_cvt_pk_bf16_f32 v192, v128, v129
  v_mfma_f32_16x16x32_bf16 v[164:167], a[188:191], v[76:79], v[32:35]
  s_add_u32 m0, s26, 16384
  v_exp_f32 v130, v130
  v_mfma_f32_16x16x32_bf16 v[164:167], a[184:187], v[72:75], v[164:167]
  buffer_load_dwordx4 v17, s[8:11], s30 offen offset:0 lds
  v_mfma_f32_16x16x32_bf16 v[164:167], a[180:183], v[68:71], v[164:167]
  v_exp_f32 v131, v131
  v_mfma_f32_16x16x32_bf16 v[164:167], a[176:179], v[64:67], v[164:167]
  ds_read_b128 a[132:135], v5 offset:0
  v_cvt_pk_bf16_f32 v193, v130, v131
  v_mfma_f32_16x16x32_bf16 v[172:175], a[176:179], v[80:83], v[36:39]
  v_exp_f32 v132, v132
  v_mfma_f32_16x16x32_bf16 v[172:175], a[180:183], v[84:87], v[172:175]
  ds_read_b64_tr_b16 a[194:195], v12 offset:33792
  v_mfma_f32_16x16x32_bf16 v[172:175], a[184:187], v[88:91], v[172:175]
  v_exp_f32 v133, v133
  v_mfma_f32_16x16x32_bf16 v[172:175], a[188:191], v[92:95], v[172:175]
  ds_read_b128 a[136:139], v6 offset:0
  v_cvt_pk_bf16_f32 v194, v132, v133
  v_mfma_f32_16x16x32_bf16 v[168:171], a[172:175], v[92:95], v[36:39]
  v_exp_f32 v134, v134
  v_mfma_f32_16x16x32_bf16 v[168:171], a[168:171], v[88:91], v[168:171]
  ds_read_b64_tr_b16 a[196:197], v12 offset:34816
  v_mfma_f32_16x16x32_bf16 v[168:171], a[164:167], v[84:87], v[168:171]
  v_exp_f32 v135, v135
  v_mfma_f32_16x16x32_bf16 v[168:171], a[160:163], v[80:83], v[168:171]
  ds_read_b128 a[140:143], v7 offset:0
  v_cvt_pk_bf16_f32 v195, v134, v135
  v_mfma_f32_16x16x32_bf16 v[176:179], a[160:163], v[96:99], v[40:43]
  ds_read_b64_tr_b16 a[198:199], v12 offset:35840
  v_mfma_f32_16x16x32_bf16 v[176:179], a[164:167], v[100:103], v[176:179]
  v_exp_f32 v136, v136
  v_mfma_f32_16x16x32_bf16 v[176:179], a[168:171], v[104:107], v[176:179]
  buffer_load_dwordx4 v17, s[8:11], s30 offen offset:1024 lds
  v_mfma_f32_16x16x32_bf16 v[176:179], a[172:175], v[108:111], v[176:179]
  v_exp_f32 v137, v137
  v_mfma_f32_16x16x32_bf16 v[180:183], a[188:191], v[108:111], v[40:43]
  v_cvt_pk_bf16_f32 v196, v136, v137
  v_mfma_f32_16x16x32_bf16 v[180:183], a[184:187], v[104:107], v[180:183]
  v_exp_f32 v138, v138
  v_mfma_f32_16x16x32_bf16 v[180:183], a[180:183], v[100:103], v[180:183]
  ds_read_b128 a[144:147], v4 offset:1024
  v_mfma_f32_16x16x32_bf16 v[180:183], a[176:179], v[96:99], v[180:183]
  v_exp_f32 v139, v139
  v_mfma_f32_16x16x32_bf16 v[188:191], a[176:179], v[112:115], v[44:47]
  ds_read_b64_tr_b16 a[200:201], v13 offset:32768
  v_cvt_pk_bf16_f32 v197, v138, v139
  v_mfma_f32_16x16x32_bf16 v[188:191], a[180:183], v[116:119], v[188:191]
  v_exp_f32 v140, v140
  v_mfma_f32_16x16x32_bf16 v[188:191], a[184:187], v[120:123], v[188:191]
L_attn_st7:
  s_cbranch_vccnz L_attn_st10
  ds_read_b128 a[148:151], v5 offset:1024
  v_mfma_f32_16x16x32_bf16 v[188:191], a[188:191], v[124:127], v[188:191]
  v_exp_f32 v141, v141
  v_mfma_f32_16x16x32_bf16 v[184:187], a[172:175], v[124:127], v[44:47]
  ds_read_b64_tr_b16 a[202:203], v13 offset:33792
  v_cvt_pk_bf16_f32 v198, v140, v141
  v_mfma_f32_16x16x32_bf16 v[184:187], a[168:171], v[120:123], v[184:187]
  v_exp_f32 v142, v142
  v_mfma_f32_16x16x32_bf16 v[184:187], a[164:167], v[116:119], v[184:187]
  ds_read_b128 a[152:155], v6 offset:1024
  v_mfma_f32_16x16x32_bf16 v[184:187], a[160:163], v[112:115], v[184:187]
  v_exp_f32 v143, v143
  v_mfma_f32_16x16x32_bf16 a[0:3], a[224:227], v[52:55], a[0:3]
  ds_read_b64_tr_b16 a[204:205], v13 offset:34816
  v_cvt_pk_bf16_f32 v199, v142, v143
  v_mfma_f32_16x16x32_bf16 a[0:3], a[228:231], v[248:251], a[0:3]
  buffer_load_dwordx4 v17, s[8:11], s30 offen offset:2048 lds
  v_mfma_f32_16x16x32_bf16 a[4:7], a[228:231], v[252:255], a[4:7]
  v_exp_f32 v144, v144
  v_mfma_f32_16x16x32_bf16 a[4:7], a[224:227], v[56:59], a[4:7]
  ds_read_b128 a[156:159], v7 offset:1024
  v_mfma_f32_16x16x32_bf16 a[8:11], a[224:227], v[60:63], a[8:11]
  v_exp_f32 v145, v145
  v_mfma_f32_16x16x32_bf16 a[8:11], a[228:231], v[20:23], a[8:11]
  ds_read_b64_tr_b16 a[206:207], v13 offset:35840
  v_cvt_pk_bf16_f32 v200, v144, v145
  v_mfma_f32_16x16x32_bf16 a[12:15], a[228:231], v[28:31], a[12:15]
  v_exp_f32 v146, v146
  v_mfma_f32_16x16x32_bf16 a[12:15], a[224:227], v[244:247], a[12:15]
  v_mfma_f32_16x16x32_bf16 a[28:31], a[232:235], v[244:247], a[28:31]
  v_exp_f32 v147, v147
  v_mfma_f32_16x16x32_bf16 a[28:31], a[236:239], v[28:31], a[28:31]
  ds_read_b64_tr_b16 a[208:209], v14 offset:32768
  v_cvt_pk_bf16_f32 v201, v146, v147
  v_mfma_f32_16x16x32_bf16 a[24:27], a[236:239], v[20:23], a[24:27]
  v_exp_f32 v148, v148
  v_mfma_f32_16x16x32_bf16 a[24:27], a[232:235], v[60:63], a[24:27]
  ds_read_b64_tr_b16 a[210:211], v14 offset:33792
  v_mfma_f32_16x16x32_bf16 a[20:23], a[232:235], v[56:59], a[20:23]
  v_exp_f32 v149, v149
  v_mfma_f32_16x16x32_bf16 a[20:23], a[236:239], v[252:255], a[20:23]
  ds_read_b64_tr_b16 a[212:213], v14 offset:34816
  v_cvt_pk_bf16_f32 v202, v148, v149
  v_mfma_f32_16x16x32_bf16 a[16:19], a[236:239], v[248:251], a[16:19]
  v_exp_f32 v150, v150
  v_mfma_f32_16x16x32_bf16 a[16:19], a[232:235], v[52:55], a[16:19]
  ds_read_b64_tr_b16 a[214:215], v14 offset:35840
  v_mfma_f32_16x16x32_bf16 a[32:35], a[240:243], v[52:55], a[32:35]
  v_exp_f32 v151, v151
  v_mfma_f32_16x16x32_bf16 a[32:35], a[244:247], v[248:251], a[32:35]
  buffer_load_dwordx4 v17, s[8:11], s30 offen offset:3072 lds
  v_mfma_f32_16x16x32_bf16 a[36:39], a[244:247], v[252:255], a[36:39]
  ds_read_b64_tr_b16 a[216:217], v15 offset:32768
  v_cvt_pk_bf16_f32 v203, v150, v151
  v_mfma_f32_16x16x32_bf16 a[36:39], a[240:243], v[56:59], a[36:39]
  v_exp_f32 v152, v152
  v_mfma_f32_16x16x32_bf16 a[40:43], a[240:243], v[60:63], a[40:43]
  ds_read_b64_tr_b16 a[218:219], v15 offset:33792
  v_mfma_f32_16x16x32_bf16 a[40:43], a[244:247], v[20:23], a[40:43]
  v_exp_f32 v153, v153
  v_mfma_f32_16x16x32_bf16 a[44:47], a[244:247], v[28:31], a[44:47]
  ds_read_b64_tr_b16 a[220:221], v15 offset:34816
  v_cvt_pk_bf16_f32 v204, v152, v153
  v_mfma_f32_16x16x32_bf16 a[44:47], a[240:243], v[244:247], a[44:47]
  v_exp_f32 v154, v154
  v_mfma_f32_16x16x32_bf16 a[60:63], a[248:251], v[244:247], a[60:63]
  ds_read_b64_tr_b16 a[222:223], v15 offset:35840
  v_mfma_f32_16x16x32_bf16 a[60:63], a[252:255], v[28:31], a[60:63]
  v_exp_f32 v155, v155
  v_mfma_f32_16x16x32_bf16 a[56:59], a[252:255], v[20:23], a[56:59]
  v_cvt_pk_bf16_f32 v205, v154, v155
  v_mfma_f32_16x16x32_bf16 a[56:59], a[248:251], v[60:63], a[56:59]
  v_exp_f32 v156, v156
  v_mfma_f32_16x16x32_bf16 a[52:55], a[248:251], v[56:59], a[52:55]
  v_mfma_f32_16x16x32_bf16 a[52:55], a[252:255], v[252:255], a[52:55]
  v_exp_f32 v157, v157
  v_mfma_f32_16x16x32_bf16 a[48:51], a[252:255], v[248:251], a[48:51]
  v_cvt_pk_bf16_f32 v206, v156, v157
  v_mfma_f32_16x16x32_bf16 a[48:51], a[248:251], v[52:55], a[48:51]
  v_exp_f32 v158, v158
  v_mfma_f32_16x16x32_bf16 v[228:231], v[224:227], v[52:55], v[228:231]
  v_mfma_f32_16x16x32_bf16 v[228:231], v[224:227], v[248:251], v[228:231]
  v_exp_f32 v159, v159
  v_mfma_f32_16x16x32_bf16 v[232:235], v[224:227], v[56:59], v[232:235]
  v_cvt_pk_bf16_f32 v207, v158, v159
  v_mfma_f32_16x16x32_bf16 v[232:235], v[224:227], v[252:255], v[232:235]
  s_waitcnt lgkmcnt(0)
  v_mfma_f32_16x16x32_bf16 v[128:131], a[128:131], v[64:67], v[32:35]
  v_exp_f32 v160, v160
  v_mfma_f32_16x16x32_bf16 v[128:131], a[132:135], v[68:71], v[128:131]
  ds_read_b128 a[160:163], v4 offset:2048
  v_mfma_f32_16x16x32_bf16 v[128:131], a[136:139], v[72:75], v[128:131]
  v_exp_f32 v161, v161
  v_mfma_f32_16x16x32_bf16 v[128:131], a[140:143], v[76:79], v[128:131]
  ds_read_b64_tr_b16 a[224:225], v8 offset:49152
  v_cvt_pk_bf16_f32 v208, v160, v161
  v_mfma_f32_16x16x32_bf16 v[132:135], a[156:159], v[76:79], v[32:35]
  s_add_u32 m0, s43, 49152
  v_exp_f32 v162, v162
  v_mfma_f32_16x16x32_bf16 v[132:135], a[152:155], v[72:75], v[132:135]
  buffer_load_dwordx4 v16, s[4:7], s27 offen offset:0 lds
  v_mfma_f32_16x16x32_bf16 v[132:135], a[148:151], v[68:71], v[132:135]
  v_exp_f32 v163, v163
  v_mfma_f32_16x16x32_bf16 v[132:135], a[144:147], v[64:67], v[132:135]
  ds_read_b128 a[164:167], v5 offset:2048
  v_cvt_pk_bf16_f32 v209, v162, v163
  v_mfma_f32_16x16x32_bf16 v[140:143], a[144:147], v[80:83], v[36:39]
  v_exp_f32 v164, v164
  v_mfma_f32_16x16x32_bf16 v[140:143], a[148:151], v[84:87], v[140:143]
  ds_read_b64_tr_b16 a[226:227], v8 offset:50176
  v_mfma_f32_16x16x32_bf16 v[140:143], a[152:155], v[88:91], v[140:143]
  v_exp_f32 v165, v165
  v_mfma_f32_16x16x32_bf16 v[140:143], a[156:159], v[92:95], v[140:143]
  ds_read_b128 a[168:171], v6 offset:2048
  v_cvt_pk_bf16_f32 v210, v164, v165
  v_mfma_f32_16x16x32_bf16 v[136:139], a[140:143], v[92:95], v[36:39]
  v_exp_f32 v166, v166
  v_mfma_f32_16x16x32_bf16 v[136:139], a[136:139], v[88:91], v[136:139]
  ds_read_b64_tr_b16 a[228:229], v8 offset:51200
  v_mfma_f32_16x16x32_bf16 v[136:139], a[132:135], v[84:87], v[136:139]
  v_exp_f32 v167, v167
  v_mfma_f32_16x16x32_bf16 v[136:139], a[128:131], v[80:83], v[136:139]
  ds_read_b128 a[172:175], v7 offset:2048
  v_cvt_pk_bf16_f32 v211, v166, v167
  v_mfma_f32_16x16x32_bf16 v[144:147], a[128:131], v[96:99], v[40:43]
  ds_read_b64_tr_b16 a[230:231], v8 offset:52224
  v_mfma_f32_16x16x32_bf16 v[144:147], a[132:135], v[100:103], v[144:147]
  v_exp_f32 v168, v168
  v_mfma_f32_16x16x32_bf16 v[144:147], a[136:139], v[104:107], v[144:147]
  buffer_load_dwordx4 v16, s[4:7], s27 offen offset:1024 lds
  v_mfma_f32_16x16x32_bf16 v[144:147], a[140:143], v[108:111], v[144:147]
  v_exp_f32 v169, v169
  v_mfma_f32_16x16x32_bf16 v[148:151], a[156:159], v[108:111], v[40:43]
  v_cvt_pk_bf16_f32 v212, v168, v169
  v_mfma_f32_16x16x32_bf16 v[148:151], a[152:155], v[104:107], v[148:151]
  v_exp_f32 v170, v170
  v_mfma_f32_16x16x32_bf16 v[148:151], a[148:151], v[100:103], v[148:151]
  ds_read_b128 a[176:179], v4 offset:3072
  v_mfma_f32_16x16x32_bf16 v[148:151], a[144:147], v[96:99], v[148:151]
  v_exp_f32 v171, v171
  v_mfma_f32_16x16x32_bf16 v[156:159], a[144:147], v[112:115], v[44:47]
  ds_read_b64_tr_b16 a[232:233], v9 offset:49152
  v_cvt_pk_bf16_f32 v213, v170, v171
  v_mfma_f32_16x16x32_bf16 v[156:159], a[148:151], v[116:119], v[156:159]
  v_exp_f32 v172, v172
  v_mfma_f32_16x16x32_bf16 v[156:159], a[152:155], v[120:123], v[156:159]
  ds_read_b128 a[180:183], v5 offset:3072
  v_mfma_f32_16x16x32_bf16 v[156:159], a[156:159], v[124:127], v[156:159]
  v_exp_f32 v173, v173
  v_mfma_f32_16x16x32_bf16 v[152:155], a[140:143], v[124:127], v[44:47]
  ds_read_b64_tr_b16 a[234:235], v9 offset:50176
  v_cvt_pk_bf16_f32 v214, v172, v173
  v_mfma_f32_16x16x32_bf16 v[152:155], a[136:139], v[120:123], v[152:155]
  v_exp_f32 v174, v174
  v_mfma_f32_16x16x32_bf16 v[152:155], a[132:135], v[116:119], v[152:155]
  ds_read_b128 a[184:187], v6 offset:3072
  v_mfma_f32_16x16x32_bf16 v[152:155], a[128:131], v[112:115], v[152:155]
  v_exp_f32 v175, v175
  v_mfma_f32_16x16x32_bf16 a[64:67], a[192:195], v[52:55], a[64:67]
  ds_read_b64_tr_b16 a[236:237], v9 offset:51200
  v_cvt_pk_bf16_f32 v215, v174, v175
  v_mfma_f32_16x16x32_bf16 a[64:67], a[196:199], v[248:251], a[64:67]
  buffer_load_dwordx4 v16, s[4:7], s27 offen offset:2048 lds
  v_mfma_f32_16x16x32_bf16 a[68:71], a[196:199], v[252:255], a[68:71]
  v_exp_f32 v176, v176
  v_mfma_f32_16x16x32_bf16 a[68:71], a[192:195], v[56:59], a[68:71]
  ds_read_b128 a[188:191], v7 offset:3072
  v_mfma_f32_16x16x32_bf16 a[72:75], a[192:195], v[60:63], a[72:75]
  v_exp_f32 v177, v177
  v_mfma_f32_16x16x32_bf16 a[72:75], a[196:199], v[20:23], a[72:75]
  ds_read_b64_tr_b16 a[238:239], v9 offset:52224
  v_cvt_pk_bf16_f32 v216, v176, v177
  v_mfma_f32_16x16x32_bf16 a[76:79], a[196:199], v[28:31], a[76:79]
  v_exp_f32 v178, v178
  v_mfma_f32_16x16x32_bf16 a[76:79], a[192:195], v[244:247], a[76:79]
  v_mfma_f32_16x16x32_bf16 a[92:95], a[200:203], v[244:247], a[92:95]
  v_exp_f32 v179, v179
  v_mfma_f32_16x16x32_bf16 a[92:95], a[204:207], v[28:31], a[92:95]
  ds_read_b64_tr_b16 a[240:241], v10 offset:49152
  v_cvt_pk_bf16_f32 v217, v178, v179
  v_mfma_f32_16x16x32_bf16 a[88:91], a[204:207], v[20:23], a[88:91]
  v_exp_f32 v180, v180
  v_mfma_f32_16x16x32_bf16 a[88:91], a[200:203], v[60:63], a[88:91]
  ds_read_b64_tr_b16 a[242:243], v10 offset:50176
  v_mfma_f32_16x16x32_bf16 a[84:87], a[200:203], v[56:59], a[84:87]
  v_exp_f32 v181, v181
  v_mfma_f32_16x16x32_bf16 a[84:87], a[204:207], v[252:255], a[84:87]
  ds_read_b64_tr_b16 a[244:245], v10 offset:51200
  v_cvt_pk_bf16_f32 v218, v180, v181
  v_mfma_f32_16x16x32_bf16 a[80:83], a[204:207], v[248:251], a[80:83]
  v_exp_f32 v182, v182
  v_mfma_f32_16x16x32_bf16 a[80:83], a[200:203], v[52:55], a[80:83]
  ds_read_b64_tr_b16 a[246:247], v10 offset:52224
  v_mfma_f32_16x16x32_bf16 a[96:99], a[208:211], v[52:55], a[96:99]
  v_exp_f32 v183, v183
  v_mfma_f32_16x16x32_bf16 a[96:99], a[212:215], v[248:251], a[96:99]
  buffer_load_dwordx4 v16, s[4:7], s27 offen offset:3072 lds
  v_mfma_f32_16x16x32_bf16 a[100:103], a[212:215], v[252:255], a[100:103]
  ds_read_b64_tr_b16 a[248:249], v11 offset:49152
  v_cvt_pk_bf16_f32 v219, v182, v183
  v_mfma_f32_16x16x32_bf16 a[100:103], a[208:211], v[56:59], a[100:103]
  v_exp_f32 v184, v184
  v_mfma_f32_16x16x32_bf16 a[104:107], a[208:211], v[60:63], a[104:107]
  ds_read_b64_tr_b16 a[250:251], v11 offset:50176
  v_mfma_f32_16x16x32_bf16 a[104:107], a[212:215], v[20:23], a[104:107]
  v_exp_f32 v185, v185
  v_mfma_f32_16x16x32_bf16 a[108:111], a[212:215], v[28:31], a[108:111]
  ds_read_b64_tr_b16 a[252:253], v11 offset:51200
  v_cvt_pk_bf16_f32 v220, v184, v185
  v_mfma_f32_16x16x32_bf16 a[108:111], a[208:211], v[244:247], a[108:111]
  v_exp_f32 v186, v186
  v_mfma_f32_16x16x32_bf16 a[124:127], a[216:219], v[244:247], a[124:127]
  ds_read_b64_tr_b16 a[254:255], v11 offset:52224
  v_mfma_f32_16x16x32_bf16 a[124:127], a[220:223], v[28:31], a[124:127]
  v_exp_f32 v187, v187
  v_mfma_f32_16x16x32_bf16 a[120:123], a[220:223], v[20:23], a[120:123]
  v_cvt_pk_bf16_f32 v221, v186, v187
  v_mfma_f32_16x16x32_bf16 a[120:123], a[216:219], v[60:63], a[120:123]
  v_exp_f32 v188, v188
  v_mfma_f32_16x16x32_bf16 a[116:119], a[216:219], v[56:59], a[116:119]
  v_mfma_f32_16x16x32_bf16 a[116:119], a[220:223], v[252:255], a[116:119]
  v_exp_f32 v189, v189
  v_mfma_f32_16x16x32_bf16 a[112:115], a[220:223], v[248:251], a[112:115]
  v_cvt_pk_bf16_f32 v222, v188, v189
  v_mfma_f32_16x16x32_bf16 a[112:115], a[216:219], v[52:55], a[112:115]
  v_exp_f32 v190, v190
  v_mfma_f32_16x16x32_bf16 v[236:239], v[224:227], v[60:63], v[236:239]
  v_mfma_f32_16x16x32_bf16 v[236:239], v[224:227], v[20:23], v[236:239]
  v_exp_f32 v191, v191
  v_mfma_f32_16x16x32_bf16 v[240:243], v[224:227], v[244:247], v[240:243]
  s_add_u32 s27, s27, 16384
  v_cvt_pk_bf16_f32 v223, v190, v191
  v_mfma_f32_16x16x32_bf16 v[240:243], v[224:227], v[28:31], v[240:243]
  s_waitcnt vmcnt(12) lgkmcnt(0)
  s_barrier
  v_mfma_f32_16x16x32_bf16 v[160:163], a[160:163], v[64:67], v[32:35]
  s_sub_u32 s30, s27, 32768
  v_exp_f32 v128, v128
  v_mfma_f32_16x16x32_bf16 v[160:163], a[164:167], v[68:71], v[160:163]
  ds_read_b128 a[128:131], v4 offset:16384
  v_mfma_f32_16x16x32_bf16 v[160:163], a[168:171], v[72:75], v[160:163]
  v_exp_f32 v129, v129
  v_mfma_f32_16x16x32_bf16 v[160:163], a[172:175], v[76:79], v[160:163]
  ds_read_b64_tr_b16 a[192:193], v12 offset:49152
  v_cvt_pk_bf16_f32 v52, v128, v129
  v_mfma_f32_16x16x32_bf16 v[164:167], a[188:191], v[76:79], v[32:35]
  s_add_u32 m0, s26, 32768
  v_exp_f32 v130, v130
  v_mfma_f32_16x16x32_bf16 v[164:167], a[184:187], v[72:75], v[164:167]
  buffer_load_dwordx4 v17, s[8:11], s30 offen offset:0 lds
  v_mfma_f32_16x16x32_bf16 v[164:167], a[180:183], v[68:71], v[164:167]
  v_exp_f32 v131, v131
  v_mfma_f32_16x16x32_bf16 v[164:167], a[176:179], v[64:67], v[164:167]
  ds_read_b128 a[132:135], v5 offset:16384
  v_cvt_pk_bf16_f32 v53, v130, v131
  v_mfma_f32_16x16x32_bf16 v[172:175], a[176:179], v[80:83], v[36:39]
  v_exp_f32 v132, v132
  v_mfma_f32_16x16x32_bf16 v[172:175], a[180:183], v[84:87], v[172:175]
  ds_read_b64_tr_b16 a[194:195], v12 offset:50176
  v_mfma_f32_16x16x32_bf16 v[172:175], a[184:187], v[88:91], v[172:175]
  v_exp_f32 v133, v133
  v_mfma_f32_16x16x32_bf16 v[172:175], a[188:191], v[92:95], v[172:175]
  ds_read_b128 a[136:139], v6 offset:16384
  v_cvt_pk_bf16_f32 v54, v132, v133
  v_mfma_f32_16x16x32_bf16 v[168:171], a[172:175], v[92:95], v[36:39]
  s_add_u32 s1, s1, 1280
  v_exp_f32 v134, v134
  v_mfma_f32_16x16x32_bf16 v[168:171], a[168:171], v[88:91], v[168:171]
  ds_read_b64_tr_b16 a[196:197], v12 offset:51200
  v_mfma_f32_16x16x32_bf16 v[168:171], a[164:167], v[84:87], v[168:171]
  s_add_u32 s38, s38, 2560
  v_exp_f32 v135, v135
  v_mfma_f32_16x16x32_bf16 v[168:171], a[160:163], v[80:83], v[168:171]
  ds_read_b128 a[140:143], v7 offset:16384
  v_cvt_pk_bf16_f32 v55, v134, v135
  v_mfma_f32_16x16x32_bf16 v[176:179], a[160:163], v[96:99], v[40:43]
  ds_read_b64_tr_b16 a[198:199], v12 offset:52224
  v_mfma_f32_16x16x32_bf16 v[176:179], a[164:167], v[100:103], v[176:179]
  v_exp_f32 v136, v136
  v_mfma_f32_16x16x32_bf16 v[176:179], a[168:171], v[104:107], v[176:179]
  buffer_load_dwordx4 v17, s[8:11], s30 offen offset:1024 lds
  v_mfma_f32_16x16x32_bf16 v[176:179], a[172:175], v[108:111], v[176:179]
  v_exp_f32 v137, v137
  v_mfma_f32_16x16x32_bf16 v[180:183], a[188:191], v[108:111], v[40:43]
  v_cvt_pk_bf16_f32 v56, v136, v137
  v_mfma_f32_16x16x32_bf16 v[180:183], a[184:187], v[104:107], v[180:183]
  v_exp_f32 v138, v138
  v_mfma_f32_16x16x32_bf16 v[180:183], a[180:183], v[100:103], v[180:183]
  ds_read_b128 a[144:147], v4 offset:17408
  v_mfma_f32_16x16x32_bf16 v[180:183], a[176:179], v[96:99], v[180:183]
  v_exp_f32 v139, v139
  v_mfma_f32_16x16x32_bf16 v[188:191], a[176:179], v[112:115], v[44:47]
  ds_read_b64_tr_b16 a[200:201], v13 offset:49152
  v_cvt_pk_bf16_f32 v57, v138, v139
  v_mfma_f32_16x16x32_bf16 v[188:191], a[180:183], v[116:119], v[188:191]
  v_exp_f32 v140, v140
  v_mfma_f32_16x16x32_bf16 v[188:191], a[184:187], v[120:123], v[188:191]
  ds_read_b128 a[148:151], v5 offset:17408
  v_mfma_f32_16x16x32_bf16 v[188:191], a[188:191], v[124:127], v[188:191]
  v_exp_f32 v141, v141
  v_mfma_f32_16x16x32_bf16 v[184:187], a[172:175], v[124:127], v[44:47]
  ds_read_b64_tr_b16 a[202:203], v13 offset:50176
  v_cvt_pk_bf16_f32 v58, v140, v141
  v_mfma_f32_16x16x32_bf16 v[184:187], a[168:171], v[120:123], v[184:187]
  v_exp_f32 v142, v142
  v_mfma_f32_16x16x32_bf16 v[184:187], a[164:167], v[116:119], v[184:187]
  ds_read_b128 a[152:155], v6 offset:17408
  v_mfma_f32_16x16x32_bf16 v[184:187], a[160:163], v[112:115], v[184:187]
  v_exp_f32 v143, v143
  v_mfma_f32_16x16x32_bf16 a[0:3], a[224:227], v[192:195], a[0:3]
  ds_read_b64_tr_b16 a[204:205], v13 offset:51200
  v_cvt_pk_bf16_f32 v59, v142, v143
  v_mfma_f32_16x16x32_bf16 a[0:3], a[228:231], v[208:211], a[0:3]
  buffer_load_dwordx4 v17, s[8:11], s30 offen offset:2048 lds
  v_mfma_f32_16x16x32_bf16 a[4:7], a[228:231], v[212:215], a[4:7]
  v_exp_f32 v144, v144
  v_mfma_f32_16x16x32_bf16 a[4:7], a[224:227], v[196:199], a[4:7]
  ds_read_b128 a[156:159], v7 offset:17408
  v_mfma_f32_16x16x32_bf16 a[8:11], a[224:227], v[200:203], a[8:11]
  v_exp_f32 v145, v145
  v_mfma_f32_16x16x32_bf16 a[8:11], a[228:231], v[216:219], a[8:11]
  ds_read_b64_tr_b16 a[206:207], v13 offset:52224
  v_cvt_pk_bf16_f32 v60, v144, v145
  v_mfma_f32_16x16x32_bf16 a[12:15], a[228:231], v[220:223], a[12:15]
  v_exp_f32 v146, v146
  v_mfma_f32_16x16x32_bf16 a[12:15], a[224:227], v[204:207], a[12:15]
  v_mfma_f32_16x16x32_bf16 a[28:31], a[232:235], v[204:207], a[28:31]
  v_exp_f32 v147, v147
  v_mfma_f32_16x16x32_bf16 a[28:31], a[236:239], v[220:223], a[28:31]
  ds_read_b64_tr_b16 a[208:209], v14 offset:49152
  v_cvt_pk_bf16_f32 v61, v146, v147
  v_mfma_f32_16x16x32_bf16 a[24:27], a[236:239], v[216:219], a[24:27]
  v_exp_f32 v148, v148
  v_mfma_f32_16x16x32_bf16 a[24:27], a[232:235], v[200:203], a[24:27]
  ds_read_b64_tr_b16 a[210:211], v14 offset:50176
  v_mfma_f32_16x16x32_bf16 a[20:23], a[232:235], v[196:199], a[20:23]
  v_exp_f32 v149, v149
  v_mfma_f32_16x16x32_bf16 a[20:23], a[236:239], v[212:215], a[20:23]
  ds_read_b64_tr_b16 a[212:213], v14 offset:51200
  v_cvt_pk_bf16_f32 v62, v148, v149
  v_mfma_f32_16x16x32_bf16 a[16:19], a[236:239], v[208:211], a[16:19]
  v_exp_f32 v150, v150
  v_mfma_f32_16x16x32_bf16 a[16:19], a[232:235], v[192:195], a[16:19]
  ds_read_b64_tr_b16 a[214:215], v14 offset:52224
  v_mfma_f32_16x16x32_bf16 a[32:35], a[240:243], v[192:195], a[32:35]
  v_exp_f32 v151, v151
  v_mfma_f32_16x16x32_bf16 a[32:35], a[244:247], v[208:211], a[32:35]
  buffer_load_dwordx4 v17, s[8:11], s30 offen offset:3072 lds
  v_mfma_f32_16x16x32_bf16 a[36:39], a[244:247], v[212:215], a[36:39]
  ds_read_b64_tr_b16 a[216:217], v15 offset:49152
  v_cvt_pk_bf16_f32 v63, v150, v151
  v_mfma_f32_16x16x32_bf16 a[36:39], a[240:243], v[196:199], a[36:39]
  v_exp_f32 v152, v152
  v_mfma_f32_16x16x32_bf16 a[40:43], a[240:243], v[200:203], a[40:43]
  ds_read_b64_tr_b16 a[218:219], v15 offset:50176
  v_mfma_f32_16x16x32_bf16 a[40:43], a[244:247], v[216:219], a[40:43]
  v_exp_f32 v153, v153
  v_mfma_f32_16x16x32_bf16 a[44:47], a[244:247], v[220:223], a[44:47]
  ds_read_b64_tr_b16 a[220:221], v15 offset:51200
  v_cvt_pk_bf16_f32 v244, v152, v153
  v_mfma_f32_16x16x32_bf16 a[44:47], a[240:243], v[204:207], a[44:47]
  v_exp_f32 v154, v154
  v_mfma_f32_16x16x32_bf16 a[60:63], a[248:251], v[204:207], a[60:63]
  ds_read_b64_tr_b16 a[222:223], v15 offset:52224
  v_mfma_f32_16x16x32_bf16 a[60:63], a[252:255], v[220:223], a[60:63]
  v_exp_f32 v155, v155
  v_mfma_f32_16x16x32_bf16 a[56:59], a[252:255], v[216:219], a[56:59]
  v_cvt_pk_bf16_f32 v245, v154, v155
  v_mfma_f32_16x16x32_bf16 a[56:59], a[248:251], v[200:203], a[56:59]
  v_exp_f32 v156, v156
  v_mfma_f32_16x16x32_bf16 a[52:55], a[248:251], v[196:199], a[52:55]
  v_mfma_f32_16x16x32_bf16 a[52:55], a[252:255], v[212:215], a[52:55]
  v_exp_f32 v157, v157
  v_mfma_f32_16x16x32_bf16 a[48:51], a[252:255], v[208:211], a[48:51]
  v_cvt_pk_bf16_f32 v246, v156, v157
  v_mfma_f32_16x16x32_bf16 a[48:51], a[248:251], v[192:195], a[48:51]
  v_exp_f32 v158, v158
  v_mfma_f32_16x16x32_bf16 v[228:231], v[224:227], v[192:195], v[228:231]
  v_mfma_f32_16x16x32_bf16 v[228:231], v[224:227], v[208:211], v[228:231]
  s_add_u32 s28, s28, 1
  v_exp_f32 v159, v159
  v_mfma_f32_16x16x32_bf16 v[232:235], v[224:227], v[196:199], v[232:235]
  s_cmp_eq_u32 s28, 7
  v_cvt_pk_bf16_f32 v247, v158, v159
  v_mfma_f32_16x16x32_bf16 v[232:235], v[224:227], v[212:215], v[232:235]
  s_waitcnt lgkmcnt(0)
  s_cbranch_scc1 L_attn_tail
  v_mfma_f32_16x16x32_bf16 v[128:131], a[128:131], v[64:67], v[32:35]
  v_exp_f32 v160, v160
  v_mfma_f32_16x16x32_bf16 v[128:131], a[132:135], v[68:71], v[128:131]
  ds_read_b128 a[160:163], v4 offset:18432
  v_mfma_f32_16x16x32_bf16 v[128:131], a[136:139], v[72:75], v[128:131]
  v_exp_f32 v161, v161
  v_mfma_f32_16x16x32_bf16 v[128:131], a[140:143], v[76:79], v[128:131]
  ds_read_b64_tr_b16 a[224:225], v8 offset:0
  v_cvt_pk_bf16_f32 v248, v160, v161
  v_mfma_f32_16x16x32_bf16 v[132:135], a[156:159], v[76:79], v[32:35]
  s_add_u32 m0, s43, 0
  v_exp_f32 v162, v162
  v_mfma_f32_16x16x32_bf16 v[132:135], a[152:155], v[72:75], v[132:135]
  buffer_load_dwordx4 v16, s[4:7], s27 offen offset:0 lds
  v_mfma_f32_16x16x32_bf16 v[132:135], a[148:151], v[68:71], v[132:135]
  v_exp_f32 v163, v163
  v_mfma_f32_16x16x32_bf16 v[132:135], a[144:147], v[64:67], v[132:135]
  ds_read_b128 a[164:167], v5 offset:18432
  v_cvt_pk_bf16_f32 v249, v162, v163
  v_mfma_f32_16x16x32_bf16 v[140:143], a[144:147], v[80:83], v[36:39]
  v_exp_f32 v164, v164
  v_mfma_f32_16x16x32_bf16 v[140:143], a[148:151], v[84:87], v[140:143]
  ds_read_b64_tr_b16 a[226:227], v8 offset:1024
  v_mfma_f32_16x16x32_bf16 v[140:143], a[152:155], v[88:91], v[140:143]
  v_exp_f32 v165, v165
  v_mfma_f32_16x16x32_bf16 v[140:143], a[156:159], v[92:95], v[140:143]
  ds_read_b128 a[168:171], v6 offset:18432
  v_cvt_pk_bf16_f32 v250, v164, v165
  v_mfma_f32_16x16x32_bf16 v[136:139], a[140:143], v[92:95], v[36:39]
  v_exp_f32 v166, v166
  v_mfma_f32_16x16x32_bf16 v[136:139], a[136:139], v[88:91], v[136:139]
  ds_read_b64_tr_b16 a[228:229], v8 offset:2048
  v_mfma_f32_16x16x32_bf16 v[136:139], a[132:135], v[84:87], v[136:139]
  v_exp_f32 v167, v167
  v_mfma_f32_16x16x32_bf16 v[136:139], a[128:131], v[80:83], v[136:139]
  ds_read_b128 a[172:175], v7 offset:18432
  v_cvt_pk_bf16_f32 v251, v166, v167
  v_mfma_f32_16x16x32_bf16 v[144:147], a[128:131], v[96:99], v[40:43]
  ds_read_b64_tr_b16 a[230:231], v8 offset:3072
  v_mfma_f32_16x16x32_bf16 v[144:147], a[132:135], v[100:103], v[144:147]
  v_exp_f32 v168, v168
  v_mfma_f32_16x16x32_bf16 v[144:147], a[136:139], v[104:107], v[144:147]
  buffer_load_dwordx4 v16, s[4:7], s27 offen offset:1024 lds
  v_mfma_f32_16x16x32_bf16 v[144:147], a[140:143], v[108:111], v[144:147]
  v_exp_f32 v169, v169
  v_mfma_f32_16x16x32_bf16 v[148:151], a[156:159], v[108:111], v[40:43]
  v_cvt_pk_bf16_f32 v252, v168, v169
  v_mfma_f32_16x16x32_bf16 v[148:151], a[152:155], v[104:107], v[148:151]
  v_exp_f32 v170, v170
  v_mfma_f32_16x16x32_bf16 v[148:151], a[148:151], v[100:103], v[148:151]
  ds_read_b128 a[176:179], v4 offset:19456
  v_mfma_f32_16x16x32_bf16 v[148:151], a[144:147], v[96:99], v[148:151]
  v_exp_f32 v171, v171
  v_mfma_f32_16x16x32_bf16 v[156:159], a[144:147], v[112:115], v[44:47]
  ds_read_b64_tr_b16 a[232:233], v9 offset:0
  v_cvt_pk_bf16_f32 v253, v170, v171
  v_mfma_f32_16x16x32_bf16 v[156:159], a[148:151], v[116:119], v[156:159]
  v_exp_f32 v172, v172
  v_mfma_f32_16x16x32_bf16 v[156:159], a[152:155], v[120:123], v[156:159]
  ds_read_b128 a[180:183], v5 offset:19456
  v_mfma_f32_16x16x32_bf16 v[156:159], a[156:159], v[124:127], v[156:159]
  v_exp_f32 v173, v173
  v_mfma_f32_16x16x32_bf16 v[152:155], a[140:143], v[124:127], v[44:47]
  ds_read_b64_tr_b16 a[234:235], v9 offset:1024
  v_cvt_pk_bf16_f32 v254, v172, v173
  v_mfma_f32_16x16x32_bf16 v[152:155], a[136:139], v[120:123], v[152:155]
  v_exp_f32 v174, v174
  v_mfma_f32_16x16x32_bf16 v[152:155], a[132:135], v[116:119], v[152:155]
  ds_read_b128 a[184:187], v6 offset:19456
  v_mfma_f32_16x16x32_bf16 v[152:155], a[128:131], v[112:115], v[152:155]
  v_exp_f32 v175, v175
  v_mfma_f32_16x16x32_bf16 a[64:67], a[192:195], v[192:195], a[64:67]
  ds_read_b64_tr_b16 a[236:237], v9 offset:2048
  v_cvt_pk_bf16_f32 v255, v174, v175
  v_mfma_f32_16x16x32_bf16 a[64:67], a[196:199], v[208:211], a[64:67]
  buffer_load_dwordx4 v16, s[4:7], s27 offen offset:2048 lds
  v_mfma_f32_16x16x32_bf16 a[68:71], a[196:199], v[212:215], a[68:71]
  v_exp_f32 v176, v176
  v_mfma_f32_16x16x32_bf16 a[68:71], a[192:195], v[196:199], a[68:71]
  ds_read_b128 a[188:191], v7 offset:19456
  v_mfma_f32_16x16x32_bf16 a[72:75], a[192:195], v[200:203], a[72:75]
  v_exp_f32 v177, v177
  v_mfma_f32_16x16x32_bf16 a[72:75], a[196:199], v[216:219], a[72:75]
  ds_read_b64_tr_b16 a[238:239], v9 offset:3072
  v_cvt_pk_bf16_f32 v20, v176, v177
  v_mfma_f32_16x16x32_bf16 a[76:79], a[196:199], v[220:223], a[76:79]
  v_exp_f32 v178, v178
  v_mfma_f32_16x16x32_bf16 a[76:79], a[192:195], v[204:207], a[76:79]
  v_mfma_f32_16x16x32_bf16 a[92:95], a[200:203], v[204:207], a[92:95]
  v_exp_f32 v179, v179
  v_mfma_f32_16x16x32_bf16 a[92:95], a[204:207], v[220:223], a[92:95]
  ds_read_b64_tr_b16 a[240:241], v10 offset:0
  v_cvt_pk_bf16_f32 v21, v178, v179
  v_mfma_f32_16x16x32_bf16 a[88:91], a[204:207], v[216:219], a[88:91]
  v_exp_f32 v180, v180
  v_mfma_f32_16x16x32_bf16 a[88:91], a[200:203], v[200:203], a[88:91]
  ds_read_b64_tr_b16 a[242:243], v10 offset:1024
  v_mfma_f32_16x16x32_bf16 a[84:87], a[200:203], v[196:199], a[84:87]
  v_exp_f32 v181, v181
  v_mfma_f32_16x16x32_bf16 a[84:87], a[204:207], v[212:215], a[84:87]
  ds_read_b64_tr_b16 a[244:245], v10 offset:2048
  v_cvt_pk_bf16_f32 v22, v180, v181
  v_mfma_f32_16x16x32_bf16 a[80:83], a[204:207], v[208:211], a[80:83]
  v_exp_f32 v182, v182
  v_mfma_f32_16x16x32_bf16 a[80:83], a[200:203], v[192:195], a[80:83]
  ds_read_b64_tr_b16 a[246:247], v10 offset:3072
  v_mfma_f32_16x16x32_bf16 a[96:99], a[208:211], v[192:195], a[96:99]
  v_exp_f32 v183, v183
  v_mfma_f32_16x16x32_bf16 a[96:99], a[212:215], v[208:211], a[96:99]
  buffer_load_dwordx4 v16, s[4:7], s27 offen offset:3072 lds
  v_mfma_f32_16x16x32_bf16 a[100:103], a[212:215], v[212:215], a[100:103]
  ds_read_b64_tr_b16 a[248:249], v11 offset:0
  v_cvt_pk_bf16_f32 v23, v182, v183
  v_mfma_f32_16x16x32_bf16 a[100:103], a[208:211], v[196:199], a[100:103]
  v_exp_f32 v184, v184
  v_mfma_f32_16x16x32_bf16 a[104:107], a[208:211], v[200:203], a[104:107]
  ds_read_b64_tr_b16 a[250:251], v11 offset:1024
  v_mfma_f32_16x16x32_bf16 a[104:107], a[212:215], v[216:219], a[104:107]
  v_exp_f32 v185, v185
  v_mfma_f32_16x16x32_bf16 a[108:111], a[212:215], v[220:223], a[108:111]
  ds_read_b64_tr_b16 a[252:253], v11 offset:2048
  v_cvt_pk_bf16_f32 v28, v184, v185
  v_mfma_f32_16x16x32_bf16 a[108:111], a[208:211], v[204:207], a[108:111]
  v_exp_f32 v186, v186
  v_mfma_f32_16x16x32_bf16 a[124:127], a[216:219], v[204:207], a[124:127]
  ds_read_b64_tr_b16 a[254:255], v11 offset:3072
  v_mfma_f32_16x16x32_bf16 a[124:127], a[220:223], v[220:223], a[124:127]
  v_exp_f32 v187, v187
  v_mfma_f32_16x16x32_bf16 a[120:123], a[220:223], v[216:219], a[120:123]
  v_cvt_pk_bf16_f32 v29, v186, v187
  v_mfma_f32_16x16x32_bf16 a[120:123], a[216:219], v[200:203], a[120:123]
  v_exp_f32 v188, v188
  v_mfma_f32_16x16x32_bf16 a[116:119], a[216:219], v[196:199], a[116:119]
  v_mfma_f32_16x16x32_bf16 a[116:119], a[220:223], v[212:215], a[116:119]
  v_exp_f32 v189, v189
  v_mfma_f32_16x16x32_bf16 a[112:115], a[220:223], v[208:211], a[112:115]
  v_cvt_pk_bf16_f32 v30, v188, v189
  v_mfma_f32_16x16x32_bf16 a[112:115], a[216:219], v[192:195], a[112:115]
  v_exp_f32 v190, v190
  v_mfma_f32_16x16x32_bf16 v[236:239], v[224:227], v[200:203], v[236:239]
  v_mfma_f32_16x16x32_bf16 v[236:239], v[224:227], v[216:219], v[236:239]
  v_exp_f32 v191, v191
  v_mfma_f32_16x16x32_bf16 v[240:243], v[224:227], v[204:207], v[240:243]
  s_add_u32 s27, s27, 16384
  v_cvt_pk_bf16_f32 v31, v190, v191
  v_mfma_f32_16x16x32_bf16 v[240:243], v[224:227], v[220:223], v[240:243]
  s_waitcnt vmcnt(12) lgkmcnt(0)
  s_barrier
  s_branch L_attn_loop
L_attn_tail:
  v_mfma_f32_16x16x32_bf16 v[128:131], a[128:131], v[64:67], v[32:35]
  s_add_u32 s30, s79, 0
  v_exp_f32 v160, v160
  v_mfma_f32_16x16x32_bf16 v[128:131], a[132:135], v[68:71], v[128:131]
  s_lshr_b32 s31, s41, 18
  s_lshl_b32 s31, s31, 2
  s_add_u32 s31, s31, s24
  s_lshl_b32 s32, s31, 14
  s_add_u32 s33, s32, 8192
  s_lshl_b32 s31, s31, 13
  s_and_b32 s34, s39, 0x300000
  s_add_u32 s31, s31, s34
  s_cmp_eq_u32 s28, 7
  s_cselect_b32 s40, s32, 2.0
  s_cselect_b32 s44, s33, 2.0
  s_cselect_b32 s45, s31, 2.0
  s_cselect_b32 s0, 0, 2.0
  s_cselect_b32 s42, 0x10000, 2.0
  ds_read_b128 a[160:163], v4 offset:18432
  v_mfma_f32_16x16x32_bf16 v[128:131], a[136:139], v[72:75], v[128:131]
  v_exp_f32 v161, v161
  v_mfma_f32_16x16x32_bf16 v[128:131], a[140:143], v[76:79], v[128:131]
  ds_read_b64_tr_b16 a[224:225], v8 offset:0
  v_cvt_pk_bf16_f32 v248, v160, v161
  v_mfma_f32_16x16x32_bf16 v[132:135], a[156:159], v[76:79], v[32:35]
  s_add_u32 m0, s43, 0
  v_exp_f32 v162, v162
  v_mfma_f32_16x16x32_bf16 v[132:135], a[152:155], v[72:75], v[132:135]
  buffer_load_dwordx4 v18, s[52:55], s30 offen offset:0 lds
  v_mfma_f32_16x16x32_bf16 v[132:135], a[148:151], v[68:71], v[132:135]
  v_exp_f32 v163, v163
  v_mfma_f32_16x16x32_bf16 v[132:135], a[144:147], v[64:67], v[132:135]
  ds_read_b128 a[164:167], v5 offset:18432
  v_cvt_pk_bf16_f32 v249, v162, v163
  v_mfma_f32_16x16x32_bf16 v[140:143], a[144:147], v[80:83], v[36:39]
  v_exp_f32 v164, v164
  v_mfma_f32_16x16x32_bf16 v[140:143], a[148:151], v[84:87], v[140:143]
  ds_read_b64_tr_b16 a[226:227], v8 offset:1024
  v_mfma_f32_16x16x32_bf16 v[140:143], a[152:155], v[88:91], v[140:143]
  v_exp_f32 v165, v165
  v_mfma_f32_16x16x32_bf16 v[140:143], a[156:159], v[92:95], v[140:143]
  ds_read_b128 a[168:171], v6 offset:18432
  v_cvt_pk_bf16_f32 v250, v164, v165
  v_mfma_f32_16x16x32_bf16 v[136:139], a[140:143], v[92:95], v[36:39]
  v_exp_f32 v166, v166
  v_mfma_f32_16x16x32_bf16 v[136:139], a[136:139], v[88:91], v[136:139]
L_attn_st8:
  s_cbranch_vccnz L_attn_walkdone2
  ds_read_b64_tr_b16 a[228:229], v8 offset:2048
  v_mfma_f32_16x16x32_bf16 v[136:139], a[132:135], v[84:87], v[136:139]
  v_exp_f32 v167, v167
  v_mfma_f32_16x16x32_bf16 v[136:139], a[128:131], v[80:83], v[136:139]
  ds_read_b128 a[172:175], v7 offset:18432
  v_cvt_pk_bf16_f32 v251, v166, v167
  v_mfma_f32_16x16x32_bf16 v[144:147], a[128:131], v[96:99], v[40:43]
  ds_read_b64_tr_b16 a[230:231], v8 offset:3072
  v_mfma_f32_16x16x32_bf16 v[144:147], a[132:135], v[100:103], v[144:147]
  s_add_u32 s30, s79, 15360
  v_exp_f32 v168, v168
  v_mfma_f32_16x16x32_bf16 v[144:147], a[136:139], v[104:107], v[144:147]
  buffer_load_dwordx4 v18, s[52:55], s30 offen offset:1024 lds
  v_mfma_f32_16x16x32_bf16 v[144:147], a[140:143], v[108:111], v[144:147]
  v_exp_f32 v169, v169
  v_mfma_f32_16x16x32_bf16 v[148:151], a[156:159], v[108:111], v[40:43]
  v_cvt_pk_bf16_f32 v252, v168, v169
  v_mfma_f32_16x16x32_bf16 v[148:151], a[152:155], v[104:107], v[148:151]
  v_exp_f32 v170, v170
  v_mfma_f32_16x16x32_bf16 v[148:151], a[148:151], v[100:103], v[148:151]
  ds_read_b128 a[176:179], v4 offset:19456
  v_mfma_f32_16x16x32_bf16 v[148:151], a[144:147], v[96:99], v[148:151]
  v_exp_f32 v171, v171
  v_mfma_f32_16x16x32_bf16 v[156:159], a[144:147], v[112:115], v[44:47]
  ds_read_b64_tr_b16 a[232:233], v9 offset:0
  v_cvt_pk_bf16_f32 v253, v170, v171
  v_mfma_f32_16x16x32_bf16 v[156:159], a[148:151], v[116:119], v[156:159]
  v_exp_f32 v172, v172
  v_mfma_f32_16x16x32_bf16 v[156:159], a[152:155], v[120:123], v[156:159]
  ds_read_b128 a[180:183], v5 offset:19456
  v_mfma_f32_16x16x32_bf16 v[156:159], a[156:159], v[124:127], v[156:159]
  v_exp_f32 v173, v173
  v_mfma_f32_16x16x32_bf16 v[152:155], a[140:143], v[124:127], v[44:47]
  ds_read_b64_tr_b16 a[234:235], v9 offset:1024
  v_cvt_pk_bf16_f32 v254, v172, v173
  v_mfma_f32_16x16x32_bf16 v[152:155], a[136:139], v[120:123], v[152:155]
  v_exp_f32 v174, v174
  v_mfma_f32_16x16x32_bf16 v[152:155], a[132:135], v[116:119], v[152:155]
  ds_read_b128 a[184:187], v6 offset:19456
  v_mfma_f32_16x16x32_bf16 v[152:155], a[128:131], v[112:115], v[152:155]
  v_exp_f32 v175, v175
  v_mfma_f32_16x16x32_bf16 a[64:67], a[192:195], v[192:195], a[64:67]
  s_add_u32 s30, s79, 30720
  ds_read_b64_tr_b16 a[236:237], v9 offset:2048
  v_cvt_pk_bf16_f32 v255, v174, v175
  v_mfma_f32_16x16x32_bf16 a[64:67], a[196:199], v[208:211], a[64:67]
  buffer_load_dwordx4 v18, s[52:55], s30 offen offset:2048 lds
  v_mfma_f32_16x16x32_bf16 a[68:71], a[196:199], v[212:215], a[68:71]
  v_exp_f32 v176, v176
  v_mfma_f32_16x16x32_bf16 a[68:71], a[192:195], v[196:199], a[68:71]
  ds_read_b128 a[188:191], v7 offset:19456
  v_mfma_f32_16x16x32_bf16 a[72:75], a[192:195], v[200:203], a[72:75]
  v_exp_f32 v177, v177
  v_mfma_f32_16x16x32_bf16 a[72:75], a[196:199], v[216:219], a[72:75]
  ds_read_b64_tr_b16 a[238:239], v9 offset:3072
  v_cvt_pk_bf16_f32 v20, v176, v177
  v_mfma_f32_16x16x32_bf16 a[76:79], a[196:199], v[220:223], a[76:79]
  v_exp_f32 v178, v178
  v_mfma_f32_16x16x32_bf16 a[76:79], a[192:195], v[204:207], a[76:79]
  v_mfma_f32_16x16x32_bf16 a[92:95], a[200:203], v[204:207], a[92:95]
  v_exp_f32 v179, v179
  v_mfma_f32_16x16x32_bf16 a[92:95], a[204:207], v[220:223], a[92:95]
  ds_read_b64_tr_b16 a[240:241], v10 offset:0
  v_cvt_pk_bf16_f32 v21, v178, v179
  v_mfma_f32_16x16x32_bf16 a[88:91], a[204:207], v[216:219], a[88:91]
  v_exp_f32 v180, v180
  v_mfma_f32_16x16x32_bf16 a[88:91], a[200:203], v[200:203], a[88:91]
  ds_read_b64_tr_b16 a[242:243], v10 offset:1024
  v_mfma_f32_16x16x32_bf16 a[84:87], a[200:203], v[196:199], a[84:87]
  v_exp_f32 v181, v181
  v_mfma_f32_16x16x32_bf16 a[84:87], a[204:207], v[212:215], a[84:87]
  ds_read_b64_tr_b16 a[244:245], v10 offset:2048
  v_cvt_pk_bf16_f32 v22, v180, v181
  v_mfma_f32_16x16x32_bf16 a[80:83], a[204:207], v[208:211], a[80:83]
  v_exp_f32 v182, v182
  v_mfma_f32_16x16x32_bf16 a[80:83], a[200:203], v[192:195], a[80:83]
  ds_read_b64_tr_b16 a[246:247], v10 offset:3072
  v_mfma_f32_16x16x32_bf16 a[96:99], a[208:211], v[192:195], a[96:99]
  s_add_u32 s30, s79, 46080
  v_exp_f32 v183, v183
  v_mfma_f32_16x16x32_bf16 a[96:99], a[212:215], v[208:211], a[96:99]
  buffer_load_dwordx4 v18, s[52:55], s30 offen offset:3072 lds
  v_mfma_f32_16x16x32_bf16 a[100:103], a[212:215], v[212:215], a[100:103]
  ds_read_b64_tr_b16 a[248:249], v11 offset:0
  v_cvt_pk_bf16_f32 v23, v182, v183
  v_mfma_f32_16x16x32_bf16 a[100:103], a[208:211], v[196:199], a[100:103]
  v_exp_f32 v184, v184
  v_mfma_f32_16x16x32_bf16 a[104:107], a[208:211], v[200:203], a[104:107]
  ds_read_b64_tr_b16 a[250:251], v11 offset:1024
  v_mfma_f32_16x16x32_bf16 a[104:107], a[212:215], v[216:219], a[104:107]
  v_exp_f32 v185, v185
  v_mfma_f32_16x16x32_bf16 a[108:111], a[212:215], v[220:223], a[108:111]
  ds_read_b64_tr_b16 a[252:253], v11 offset:2048
  v_cvt_pk_bf16_f32 v28, v184, v185
  v_mfma_f32_16x16x32_bf16 a[108:111], a[208:211], v[204:207], a[108:111]
  v_exp_f32 v186, v186
  v_mfma_f32_16x16x32_bf16 a[124:127], a[216:219], v[204:207], a[124:127]
  ds_read_b64_tr_b16 a[254:255], v11 offset:3072
  v_mfma_f32_16x16x32_bf16 a[124:127], a[220:223], v[220:223], a[124:127]
  v_exp_f32 v187, v187
  v_mfma_f32_16x16x32_bf16 a[120:123], a[220:223], v[216:219], a[120:123]
  v_cvt_pk_bf16_f32 v29, v186, v187
  v_mfma_f32_16x16x32_bf16 a[120:123], a[216:219], v[200:203], a[120:123]
  v_exp_f32 v188, v188
  v_mfma_f32_16x16x32_bf16 a[116:119], a[216:219], v[196:199], a[116:119]
  v_mfma_f32_16x16x32_bf16 a[116:119], a[220:223], v[212:215], a[116:119]
  v_exp_f32 v189, v189
  v_mfma_f32_16x16x32_bf16 a[112:115], a[220:223], v[208:211], a[112:115]
  v_cvt_pk_bf16_f32 v30, v188, v189
  v_mfma_f32_16x16x32_bf16 a[112:115], a[216:219], v[192:195], a[112:115]
  v_exp_f32 v190, v190
  v_mfma_f32_16x16x32_bf16 v[236:239], v[224:227], v[200:203], v[236:239]
  v_mfma_f32_16x16x32_bf16 v[236:239], v[224:227], v[216:219], v[236:239]
  v_exp_f32 v191, v191
  v_mfma_f32_16x16x32_bf16 v[240:243], v[224:227], v[204:207], v[240:243]
  s_add_u32 s27, s27, 16384
  v_cvt_pk_bf16_f32 v31, v190, v191
  v_mfma_f32_16x16x32_bf16 v[240:243], v[224:227], v[220:223], v[240:243]
  s_waitcnt vmcnt(12) lgkmcnt(0)
  s_barrier
  v_mfma_f32_16x16x32_bf16 v[160:163], a[160:163], v[64:67], v[32:35]
  s_sub_u32 s30, s27, 32768
  v_exp_f32 v128, v128
  v_mfma_f32_16x16x32_bf16 v[160:163], a[164:167], v[68:71], v[160:163]
  ds_read_b128 a[128:131], v4 offset:32768
  v_mfma_f32_16x16x32_bf16 v[160:163], a[168:171], v[72:75], v[160:163]
  v_exp_f32 v129, v129
  v_mfma_f32_16x16x32_bf16 v[160:163], a[172:175], v[76:79], v[160:163]
  ds_read_b64_tr_b16 a[192:193], v12 offset:0
  v_cvt_pk_bf16_f32 v192, v128, v129
  v_mfma_f32_16x16x32_bf16 v[164:167], a[188:191], v[76:79], v[32:35]
  s_add_u32 m0, s26, 49152
  v_exp_f32 v130, v130
  v_mfma_f32_16x16x32_bf16 v[164:167], a[184:187], v[72:75], v[164:167]
  buffer_load_dwordx4 v17, s[8:11], s30 offen offset:0 lds
  v_mfma_f32_16x16x32_bf16 v[164:167], a[180:183], v[68:71], v[164:167]
  v_exp_f32 v131, v131
  v_mfma_f32_16x16x32_bf16 v[164:167], a[176:179], v[64:67], v[164:167]
  ds_read_b128 a[132:135], v5 offset:32768
  v_cvt_pk_bf16_f32 v193, v130, v131
  v_mfma_f32_16x16x32_bf16 v[172:175], a[176:179], v[80:83], v[36:39]
  v_exp_f32 v132, v132
  v_mfma_f32_16x16x32_bf16 v[172:175], a[180:183], v[84:87], v[172:175]
  ds_read_b64_tr_b16 a[194:195], v12 offset:1024
  v_mfma_f32_16x16x32_bf16 v[172:175], a[184:187], v[88:91], v[172:175]
  v_exp_f32 v133, v133
  v_mfma_f32_16x16x32_bf16 v[172:175], a[188:191], v[92:95], v[172:175]
  ds_read_b128 a[136:139], v6 offset:32768
  v_cvt_pk_bf16_f32 v194, v132, v133
  v_mfma_f32_16x16x32_bf16 v[168:171], a[172:175], v[92:95], v[36:39]
  v_exp_f32 v134, v134
  v_mfma_f32_16x16x32_bf16 v[168:171], a[168:171], v[88:91], v[168:171]
  ds_read_b64_tr_b16 a[196:197], v12 offset:2048
  v_mfma_f32_16x16x32_bf16 v[168:171], a[164:167], v[84:87], v[168:171]
  v_exp_f32 v135, v135
  v_mfma_f32_16x16x32_bf16 v[168:171], a[160:163], v[80:83], v[168:171]
  buffer_load_dwordx4 v17, s[8:11], s30 offen offset:1024 lds
  v_mfma_f32_16x16x32_bf16 v[176:179], a[160:163], v[96:99], v[40:43]
  ds_read_b128 a[140:143], v7 offset:32768
  v_cvt_pk_bf16_f32 v195, v134, v135
  v_mfma_f32_16x16x32_bf16 v[176:179], a[164:167], v[100:103], v[176:179]
  v_exp_f32 v136, v136
  v_mfma_f32_16x16x32_bf16 v[176:179], a[168:171], v[104:107], v[176:179]
  ds_read_b64_tr_b16 a[198:199], v12 offset:3072
  v_mfma_f32_16x16x32_bf16 v[176:179], a[172:175], v[108:111], v[176:179]
  v_exp_f32 v137, v137
  v_mfma_f32_16x16x32_bf16 v[180:183], a[188:191], v[108:111], v[40:43]
  ds_read_b128 a[144:147], v4 offset:33792
  v_cvt_pk_bf16_f32 v196, v136, v137
  v_mfma_f32_16x16x32_bf16 v[180:183], a[184:187], v[104:107], v[180:183]
  v_exp_f32 v138, v138
  v_mfma_f32_16x16x32_bf16 v[180:183], a[180:183], v[100:103], v[180:183]
  ds_read_b64_tr_b16 a[200:201], v13 offset:0
  v_mfma_f32_16x16x32_bf16 v[180:183], a[176:179], v[96:99], v[180:183]
  v_exp_f32 v139, v139
  v_mfma_f32_16x16x32_bf16 v[188:191], a[176:179], v[112:115], v[44:47]
  ds_read_b128 a[148:151], v5 offset:33792
  v_cvt_pk_bf16_f32 v197, v138, v139
  v_mfma_f32_16x16x32_bf16 v[188:191], a[180:183], v[116:119], v[188:191]
  v_exp_f32 v140, v140
  v_mfma_f32_16x16x32_bf16 v[188:191], a[184:187], v[120:123], v[188:191]
  buffer_load_dwordx4 v17, s[8:11], s30 offen offset:2048 lds
  v_mfma_f32_16x16x32_bf16 v[188:191], a[188:191], v[124:127], v[188:191]
  v_exp_f32 v141, v141
  v_mfma_f32_16x16x32_bf16 v[184:187], a[172:175], v[124:127], v[44:47]
  ds_read_b64_tr_b16 a[202:203], v13 offset:1024
  v_cvt_pk_bf16_f32 v198, v140, v141
  v_mfma_f32_16x16x32_bf16 v[184:187], a[168:171], v[120:123], v[184:187]
  v_exp_f32 v142, v142
  v_mfma_f32_16x16x32_bf16 v[184:187], a[164:167], v[116:119], v[184:187]
  v_mfma_f32_16x16x32_bf16 v[184:187], a[160:163], v[112:115], v[184:187]
  v_exp_f32 v143, v143
  v_mfma_f32_16x16x32_bf16 a[0:3], a[224:227], v[52:55], a[0:3]
  ds_read_b128 a[152:155], v6 offset:33792
  v_cvt_pk_bf16_f32 v199, v142, v143
  v_mfma_f32_16x16x32_bf16 a[0:3], a[228:231], v[248:251], a[0:3]
  ds_read_b64_tr_b16 a[204:205], v13 offset:2048
  v_mfma_f32_16x16x32_bf16 a[4:7], a[228:231], v[252:255], a[4:7]
  v_exp_f32 v144, v144
  v_mfma_f32_16x16x32_bf16 a[4:7], a[224:227], v[56:59], a[4:7]
  ds_read_b128 a[156:159], v7 offset:33792
  v_mfma_f32_16x16x32_bf16 a[8:11], a[224:227], v[60:63], a[8:11]
  v_exp_f32 v145, v145
  v_mfma_f32_16x16x32_bf16 a[8:11], a[228:231], v[20:23], a[8:11]
  ds_read_b64_tr_b16 a[206:207], v13 offset:3072
  v_cvt_pk_bf16_f32 v200, v144, v145
  v_mfma_f32_16x16x32_bf16 a[12:15], a[228:231], v[28:31], a[12:15]
  v_exp_f32 v146, v146
  v_mfma_f32_16x16x32_bf16 a[12:15], a[224:227], v[244:247], a[12:15]
  buffer_load_dwordx4 v17, s[8:11], s30 offen offset:3072 lds
  v_mfma_f32_16x16x32_bf16 a[28:31], a[232:235], v[244:247], a[28:31]
  v_exp_f32 v147, v147
  v_mfma_f32_16x16x32_bf16 a[28:31], a[236:239], v[28:31], a[28:31]
  ds_read_b64_tr_b16 a[208:209], v14 offset:0
  v_cvt_pk_bf16_f32 v201, v146, v147
  v_mfma_f32_16x16x32_bf16 a[24:27], a[236:239], v[20:23], a[24:27]
  v_exp_f32 v148, v148
  v_mfma_f32_16x16x32_bf16 a[24:27], a[232:235], v[60:63], a[24:27]
  ds_read_b64_tr_b16 a[210:211], v14 offset:1024
  v_mfma_f32_16x16x32_bf16 a[20:23], a[232:235], v[56:59], a[20:23]
  v_exp_f32 v149, v149
  v_mfma_f32_16x16x32_bf16 a[20:23], a[236:239], v[252:255], a[20:23]
  ds_read_b64_tr_b16 a[212:213], v14 offset:2048
  v_cvt_pk_bf16_f32 v202, v148, v149
  v_mfma_f32_16x16x32_bf16 a[16:19], a[236:239], v[248:251], a[16:19]
  v_exp_f32 v150, v150
  v_mfma_f32_16x16x32_bf16 a[16:19], a[232:235], v[52:55], a[16:19]
  ds_read_b64_tr_b16 a[214:215], v14 offset:3072
  v_mfma_f32_16x16x32_bf16 a[32:35], a[240:243], v[52:55], a[32:35]
  v_exp_f32 v151, v151
  v_mfma_f32_16x16x32_bf16 a[32:35], a[244:247], v[248:251], a[32:35]
  ds_read_b64_tr_b16 a[216:217], v15 offset:0
  v_cvt_pk_bf16_f32 v203, v150, v151
  v_mfma_f32_16x16x32_bf16 a[36:39], a[244:247], v[252:255], a[36:39]
  buffer_load_dword v50, v2, s[20:23], s0 offen
  v_mfma_f32_16x16x32_bf16 a[36:39], a[240:243], v[56:59], a[36:39]
  v_exp_f32 v152, v152
  v_mfma_f32_16x16x32_bf16 a[40:43], a[240:243], v[60:63], a[40:43]
  ds_read_b64_tr_b16 a[218:219], v15 offset:1024
  v_mfma_f32_16x16x32_bf16 a[40:43], a[244:247], v[20:23], a[40:43]
  v_exp_f32 v153, v153
  v_mfma_f32_16x16x32_bf16 a[44:47], a[244:247], v[28:31], a[44:47]
  ds_read_b64_tr_b16 a[220:221], v15 offset:2048
  v_cvt_pk_bf16_f32 v204, v152, v153
  v_mfma_f32_16x16x32_bf16 a[44:47], a[240:243], v[244:247], a[44:47]
  v_exp_f32 v154, v154
  v_mfma_f32_16x16x32_bf16 a[60:63], a[248:251], v[244:247], a[60:63]
  ds_read_b64_tr_b16 a[222:223], v15 offset:3072
  v_mfma_f32_16x16x32_bf16 a[60:63], a[252:255], v[28:31], a[60:63]
  v_exp_f32 v155, v155
  v_mfma_f32_16x16x32_bf16 a[56:59], a[252:255], v[20:23], a[56:59]
  v_cvt_pk_bf16_f32 v205, v154, v155
  v_mfma_f32_16x16x32_bf16 a[56:59], a[248:251], v[60:63], a[56:59]
  v_exp_f32 v156, v156
  v_mfma_f32_16x16x32_bf16 a[52:55], a[248:251], v[56:59], a[52:55]
  v_mfma_f32_16x16x32_bf16 a[52:55], a[252:255], v[252:255], a[52:55]
  v_exp_f32 v157, v157
  v_mfma_f32_16x16x32_bf16 a[48:51], a[252:255], v[248:251], a[48:51]
  v_cvt_pk_bf16_f32 v206, v156, v157
  v_mfma_f32_16x16x32_bf16 a[48:51], a[248:251], v[52:55], a[48:51]
  v_exp_f32 v158, v158
  v_mfma_f32_16x16x32_bf16 v[228:231], v[224:227], v[52:55], v[228:231]
  v_mfma_f32_16x16x32_bf16 v[228:231], v[224:227], v[248:251], v[228:231]
  v_exp_f32 v159, v159
  v_mfma_f32_16x16x32_bf16 v[232:235], v[224:227], v[56:59], v[232:235]
  v_cvt_pk_bf16_f32 v207, v158, v159
  v_mfma_f32_16x16x32_bf16 v[232:235], v[224:227], v[252:255], v[232:235]
  s_waitcnt lgkmcnt(0)
  v_mfma_f32_16x16x32_bf16 v[128:131], a[128:131], v[64:67], v[32:35]
  s_add_u32 s30, s79, 65536
  v_exp_f32 v160, v160
  v_mfma_f32_16x16x32_bf16 v[128:131], a[132:135], v[68:71], v[128:131]
  ds_read_b128 a[160:163], v4 offset:34816
  v_mfma_f32_16x16x32_bf16 v[128:131], a[136:139], v[72:75], v[128:131]
  v_exp_f32 v161, v161
  v_mfma_f32_16x16x32_bf16 v[128:131], a[140:143], v[76:79], v[128:131]
  ds_read_b64_tr_b16 a[224:225], v8 offset:16384
  v_cvt_pk_bf16_f32 v208, v160, v161
  v_mfma_f32_16x16x32_bf16 v[132:135], a[156:159], v[76:79], v[32:35]
  s_add_u32 m0, s43, 16384
  v_exp_f32 v162, v162
  v_mfma_f32_16x16x32_bf16 v[132:135], a[152:155], v[72:75], v[132:135]
  buffer_load_dwordx4 v18, s[52:55], s30 offen offset:0 lds
  v_mfma_f32_16x16x32_bf16 v[132:135], a[148:151], v[68:71], v[132:135]
  v_exp_f32 v163, v163
  v_mfma_f32_16x16x32_bf16 v[132:135], a[144:147], v[64:67], v[132:135]
  ds_read_b128 a[164:167], v5 offset:34816
  v_cvt_pk_bf16_f32 v209, v162, v163
  v_mfma_f32_16x16x32_bf16 v[140:143], a[144:147], v[80:83], v[36:39]
  v_exp_f32 v164, v164
  v_mfma_f32_16x16x32_bf16 v[140:143], a[148:151], v[84:87], v[140:143]
  ds_read_b64_tr_b16 a[226:227], v8 offset:17408
  v_mfma_f32_16x16x32_bf16 v[140:143], a[152:155], v[88:91], v[140:143]
  v_exp_f32 v165, v165
  v_mfma_f32_16x16x32_bf16 v[140:143], a[156:159], v[92:95], v[140:143]
  ds_read_b128 a[168:171], v6 offset:34816
  v_cvt_pk_bf16_f32 v210, v164, v165
  v_mfma_f32_16x16x32_bf16 v[136:139], a[140:143], v[92:95], v[36:39]
  v_exp_f32 v166, v166
  v_mfma_f32_16x16x32_bf16 v[136:139], a[136:139], v[88:91], v[136:139]
  ds_read_b64_tr_b16 a[228:229], v8 offset:18432
  v_mfma_f32_16x16x32_bf16 v[136:139], a[132:135], v[84:87], v[136:139]
  v_exp_f32 v167, v167
  v_mfma_f32_16x16x32_bf16 v[136:139], a[128:131], v[80:83], v[136:139]
  ds_read_b128 a[172:175], v7 offset:34816
  v_cvt_pk_bf16_f32 v211, v166, v167
  v_mfma_f32_16x16x32_bf16 v[144:147], a[128:131], v[96:99], v[40:43]
  ds_read_b64_tr_b16 a[230:231], v8 offset:19456
  v_mfma_f32_16x16x32_bf16 v[144:147], a[132:135], v[100:103], v[144:147]
  s_add_u32 s30, s79, 80896
  v_exp_f32 v168, v168
  v_mfma_f32_16x16x32_bf16 v[144:147], a[136:139], v[104:107], v[144:147]
  buffer_load_dwordx4 v18, s[52:55], s30 offen offset:1024 lds
  v_mfma_f32_16x16x32_bf16 v[144:147], a[140:143], v[108:111], v[144:147]
  v_exp_f32 v169, v169
  v_mfma_f32_16x16x32_bf16 v[148:151], a[156:159], v[108:111], v[40:43]
  v_cvt_pk_bf16_f32 v212, v168, v169
  v_mfma_f32_16x16x32_bf16 v[148:151], a[152:155], v[104:107], v[148:151]
  v_exp_f32 v170, v170
  v_mfma_f32_16x16x32_bf16 v[148:151], a[148:151], v[100:103], v[148:151]
  ds_read_b128 a[176:179], v4 offset:35840
  v_mfma_f32_16x16x32_bf16 v[148:151], a[144:147], v[96:99], v[148:151]
  v_exp_f32 v171, v171
  v_mfma_f32_16x16x32_bf16 v[156:159], a[144:147], v[112:115], v[44:47]
  ds_read_b64_tr_b16 a[232:233], v9 offset:16384
  v_cvt_pk_bf16_f32 v213, v170, v171
  v_mfma_f32_16x16x32_bf16 v[156:159], a[148:151], v[116:119], v[156:159]
  v_exp_f32 v172, v172
  v_mfma_f32_16x16x32_bf16 v[156:159], a[152:155], v[120:123], v[156:159]
  ds_read_b128 a[180:183], v5 offset:35840
  v_mfma_f32_16x16x32_bf16 v[156:159], a[156:159], v[124:127], v[156:159]
  v_exp_f32 v173, v173
  v_mfma_f32_16x16x32_bf16 v[152:155], a[140:143], v[124:127], v[44:47]
  ds_read_b64_tr_b16 a[234:235], v9 offset:17408
  v_cvt_pk_bf16_f32 v214, v172, v173
  v_mfma_f32_16x16x32_bf16 v[152:155], a[136:139], v[120:123], v[152:155]
  v_exp_f32 v174, v174
  v_mfma_f32_16x16x32_bf16 v[152:155], a[132:135], v[116:119], v[152:155]
  ds_read_b128 a[184:187], v6 offset:35840
  v_mfma_f32_16x16x32_bf16 v[152:155], a[128:131], v[112:115], v[152:155]
  v_exp_f32 v175, v175
  v_mfma_f32_16x16x32_bf16 a[64:67], a[192:195], v[52:55], a[64:67]
  s_add_u32 s30, s79, 96256
  ds_read_b64_tr_b16 a[236:237], v9 offset:18432
  v_cvt_pk_bf16_f32 v215, v174, v175
  v_mfma_f32_16x16x32_bf16 a[64:67], a[196:199], v[248:251], a[64:67]
  buffer_load_dwordx4 v18, s[52:55], s30 offen offset:2048 lds
  v_mfma_f32_16x16x32_bf16 a[68:71], a[196:199], v[252:255], a[68:71]
  v_exp_f32 v176, v176
  v_mfma_f32_16x16x32_bf16 a[68:71], a[192:195], v[56:59], a[68:71]
  ds_read_b128 a[188:191], v7 offset:35840
  v_mfma_f32_16x16x32_bf16 a[72:75], a[192:195], v[60:63], a[72:75]
  v_exp_f32 v177, v177
  v_mfma_f32_16x16x32_bf16 a[72:75], a[196:199], v[20:23], a[72:75]
  ds_read_b64_tr_b16 a[238:239], v9 offset:19456
  v_cvt_pk_bf16_f32 v216, v176, v177
  v_mfma_f32_16x16x32_bf16 a[76:79], a[196:199], v[28:31], a[76:79]
  v_exp_f32 v178, v178
  v_mfma_f32_16x16x32_bf16 a[76:79], a[192:195], v[244:247], a[76:79]
  v_mfma_f32_16x16x32_bf16 a[92:95], a[200:203], v[244:247], a[92:95]
  v_exp_f32 v179, v179
  v_mfma_f32_16x16x32_bf16 a[92:95], a[204:207], v[28:31], a[92:95]
  ds_read_b64_tr_b16 a[240:241], v10 offset:16384
  v_cvt_pk_bf16_f32 v217, v178, v179
  v_mfma_f32_16x16x32_bf16 a[88:91], a[204:207], v[20:23], a[88:91]
  v_exp_f32 v180, v180
  v_mfma_f32_16x16x32_bf16 a[88:91], a[200:203], v[60:63], a[88:91]
  ds_read_b64_tr_b16 a[242:243], v10 offset:17408
  v_mfma_f32_16x16x32_bf16 a[84:87], a[200:203], v[56:59], a[84:87]
  v_exp_f32 v181, v181
  v_mfma_f32_16x16x32_bf16 a[84:87], a[204:207], v[252:255], a[84:87]
  ds_read_b64_tr_b16 a[244:245], v10 offset:18432
  v_cvt_pk_bf16_f32 v218, v180, v181
  v_mfma_f32_16x16x32_bf16 a[80:83], a[204:207], v[248:251], a[80:83]
  v_exp_f32 v182, v182
  v_mfma_f32_16x16x32_bf16 a[80:83], a[200:203], v[52:55], a[80:83]
  ds_read_b64_tr_b16 a[246:247], v10 offset:19456
  v_mfma_f32_16x16x32_bf16 a[96:99], a[208:211], v[52:55], a[96:99]
  s_add_u32 s30, s79, 111616
  v_exp_f32 v183, v183
  v_mfma_f32_16x16x32_bf16 a[96:99], a[212:215], v[248:251], a[96:99]
  buffer_load_dwordx4 v18, s[52:55], s30 offen offset:3072 lds
  v_mfma_f32_16x16x32_bf16 a[100:103], a[212:215], v[252:255], a[100:103]
  ds_read_b64_tr_b16 a[248:249], v11 offset:16384
  v_cvt_pk_bf16_f32 v219, v182, v183
  v_mfma_f32_16x16x32_bf16 a[100:103], a[208:211], v[56:59], a[100:103]
  v_exp_f32 v184, v184
  v_mfma_f32_16x16x32_bf16 a[104:107], a[208:211], v[60:63], a[104:107]
  ds_read_b64_tr_b16 a[250:251], v11 offset:17408
  v_mfma_f32_16x16x32_bf16 a[104:107], a[212:215], v[20:23], a[104:107]
  v_exp_f32 v185, v185
  v_mfma_f32_16x16x32_bf16 a[108:111], a[212:215], v[28:31], a[108:111]
  ds_read_b64_tr_b16 a[252:253], v11 offset:18432
  v_cvt_pk_bf16_f32 v220, v184, v185
  v_mfma_f32_16x16x32_bf16 a[108:111], a[208:211], v[244:247], a[108:111]
  v_exp_f32 v186, v186
  v_mfma_f32_16x16x32_bf16 a[124:127], a[216:219], v[244:247], a[124:127]
  ds_read_b64_tr_b16 a[254:255], v11 offset:19456
  v_mfma_f32_16x16x32_bf16 a[124:127], a[220:223], v[28:31], a[124:127]
  v_exp_f32 v187, v187
  v_mfma_f32_16x16x32_bf16 a[120:123], a[220:223], v[20:23], a[120:123]
  v_cvt_pk_bf16_f32 v221, v186, v187
  v_mfma_f32_16x16x32_bf16 a[120:123], a[216:219], v[60:63], a[120:123]
  v_exp_f32 v188, v188
  v_mfma_f32_16x16x32_bf16 a[116:119], a[216:219], v[56:59], a[116:119]
  v_mfma_f32_16x16x32_bf16 a[116:119], a[220:223], v[252:255], a[116:119]
  v_exp_f32 v189, v189
  v_mfma_f32_16x16x32_bf16 a[112:115], a[220:223], v[248:251], a[112:115]
  v_cvt_pk_bf16_f32 v222, v188, v189
  v_mfma_f32_16x16x32_bf16 a[112:115], a[216:219], v[52:55], a[112:115]
  v_exp_f32 v190, v190
  v_mfma_f32_16x16x32_bf16 v[236:239], v[224:227], v[60:63], v[236:239]
  v_mfma_f32_16x16x32_bf16 v[236:239], v[224:227], v[20:23], v[236:239]
  v_exp_f32 v191, v191
  v_mfma_f32_16x16x32_bf16 v[240:243], v[224:227], v[244:247], v[240:243]
  v_cvt_pk_bf16_f32 v223, v190, v191
  v_mfma_f32_16x16x32_bf16 v[240:243], v[224:227], v[28:31], v[240:243]
  s_waitcnt vmcnt(13) lgkmcnt(0)
  s_barrier
  v_mfma_f32_16x16x32_bf16 v[160:163], a[160:163], v[64:67], v[32:35]
  s_add_u32 s30, s81, 0
  v_exp_f32 v128, v128
  v_mfma_f32_16x16x32_bf16 v[160:163], a[164:167], v[68:71], v[160:163]
  ds_read_b128 a[128:131], v4 offset:49152
  v_mfma_f32_16x16x32_bf16 v[160:163], a[168:171], v[72:75], v[160:163]
  v_exp_f32 v129, v129
  v_mfma_f32_16x16x32_bf16 v[160:163], a[172:175], v[76:79], v[160:163]
  ds_read_b64_tr_b16 a[192:193], v12 offset:16384
  v_cvt_pk_bf16_f32 v52, v128, v129
  v_mfma_f32_16x16x32_bf16 v[164:167], a[188:191], v[76:79], v[32:35]
  s_add_u32 m0, s43, 65536
  v_exp_f32 v130, v130
  v_mfma_f32_16x16x32_bf16 v[164:167], a[184:187], v[72:75], v[164:167]
  buffer_load_dwordx4 v18, s[52:55], s30 offen offset:0 lds
  v_mfma_f32_16x16x32_bf16 v[164:167], a[180:183], v[68:71], v[164:167]
  v_exp_f32 v131, v131
  v_mfma_f32_16x16x32_bf16 v[164:167], a[176:179], v[64:67], v[164:167]
  ds_read_b128 a[132:135], v5 offset:49152
  v_cvt_pk_bf16_f32 v53, v130, v131
  v_mfma_f32_16x16x32_bf16 v[172:175], a[176:179], v[80:83], v[36:39]
  v_exp_f32 v132, v132
  v_mfma_f32_16x16x32_bf16 v[172:175], a[180:183], v[84:87], v[172:175]
  ds_read_b64_tr_b16 a[194:195], v12 offset:17408
  v_mfma_f32_16x16x32_bf16 v[172:175], a[184:187], v[88:91], v[172:175]
  v_exp_f32 v133, v133
  v_mfma_f32_16x16x32_bf16 v[172:175], a[188:191], v[92:95], v[172:175]
  ds_read_b128 a[136:139], v6 offset:49152
  v_cvt_pk_bf16_f32 v54, v132, v133
  v_mfma_f32_16x16x32_bf16 v[168:171], a[172:175], v[92:95], v[36:39]
  v_exp_f32 v134, v134
  v_mfma_f32_16x16x32_bf16 v[168:171], a[168:171], v[88:91], v[168:171]
  ds_read_b64_tr_b16 a[196:197], v12 offset:18432
  v_mfma_f32_16x16x32_bf16 v[168:171], a[164:167], v[84:87], v[168:171]
  s_add_u32 s30, s81, 15360
  v_exp_f32 v135, v135
  v_mfma_f32_16x16x32_bf16 v[168:171], a[160:163], v[80:83], v[168:171]
  buffer_load_dwordx4 v18, s[52:55], s30 offen offset:1024 lds
  v_mfma_f32_16x16x32_bf16 v[176:179], a[160:163], v[96:99], v[40:43]
  ds_read_b128 a[140:143], v7 offset:49152
  v_cvt_pk_bf16_f32 v55, v134, v135
  v_mfma_f32_16x16x32_bf16 v[176:179], a[164:167], v[100:103], v[176:179]
  v_exp_f32 v136, v136
  v_mfma_f32_16x16x32_bf16 v[176:179], a[168:171], v[104:107], v[176:179]
  ds_read_b64_tr_b16 a[198:199], v12 offset:19456
  v_mfma_f32_16x16x32_bf16 v[176:179], a[172:175], v[108:111], v[176:179]
  v_exp_f32 v137, v137
  v_mfma_f32_16x16x32_bf16 v[180:183], a[188:191], v[108:111], v[40:43]
  ds_read_b128 a[144:147], v4 offset:50176
  v_cvt_pk_bf16_f32 v56, v136, v137
  v_mfma_f32_16x16x32_bf16 v[180:183], a[184:187], v[104:107], v[180:183]
  v_exp_f32 v138, v138
  v_mfma_f32_16x16x32_bf16 v[180:183], a[180:183], v[100:103], v[180:183]
  ds_read_b64_tr_b16 a[200:201], v13 offset:16384
  v_mfma_f32_16x16x32_bf16 v[180:183], a[176:179], v[96:99], v[180:183]
  v_exp_f32 v139, v139
  v_mfma_f32_16x16x32_bf16 v[188:191], a[176:179], v[112:115], v[44:47]
  ds_read_b128 a[148:151], v5 offset:50176
  v_cvt_pk_bf16_f32 v57, v138, v139
  v_mfma_f32_16x16x32_bf16 v[188:191], a[180:183], v[116:119], v[188:191]
  s_add_u32 s30, s81, 30720
  v_exp_f32 v140, v140
  v_mfma_f32_16x16x32_bf16 v[188:191], a[184:187], v[120:123], v[188:191]
  buffer_load_dwordx4 v18, s[52:55], s30 offen offset:2048 lds
  v_mfma_f32_16x16x32_bf16 v[188:191], a[188:191], v[124:127], v[188:191]
  v_exp_f32 v141, v141
  v_mfma_f32_16x16x32_bf16 v[184:187], a[172:175], v[124:127], v[44:47]
  ds_read_b64_tr_b16 a[202:203], v13 offset:17408
  v_cvt_pk_bf16_f32 v58, v140, v141
  v_mfma_f32_16x16x32_bf16 v[184:187], a[168:171], v[120:123], v[184:187]
  v_exp_f32 v142, v142
  v_mfma_f32_16x16x32_bf16 v[184:187], a[164:167], v[116:119], v[184:187]
  v_mfma_f32_16x16x32_bf16 v[184:187], a[160:163], v[112:115], v[184:187]
  v_exp_f32 v143, v143
  v_mfma_f32_16x16x32_bf16 a[0:3], a[224:227], v[192:195], a[0:3]
  ds_read_b128 a[152:155], v6 offset:50176
  v_cvt_pk_bf16_f32 v59, v142, v143
  v_mfma_f32_16x16x32_bf16 a[0:3], a[228:231], v[208:211], a[0:3]
  ds_read_b64_tr_b16 a[204:205], v13 offset:18432
  v_mfma_f32_16x16x32_bf16 a[4:7], a[228:231], v[212:215], a[4:7]
  v_exp_f32 v144, v144
  v_mfma_f32_16x16x32_bf16 a[4:7], a[224:227], v[196:199], a[4:7]
  ds_read_b128 a[156:159], v7 offset:50176
  v_mfma_f32_16x16x32_bf16 a[8:11], a[224:227], v[200:203], a[8:11]
  v_exp_f32 v145, v145
  v_mfma_f32_16x16x32_bf16 a[8:11], a[228:231], v[216:219], a[8:11]
  ds_read_b64_tr_b16 a[206:207], v13 offset:19456
  v_cvt_pk_bf16_f32 v60, v144, v145
  v_mfma_f32_16x16x32_bf16 a[12:15], a[228:231], v[220:223], a[12:15]
  s_add_u32 s30, s81, 46080
  v_exp_f32 v146, v146
  v_mfma_f32_16x16x32_bf16 a[12:15], a[224:227], v[204:207], a[12:15]
  buffer_load_dwordx4 v18, s[52:55], s30 offen offset:3072 lds
  v_mfma_f32_16x16x32_bf16 a[28:31], a[232:235], v[204:207], a[28:31]
  v_exp_f32 v147, v147
  v_mfma_f32_16x16x32_bf16 a[28:31], a[236:239], v[220:223], a[28:31]
  ds_read_b64_tr_b16 a[208:209], v14 offset:16384
  v_cvt_pk_bf16_f32 v61, v146, v147
  v_mfma_f32_16x16x32_bf16 a[24:27], a[236:239], v[216:219], a[24:27]
  v_exp_f32 v148, v148
  v_mfma_f32_16x16x32_bf16 a[24:27], a[232:235], v[200:203], a[24:27]
  ds_read_b64_tr_b16 a[210:211], v14 offset:17408
  v_mfma_f32_16x16x32_bf16 a[20:23], a[232:235], v[196:199], a[20:23]
  v_exp_f32 v149, v149
  v_mfma_f32_16x16x32_bf16 a[20:23], a[236:239], v[212:215], a[20:23]
  ds_read_b64_tr_b16 a[212:213], v14 offset:18432
  v_cvt_pk_bf16_f32 v62, v148, v149
  v_mfma_f32_16x16x32_bf16 a[16:19], a[236:239], v[208:211], a[16:19]
  v_exp_f32 v150, v150
  v_mfma_f32_16x16x32_bf16 a[16:19], a[232:235], v[192:195], a[16:19]
  ds_read_b64_tr_b16 a[214:215], v14 offset:19456
  v_mfma_f32_16x16x32_bf16 a[32:35], a[240:243], v[192:195], a[32:35]
  v_exp_f32 v151, v151
  v_mfma_f32_16x16x32_bf16 a[32:35], a[244:247], v[208:211], a[32:35]
  ds_read_b64_tr_b16 a[216:217], v15 offset:16384
  v_cvt_pk_bf16_f32 v63, v150, v151
  v_mfma_f32_16x16x32_bf16 a[36:39], a[244:247], v[212:215], a[36:39]
  buffer_load_dword v50, v2, s[20:23], s42 offen
  v_mfma_f32_16x16x32_bf16 a[36:39], a[240:243], v[196:199], a[36:39]
  v_exp_f32 v152, v152
  v_mfma_f32_16x16x32_bf16 a[40:43], a[240:243], v[200:203], a[40:43]
  ds_read_b64_tr_b16 a[218:219], v15 offset:17408
  v_mfma_f32_16x16x32_bf16 a[40:43], a[244:247], v[216:219], a[40:43]
  v_exp_f32 v153, v153
  v_mfma_f32_16x16x32_bf16 a[44:47], a[244:247], v[220:223], a[44:47]
  ds_read_b64_tr_b16 a[220:221], v15 offset:18432
  v_cvt_pk_bf16_f32 v244, v152, v153
  v_mfma_f32_16x16x32_bf16 a[44:47], a[240:243], v[204:207], a[44:47]
  v_exp_f32 v154, v154
  v_mfma_f32_16x16x32_bf16 a[60:63], a[248:251], v[204:207], a[60:63]
  ds_read_b64_tr_b16 a[222:223], v15 offset:19456
  v_mfma_f32_16x16x32_bf16 a[60:63], a[252:255], v[220:223], a[60:63]
  v_exp_f32 v155, v155
  v_mfma_f32_16x16x32_bf16 a[56:59], a[252:255], v[216:219], a[56:59]
  v_cvt_pk_bf16_f32 v245, v154, v155
  v_mfma_f32_16x16x32_bf16 a[56:59], a[248:251], v[200:203], a[56:59]
  v_exp_f32 v156, v156
  v_mfma_f32_16x16x32_bf16 a[52:55], a[248:251], v[196:199], a[52:55]
  v_mfma_f32_16x16x32_bf16 a[52:55], a[252:255], v[212:215], a[52:55]
  v_exp_f32 v157, v157
  v_mfma_f32_16x16x32_bf16 a[48:51], a[252:255], v[208:211], a[48:51]
  v_cvt_pk_bf16_f32 v246, v156, v157
  v_mfma_f32_16x16x32_bf16 a[48:51], a[248:251], v[192:195], a[48:51]
  v_exp_f32 v158, v158
  v_mfma_f32_16x16x32_bf16 v[228:231], v[224:227], v[192:195], v[228:231]
  v_mfma_f32_16x16x32_bf16 v[228:231], v[224:227], v[208:211], v[228:231]
  v_exp_f32 v159, v159
  v_mfma_f32_16x16x32_bf16 v[232:235], v[224:227], v[196:199], v[232:235]
  v_cvt_pk_bf16_f32 v247, v158, v159
  v_mfma_f32_16x16x32_bf16 v[232:235], v[224:227], v[212:215], v[232:235]
  s_waitcnt lgkmcnt(0)
  v_mfma_f32_16x16x32_bf16 v[128:131], a[128:131], v[64:67], v[32:35]
  s_add_u32 s30, s80, 0
  v_exp_f32 v160, v160
  v_mfma_f32_16x16x32_bf16 v[128:131], a[132:135], v[68:71], v[128:131]
  ds_read_b128 a[160:163], v4 offset:51200
  v_mfma_f32_16x16x32_bf16 v[128:131], a[136:139], v[72:75], v[128:131]
  v_exp_f32 v161, v161
  v_mfma_f32_16x16x32_bf16 v[128:131], a[140:143], v[76:79], v[128:131]
L_attn_st9:
  s_cbranch_vccnz L_attn_walkdone2
  ds_read_b64_tr_b16 a[224:225], v8 offset:32768
  v_cvt_pk_bf16_f32 v248, v160, v161
  v_mfma_f32_16x16x32_bf16 v[132:135], a[156:159], v[76:79], v[32:35]
  s_add_u32 m0, s43, 32768
  v_exp_f32 v162, v162
  v_mfma_f32_16x16x32_bf16 v[132:135], a[152:155], v[72:75], v[132:135]
  buffer_load_dwordx4 v18, s[52:55], s30 offen offset:0 lds
  v_mfma_f32_16x16x32_bf16 v[132:135], a[148:151], v[68:71], v[132:135]
  v_exp_f32 v163, v163
  v_mfma_f32_16x16x32_bf16 v[132:135], a[144:147], v[64:67], v[132:135]
  ds_read_b128 a[164:167], v5 offset:51200
  v_cvt_pk_bf16_f32 v249, v162, v163
  v_mfma_f32_16x16x32_bf16 v[140:143], a[144:147], v[80:83], v[36:39]
  v_exp_f32 v164, v164
  v_mfma_f32_16x16x32_bf16 v[140:143], a[148:151], v[84:87], v[140:143]
  ds_read_b64_tr_b16 a[226:227], v8 offset:33792
  v_mfma_f32_16x16x32_bf16 v[140:143], a[152:155], v[88:91], v[140:143]
  v_exp_f32 v165, v165
  v_mfma_f32_16x16x32_bf16 v[140:143], a[156:159], v[92:95], v[140:143]
  ds_read_b128 a[168:171], v6 offset:51200
  v_cvt_pk_bf16_f32 v250, v164, v165
  v_mfma_f32_16x16x32_bf16 v[136:139], a[140:143], v[92:95], v[36:39]
  v_exp_f32 v166, v166
  v_mfma_f32_16x16x32_bf16 v[136:139], a[136:139], v[88:91], v[136:139]
  ds_read_b64_tr_b16 a[228:229], v8 offset:34816
  v_mfma_f32_16x16x32_bf16 v[136:139], a[132:135], v[84:87], v[136:139]
  s_add_u32 s30, s80, 15360
  v_exp_f32 v167, v167
  v_mfma_f32_16x16x32_bf16 v[136:139], a[128:131], v[80:83], v[136:139]
  buffer_load_dwordx4 v18, s[52:55], s30 offen offset:1024 lds
  v_mfma_f32_16x16x32_bf16 v[144:147], a[128:131], v[96:99], v[40:43]
  ds_read_b128 a[172:175], v7 offset:51200
  v_cvt_pk_bf16_f32 v251, v166, v167
  v_mfma_f32_16x16x32_bf16 v[144:147], a[132:135], v[100:103], v[144:147]
  v_exp_f32 v168, v168
  v_mfma_f32_16x16x32_bf16 v[144:147], a[136:139], v[104:107], v[144:147]
  ds_read_b64_tr_b16 a[230:231], v8 offset:35840
  v_mfma_f32_16x16x32_bf16 v[144:147], a[140:143], v[108:111], v[144:147]
  v_exp_f32 v169, v169
  v_mfma_f32_16x16x32_bf16 v[148:151], a[156:159], v[108:111], v[40:43]
  ds_read_b128 a[176:179], v4 offset:52224
  v_cvt_pk_bf16_f32 v252, v168, v169
  v_mfma_f32_16x16x32_bf16 v[148:151], a[152:155], v[104:107], v[148:151]
  v_exp_f32 v170, v170
  v_mfma_f32_16x16x32_bf16 v[148:151], a[148:151], v[100:103], v[148:151]
  ds_read_b64_tr_b16 a[232:233], v9 offset:32768
  v_mfma_f32_16x16x32_bf16 v[148:151], a[144:147], v[96:99], v[148:151]
  v_exp_f32 v171, v171
  v_mfma_f32_16x16x32_bf16 v[156:159], a[144:147], v[112:115], v[44:47]
  ds_read_b128 a[180:183], v5 offset:52224
  v_cvt_pk_bf16_f32 v253, v170, v171
  v_mfma_f32_16x16x32_bf16 v[156:159], a[148:151], v[116:119], v[156:159]
  s_add_u32 s30, s80, 30720
  v_exp_f32 v172, v172
  v_mfma_f32_16x16x32_bf16 v[156:159], a[152:155], v[120:123], v[156:159]
  buffer_load_dwordx4 v18, s[52:55], s30 offen offset:2048 lds
  v_mfma_f32_16x16x32_bf16 v[156:159], a[156:159], v[124:127], v[156:159]
  v_exp_f32 v173, v173
  v_mfma_f32_16x16x32_bf16 v[152:155], a[140:143], v[124:127], v[44:47]
  ds_read_b64_tr_b16 a[234:235], v9 offset:33792
  v_cvt_pk_bf16_f32 v254, v172, v173
  v_mfma_f32_16x16x32_bf16 v[152:155], a[136:139], v[120:123], v[152:155]
  v_exp_f32 v174, v174
  v_mfma_f32_16x16x32_bf16 v[152:155], a[132:135], v[116:119], v[152:155]
  v_mfma_f32_16x16x32_bf16 v[152:155], a[128:131], v[112:115], v[152:155]
  v_exp_f32 v175, v175
  v_mfma_f32_16x16x32_bf16 a[64:67], a[192:195], v[192:195], a[64:67]
  ds_read_b128 a[184:187], v6 offset:52224
  v_cvt_pk_bf16_f32 v255, v174, v175
  v_mfma_f32_16x16x32_bf16 a[64:67], a[196:199], v[208:211], a[64:67]
  ds_read_b64_tr_b16 a[236:237], v9 offset:34816
  v_mfma_f32_16x16x32_bf16 a[68:71], a[196:199], v[212:215], a[68:71]
  v_exp_f32 v176, v176
  v_mfma_f32_16x16x32_bf16 a[68:71], a[192:195], v[196:199], a[68:71]
  ds_read_b128 a[188:191], v7 offset:52224
  v_mfma_f32_16x16x32_bf16 a[72:75], a[192:195], v[200:203], a[72:75]
  v_exp_f32 v177, v177
  v_mfma_f32_16x16x32_bf16 a[72:75], a[196:199], v[216:219], a[72:75]
  ds_read_b64_tr_b16 a[238:239], v9 offset:35840
  v_cvt_pk_bf16_f32 v20, v176, v177
  v_mfma_f32_16x16x32_bf16 a[76:79], a[196:199], v[220:223], a[76:79]
  s_add_u32 s30, s80, 46080
  v_exp_f32 v178, v178
  v_mfma_f32_16x16x32_bf16 a[76:79], a[192:195], v[204:207], a[76:79]
  buffer_load_dwordx4 v18, s[52:55], s30 offen offset:3072 lds
  v_mfma_f32_16x16x32_bf16 a[92:95], a[200:203], v[204:207], a[92:95]
  v_exp_f32 v179, v179
  v_mfma_f32_16x16x32_bf16 a[92:95], a[204:207], v[220:223], a[92:95]
  ds_read_b64_tr_b16 a[240:241], v10 offset:32768
  v_cvt_pk_bf16_f32 v21, v178, v179
  v_mfma_f32_16x16x32_bf16 a[88:91], a[204:207], v[216:219], a[88:91]
  v_exp_f32 v180, v180
  v_mfma_f32_16x16x32_bf16 a[88:91], a[200:203], v[200:203], a[88:91]
  ds_read_b64_tr_b16 a[242:243], v10 offset:33792
  v_mfma_f32_16x16x32_bf16 a[84:87], a[200:203], v[196:199], a[84:87]
  v_exp_f32 v181, v181
  v_mfma_f32_16x16x32_bf16 a[84:87], a[204:207], v[212:215], a[84:87]
  ds_read_b64_tr_b16 a[244:245], v10 offset:34816
  v_cvt_pk_bf16_f32 v22, v180, v181
  v_mfma_f32_16x16x32_bf16 a[80:83], a[204:207], v[208:211], a[80:83]
  v_exp_f32 v182, v182
  v_mfma_f32_16x16x32_bf16 a[80:83], a[200:203], v[192:195], a[80:83]
  ds_read_b64_tr_b16 a[246:247], v10 offset:35840
  v_mfma_f32_16x16x32_bf16 a[96:99], a[208:211], v[192:195], a[96:99]
  v_exp_f32 v183, v183
  v_mfma_f32_16x16x32_bf16 a[96:99], a[212:215], v[208:211], a[96:99]
  ds_read_b64_tr_b16 a[248:249], v11 offset:32768
  v_cvt_pk_bf16_f32 v23, v182, v183
  v_mfma_f32_16x16x32_bf16 a[100:103], a[212:215], v[212:215], a[100:103]
  buffer_load_dword v50, v49, s[52:55], s45 offen
  v_mfma_f32_16x16x32_bf16 a[100:103], a[208:211], v[196:199], a[100:103]
  v_exp_f32 v184, v184
  v_mfma_f32_16x16x32_bf16 a[104:107], a[208:211], v[200:203], a[104:107]
  ds_read_b64_tr_b16 a[250:251], v11 offset:33792
  v_mfma_f32_16x16x32_bf16 a[104:107], a[212:215], v[216:219], a[104:107]
  v_exp_f32 v185, v185
  v_mfma_f32_16x16x32_bf16 a[108:111], a[212:215], v[220:223], a[108:111]
  ds_read_b64_tr_b16 a[252:253], v11 offset:34816
  v_cvt_pk_bf16_f32 v28, v184, v185
  v_mfma_f32_16x16x32_bf16 a[108:111], a[208:211], v[204:207], a[108:111]
  v_exp_f32 v186, v186
  v_mfma_f32_16x16x32_bf16 a[124:127], a[216:219], v[204:207], a[124:127]
  ds_read_b64_tr_b16 a[254:255], v11 offset:35840
  v_mfma_f32_16x16x32_bf16 a[124:127], a[220:223], v[220:223], a[124:127]
  v_exp_f32 v187, v187
  v_mfma_f32_16x16x32_bf16 a[120:123], a[220:223], v[216:219], a[120:123]
  v_cvt_pk_bf16_f32 v29, v186, v187
  v_mfma_f32_16x16x32_bf16 a[120:123], a[216:219], v[200:203], a[120:123]
  v_exp_f32 v188, v188
  v_mfma_f32_16x16x32_bf16 a[116:119], a[216:219], v[196:199], a[116:119]
  v_mfma_f32_16x16x32_bf16 a[116:119], a[220:223], v[212:215], a[116:119]
  v_exp_f32 v189, v189
  v_mfma_f32_16x16x32_bf16 a[112:115], a[220:223], v[208:211], a[112:115]
  v_cvt_pk_bf16_f32 v30, v188, v189
  v_mfma_f32_16x16x32_bf16 a[112:115], a[216:219], v[192:195], a[112:115]
  v_exp_f32 v190, v190
  v_mfma_f32_16x16x32_bf16 v[236:239], v[224:227], v[200:203], v[236:239]
  v_mfma_f32_16x16x32_bf16 v[236:239], v[224:227], v[216:219], v[236:239]
  v_exp_f32 v191, v191
  v_mfma_f32_16x16x32_bf16 v[240:243], v[224:227], v[204:207], v[240:243]
  v_cvt_pk_bf16_f32 v31, v190, v191
  v_mfma_f32_16x16x32_bf16 v[240:243], v[224:227], v[220:223], v[240:243]
  s_waitcnt vmcnt(14) lgkmcnt(0)
  s_barrier
  v_mfma_f32_16x16x32_bf16 v[160:163], a[160:163], v[64:67], v[32:35]
  s_add_u32 s30, s81, 65536
  v_exp_f32 v128, v128
  v_mfma_f32_16x16x32_bf16 v[160:163], a[164:167], v[68:71], v[160:163]
  ds_read_b64_tr_b16 a[192:193], v12 offset:32768
  v_mfma_f32_16x16x32_bf16 v[160:163], a[168:171], v[72:75], v[160:163]
  v_exp_f32 v129, v129
  v_mfma_f32_16x16x32_bf16 v[160:163], a[172:175], v[76:79], v[160:163]
  ds_read_b64_tr_b16 a[194:195], v12 offset:33792
  v_cvt_pk_bf16_f32 v192, v128, v129
  v_mfma_f32_16x16x32_bf16 v[164:167], a[188:191], v[76:79], v[32:35]
  s_add_u32 m0, s43, 81920
  v_exp_f32 v130, v130
  v_mfma_f32_16x16x32_bf16 v[164:167], a[184:187], v[72:75], v[164:167]
  buffer_load_dwordx4 v18, s[52:55], s30 offen offset:0 lds
  v_mfma_f32_16x16x32_bf16 v[164:167], a[180:183], v[68:71], v[164:167]
  v_exp_f32 v131, v131
  v_mfma_f32_16x16x32_bf16 v[164:167], a[176:179], v[64:67], v[164:167]
  ds_read_b64_tr_b16 a[196:197], v12 offset:34816
  v_cvt_pk_bf16_f32 v193, v130, v131
  v_mfma_f32_16x16x32_bf16 v[172:175], a[176:179], v[80:83], v[36:39]
  v_exp_f32 v132, v132
  v_mfma_f32_16x16x32_bf16 v[172:175], a[180:183], v[84:87], v[172:175]
  v_mfma_f32_16x16x32_bf16 v[172:175], a[184:187], v[88:91], v[172:175]
  v_exp_f32 v133, v133
  v_mfma_f32_16x16x32_bf16 v[172:175], a[188:191], v[92:95], v[172:175]
  ds_read_b64_tr_b16 a[198:199], v12 offset:35840
  v_cvt_pk_bf16_f32 v194, v132, v133
  v_mfma_f32_16x16x32_bf16 v[168:171], a[172:175], v[92:95], v[36:39]
  s_add_u32 s30, s81, 80896
  v_exp_f32 v134, v134
  v_mfma_f32_16x16x32_bf16 v[168:171], a[168:171], v[88:91], v[168:171]
  buffer_load_dwordx4 v18, s[52:55], s30 offen offset:1024 lds
  v_mfma_f32_16x16x32_bf16 v[168:171], a[164:167], v[84:87], v[168:171]
  v_exp_f32 v135, v135
  v_mfma_f32_16x16x32_bf16 v[168:171], a[160:163], v[80:83], v[168:171]
  ds_read_b64_tr_b16 a[200:201], v13 offset:32768
  v_cvt_pk_bf16_f32 v195, v134, v135
  v_mfma_f32_16x16x32_bf16 v[176:179], a[160:163], v[96:99], v[40:43]
  v_mfma_f32_16x16x32_bf16 v[176:179], a[164:167], v[100:103], v[176:179]
  v_exp_f32 v136, v136
  v_mfma_f32_16x16x32_bf16 v[176:179], a[168:171], v[104:107], v[176:179]
  ds_read_b64_tr_b16 a[202:203], v13 offset:33792
  v_mfma_f32_16x16x32_bf16 v[176:179], a[172:175], v[108:111], v[176:179]
  s_add_u32 s30, s81, 96256
  v_exp_f32 v137, v137
  v_mfma_f32_16x16x32_bf16 v[180:183], a[188:191], v[108:111], v[40:43]
  buffer_load_dwordx4 v18, s[52:55], s30 offen offset:2048 lds
  v_mfma_f32_16x16x32_bf16 v[180:183], a[184:187], v[104:107], v[180:183]
  v_exp_f32 v138, v138
  v_mfma_f32_16x16x32_bf16 v[180:183], a[180:183], v[100:103], v[180:183]
  ds_read_b64_tr_b16 a[204:205], v13 offset:34816
  v_cvt_pk_bf16_f32 v196, v136, v137
  v_mfma_f32_16x16x32_bf16 v[180:183], a[176:179], v[96:99], v[180:183]
  v_exp_f32 v139, v139
  v_mfma_f32_16x16x32_bf16 v[188:191], a[176:179], v[112:115], v[44:47]
  ds_read_b64_tr_b16 a[206:207], v13 offset:35840
  v_cvt_pk_bf16_f32 v197, v138, v139
  v_mfma_f32_16x16x32_bf16 v[188:191], a[180:183], v[116:119], v[188:191]
  v_exp_f32 v140, v140
  v_mfma_f32_16x16x32_bf16 v[188:191], a[184:187], v[120:123], v[188:191]
  v_mfma_f32_16x16x32_bf16 v[188:191], a[188:191], v[124:127], v[188:191]
  s_add_u32 s30, s81, 111616
  v_exp_f32 v141, v141
  v_mfma_f32_16x16x32_bf16 v[184:187], a[172:175], v[124:127], v[44:47]
  buffer_load_dwordx4 v18, s[52:55], s30 offen offset:3072 lds
  v_mfma_f32_16x16x32_bf16 v[184:187], a[168:171], v[120:123], v[184:187]
  v_exp_f32 v142, v142
  v_mfma_f32_16x16x32_bf16 v[184:187], a[164:167], v[116:119], v[184:187]
  ds_read_b64_tr_b16 a[208:209], v14 offset:32768
  v_cvt_pk_bf16_f32 v198, v140, v141
  v_mfma_f32_16x16x32_bf16 v[184:187], a[160:163], v[112:115], v[184:187]
  v_exp_f32 v143, v143
  v_mfma_f32_16x16x32_bf16 a[0:3], a[224:227], v[52:55], a[0:3]
  ds_read_b64_tr_b16 a[210:211], v14 offset:33792
  v_cvt_pk_bf16_f32 v199, v142, v143
  v_mfma_f32_16x16x32_bf16 a[0:3], a[228:231], v[248:251], a[0:3]
  v_mfma_f32_16x16x32_bf16 a[4:7], a[228:231], v[252:255], a[4:7]
  s_add_u32 m0, s43, 49152
  s_add_u32 s30, s80, 65536
  v_exp_f32 v144, v144
  v_mfma_f32_16x16x32_bf16 a[4:7], a[224:227], v[56:59], a[4:7]
  buffer_load_dwordx4 v18, s[52:55], s30 offen offset:0 lds
  v_mfma_f32_16x16x32_bf16 a[8:11], a[224:227], v[60:63], a[8:11]
  v_exp_f32 v145, v145
  v_mfma_f32_16x16x32_bf16 a[8:11], a[228:231], v[20:23], a[8:11]
  ds_read_b64_tr_b16 a[212:213], v14 offset:34816
  v_cvt_pk_bf16_f32 v200, v144, v145
  v_mfma_f32_16x16x32_bf16 a[12:15], a[228:231], v[28:31], a[12:15]
  v_exp_f32 v146, v146
  v_mfma_f32_16x16x32_bf16 a[12:15], a[224:227], v[244:247], a[12:15]
  ds_read_b64_tr_b16 a[214:215], v14 offset:35840
  v_mfma_f32_16x16x32_bf16 a[28:31], a[232:235], v[244:247], a[28:31]
  s_add_u32 s30, s80, 80896
  v_exp_f32 v147, v147
  v_mfma_f32_16x16x32_bf16 a[28:31], a[236:239], v[28:31], a[28:31]
  buffer_load_dwordx4 v18, s[52:55], s30 offen offset:1024 lds
  v_mfma_f32_16x16x32_bf16 a[24:27], a[236:239], v[20:23], a[24:27]
  v_exp_f32 v148, v148
  v_mfma_f32_16x16x32_bf16 a[24:27], a[232:235], v[60:63], a[24:27]
  v_cvt_pk_bf16_f32 v201, v146, v147
  v_mfma_f32_16x16x32_bf16 a[20:23], a[232:235], v[56:59], a[20:23]
  v_exp_f32 v149, v149
  v_mfma_f32_16x16x32_bf16 a[20:23], a[236:239], v[252:255], a[20:23]
  ds_read_b64_tr_b16 a[216:217], v15 offset:32768
  v_cvt_pk_bf16_f32 v202, v148, v149
  v_mfma_f32_16x16x32_bf16 a[16:19], a[236:239], v[248:251], a[16:19]
  v_exp_f32 v150, v150
  v_mfma_f32_16x16x32_bf16 a[16:19], a[232:235], v[52:55], a[16:19]
  ds_read_b64_tr_b16 a[218:219], v15 offset:33792
  v_mfma_f32_16x16x32_bf16 a[32:35], a[240:243], v[52:55], a[32:35]
  s_add_u32 s30, s80, 96256
  v_exp_f32 v151, v151
  v_mfma_f32_16x16x32_bf16 a[32:35], a[244:247], v[248:251], a[32:35]
  buffer_load_dwordx4 v18, s[52:55], s30 offen offset:2048 lds
  v_mfma_f32_16x16x32_bf16 a[36:39], a[244:247], v[252:255], a[36:39]
  v_cvt_pk_bf16_f32 v203, v150, v151
  v_mfma_f32_16x16x32_bf16 a[36:39], a[240:243], v[56:59], a[36:39]
  v_exp_f32 v152, v152
  v_mfma_f32_16x16x32_bf16 a[40:43], a[240:243], v[60:63], a[40:43]
  ds_read_b64_tr_b16 a[220:221], v15 offset:34816
  v_mfma_f32_16x16x32_bf16 a[40:43], a[244:247], v[20:23], a[40:43]
  v_exp_f32 v153, v153
  v_mfma_f32_16x16x32_bf16 a[44:47], a[244:247], v[28:31], a[44:47]
  ds_read_b64_tr_b16 a[222:223], v15 offset:35840
  v_cvt_pk_bf16_f32 v204, v152, v153
  v_mfma_f32_16x16x32_bf16 a[44:47], a[240:243], v[244:247], a[44:47]
  s_add_u32 s30, s80, 111616
  v_exp_f32 v154, v154
  v_mfma_f32_16x16x32_bf16 a[60:63], a[248:251], v[244:247], a[60:63]
  buffer_load_dwordx4 v18, s[52:55], s30 offen offset:3072 lds
  v_mfma_f32_16x16x32_bf16 a[60:63], a[252:255], v[28:31], a[60:63]
  v_exp_f32 v155, v155
  v_mfma_f32_16x16x32_bf16 a[56:59], a[252:255], v[20:23], a[56:59]
  v_cvt_pk_bf16_f32 v205, v154, v155
  v_mfma_f32_16x16x32_bf16 a[56:59], a[248:251], v[60:63], a[56:59]
  v_exp_f32 v156, v156
  v_mfma_f32_16x16x32_bf16 a[52:55], a[248:251], v[56:59], a[52:55]
  v_mfma_f32_16x16x32_bf16 a[52:55], a[252:255], v[252:255], a[52:55]
  v_exp_f32 v157, v157
  v_mfma_f32_16x16x32_bf16 a[48:51], a[252:255], v[248:251], a[48:51]
  v_cvt_pk_bf16_f32 v206, v156, v157
  v_mfma_f32_16x16x32_bf16 a[48:51], a[248:251], v[52:55], a[48:51]
  v_exp_f32 v158, v158
  v_mfma_f32_16x16x32_bf16 v[228:231], v[224:227], v[52:55], v[228:231]
  v_mfma_f32_16x16x32_bf16 v[228:231], v[224:227], v[248:251], v[228:231]
  v_exp_f32 v159, v159
  v_mfma_f32_16x16x32_bf16 v[232:235], v[224:227], v[56:59], v[232:235]
  v_cvt_pk_bf16_f32 v207, v158, v159
  v_mfma_f32_16x16x32_bf16 v[232:235], v[224:227], v[252:255], v[232:235]
  s_waitcnt lgkmcnt(0)
L_attn_fin:
  s_bfe_u32 s39, s2, 0x20001
  s_lshl_b32 s39, s39, 20
  s_bfe_u32 s0, s2, 0x20003
  s_lshl_b32 s0, s0, 8
  s_add_u32 s39, s39, s0
  s_bfe_u32 s69, s2, 0x30003
  s_lshl_b32 s0, s69, 17
  s_add_u32 s0, s0, s39
  s_mov_b32 s39, s80
  s_lshl_b32 s69, s69, 12
  s_bfe_u32 s40, s2, 0x10005
  s_lshl_b32 s40, s40, 16
  v_mfma_f32_16x16x32_bf16 a[64:67], a[192:195], v[52:55], a[64:67]
  ds_read_b64_tr_b16 a[224:225], v8 offset:49152
  v_exp_f32 v160, v160
  v_mfma_f32_16x16x32_bf16 a[64:67], a[196:199], v[248:251], a[64:67]
  v_exp_f32 v161, v161
  v_mfma_f32_16x16x32_bf16 a[68:71], a[196:199], v[252:255], a[68:71]
  ds_read_b64_tr_b16 a[226:227], v8 offset:50176
  v_exp_f32 v162, v162
  v_mfma_f32_16x16x32_bf16 a[68:71], a[192:195], v[56:59], a[68:71]
  v_exp_f32 v163, v163
  v_cvt_pk_bf16_f32 v208, v160, v161
  v_mfma_f32_16x16x32_bf16 a[72:75], a[192:195], v[60:63], a[72:75]
  ds_read_b64_tr_b16 a[228:229], v8 offset:51200
  v_exp_f32 v164, v164
  v_mfma_f32_16x16x32_bf16 a[72:75], a[196:199], v[20:23], a[72:75]
  v_exp_f32 v165, v165
  v_mfma_f32_16x16x32_bf16 a[76:79], a[196:199], v[28:31], a[76:79]
  ds_read_b64_tr_b16 a[230:231], v8 offset:52224
  v_exp_f32 v166, v166
  v_mfma_f32_16x16x32_bf16 a[76:79], a[192:195], v[244:247], a[76:79]
  v_exp_f32 v167, v167
  v_cvt_pk_bf16_f32 v210, v164, v165
  v_mfma_f32_16x16x32_bf16 a[92:95], a[200:203], v[244:247], a[92:95]
  ds_read_b64_tr_b16 a[232:233], v9 offset:49152
  v_cvt_pk_bf16_f32 v209, v162, v163
  v_cvt_pk_bf16_f32 v211, v166, v167
  v_mfma_f32_16x16x32_bf16 a[92:95], a[204:207], v[28:31], a[92:95]
  v_exp_f32 v168, v168
  v_mfma_f32_16x16x32_bf16 a[88:91], a[204:207], v[20:23], a[88:91]
  ds_read_b64_tr_b16 a[234:235], v9 offset:50176
  v_exp_f32 v169, v169
  v_mfma_f32_16x16x32_bf16 a[88:91], a[200:203], v[60:63], a[88:91]
  v_exp_f32 v170, v170
  v_cvt_pk_bf16_f32 v212, v168, v169
  v_mfma_f32_16x16x32_bf16 a[84:87], a[200:203], v[56:59], a[84:87]
  ds_read_b64_tr_b16 a[236:237], v9 offset:51200
  v_exp_f32 v171, v171
  v_mfma_f32_16x16x32_bf16 a[84:87], a[204:207], v[252:255], a[84:87]
  v_exp_f32 v172, v172
  v_mfma_f32_16x16x32_bf16 a[80:83], a[204:207], v[248:251], a[80:83]
  ds_read_b64_tr_b16 a[238:239], v9 offset:52224
  v_exp_f32 v173, v173
  v_mfma_f32_16x16x32_bf16 a[80:83], a[200:203], v[52:55], a[80:83]
  v_exp_f32 v174, v174
  v_mfma_f32_16x16x32_bf16 a[96:99], a[208:211], v[52:55], a[96:99]
  ds_read_b64_tr_b16 a[240:241], v10 offset:49152
  v_exp_f32 v175, v175
  v_mfma_f32_16x16x32_bf16 a[96:99], a[212:215], v[248:251], a[96:99]
  v_cvt_pk_bf16_f32 v213, v170, v171
  v_cvt_pk_bf16_f32 v214, v172, v173
  v_cvt_pk_bf16_f32 v215, v174, v175
  v_mfma_f32_16x16x32_bf16 a[100:103], a[212:215], v[252:255], a[100:103]
  ds_read_b64_tr_b16 a[242:243], v10 offset:50176
  v_exp_f32 v176, v176
  v_mfma_f32_16x16x32_bf16 a[100:103], a[208:211], v[56:59], a[100:103]
  v_exp_f32 v177, v177
  v_mfma_f32_16x16x32_bf16 a[104:107], a[208:211], v[60:63], a[104:107]
  ds_read_b64_tr_b16 a[244:245], v10 offset:51200
  v_exp_f32 v178, v178
  v_mfma_f32_16x16x32_bf16 a[104:107], a[212:215], v[20:23], a[104:107]
  v_exp_f32 v179, v179
  v_cvt_pk_bf16_f32 v216, v176, v177
  v_mfma_f32_16x16x32_bf16 a[108:111], a[212:215], v[28:31], a[108:111]
  ds_read_b64_tr_b16 a[246:247], v10 offset:52224
  v_exp_f32 v180, v180
  v_mfma_f32_16x16x32_bf16 a[108:111], a[208:211], v[244:247], a[108:111]
  v_exp_f32 v181, v181
  v_mfma_f32_16x16x32_bf16 a[124:127], a[216:219], v[244:247], a[124:127]
  ds_read_b64_tr_b16 a[248:249], v11 offset:49152
  v_exp_f32 v182, v182
  v_mfma_f32_16x16x32_bf16 a[124:127], a[220:223], v[28:31], a[124:127]
  v_exp_f32 v183, v183
  v_cvt_pk_bf16_f32 v218, v180, v181
  v_mfma_f32_16x16x32_bf16 a[120:123], a[220:223], v[20:23], a[120:123]
  ds_read_b64_tr_b16 a[250:251], v11 offset:50176
  v_cvt_pk_bf16_f32 v217, v178, v179
  v_cvt_pk_bf16_f32 v219, v182, v183
  v_mfma_f32_16x16x32_bf16 a[120:123], a[216:219], v[60:63], a[120:123]
  v_exp_f32 v184, v184
  v_mfma_f32_16x16x32_bf16 a[116:119], a[216:219], v[56:59], a[116:119]
  ds_read_b64_tr_b16 a[252:253], v11 offset:51200
  v_exp_f32 v185, v185
  v_mfma_f32_16x16x32_bf16 a[116:119], a[220:223], v[252:255], a[116:119]
  v_exp_f32 v186, v186
  v_cvt_pk_bf16_f32 v220, v184, v185
  v_mfma_f32_16x16x32_bf16 a[112:115], a[220:223], v[248:251], a[112:115]
  ds_read_b64_tr_b16 a[254:255], v11 offset:52224
  v_exp_f32 v187, v187
  v_mfma_f32_16x16x32_bf16 a[112:115], a[216:219], v[52:55], a[112:115]
  v_exp_f32 v188, v188
  v_mfma_f32_16x16x32_bf16 v[236:239], v[224:227], v[60:63], v[236:239]
  v_exp_f32 v189, v189
  v_mfma_f32_16x16x32_bf16 v[236:239], v[224:227], v[20:23], v[236:239]
  v_exp_f32 v190, v190
  v_mfma_f32_16x16x32_bf16 v[240:243], v[224:227], v[244:247], v[240:243]
  v_exp_f32 v191, v191
  v_mfma_f32_16x16x32_bf16 v[240:243], v[224:227], v[28:31], v[240:243]
  s_waitcnt lgkmcnt(0)
  s_barrier
  v_cvt_pk_bf16_f32 v221, v186, v187
  v_cvt_pk_bf16_f32 v222, v188, v189
  v_cvt_pk_bf16_f32 v223, v190, v191
  s_bitcmp1_b32 s25, 1
  s_cbranch_scc0 L_f_far
  s_waitcnt vmcnt(16)
  s_nop 0
  v_mfma_f32_16x16x32_bf16 v[228:231], v[224:227], v[192:195], v[228:231]
  ds_read_b64_tr_b16 a[192:193], v12 offset:49152
  ds_read_b64_tr_b16 a[194:195], v12 offset:50176
  v_mfma_f32_16x16x32_bf16 v[228:231], v[224:227], v[208:211], v[228:231]
  ds_read_b64_tr_b16 a[196:197], v12 offset:51200
  ds_read_b64_tr_b16 a[198:199], v12 offset:52224
  v_mfma_f32_16x16x32_bf16 v[232:235], v[224:227], v[196:199], v[232:235]
  ds_read_b64_tr_b16 a[200:201], v13 offset:49152
  ds_read_b64_tr_b16 a[202:203], v13 offset:50176
  v_mfma_f32_16x16x32_bf16 v[232:235], v[224:227], v[212:215], v[232:235]
  ds_read_b64_tr_b16 a[204:205], v13 offset:51200
  ds_read_b64_tr_b16 a[206:207], v13 offset:52224
  v_mfma_f32_16x16x32_bf16 v[236:239], v[224:227], v[200:203], v[236:239]
  ds_read_b64_tr_b16 a[208:209], v14 offset:49152
  ds_read_b64_tr_b16 a[210:211], v14 offset:50176
  v_mfma_f32_16x16x32_bf16 v[236:239], v[224:227], v[216:219], v[236:239]
  ds_read_b64_tr_b16 a[212:213], v14 offset:51200
  ds_read_b64_tr_b16 a[214:215], v14 offset:52224
  v_mfma_f32_16x16x32_bf16 v[240:243], v[224:227], v[204:207], v[240:243]
  ds_read_b64_tr_b16 a[216:217], v15 offset:49152
  ds_read_b64_tr_b16 a[218:219], v15 offset:50176
  v_mfma_f32_16x16x32_bf16 v[240:243], v[224:227], v[220:223], v[240:243]
  ds_read_b64_tr_b16 a[220:221], v15 offset:51200
  ds_read_b64_tr_b16 a[222:223], v15 offset:52224
  v_mfma_f32_16x16x32_bf16 a[0:3], a[224:227], v[192:195], a[0:3]
  v_mfma_f32_16x16x32_bf16 a[0:3], a[228:231], v[208:211], a[0:3]
  v_mfma_f32_16x16x32_bf16 a[16:19], a[232:235], v[192:195], a[16:19]
  v_mfma_f32_16x16x32_bf16 a[16:19], a[236:239], v[208:211], a[16:19]
  v_mfma_f32_16x16x32_bf16 a[4:7], a[224:227], v[196:199], a[4:7]
  v_mfma_f32_16x16x32_bf16 a[4:7], a[228:231], v[212:215], a[4:7]
  v_mfma_f32_16x16x32_bf16 a[20:23], a[232:235], v[196:199], a[20:23]
  v_mfma_f32_16x16x32_bf16 a[20:23], a[236:239], v[212:215], a[20:23]
  v_mfma_f32_16x16x32_bf16 a[8:11], a[224:227], v[200:203], a[8:11]
  v_rcp_f32 v32, v228
  v_rcp_f32 v33, v232
  v_rcp_f32 v34, v236
  v_rcp_f32 v35, v240
  v_mfma_f32_16x16x32_bf16 a[8:11], a[228:231], v[216:219], a[8:11]
  v_add_f32 v28, v228, v232
  v_add_f32 v29, v236, v240
  v_add_f32 v28, v28, v29
  v_mov_b32 v29, 0x53800000
  v_mfma_f32_16x16x32_bf16 a[24:27], a[232:235], v[200:203], a[24:27]
  v_cmp_nlt_f32 s[32:33], v28, v29
  s_cmp_lg_u64 s[32:33], 0
  s_cselect_b32 s31, 1, 0
  s_lshl_b32 s32, s24, 2
  s_add_u32 s32, s32, 131296
  v_mov_b32 v28, s32
  v_mov_b32 v29, s31
  v_mov_b32 v30, 131296
  v_mfma_f32_16x16x32_bf16 a[24:27], a[236:239], v[216:219], a[24:27]
  ds_write_b32 v28, v29
  v_mfma_f32_16x16x32_bf16 a[12:15], a[224:227], v[204:207], a[12:15]
  s_xor_b32 s32, s40, 0
  v_accvgpr_read_b32 v128, a0
  v_accvgpr_read_b32 v129, a1
  v_mfma_f32_16x16x32_bf16 a[12:15], a[228:231], v[220:223], a[12:15]
  v_accvgpr_read_b32 v130, a2
  v_accvgpr_read_b32 v131, a3
  v_mfma_f32_16x16x32_bf16 a[28:31], a[232:235], v[204:207], a[28:31]
  v_accvgpr_read_b32 v132, a16
  v_accvgpr_read_b32 v133, a17
  v_mfma_f32_16x16x32_bf16 a[28:31], a[236:239], v[220:223], a[28:31]
  v_accvgpr_read_b32 v134, a18
  v_accvgpr_read_b32 v135, a19
  v_mfma_f32_16x16x32_bf16 a[32:35], a[240:243], v[192:195], a[32:35]
  v_mul_f32 v128, v128, v32
  v_mul_f32 v129, v129, v32
  v_mfma_f32_16x16x32_bf16 a[32:35], a[244:247], v[208:211], a[32:35]
  v_mul_f32 v130, v130, v32
  v_mul_f32 v131, v131, v32
  v_mfma_f32_16x16x32_bf16 a[48:51], a[248:251], v[192:195], a[48:51]
  v_mul_f32 v132, v132, v32
  v_mul_f32 v133, v133, v32
  v_mfma_f32_16x16x32_bf16 a[48:51], a[252:255], v[208:211], a[48:51]
  v_mul_f32 v134, v134, v32
  v_mul_f32 v135, v135, v32
  v_mfma_f32_16x16x32_bf16 a[36:39], a[240:243], v[196:199], a[36:39]
  v_cvt_pk_bf16_f32 v128, v128, v129
  v_cvt_pk_bf16_f32 v129, v130, v131
  v_mfma_f32_16x16x32_bf16 a[36:39], a[244:247], v[212:215], a[36:39]
  v_cvt_pk_bf16_f32 v130, v132, v133
  v_cvt_pk_bf16_f32 v131, v134, v135
  v_mfma_f32_16x16x32_bf16 a[52:55], a[248:251], v[196:199], a[52:55]
  buffer_store_dwordx4 v[128:131], v19, s[20:23], s32 offen offset:0
  v_mfma_f32_16x16x32_bf16 a[52:55], a[252:255], v[212:215], a[52:55]
  v_accvgpr_write_b32 a128, v128
  v_accvgpr_write_b32 a129, v129
  v_mfma_f32_16x16x32_bf16 a[40:43], a[240:243], v[200:203], a[40:43]
  v_accvgpr_write_b32 a130, v130
  v_accvgpr_write_b32 a131, v131
  v_mfma_f32_16x16x32_bf16 a[40:43], a[244:247], v[216:219], a[40:43]
  s_xor_b32 s32, s40, 32768
  s_mov_b32 s39, s81
  s_add_u32 s39, s39, 0x20000
  s_cmp_eq_u32 s39, s0
  s_cselect_b32 s34, 0x20000, 0
  s_add_u32 s39, s39, s34
  s_add_u32 s34, s39, 0
  s_add_u32 m0, s43, 98304
  v_accvgpr_read_b32 v136, a4
  buffer_load_dwordx4 v18, s[52:55], s34 offen offset:0 lds
  v_mfma_f32_16x16x32_bf16 a[56:59], a[248:251], v[200:203], a[56:59]
  v_accvgpr_read_b32 v137, a5
  v_accvgpr_read_b32 v138, a6
  v_mfma_f32_16x16x32_bf16 a[56:59], a[252:255], v[216:219], a[56:59]
  v_accvgpr_read_b32 v139, a7
  v_accvgpr_read_b32 v140, a20
  v_mfma_f32_16x16x32_bf16 a[44:47], a[240:243], v[204:207], a[44:47]
  v_accvgpr_read_b32 v141, a21
  v_accvgpr_read_b32 v142, a22
  v_mfma_f32_16x16x32_bf16 a[44:47], a[244:247], v[220:223], a[44:47]
  v_accvgpr_read_b32 v143, a23
  v_mul_f32 v136, v136, v33
  v_mfma_f32_16x16x32_bf16 a[60:63], a[248:251], v[204:207], a[60:63]
  v_mul_f32 v137, v137, v33
  v_mul_f32 v138, v138, v33
  v_mfma_f32_16x16x32_bf16 a[60:63], a[252:255], v[220:223], a[60:63]
  v_mul_f32 v139, v139, v33
  v_mul_f32 v140, v140, v33
  s_waitcnt lgkmcnt(0)
  v_mfma_f32_16x16x32_bf16 a[64:67], a[192:195], v[192:195], a[64:67]
  v_mul_f32 v141, v141, v33
  v_mul_f32 v142, v142, v33
  v_mfma_f32_16x16x32_bf16 a[64:67], a[196:199], v[208:211], a[64:67]
  v_mul_f32 v143, v143, v33
  v_cvt_pk_bf16_f32 v136, v136, v137
  v_mfma_f32_16x16x32_bf16 a[80:83], a[200:203], v[192:195], a[80:83]
  v_cvt_pk_bf16_f32 v137, v138, v139
  v_cvt_pk_bf16_f32 v138, v140, v141
  v_mfma_f32_16x16x32_bf16 a[80:83], a[204:207], v[208:211], a[80:83]
  v_cvt_pk_bf16_f32 v139, v142, v143
  buffer_store_dwordx4 v[136:139], v19, s[20:23], s32 offen offset:0
  v_mfma_f32_16x16x32_bf16 a[68:71], a[192:195], v[196:199], a[68:71]
  v_accvgpr_write_b32 a132, v136
  v_accvgpr_write_b32 a133, v137
  v_mfma_f32_16x16x32_bf16 a[68:71], a[196:199], v[212:215], a[68:71]
  v_accvgpr_write_b32 a134, v138
  v_accvgpr_write_b32 a135, v139
  v_mfma_f32_16x16x32_bf16 a[84:87], a[200:203], v[196:199], a[84:87]
  s_xor_b32 s32, s40, 65536
  v_accvgpr_read_b32 v144, a8
  v_accvgpr_read_b32 v145, a9
  v_mfma_f32_16x16x32_bf16 a[84:87], a[204:207], v[212:215], a[84:87]
  v_accvgpr_read_b32 v146, a10
  v_accvgpr_read_b32 v147, a11
  v_mfma_f32_16x16x32_bf16 a[72:75], a[192:195], v[200:203], a[72:75]
  v_accvgpr_read_b32 v148, a24
  v_accvgpr_read_b32 v149, a25
  v_mfma_f32_16x16x32_bf16 a[72:75], a[196:199], v[216:219], a[72:75]
  v_accvgpr_read_b32 v150, a26
  v_accvgpr_read_b32 v151, a27
  v_mfma_f32_16x16x32_bf16 a[88:91], a[200:203], v[200:203], a[88:91]
  v_mul_f32 v144, v144, v34
  v_mul_f32 v145, v145, v34
  v_mfma_f32_16x16x32_bf16 a[88:91], a[204:207], v[216:219], a[88:91]
  v_mul_f32 v146, v146, v34
  v_mul_f32 v147, v147, v34
  v_mfma_f32_16x16x32_bf16 a[76:79], a[192:195], v[204:207], a[76:79]
  v_mul_f32 v148, v148, v34
  v_mul_f32 v149, v149, v34
  v_mfma_f32_16x16x32_bf16 a[76:79], a[196:199], v[220:223], a[76:79]
  v_mul_f32 v150, v150, v34
  v_mul_f32 v151, v151, v34
  v_mfma_f32_16x16x32_bf16 a[92:95], a[200:203], v[204:207], a[92:95]
  v_cvt_pk_bf16_f32 v144, v144, v145
  v_cvt_pk_bf16_f32 v145, v146, v147
  v_mfma_f32_16x16x32_bf16 a[92:95], a[204:207], v[220:223], a[92:95]
  v_cvt_pk_bf16_f32 v146, v148, v149
  v_cvt_pk_bf16_f32 v147, v150, v151
  v_mfma_f32_16x16x32_bf16 a[96:99], a[208:211], v[192:195], a[96:99]
  buffer_store_dwordx4 v[144:147], v19, s[20:23], s32 offen offset:0
  v_mfma_f32_16x16x32_bf16 a[96:99], a[212:215], v[208:211], a[96:99]
  s_xor_b32 s32, s40, 98304
  s_add_u32 s35, s39, 15360
  s_add_u32 m0, s43, 98304
  v_accvgpr_read_b32 v152, a12
  buffer_load_dwordx4 v18, s[52:55], s35 offen offset:1024 lds
  v_mfma_f32_16x16x32_bf16 a[112:115], a[216:219], v[192:195], a[112:115]
L_attn_st10:
  s_cbranch_vccnz L_attn_walkdone2
  v_accvgpr_read_b32 v153, a13
  v_accvgpr_read_b32 v154, a14
  v_mfma_f32_16x16x32_bf16 a[112:115], a[220:223], v[208:211], a[112:115]
  v_accvgpr_read_b32 v155, a15
  v_accvgpr_read_b32 v156, a28
  v_mfma_f32_16x16x32_bf16 a[100:103], a[208:211], v[196:199], a[100:103]
  v_accvgpr_read_b32 v157, a29
  v_accvgpr_read_b32 v158, a30
  v_mfma_f32_16x16x32_bf16 a[100:103], a[212:215], v[212:215], a[100:103]
  v_accvgpr_read_b32 v159, a31
  v_mul_f32 v152, v152, v35
  v_mfma_f32_16x16x32_bf16 a[116:119], a[216:219], v[196:199], a[116:119]
  v_mul_f32 v153, v153, v35
  v_mul_f32 v154, v154, v35
  v_mfma_f32_16x16x32_bf16 a[116:119], a[220:223], v[212:215], a[116:119]
  v_mul_f32 v155, v155, v35
  v_mul_f32 v156, v156, v35
  v_mfma_f32_16x16x32_bf16 a[104:107], a[208:211], v[200:203], a[104:107]
  v_mul_f32 v157, v157, v35
  v_mul_f32 v158, v158, v35
  v_mfma_f32_16x16x32_bf16 a[104:107], a[212:215], v[216:219], a[104:107]
  v_mul_f32 v159, v159, v35
  v_cvt_pk_bf16_f32 v152, v152, v153
  v_mfma_f32_16x16x32_bf16 a[120:123], a[216:219], v[200:203], a[120:123]
  v_cvt_pk_bf16_f32 v153, v154, v155
  v_cvt_pk_bf16_f32 v154, v156, v157
  v_mfma_f32_16x16x32_bf16 a[120:123], a[220:223], v[216:219], a[120:123]
  v_cvt_pk_bf16_f32 v155, v158, v159
  buffer_store_dwordx4 v[152:155], v19, s[20:23], s32 offen offset:0
  v_mfma_f32_16x16x32_bf16 a[108:111], a[208:211], v[204:207], a[108:111]
  s_xor_b32 s32, s40, 0
  v_accvgpr_read_b32 v160, a32
  v_accvgpr_read_b32 v161, a33
  v_mfma_f32_16x16x32_bf16 a[108:111], a[212:215], v[220:223], a[108:111]
  v_accvgpr_read_b32 v162, a34
  v_accvgpr_read_b32 v163, a35
  v_mfma_f32_16x16x32_bf16 a[124:127], a[216:219], v[204:207], a[124:127]
  v_accvgpr_read_b32 v164, a48
  v_accvgpr_read_b32 v165, a49
  v_mfma_f32_16x16x32_bf16 a[124:127], a[220:223], v[220:223], a[124:127]
  v_accvgpr_read_b32 v166, a50
  v_accvgpr_read_b32 v167, a51
  v_pk_mul_f32 v[160:161], v[160:161], v[32:33] op_sel:[0,0] op_sel_hi:[1,0]
  v_pk_mul_f32 v[162:163], v[162:163], v[32:33] op_sel:[0,0] op_sel_hi:[1,0]
  v_pk_mul_f32 v[164:165], v[164:165], v[32:33] op_sel:[0,0] op_sel_hi:[1,0]
  v_pk_mul_f32 v[166:167], v[166:167], v[32:33] op_sel:[0,0] op_sel_hi:[1,0]
  v_cvt_pk_bf16_f32 v160, v160, v161
  v_cvt_pk_bf16_f32 v161, v162, v163
  v_cvt_pk_bf16_f32 v162, v164, v165
  v_cvt_pk_bf16_f32 v163, v166, v167
  buffer_store_dwordx4 v[160:163], v19, s[20:23], s32 offen offset:1024
  v_accvgpr_write_b32 a136, v160
  v_accvgpr_write_b32 a137, v161
  v_accvgpr_write_b32 a138, v162
  v_accvgpr_write_b32 a139, v163
  s_xor_b32 s32, s40, 32768
  s_add_u32 s36, s39, 30720
  s_add_u32 m0, s43, 98304
  v_accvgpr_read_b32 v168, a36
  buffer_load_dwordx4 v18, s[52:55], s36 offen offset:2048 lds
  v_accvgpr_read_b32 v169, a37
  v_accvgpr_read_b32 v170, a38
  v_accvgpr_read_b32 v171, a39
  v_accvgpr_read_b32 v172, a52
  v_accvgpr_read_b32 v173, a53
  v_accvgpr_read_b32 v174, a54
  v_accvgpr_read_b32 v175, a55
  v_pk_mul_f32 v[168:169], v[168:169], v[32:33] op_sel:[0,1] op_sel_hi:[1,1]
  v_pk_mul_f32 v[170:171], v[170:171], v[32:33] op_sel:[0,1] op_sel_hi:[1,1]
  v_pk_mul_f32 v[172:173], v[172:173], v[32:33] op_sel:[0,1] op_sel_hi:[1,1]
  v_pk_mul_f32 v[174:175], v[174:175], v[32:33] op_sel:[0,1] op_sel_hi:[1,1]
  v_cvt_pk_bf16_f32 v168, v168, v169
  v_cvt_pk_bf16_f32 v169, v170, v171
  v_cvt_pk_bf16_f32 v170, v172, v173
  v_cvt_pk_bf16_f32 v171, v174, v175
  buffer_store_dwordx4 v[168:171], v19, s[20:23], s32 offen offset:1024
  v_accvgpr_write_b32 a140, v168
  v_accvgpr_write_b32 a141, v169
  v_accvgpr_write_b32 a142, v170
  v_accvgpr_write_b32 a143, v171
  s_xor_b32 s32, s40, 65536
  s_add_u32 s37, s39, 46080
  s_add_u32 m0, s43, 98304
  v_accvgpr_read_b32 v176, a40
  buffer_load_dwordx4 v18, s[52:55], s37 offen offset:3072 lds
  v_accvgpr_read_b32 v177, a41
  v_accvgpr_read_b32 v178, a42
  v_accvgpr_read_b32 v179, a43
  v_accvgpr_read_b32 v180, a56
  v_accvgpr_read_b32 v181, a57
  v_accvgpr_read_b32 v182, a58
  v_accvgpr_read_b32 v183, a59
  v_pk_mul_f32 v[176:177], v[176:177], v[34:35] op_sel:[0,0] op_sel_hi:[1,0]
  v_pk_mul_f32 v[178:179], v[178:179], v[34:35] op_sel:[0,0] op_sel_hi:[1,0]
  v_pk_mul_f32 v[180:181], v[180:181], v[34:35] op_sel:[0,0] op_sel_hi:[1,0]
  v_pk_mul_f32 v[182:183], v[182:183], v[34:35] op_sel:[0,0] op_sel_hi:[1,0]
  v_cvt_pk_bf16_f32 v176, v176, v177
  v_cvt_pk_bf16_f32 v177, v178, v179
  v_cvt_pk_bf16_f32 v178, v180, v181
  v_cvt_pk_bf16_f32 v179, v182, v183
  buffer_store_dwordx4 v[176:179], v19, s[20:23], s32 offen offset:1024
  s_waitcnt vmcnt(11) lgkmcnt(0)
  s_barrier
  ds_read_b128 v[36:39], v30
  s_xor_b32 s32, s40, 98304
  v_accvgpr_read_b32 v184, a44
  v_accvgpr_read_b32 v185, a45
  v_accvgpr_read_b32 v186, a46
  v_accvgpr_read_b32 v187, a47
  v_accvgpr_read_b32 v188, a60
  v_accvgpr_read_b32 v189, a61
  v_accvgpr_read_b32 v190, a62
  v_accvgpr_read_b32 v191, a63
  v_pk_mul_f32 v[184:185], v[184:185], v[34:35] op_sel:[0,1] op_sel_hi:[1,1]
  v_pk_mul_f32 v[186:187], v[186:187], v[34:35] op_sel:[0,1] op_sel_hi:[1,1]
  v_pk_mul_f32 v[188:189], v[188:189], v[34:35] op_sel:[0,1] op_sel_hi:[1,1]
  v_pk_mul_f32 v[190:191], v[190:191], v[34:35] op_sel:[0,1] op_sel_hi:[1,1]
  v_cvt_pk_bf16_f32 v184, v184, v185
  v_cvt_pk_bf16_f32 v185, v186, v187
  v_cvt_pk_bf16_f32 v186, v188, v189
  v_cvt_pk_bf16_f32 v187, v190, v191
  buffer_store_dwordx4 v[184:187], v19, s[20:23], s32 offen offset:1024
  s_waitcnt lgkmcnt(0)
  v_or_b32 v36, v36, v37
  v_or3_b32 v36, v36, v38, v39
  s_nop 0
  v_readfirstlane_b32 s31, v36
  s_nop 3
  s_andn2_b32 s31, s31, s29
  s_cbranch_scc1 L_attn_fallback
  s_xor_b32 s32, s40, 0
  s_add_u32 s34, s39, 65536
  s_add_u32 m0, s43, 114688
  v_accvgpr_read_b32 v128, a64
  buffer_load_dwordx4 v18, s[52:55], s34 offen offset:0 lds
  v_accvgpr_read_b32 v129, a65
  v_accvgpr_read_b32 v130, a66
  v_accvgpr_read_b32 v131, a67
  v_accvgpr_read_b32 v132, a80
  v_accvgpr_read_b32 v133, a81
  v_accvgpr_read_b32 v134, a82
  v_accvgpr_read_b32 v135, a83
  v_pk_mul_f32 v[128:129], v[128:129], v[32:33] op_sel:[0,0] op_sel_hi:[1,0]
  v_pk_mul_f32 v[130:131], v[130:131], v[32:33] op_sel:[0,0] op_sel_hi:[1,0]
  v_pk_mul_f32 v[132:133], v[132:133], v[32:33] op_sel:[0,0] op_sel_hi:[1,0]
  v_pk_mul_f32 v[134:135], v[134:135], v[32:33] op_sel:[0,0] op_sel_hi:[1,0]
  v_cvt_pk_bf16_f32 v128, v128, v129
  v_cvt_pk_bf16_f32 v129, v130, v131
  v_cvt_pk_bf16_f32 v130, v132, v133
  v_cvt_pk_bf16_f32 v131, v134, v135
  buffer_store_dwordx4 v[128:131], v19, s[20:23], s32 offen offset:2048
  v_accvgpr_write_b32 a144, v128
  v_accvgpr_write_b32 a145, v129
  v_accvgpr_write_b32 a146, v130
  v_accvgpr_write_b32 a147, v131
  s_xor_b32 s32, s40, 32768
  v_accvgpr_read_b32 v136, a68
  v_accvgpr_read_b32 v137, a69
  v_accvgpr_read_b32 v138, a70
  v_accvgpr_read_b32 v139, a71
  v_accvgpr_read_b32 v140, a84
  v_accvgpr_read_b32 v141, a85
  v_accvgpr_read_b32 v142, a86
  v_accvgpr_read_b32 v143, a87
  v_pk_mul_f32 v[136:137], v[136:137], v[32:33] op_sel:[0,1] op_sel_hi:[1,1]
  v_pk_mul_f32 v[138:139], v[138:139], v[32:33] op_sel:[0,1] op_sel_hi:[1,1]
  v_pk_mul_f32 v[140:141], v[140:141], v[32:33] op_sel:[0,1] op_sel_hi:[1,1]
  v_pk_mul_f32 v[142:143], v[142:143], v[32:33] op_sel:[0,1] op_sel_hi:[1,1]
  v_cvt_pk_bf16_f32 v136, v136, v137
  v_cvt_pk_bf16_f32 v137, v138, v139
  v_cvt_pk_bf16_f32 v138, v140, v141
  v_cvt_pk_bf16_f32 v139, v142, v143
  buffer_store_dwordx4 v[136:139], v19, s[20:23], s32 offen offset:2048
  v_accvgpr_write_b32 a148, v136
  v_accvgpr_write_b32 a149, v137
  v_accvgpr_write_b32 a150, v138
  v_accvgpr_write_b32 a151, v139
  s_xor_b32 s32, s40, 65536
  s_add_u32 s35, s39, 80896
  s_add_u32 m0, s43, 114688
  v_accvgpr_read_b32 v144, a72
  buffer_load_dwordx4 v18, s[52:55], s35 offen offset:1024 lds
  v_accvgpr_read_b32 v145, a73
  v_accvgpr_read_b32 v146, a74
  v_accvgpr_read_b32 v147, a75
  v_accvgpr_read_b32 v148, a88
  v_accvgpr_read_b32 v149, a89
  v_accvgpr_read_b32 v150, a90
  v_accvgpr_read_b32 v151, a91
  v_pk_mul_f32 v[144:145], v[144:145], v[34:35] op_sel:[0,0] op_sel_hi:[1,0]
  v_pk_mul_f32 v[146:147], v[146:147], v[34:35] op_sel:[0,0] op_sel_hi:[1,0]
  v_pk_mul_f32 v[148:149], v[148:149], v[34:35] op_sel:[0,0] op_sel_hi:[1,0]
  v_pk_mul_f32 v[150:151], v[150:151], v[34:35] op_sel:[0,0] op_sel_hi:[1,0]
  v_cvt_pk_bf16_f32 v144, v144, v145
  v_cvt_pk_bf16_f32 v145, v146, v147
  v_cvt_pk_bf16_f32 v146, v148, v149
  v_cvt_pk_bf16_f32 v147, v150, v151
  buffer_store_dwordx4 v[144:147], v19, s[20:23], s32 offen offset:2048
  s_xor_b32 s32, s40, 98304
  v_accvgpr_read_b32 v152, a76
  v_accvgpr_read_b32 v153, a77
  v_accvgpr_read_b32 v154, a78
  v_accvgpr_read_b32 v155, a79
  v_accvgpr_read_b32 v156, a92
  v_accvgpr_read_b32 v157, a93
  v_accvgpr_read_b32 v158, a94
  v_accvgpr_read_b32 v159, a95
  v_pk_mul_f32 v[152:153], v[152:153], v[34:35] op_sel:[0,1] op_sel_hi:[1,1]
  v_pk_mul_f32 v[154:155], v[154:155], v[34:35] op_sel:[0,1] op_sel_hi:[1,1]
  v_pk_mul_f32 v[156:157], v[156:157], v[34:35] op_sel:[0,1] op_sel_hi:[1,1]
  v_pk_mul_f32 v[158:159], v[158:159], v[34:35] op_sel:[0,1] op_sel_hi:[1,1]
  v_cvt_pk_bf16_f32 v152, v152, v153
  v_cvt_pk_bf16_f32 v153, v154, v155
  v_cvt_pk_bf16_f32 v154, v156, v157
  v_cvt_pk_bf16_f32 v155, v158, v159
  buffer_store_dwordx4 v[152:155], v19, s[20:23], s32 offen offset:2048
  s_xor_b32 s32, s40, 0
  s_add_u32 s36, s39, 96256
  s_add_u32 m0, s43, 114688
  v_accvgpr_read_b32 v160, a96
  buffer_load_dwordx4 v18, s[52:55], s36 offen offset:2048 lds
  v_accvgpr_read_b32 v161, a97
  v_accvgpr_read_b32 v162, a98
  v_accvgpr_read_b32 v163, a99
  v_accvgpr_read_b32 v164, a112
  v_accvgpr_read_b32 v165, a113
  v_accvgpr_read_b32 v166, a114
  v_accvgpr_read_b32 v167, a115
  v_pk_mul_f32 v[160:161], v[160:161], v[32:33] op_sel:[0,0] op_sel_hi:[1,0]
  v_pk_mul_f32 v[162:163], v[162:163], v[32:33] op_sel:[0,0] op_sel_hi:[1,0]
  v_pk_mul_f32 v[164:165], v[164:165], v[32:33] op_sel:[0,0] op_sel_hi:[1,0]
  v_pk_mul_f32 v[166:167], v[166:167], v[32:33] op_sel:[0,0] op_sel_hi:[1,0]
  v_cvt_pk_bf16_f32 v160, v160, v161
  v_cvt_pk_bf16_f32 v161, v162, v163
  v_cvt_pk_bf16_f32 v162, v164, v165
  v_cvt_pk_bf16_f32 v163, v166, v167
  buffer_store_dwordx4 v[160:163], v19, s[20:23], s32 offen offset:3072
  v_accvgpr_write_b32 a152, v160
  v_accvgpr_write_b32 a153, v161
  v_accvgpr_write_b32 a154, v162
  v_accvgpr_write_b32 a155, v163
  s_xor_b32 s32, s40, 32768
  s_add_u32 s37, s39, 111616
  s_add_u32 m0, s43, 114688
  v_accvgpr_read_b32 v168, a100
  buffer_load_dwordx4 v18, s[52:55], s37 offen offset:3072 lds
  v_accvgpr_read_b32 v169, a101
  v_accvgpr_read_b32 v170, a102
  v_accvgpr_read_b32 v171, a103
  v_accvgpr_read_b32 v172, a116
  v_accvgpr_read_b32 v173, a117
  v_accvgpr_read_b32 v174, a118
  v_accvgpr_read_b32 v175, a119
  v_pk_mul_f32 v[168:169], v[168:169], v[32:33] op_sel:[0,1] op_sel_hi:[1,1]
  v_pk_mul_f32 v[170:171], v[170:171], v[32:33] op_sel:[0,1] op_sel_hi:[1,1]
  v_pk_mul_f32 v[172:173], v[172:173], v[32:33] op_sel:[0,1] op_sel_hi:[1,1]
  v_pk_mul_f32 v[174:175], v[174:175], v[32:33] op_sel:[0,1] op_sel_hi:[1,1]
  v_cvt_pk_bf16_f32 v168, v168, v169
  v_cvt_pk_bf16_f32 v169, v170, v171
  v_cvt_pk_bf16_f32 v170, v172, v173
  v_cvt_pk_bf16_f32 v171, v174, v175
  buffer_store_dwordx4 v[168:171], v19, s[20:23], s32 offen offset:3072
  v_accvgpr_write_b32 a156, v168
  v_accvgpr_write_b32 a157, v169
  v_accvgpr_write_b32 a158, v170
  v_accvgpr_write_b32 a159, v171
  s_xor_b32 s32, s40, 65536
  v_accvgpr_read_b32 v176, a104
  v_accvgpr_read_b32 v177, a105
  v_accvgpr_read_b32 v178, a106
  v_accvgpr_read_b32 v179, a107
  v_accvgpr_read_b32 v180, a120
  v_accvgpr_read_b32 v181, a121
  v_accvgpr_read_b32 v182, a122
  v_accvgpr_read_b32 v183, a123
  v_pk_mul_f32 v[176:177], v[176:177], v[34:35] op_sel:[0,0] op_sel_hi:[1,0]
  v_pk_mul_f32 v[178:179], v[178:179], v[34:35] op_sel:[0,0] op_sel_hi:[1,0]
  v_pk_mul_f32 v[180:181], v[180:181], v[34:35] op_sel:[0,0] op_sel_hi:[1,0]
  v_pk_mul_f32 v[182:183], v[182:183], v[34:35] op_sel:[0,0] op_sel_hi:[1,0]
  v_cvt_pk_bf16_f32 v176, v176, v177
  v_cvt_pk_bf16_f32 v177, v178, v179
  v_cvt_pk_bf16_f32 v178, v180, v181
  v_cvt_pk_bf16_f32 v179, v182, v183
  buffer_store_dwordx4 v[176:179], v19, s[20:23], s32 offen offset:3072
  s_xor_b32 s32, s40, 98304
  v_accvgpr_read_b32 v184, a108
  v_accvgpr_read_b32 v185, a109
  v_accvgpr_read_b32 v186, a110
  v_accvgpr_read_b32 v187, a111
  v_accvgpr_read_b32 v188, a124
  v_accvgpr_read_b32 v189, a125
  v_accvgpr_read_b32 v190, a126
  v_accvgpr_read_b32 v191, a127
  v_pk_mul_f32 v[184:185], v[184:185], v[34:35] op_sel:[0,1] op_sel_hi:[1,1]
  v_pk_mul_f32 v[186:187], v[186:187], v[34:35] op_sel:[0,1] op_sel_hi:[1,1]
  v_pk_mul_f32 v[188:189], v[188:189], v[34:35] op_sel:[0,1] op_sel_hi:[1,1]
  v_pk_mul_f32 v[190:191], v[190:191], v[34:35] op_sel:[0,1] op_sel_hi:[1,1]
  v_cvt_pk_bf16_f32 v184, v184, v185
  v_cvt_pk_bf16_f32 v185, v186, v187
  v_cvt_pk_bf16_f32 v186, v188, v189
  v_cvt_pk_bf16_f32 v187, v190, v191
  buffer_store_dwordx4 v[184:187], v19, s[20:23], s32 offen offset:3072
L_f_done:
  s_lshl_b32 s30, s2, 7
  v_mov_b32 v5, s30
  s_bitcmp1_b32 s25, 1
  s_cselect_b32 s5, 0, 2.0
  s_cselect_b32 s6, 2.0, 0
  v_mov_b32 v17, v51
  v_subrev_u32 v20, 65536, v8
  v_subrev_u32 v21, 65536, v9
  v_subrev_u32 v22, 65536, v10
  v_subrev_u32 v23, 65536, v11
  v_subrev_u32 v24, 65536, v12
  v_subrev_u32 v25, 65536, v13
  v_subrev_u32 v26, 65536, v14
  v_subrev_u32 v27, 65536, v15
  ds_read_b64_tr_b16 v[32:33], v20 offset:0
  ds_read_b64_tr_b16 v[34:35], v20 offset:1024
  ds_read_b64_tr_b16 v[36:37], v20 offset:2048
  ds_read_b64_tr_b16 v[38:39], v20 offset:3072
  ds_read_b64_tr_b16 v[40:41], v21 offset:0
  ds_read_b64_tr_b16 v[42:43], v21 offset:1024
  ds_read_b64_tr_b16 v[44:45], v21 offset:2048
  ds_read_b64_tr_b16 v[46:47], v21 offset:3072
  ds_read_b64_tr_b16 v[48:49], v22 offset:0
  ds_read_b64_tr_b16 v[50:51], v22 offset:1024
  ds_read_b64_tr_b16 v[52:53], v22 offset:2048
  ds_read_b64_tr_b16 v[54:55], v22 offset:3072
  ds_read_b64_tr_b16 v[56:57], v23 offset:0
  ds_read_b64_tr_b16 v[58:59], v23 offset:1024
  ds_read_b64_tr_b16 v[60:61], v23 offset:2048
  ds_read_b64_tr_b16 v[62:63], v23 offset:3072
  v_and_b32 v2, 7, v1
  s_and_b32 s30, s2, 0xc7
  v_lshl_or_b32 v2, v2, 3, s30
  v_lshlrev_b32 v4, 7, v2
  v_add_u32 v28, 64, v1
  v_lshlrev_b32 v103, 7, v28
  s_and_b32 s30, s2, 1
  s_lshl_b32 s30, s30, 2
  s_lshr_b32 s31, s2, 6
  s_add_u32 s30, s30, s31
  s_lshl_b32 s30, s30, 2
  s_add_u32 s30, s30, s24
  s_lshl_b32 s30, s30, 1
  s_bfe_u32 s31, s2, 0x10005
  s_add_u32 s30, s30, s31
  s_lshl_b32 s40, s30, 1
  s_mov_b32 s1, -4096
  s_bfe_u32 s41, s2, 0x20001
  s_lshl_b32 s30, s40, 15
  s_lshl_b32 s31, s41, 22
  s_add_u32 s30, s30, s31
  s_add_u32 s30, s30, 4194304
  s_add_u32 s8, s46, s30
  s_addc_u32 s9, s47, 0
  s_mov_b32 s10, 65536
  s_mov_b32 s11, 0x20000
  s_lshl_b32 s30, s41, 21
  s_lshl_b32 s31, s40, 14
  s_add_u32 s30, s30, s31
  s_bfe_u32 s31, s2, 0x20003
  s_lshl_b32 s31, s31, 12
  s_add_u32 s30, s30, s31
  s_add_u32 s30, s30, 20971520
  s_add_u32 s12, s46, s30
  s_addc_u32 s13, s47, 0
  s_mov_b32 s14, 20480
  s_mov_b32 s15, 0x20000
  s_mov_b32 s16, s48
  s_mov_b32 s17, s49
  s_mov_b32 s18, 2097152
  s_mov_b32 s19, 0x20000
  s_add_u32 s20, s46, 32768
  s_addc_u32 s21, s47, 0
  s_mov_b32 s22, 49152
  s_mov_b32 s23, 0x20000
  s_and_b32 s30, s2, 7
  s_lshl_b32 s30, s30, 4
  s_lshr_b32 s31, s2, 4
  s_add_u32 s30, s30, s31
  s_bfe_u32 s31, s2, 0x10003
  s_lshl_b32 s30, s30, 14
  s_lshl_b32 s40, s31, 7
  s_add_u32 s40, s40, s30
  s_lshl_b32 s41, s31, 13
  s_add_u32 s41, s41, s30
  s_lshl_b32 s31, s24, 11
  s_add_u32 s41, s41, s31
  s_and_b32 s30, s2, 7
  s_lshl_b32 s30, s30, 1
  s_lshr_b32 s31, s2, 7
  s_add_u32 s42, s30, s31
  s_bfe_u32 s31, s2, 0x10005
  s_add_u32 s29, s30, s31
  s_bfe_u32 s38, s2, 0x40003
  s_lshl_b32 s26, s24, 11
  s_add_u32 s26, s26, 4096
  s_lshr_b32 s28, s2, 3
  s_lshl_b32 s28, s28, 2
  s_add_u32 s28, s28, s24
  s_mul_i32 s28, s28, 11264
  s_lshl_b32 s27, s24, 15
  s_add_u32 s30, s2, 64
  s_bfe_u32 s30, s30, 0x30004
  s_lshl_b32 s30, s30, 7
  s_add_u32 s27, s27, s30
  s_add_u32 s25, s27, 1441792
  s_lshr_b32 s30, s2, 7
  s_lshl_b32 s30, s30, 1
  s_bfe_u32 s31, s2, 0x10003
  s_add_u32 s30, s30, s31
  s_mul_i32 s30, s30, 3
  s_add_u32 s31, s2, 64
  s_bfe_u32 s31, s31, 0x30004
  s_and_b32 s31, s31, 7
  s_mul_i32 s31, s31, 0
  s_add_u32 s30, s30, s31
  s_mul_i32 s31, s30, 373
  s_lshr_b32 s31, s31, 12
  s_mul_i32 s31, s31, 11
  s_sub_u32 s30, s30, s31
  s_lshl_b32 s30, s30, 17
  s_add_u32 s27, s27, s30
  s_waitcnt lgkmcnt(12)
  s_waitcnt vmcnt(0)
  s_barrier
  s_cmp_lg_u32 s24, 3
  s_cbranch_scc1 L_sync1_a
  v_mov_b32 v6, s68
  s_mov_b64 exec, 1
  buffer_store_dword v6, v5, s[64:67], s5 offen
  buffer_store_dword v6, v5, s[64:67], s6 offen sc1
  s_mov_b64 exec, -1
  s_nop 3
L_sync1_a:
  v_mfma_f32_16x16x32_bf16 v[128:131], v[32:35], a[128:131], 0
  ds_read_b64_tr_b16 v[64:65], v24 offset:0
  v_lshlrev_b32 v2, 7, v1
  v_mfma_f32_16x16x32_bf16 v[128:131], v[36:39], a[136:139], v[128:131]
  ds_read_b64_tr_b16 v[66:67], v24 offset:1024
  v_mov_b32 v3, 0x40000000
  v_mfma_f32_16x16x32_bf16 v[132:135], v[36:39], a[140:143], 0
  ds_read_b64_tr_b16 v[68:69], v24 offset:2048
  v_cmp_gt_u32 s[32:33], 22, v1
  v_mfma_f32_16x16x32_bf16 v[132:135], v[32:35], a[132:135], v[132:135]
  s_waitcnt lgkmcnt(11)
  ds_read_b64_tr_b16 v[70:71], v24 offset:3072
  v_nop
  v_mfma_f32_16x16x32_bf16 v[140:143], v[40:43], a[132:135], 0
  ds_read_b64_tr_b16 v[72:73], v25 offset:0
  v_nop
  v_mfma_f32_16x16x32_bf16 v[140:143], v[44:47], a[140:143], v[140:143]
  ds_read_b64_tr_b16 v[74:75], v25 offset:1024
  v_cndmask_b32 v248, v3, v2, s[32:33]
  v_mfma_f32_16x16x32_bf16 v[136:139], v[44:47], a[136:139], 0
  ds_read_b64_tr_b16 v[76:77], v25 offset:2048
  v_and_b32 v30, 7, v1
  v_mfma_f32_16x16x32_bf16 v[136:139], v[40:43], a[128:131], v[136:139]
  s_waitcnt lgkmcnt(11)
  ds_read_b64_tr_b16 v[78:79], v25 offset:3072
  v_bfe_u32 v31, v1, 3, 2
  v_mfma_f32_16x16x32_bf16 v[144:147], v[48:51], a[128:131], 0
  ds_read_b64_tr_b16 v[80:81], v26 offset:0
  v_add_u32 v224, 65536, v8
  v_mfma_f32_16x16x32_bf16 v[144:147], v[52:55], a[136:139], v[144:147]
  ds_read_b64_tr_b16 v[82:83], v26 offset:1024
  v_add_u32 v225, 65536, v9
  v_mfma_f32_16x16x32_bf16 v[148:151], v[52:55], a[140:143], 0
  ds_read_b64_tr_b16 v[84:85], v26 offset:2048
  v_mfma_f32_16x16x32_bf16 v[148:151], v[48:51], a[132:135], v[148:151]
  s_waitcnt lgkmcnt(11)
  ds_read_b64_tr_b16 v[86:87], v26 offset:3072
  v_mfma_f32_16x16x32_bf16 v[156:159], v[56:59], a[132:135], 0
  ds_read_b64_tr_b16 v[88:89], v27 offset:0
  v_mfma_f32_16x16x32_bf16 v[156:159], v[60:63], a[140:143], v[156:159]
  ds_read_b64_tr_b16 v[90:91], v27 offset:1024
  v_mfma_f32_16x16x32_bf16 v[152:155], v[60:63], a[136:139], 0
  ds_read_b64_tr_b16 v[92:93], v27 offset:2048
  v_mfma_f32_16x16x32_bf16 v[152:155], v[56:59], a[128:131], v[152:155]
  s_waitcnt lgkmcnt(11)
  ds_read_b64_tr_b16 v[94:95], v27 offset:3072
  s_mov_b64 vcc, -1
  s_cmp_eq_u32 s24, 0
  s_cbranch_scc1 L_attn_st11
  s_cmp_eq_u32 s24, 1
  s_cbranch_scc1 L_attn_st12
  s_cmp_eq_u32 s24, 2
  s_cbranch_scc1 L_attn_st13
L_attn_walkdone1:
  s_mov_b64 vcc, 0
  s_cmp_lg_u32 s24, 3
  s_cbranch_scc1 L_sync1_b
  s_mov_b32 s31, 0
  s_mov_b32 s30, 0
L_sync1_poll:
  buffer_load_dword v7, v4, s[64:67], s30 offen sc1
  s_add_u32 s31, s31, 1
  s_waitcnt vmcnt(0)
  v_cmp_eq_u32 s[32:33], s68, v7
  s_cmp_gt_u32 s31, 2097152
  s_cbranch_scc1 L_sync1_x
  s_cmp_eq_u64 s[32:33], -1
  s_cbranch_scc0 L_sync1_poll
L_sync1_x:
L_sync1_b:
  s_barrier
  s_add_u32 s1, s1, 4096
  s_cmp_eq_u32 s1, s69
  s_cselect_b32 s44, 4096, 0
  s_add_u32 s1, s1, s44
  s_add_u32 s44, s1, 0
  buffer_load_dwordx4 a[32:35], v19, s[8:11], s44 offen sc1
  s_add_u32 s45, s1, 32768
  buffer_load_dwordx4 a[36:39], v19, s[8:11], s45 offen sc1
  s_add_u32 s44, s1, 1024
  buffer_load_dwordx4 a[40:43], v19, s[8:11], s44 offen sc1
  s_add_u32 s45, s1, 33792
  buffer_load_dwordx4 a[44:47], v19, s[8:11], s45 offen sc1
  s_add_u32 s44, s1, 2048
  buffer_load_dwordx4 a[48:51], v19, s[8:11], s44 offen sc1
  s_add_u32 s45, s1, 34816
  buffer_load_dwordx4 a[52:55], v19, s[8:11], s45 offen sc1
  s_add_u32 s44, s1, 3072
  buffer_load_dwordx4 a[56:59], v19, s[8:11], s44 offen sc1
  s_add_u32 s45, s1, 35840
  buffer_load_dwordx4 a[60:63], v19, s[8:11], s45 offen sc1
  v_mfma_f32_16x16x32_bf16 v[160:163], v[64:67], a[128:131], 0
  ds_read_b64_tr_b16 v[32:33], v20 offset:16384
  v_add_u32 v226, 65536, v10
  v_mfma_f32_16x16x32_bf16 v[160:163], v[68:71], a[136:139], v[160:163]
  s_add_u32 s1, s1, 4096
  s_cmp_eq_u32 s1, s69
  s_cselect_b32 s44, 4096, 0
  s_add_u32 s1, s1, s44
  s_add_u32 s44, s1, 0
  ds_read_b64_tr_b16 v[34:35], v20 offset:17408
  v_add_u32 v227, 65536, v11
  v_mfma_f32_16x16x32_bf16 v[164:167], v[68:71], a[140:143], 0
  ds_read_b64_tr_b16 v[36:37], v20 offset:18432
  buffer_load_dwordx4 a[64:67], v19, s[8:11], s44 offen sc1
  v_mfma_f32_16x16x32_bf16 v[164:167], v[64:67], a[132:135], v[164:167]
  s_waitcnt lgkmcnt(11)
  s_add_u32 s45, s1, 32768
  ds_read_b64_tr_b16 v[38:39], v20 offset:19456
  v_add_u32 v228, 65536, v12
  v_mfma_f32_16x16x32_bf16 v[172:175], v[72:75], a[132:135], 0
  ds_read_b64_tr_b16 v[40:41], v21 offset:16384
  buffer_load_dwordx4 a[68:71], v19, s[8:11], s45 offen sc1
  v_mfma_f32_16x16x32_bf16 v[172:175], v[76:79], a[140:143], v[172:175]
  ds_read_b64_tr_b16 v[42:43], v21 offset:17408
  v_add_u32 v229, 65536, v13
  v_mfma_f32_16x16x32_bf16 v[168:171], v[76:79], a[136:139], 0
  s_add_u32 s44, s1, 1024
  ds_read_b64_tr_b16 v[44:45], v21 offset:18432
  v_lshrrev_b32 v28, 5, v1
  v_mfma_f32_16x16x32_bf16 v[168:171], v[72:75], a[128:131], v[168:171]
  s_waitcnt lgkmcnt(11)
  ds_read_b64_tr_b16 v[46:47], v21 offset:19456
  buffer_load_dwordx4 a[72:75], v19, s[8:11], s44 offen sc1
  v_mfma_f32_16x16x32_bf16 v[176:179], v[80:83], a[128:131], 0
  s_add_u32 s45, s1, 33792
  ds_read_b64_tr_b16 v[48:49], v22 offset:16384
  v_lshrrev_b32 v29, 6, v0
  v_mfma_f32_16x16x32_bf16 v[176:179], v[84:87], a[136:139], v[176:179]
  ds_read_b64_tr_b16 v[50:51], v22 offset:17408
  buffer_load_dwordx4 a[76:79], v19, s[8:11], s45 offen sc1
  v_mfma_f32_16x16x32_bf16 v[180:183], v[84:87], a[140:143], 0
  ds_read_b64_tr_b16 v[52:53], v22 offset:18432
  v_lshlrev_b32 v96, 10, v28
  v_mfma_f32_16x16x32_bf16 v[180:183], v[80:83], a[132:135], v[180:183]
  s_waitcnt lgkmcnt(11)
  ds_read_b64_tr_b16 v[54:55], v22 offset:19456
  v_lshl_add_u32 v96, v31, 8, v96
  v_mfma_f32_16x16x32_bf16 v[188:191], v[88:91], a[132:135], 0
  ds_read_b64_tr_b16 v[56:57], v23 offset:16384
  buffer_load_dwordx4 v[104:107], v19, s[16:19], s41 offen offset:0
  v_mfma_f32_16x16x32_bf16 v[188:191], v[92:95], a[140:143], v[188:191]
  ds_read_b64_tr_b16 v[58:59], v23 offset:17408
  v_lshl_add_u32 v96, v30, 4, v96
  v_mfma_f32_16x16x32_bf16 v[184:187], v[92:95], a[136:139], 0
  ds_read_b64_tr_b16 v[60:61], v23 offset:18432
  buffer_load_dwordx4 v[108:111], v19, s[16:19], s41 offen offset:1024
  v_mfma_f32_16x16x32_bf16 v[184:187], v[88:91], a[128:131], v[184:187]
  s_waitcnt lgkmcnt(11)
  ds_read_b64_tr_b16 v[62:63], v23 offset:19456
  v_add_u32 v96, s43, v96
  v_mfma_f32_16x16x32_bf16 v[128:131], v[32:35], a[144:147], v[128:131]
L_attn_st11:
  s_cbranch_vccnz L_attn_walkdone1
  ds_read_b64_tr_b16 v[64:65], v24 offset:16384
  v_lshlrev_b32 v97, 10, v30
  v_mfma_f32_16x16x32_bf16 v[128:131], v[36:39], a[152:155], v[128:131]
  s_add_u32 s44, s1, 2048
  ds_read_b64_tr_b16 v[66:67], v24 offset:17408
  v_add_u32 v97, 122880, v97
  v_mfma_f32_16x16x32_bf16 v[132:135], v[36:39], a[156:159], v[132:135]
  ds_read_b64_tr_b16 v[68:69], v24 offset:18432
  buffer_load_dwordx4 a[80:83], v19, s[8:11], s44 offen sc1
  v_mfma_f32_16x16x32_bf16 v[132:135], v[32:35], a[148:151], v[132:135]
  s_waitcnt lgkmcnt(11)
  ds_read_b64_tr_b16 v[70:71], v24 offset:19456
  v_lshl_add_u32 v97, v28, 6, v97
  v_mfma_f32_16x16x32_bf16 v[140:143], v[40:43], a[148:151], v[140:143]
  ds_read_b64_tr_b16 v[72:73], v25 offset:16384
  v_lshl_add_u32 v97, v31, 3, v97
  v_mfma_f32_16x16x32_bf16 v[140:143], v[44:47], a[156:159], v[140:143]
  ds_read_b64_tr_b16 v[74:75], v25 offset:17408
  v_lshl_add_u32 v97, v29, 8, v97
  v_mfma_f32_16x16x32_bf16 v[136:139], v[44:47], a[152:155], v[136:139]
  ds_read_b64_tr_b16 v[76:77], v25 offset:18432
  v_lshlrev_b32 v2, 5, v30
  v_mfma_f32_16x16x32_bf16 v[136:139], v[40:43], a[144:147], v[136:139]
  s_waitcnt lgkmcnt(11)
  ds_read_b64_tr_b16 v[78:79], v25 offset:19456
  v_xor_b32 v97, v97, v2
  v_mfma_f32_16x16x32_bf16 v[144:147], v[48:51], a[144:147], v[144:147]
  s_add_u32 s45, s1, 34816
  ds_read_b64_tr_b16 v[80:81], v26 offset:16384
  v_lshlrev_b32 v98, 7, v28
  v_mfma_f32_16x16x32_bf16 v[144:147], v[52:55], a[152:155], v[144:147]
  ds_read_b64_tr_b16 v[82:83], v26 offset:17408
  buffer_load_dwordx4 a[84:87], v19, s[8:11], s45 offen sc1
  v_mfma_f32_16x16x32_bf16 v[148:151], v[52:55], a[156:159], v[148:151]
  ds_read_b64_tr_b16 v[84:85], v26 offset:18432
  v_lshl_add_u32 v98, v31, 4, v98
  v_mfma_f32_16x16x32_bf16 v[148:151], v[48:51], a[148:151], v[148:151]
  s_waitcnt lgkmcnt(11)
  ds_read_b64_tr_b16 v[86:87], v26 offset:19456
  v_lshl_add_u32 v98, v29, 9, v98
  v_mfma_f32_16x16x32_bf16 v[156:159], v[56:59], a[148:151], v[156:159]
  ds_read_b64_tr_b16 v[88:89], v27 offset:16384
  v_mfma_f32_16x16x32_bf16 v[156:159], v[60:63], a[156:159], v[156:159]
  ds_read_b64_tr_b16 v[90:91], v27 offset:17408
  v_mfma_f32_16x16x32_bf16 v[152:155], v[60:63], a[152:155], v[152:155]
  ds_read_b64_tr_b16 v[92:93], v27 offset:18432
  v_mfma_f32_16x16x32_bf16 v[152:155], v[56:59], a[144:147], v[152:155]
  s_waitcnt lgkmcnt(11)
  ds_read_b64_tr_b16 v[94:95], v27 offset:19456
  v_mfma_f32_16x16x32_bf16 v[160:163], v[64:67], a[144:147], v[160:163]
  s_barrier
  ds_read_b64_tr_b16 v[32:33], v20 offset:32768
  v_and_b32 v2, 1, v30
  v_mfma_f32_16x16x32_bf16 v[160:163], v[68:71], a[152:155], v[160:163]
  s_add_u32 s39, s39, 0x20000
  s_cmp_eq_u32 s39, s0
  s_cselect_b32 s34, 0x20000, 0
  s_add_u32 s39, s39, s34
  s_add_u32 s34, s39, 0
  s_add_u32 m0, s43, 0
  ds_read_b64_tr_b16 v[34:35], v20 offset:33792
  v_bfe_u32 v3, v30, 1, 1
  v_mfma_f32_16x16x32_bf16 v[164:167], v[68:71], a[156:159], v[164:167]
  ds_read_b64_tr_b16 v[36:37], v20 offset:34816
  buffer_load_dwordx4 v18, s[52:55], s34 offen offset:0 lds
  v_mfma_f32_16x16x32_bf16 v[164:167], v[64:67], a[148:151], v[164:167]
  s_waitcnt lgkmcnt(11)
  ds_read_b64_tr_b16 v[38:39], v20 offset:35840
  v_mul_u32_u24 v100, 448, v2
  v_mfma_f32_16x16x32_bf16 v[172:175], v[72:75], a[148:151], v[172:175]
  s_add_u32 s44, s1, 3072
  ds_read_b64_tr_b16 v[40:41], v21 offset:32768
  v_mul_u32_u24 v3, 3968, v3
  v_mfma_f32_16x16x32_bf16 v[172:175], v[76:79], a[156:159], v[172:175]
  ds_read_b64_tr_b16 v[42:43], v21 offset:33792
  buffer_load_dwordx4 a[88:91], v19, s[8:11], s44 offen sc1
  v_mfma_f32_16x16x32_bf16 v[168:171], v[76:79], a[152:155], v[168:171]
  ds_read_b64_tr_b16 v[44:45], v21 offset:34816
  v_lshrrev_b32 v2, 2, v30
  v_mfma_f32_16x16x32_bf16 v[168:171], v[72:75], a[144:147], v[168:171]
  s_waitcnt lgkmcnt(11)
  s_add_u32 s35, s39, 15360
  ds_read_b64_tr_b16 v[46:47], v21 offset:35840
  v_lshl_add_u32 v3, v2, 5, v3
  v_mfma_f32_16x16x32_bf16 v[176:179], v[80:83], a[144:147], v[176:179]
  s_add_u32 m0, s43, 0
  ds_read_b64_tr_b16 v[48:49], v22 offset:32768
  v_add_u32 v100, v100, v3
  v_mfma_f32_16x16x32_bf16 v[176:179], v[84:87], a[152:155], v[176:179]
  ds_read_b64_tr_b16 v[50:51], v22 offset:33792
  buffer_load_dwordx4 v18, s[52:55], s35 offen offset:1024 lds
  v_mfma_f32_16x16x32_bf16 v[180:183], v[84:87], a[156:159], v[180:183]
  ds_read_b64_tr_b16 v[52:53], v22 offset:34816
  v_add_u32 v100, 131264, v100
  v_mfma_f32_16x16x32_bf16 v[180:183], v[80:83], a[148:151], v[180:183]
  s_waitcnt lgkmcnt(11)
  ds_read_b64_tr_b16 v[54:55], v22 offset:35840
  v_lshl_add_u32 v99, v29, 2, v100
  v_mfma_f32_16x16x32_bf16 v[188:191], v[88:91], a[148:151], v[188:191]
  s_add_u32 s45, s1, 35840
  ds_read_b64_tr_b16 v[56:57], v23 offset:32768
  v_and_b32 v2, 3, v1
  v_mfma_f32_16x16x32_bf16 v[188:191], v[92:95], a[156:159], v[188:191]
  ds_read_b64_tr_b16 v[58:59], v23 offset:33792
  buffer_load_dwordx4 a[92:95], v19, s[8:11], s45 offen sc1
  v_mfma_f32_16x16x32_bf16 v[184:187], v[92:95], a[152:155], v[184:187]
  ds_read_b64_tr_b16 v[60:61], v23 offset:34816
  v_mfma_f32_16x16x32_bf16 v[184:187], v[88:91], a[144:147], v[184:187]
  s_waitcnt vmcnt(16) lgkmcnt(11)
  ds_read_b64_tr_b16 v[62:63], v23 offset:35840
  v_mfma_f32_16x16x32_bf16 v[128:131], v[32:35], a[32:35], v[128:131]
  ds_read_b64_tr_b16 v[64:65], v24 offset:32768
  v_lshlrev_b32 v2, 1, v2
  v_mfma_f32_16x16x32_bf16 v[128:131], v[36:39], a[40:43], v[128:131]
  s_add_u32 s36, s39, 30720
  s_add_u32 m0, s43, 0
  ds_read_b64_tr_b16 v[66:67], v24 offset:33792
  v_lshl_add_u32 v2, v29, 3, v2
  v_mfma_f32_16x16x32_bf16 v[132:135], v[36:39], a[44:47], v[132:135]
  ds_read_b64_tr_b16 v[68:69], v24 offset:34816
  buffer_load_dwordx4 v18, s[52:55], s36 offen offset:2048 lds
  v_mfma_f32_16x16x32_bf16 v[132:135], v[32:35], a[36:39], v[132:135]
  s_waitcnt lgkmcnt(11)
  ds_read_b64_tr_b16 v[70:71], v24 offset:35840
  v_lshrrev_b32_e64 v3, 3, s29
  v_mfma_f32_16x16x32_bf16 v[140:143], v[40:43], a[36:39], v[140:143]
  s_add_u32 s1, s1, 4096
  s_cmp_eq_u32 s1, s69
  s_cselect_b32 s44, 4096, 0
  s_add_u32 s1, s1, s44
  s_add_u32 s44, s1, 0
  ds_read_b64_tr_b16 v[72:73], v25 offset:32768
  v_add_u32 v2, v2, v3
  v_mfma_f32_16x16x32_bf16 v[140:143], v[44:47], a[44:47], v[140:143]
  ds_read_b64_tr_b16 v[74:75], v25 offset:33792
  buffer_load_dwordx4 a[96:99], v19, s[8:11], s44 offen sc1
  v_mfma_f32_16x16x32_bf16 v[136:139], v[44:47], a[40:43], v[136:139]
  ds_read_b64_tr_b16 v[76:77], v25 offset:34816
  v_and_b32_e64 v3, s29, 7
  v_mfma_f32_16x16x32_bf16 v[136:139], v[40:43], a[32:35], v[136:139]
  s_waitcnt lgkmcnt(11)
  s_add_u32 s37, s39, 46080
  ds_read_b64_tr_b16 v[78:79], v25 offset:35840
  v_lshl_add_u32 v2, v3, 5, v2
  v_mfma_f32_16x16x32_bf16 v[144:147], v[48:51], a[32:35], v[144:147]
  s_add_u32 m0, s43, 0
  ds_read_b64_tr_b16 v[80:81], v26 offset:32768
  v_lshlrev_b32 v101, 7, v2
  v_mfma_f32_16x16x32_bf16 v[144:147], v[52:55], a[40:43], v[144:147]
  ds_read_b64_tr_b16 v[82:83], v26 offset:33792
  buffer_load_dwordx4 v18, s[52:55], s37 offen offset:3072 lds
  v_mfma_f32_16x16x32_bf16 v[148:151], v[52:55], a[44:47], v[148:151]
  ds_read_b64_tr_b16 v[84:85], v26 offset:34816
  v_and_b32 v2, 15, v1
  v_mfma_f32_16x16x32_bf16 v[148:151], v[48:51], a[36:39], v[148:151]
  s_waitcnt lgkmcnt(11)
  ds_read_b64_tr_b16 v[86:87], v26 offset:35840
  v_mov_b32 v3, 0x87
  v_mfma_f32_16x16x32_bf16 v[156:159], v[56:59], a[36:39], v[156:159]
  s_add_u32 s45, s1, 32768
  ds_read_b64_tr_b16 v[88:89], v27 offset:32768
  v_and_b32 v3, s2, v3
  v_mfma_f32_16x16x32_bf16 v[156:159], v[60:63], a[44:47], v[156:159]
  ds_read_b64_tr_b16 v[90:91], v27 offset:33792
  buffer_load_dwordx4 a[100:103], v19, s[8:11], s45 offen sc1
  v_mfma_f32_16x16x32_bf16 v[152:155], v[60:63], a[40:43], v[152:155]
  ds_read_b64_tr_b16 v[92:93], v27 offset:34816
  v_mfma_f32_16x16x32_bf16 v[152:155], v[56:59], a[32:35], v[152:155]
  s_waitcnt vmcnt(20) lgkmcnt(11)
  ds_read_b64_tr_b16 v[94:95], v27 offset:35840
  v_mfma_f32_16x16x32_bf16 v[160:163], v[64:67], a[32:35], v[160:163]
  ds_read_b64_tr_b16 v[32:33], v20 offset:49152
  v_lshl_or_b32 v2, v2, 3, v3
  v_mfma_f32_16x16x32_bf16 v[160:163], v[68:71], a[40:43], v[160:163]
  s_add_u32 s44, s1, 1024
  ds_read_b64_tr_b16 v[34:35], v20 offset:50176
  v_lshlrev_b32 v102, 7, v2
  v_mfma_f32_16x16x32_bf16 v[164:167], v[68:71], a[44:47], v[164:167]
  ds_read_b64_tr_b16 v[36:37], v20 offset:51200
  buffer_load_dwordx4 a[104:107], v19, s[8:11], s44 offen sc1
  v_mfma_f32_16x16x32_bf16 v[164:167], v[64:67], a[36:39], v[164:167]
  s_waitcnt lgkmcnt(11)
  ds_read_b64_tr_b16 v[38:39], v20 offset:52224
  v_lshrrev_b32 v2, 4, v1
  v_mfma_f32_16x16x32_bf16 v[172:175], v[72:75], a[36:39], v[172:175]
  ds_read_b64_tr_b16 v[40:41], v21 offset:49152
  v_lshlrev_b32 v2, 1, v2
  v_mfma_f32_16x16x32_bf16 v[172:175], v[76:79], a[44:47], v[172:175]
  ds_read_b64_tr_b16 v[42:43], v21 offset:50176
  v_and_b32 v3, 7, v1
  v_mfma_f32_16x16x32_bf16 v[168:171], v[76:79], a[40:43], v[168:171]
  s_add_u32 s45, s1, 33792
  ds_read_b64_tr_b16 v[44:45], v21 offset:51200
  v_xor_b32 v2, v2, v3
  v_mfma_f32_16x16x32_bf16 v[168:171], v[72:75], a[32:35], v[168:171]
  s_waitcnt lgkmcnt(11)
  ds_read_b64_tr_b16 v[46:47], v21 offset:52224
  buffer_load_dwordx4 a[108:111], v19, s[8:11], s45 offen sc1
  v_mfma_f32_16x16x32_bf16 v[176:179], v[80:83], a[32:35], v[176:179]
  ds_read_b64_tr_b16 v[48:49], v22 offset:49152
  v_lshrrev_b32 v3, 3, v1
  v_mfma_f32_16x16x32_bf16 v[176:179], v[84:87], a[40:43], v[176:179]
  ds_read_b64_tr_b16 v[50:51], v22 offset:50176
  v_lshlrev_b32 v3, 10, v3
  v_mfma_f32_16x16x32_bf16 v[180:183], v[84:87], a[44:47], v[180:183]
  ds_read_b64_tr_b16 v[52:53], v22 offset:51200
  v_lshl_add_u32 v232, v2, 4, v3
  v_mfma_f32_16x16x32_bf16 v[180:183], v[80:83], a[36:39], v[180:183]
  s_waitcnt lgkmcnt(11)
  s_mov_b32 s30, 131072
  ds_read_b64_tr_b16 v[54:55], v22 offset:52224
  v_add_u32 v233, 7168, v232
  v_mfma_f32_16x16x32_bf16 v[188:191], v[88:91], a[36:39], v[188:191]
  ds_read_b64_tr_b16 v[56:57], v23 offset:49152
  buffer_load_dword v7, v103, s[64:67], s30 offen sc1
  v_mfma_f32_16x16x32_bf16 v[188:191], v[92:95], a[44:47], v[188:191]
  ds_read_b64_tr_b16 v[58:59], v23 offset:50176
  v_mfma_f32_16x16x32_bf16 v[184:187], v[92:95], a[40:43], v[184:187]
  ds_read_b64_tr_b16 v[60:61], v23 offset:51200
  v_mfma_f32_16x16x32_bf16 v[184:187], v[88:91], a[32:35], v[184:187]
  s_waitcnt vmcnt(19) lgkmcnt(11)
  ds_read_b64_tr_b16 v[62:63], v23 offset:52224
  v_mfma_f32_16x16x32_bf16 v[128:131], v[32:35], a[48:51], v[128:131]
  ds_read_b64_tr_b16 v[64:65], v24 offset:49152
  v_add_u32 v234, 14336, v232
  v_mfma_f32_16x16x32_bf16 v[128:131], v[36:39], a[56:59], v[128:131]
  s_add_u32 s44, s1, 2048
  ds_read_b64_tr_b16 v[66:67], v24 offset:50176
  v_add_u32 v235, 21504, v232
  v_mfma_f32_16x16x32_bf16 v[132:135], v[36:39], a[60:63], v[132:135]
  ds_read_b64_tr_b16 v[68:69], v24 offset:51200
  buffer_load_dwordx4 a[112:115], v19, s[8:11], s44 offen sc1
  v_mfma_f32_16x16x32_bf16 v[132:135], v[32:35], a[52:55], v[132:135]
  s_waitcnt lgkmcnt(11)
  ds_read_b64_tr_b16 v[70:71], v24 offset:52224
  v_lshrrev_b32 v3, 2, v1
  v_mfma_f32_16x16x32_bf16 v[140:143], v[40:43], a[52:55], v[140:143]
  ds_read_b64_tr_b16 v[72:73], v25 offset:49152
  v_bfe_u32 v2, v3, 1, 2
  v_mfma_f32_16x16x32_bf16 v[140:143], v[44:47], a[60:63], v[140:143]
  ds_read_b64_tr_b16 v[74:75], v25 offset:50176
  v_lshlrev_b32 v3, 7, v3
  v_mfma_f32_16x16x32_bf16 v[136:139], v[44:47], a[56:59], v[136:139]
  ds_read_b64_tr_b16 v[76:77], v25 offset:51200
  v_lshl_add_u32 v3, v2, 5, v3
  v_mfma_f32_16x16x32_bf16 v[136:139], v[40:43], a[48:51], v[136:139]
  s_waitcnt lgkmcnt(11)
  ds_read_b64_tr_b16 v[78:79], v25 offset:52224
  v_and_b32 v2, 3, v1
  v_mfma_f32_16x16x32_bf16 v[144:147], v[48:51], a[48:51], v[144:147]
  s_add_u32 s45, s1, 34816
  ds_read_b64_tr_b16 v[80:81], v26 offset:49152
  v_lshl_add_u32 v3, v2, 3, v3
  v_mfma_f32_16x16x32_bf16 v[144:147], v[52:55], a[56:59], v[144:147]
  ds_read_b64_tr_b16 v[82:83], v26 offset:50176
  buffer_load_dwordx4 a[116:119], v19, s[8:11], s45 offen sc1
  v_mfma_f32_16x16x32_bf16 v[148:151], v[52:55], a[60:63], v[148:151]
  ds_read_b64_tr_b16 v[84:85], v26 offset:51200
  v_add_u32 v236, s43, v3
  v_mfma_f32_16x16x32_bf16 v[148:151], v[48:51], a[52:55], v[148:151]
  s_waitcnt lgkmcnt(11)
  ds_read_b64_tr_b16 v[86:87], v26 offset:52224
  v_xor_b32 v237, 32, v236
  v_mfma_f32_16x16x32_bf16 v[156:159], v[56:59], a[52:55], v[156:159]
  ds_read_b64_tr_b16 v[88:89], v27 offset:49152
  v_mfma_f32_16x16x32_bf16 v[156:159], v[60:63], a[60:63], v[156:159]
  ds_read_b64_tr_b16 v[90:91], v27 offset:50176
  v_mfma_f32_16x16x32_bf16 v[152:155], v[60:63], a[56:59], v[152:155]
  ds_read_b64_tr_b16 v[92:93], v27 offset:51200
  v_mfma_f32_16x16x32_bf16 v[152:155], v[56:59], a[48:51], v[152:155]
  s_waitcnt vmcnt(21) lgkmcnt(11)
  ds_read_b64_tr_b16 v[94:95], v27 offset:52224
  v_mfma_f32_16x16x32_bf16 v[160:163], v[64:67], a[48:51], v[160:163]
  s_barrier
  ds_read_b64_tr_b16 v[32:33], v8 offset:0
  v_xor_b32 v238, 64, v236
  v_mfma_f32_16x16x32_bf16 v[160:163], v[68:71], a[56:59], v[160:163]
  s_add_u32 s34, s39, 65536
  s_add_u32 m0, s43, 16384
  ds_read_b64_tr_b16 v[34:35], v8 offset:1024
  v_xor_b32 v239, 96, v236
  v_mfma_f32_16x16x32_bf16 v[164:167], v[68:71], a[60:63], v[164:167]
  ds_read_b64_tr_b16 v[36:37], v8 offset:2048
  buffer_load_dwordx4 v18, s[52:55], s34 offen offset:0 lds
  v_mfma_f32_16x16x32_bf16 v[164:167], v[64:67], a[52:55], v[164:167]
  s_waitcnt lgkmcnt(11)
  ds_read_b64_tr_b16 v[38:39], v8 offset:3072
  v_add_u32 v240, 65536, v236
  v_mfma_f32_16x16x32_bf16 v[172:175], v[72:75], a[52:55], v[172:175]
  s_add_u32 s44, s1, 3072
  ds_read_b64_tr_b16 v[40:41], v9 offset:0
  v_add_u32 v241, 65536, v237
  v_mfma_f32_16x16x32_bf16 v[172:175], v[76:79], a[60:63], v[172:175]
  ds_read_b64_tr_b16 v[42:43], v9 offset:1024
  buffer_load_dwordx4 a[120:123], v19, s[8:11], s44 offen sc1
  v_mfma_f32_16x16x32_bf16 v[168:171], v[76:79], a[56:59], v[168:171]
  ds_read_b64_tr_b16 v[44:45], v9 offset:2048
  v_add_u32 v242, 65536, v238
  v_mfma_f32_16x16x32_bf16 v[168:171], v[72:75], a[48:51], v[168:171]
  s_waitcnt lgkmcnt(11)
  s_add_u32 s35, s39, 80896
  ds_read_b64_tr_b16 v[46:47], v9 offset:3072
  v_add_u32 v243, 65536, v239
  v_mfma_f32_16x16x32_bf16 v[176:179], v[80:83], a[48:51], v[176:179]
  s_add_u32 m0, s43, 16384
  ds_read_b64_tr_b16 v[48:49], v10 offset:0
  v_add_u32 v244, 131072, v236
  v_mfma_f32_16x16x32_bf16 v[176:179], v[84:87], a[56:59], v[176:179]
  ds_read_b64_tr_b16 v[50:51], v10 offset:1024
  buffer_load_dwordx4 v18, s[52:55], s35 offen offset:1024 lds
  v_mfma_f32_16x16x32_bf16 v[180:183], v[84:87], a[60:63], v[180:183]
  ds_read_b64_tr_b16 v[52:53], v10 offset:2048
  v_add_u32 v245, 131072, v237
  v_mfma_f32_16x16x32_bf16 v[180:183], v[80:83], a[52:55], v[180:183]
  s_waitcnt lgkmcnt(11)
  ds_read_b64_tr_b16 v[54:55], v10 offset:3072
  v_add_u32 v246, 131072, v238
  v_mfma_f32_16x16x32_bf16 v[188:191], v[88:91], a[52:55], v[188:191]
  s_add_u32 s45, s1, 35840
  ds_read_b64_tr_b16 v[56:57], v11 offset:0
  v_add_u32 v247, 131072, v239
  v_mfma_f32_16x16x32_bf16 v[188:191], v[92:95], a[60:63], v[188:191]
  ds_read_b64_tr_b16 v[58:59], v11 offset:1024
  buffer_load_dwordx4 a[124:127], v19, s[8:11], s45 offen sc1
  v_mfma_f32_16x16x32_bf16 v[184:187], v[92:95], a[56:59], v[184:187]
  ds_read_b64_tr_b16 v[60:61], v11 offset:2048
  v_mfma_f32_16x16x32_bf16 v[184:187], v[88:91], a[48:51], v[184:187]
  s_waitcnt vmcnt(21) lgkmcnt(11)
  ds_read_b64_tr_b16 v[62:63], v11 offset:3072
  v_mfma_f32_16x16x32_bf16 v[128:131], v[32:35], a[64:67], v[128:131]
  ds_read_b64_tr_b16 v[64:65], v12 offset:0
  v_and_b32 v16, 48, v1
  v_mfma_f32_16x16x32_bf16 v[128:131], v[36:39], a[72:75], v[128:131]
  s_add_u32 s36, s39, 96256
  s_add_u32 m0, s43, 16384
  ds_read_b64_tr_b16 v[66:67], v12 offset:1024
  v_mfma_f32_16x16x32_bf16 v[132:135], v[36:39], a[76:79], v[132:135]
  ds_read_b64_tr_b16 v[68:69], v12 offset:2048
  buffer_load_dwordx4 v18, s[52:55], s36 offen offset:2048 lds
  v_mfma_f32_16x16x32_bf16 v[132:135], v[32:35], a[68:71], v[132:135]
  s_waitcnt lgkmcnt(11)
  ds_read_b64_tr_b16 v[70:71], v12 offset:3072
  v_mfma_f32_16x16x32_bf16 v[140:143], v[40:43], a[68:71], v[140:143]
  s_add_u32 s1, s1, 4096
  s_cmp_eq_u32 s1, s69
  s_cselect_b32 s44, 4096, 0
  s_add_u32 s1, s1, s44
  s_add_u32 s44, s1, 0
  ds_read_b64_tr_b16 v[72:73], v13 offset:0
  v_mfma_f32_16x16x32_bf16 v[140:143], v[44:47], a[76:79], v[140:143]
  ds_read_b64_tr_b16 v[74:75], v13 offset:1024
  buffer_load_dwordx4 a[128:131], v19, s[8:11], s44 offen sc1
  v_mfma_f32_16x16x32_bf16 v[136:139], v[44:47], a[72:75], v[136:139]
  ds_read_b64_tr_b16 v[76:77], v13 offset:2048
  v_mfma_f32_16x16x32_bf16 v[136:139], v[40:43], a[64:67], v[136:139]
  s_waitcnt lgkmcnt(11)
  s_add_u32 s37, s39, 111616
  ds_read_b64_tr_b16 v[78:79], v13 offset:3072
  v_mfma_f32_16x16x32_bf16 v[144:147], v[48:51], a[64:67], v[144:147]
  s_add_u32 m0, s43, 16384
  ds_read_b64_tr_b16 v[80:81], v14 offset:0
  v_mfma_f32_16x16x32_bf16 v[144:147], v[52:55], a[72:75], v[144:147]
  ds_read_b64_tr_b16 v[82:83], v14 offset:1024
  buffer_load_dwordx4 v18, s[52:55], s37 offen offset:3072 lds
  v_mfma_f32_16x16x32_bf16 v[148:151], v[52:55], a[76:79], v[148:151]
  ds_read_b64_tr_b16 v[84:85], v14 offset:2048
  v_mfma_f32_16x16x32_bf16 v[148:151], v[48:51], a[68:71], v[148:151]
  s_waitcnt lgkmcnt(11)
  ds_read_b64_tr_b16 v[86:87], v14 offset:3072
  v_mfma_f32_16x16x32_bf16 v[156:159], v[56:59], a[68:71], v[156:159]
  s_add_u32 s45, s1, 32768
  ds_read_b64_tr_b16 v[88:89], v15 offset:0
  v_mfma_f32_16x16x32_bf16 v[156:159], v[60:63], a[76:79], v[156:159]
  ds_read_b64_tr_b16 v[90:91], v15 offset:1024
  buffer_load_dwordx4 a[132:135], v19, s[8:11], s45 offen sc1
  v_mfma_f32_16x16x32_bf16 v[152:155], v[60:63], a[72:75], v[152:155]
  ds_read_b64_tr_b16 v[92:93], v15 offset:2048
  v_mfma_f32_16x16x32_bf16 v[152:155], v[56:59], a[64:67], v[152:155]
  s_waitcnt vmcnt(25) lgkmcnt(11)
  ds_read_b64_tr_b16 v[94:95], v15 offset:3072
  v_mfma_f32_16x16x32_bf16 v[160:163], v[64:67], a[64:67], v[160:163]
  ds_read_b64_tr_b16 v[32:33], v8 offset:16384
  v_mfma_f32_16x16x32_bf16 v[160:163], v[68:71], a[72:75], v[160:163]
  s_add_u32 s39, s39, 0x20000
  s_cmp_eq_u32 s39, s0
  s_cselect_b32 s34, 0x20000, 0
  s_add_u32 s39, s39, s34
  s_add_u32 s34, s39, 0
  s_add_u32 m0, s43, 32768
  ds_read_b64_tr_b16 v[34:35], v8 offset:17408
  v_mfma_f32_16x16x32_bf16 v[164:167], v[68:71], a[76:79], v[164:167]
  ds_read_b64_tr_b16 v[36:37], v8 offset:18432
  buffer_load_dwordx4 v18, s[52:55], s34 offen offset:0 lds
  v_mfma_f32_16x16x32_bf16 v[164:167], v[64:67], a[68:71], v[164:167]
  s_waitcnt lgkmcnt(11)
  ds_read_b64_tr_b16 v[38:39], v8 offset:19456
  v_mfma_f32_16x16x32_bf16 v[172:175], v[72:75], a[68:71], v[172:175]
  s_add_u32 s44, s1, 1024
  ds_read_b64_tr_b16 v[40:41], v9 offset:16384
  v_mfma_f32_16x16x32_bf16 v[172:175], v[76:79], a[76:79], v[172:175]
  ds_read_b64_tr_b16 v[42:43], v9 offset:17408
  buffer_load_dwordx4 a[136:139], v19, s[8:11], s44 offen sc1
  v_mfma_f32_16x16x32_bf16 v[168:171], v[76:79], a[72:75], v[168:171]
  ds_read_b64_tr_b16 v[44:45], v9 offset:18432
  v_mfma_f32_16x16x32_bf16 v[168:171], v[72:75], a[64:67], v[168:171]
  s_waitcnt lgkmcnt(11)
  s_add_u32 s35, s39, 15360
  ds_read_b64_tr_b16 v[46:47], v9 offset:19456
  v_mfma_f32_16x16x32_bf16 v[176:179], v[80:83], a[64:67], v[176:179]
  s_add_u32 m0, s43, 32768
  ds_read_b64_tr_b16 v[48:49], v10 offset:16384
  v_mfma_f32_16x16x32_bf16 v[176:179], v[84:87], a[72:75], v[176:179]
  ds_read_b64_tr_b16 v[50:51], v10 offset:17408
  buffer_load_dwordx4 v18, s[52:55], s35 offen offset:1024 lds
  v_mfma_f32_16x16x32_bf16 v[180:183], v[84:87], a[76:79], v[180:183]
  ds_read_b64_tr_b16 v[52:53], v10 offset:18432
  v_mfma_f32_16x16x32_bf16 v[180:183], v[80:83], a[68:71], v[180:183]
  s_waitcnt lgkmcnt(11)
  ds_read_b64_tr_b16 v[54:55], v10 offset:19456
  v_mfma_f32_16x16x32_bf16 v[188:191], v[88:91], a[68:71], v[188:191]
  s_add_u32 s45, s1, 33792
  ds_read_b64_tr_b16 v[56:57], v11 offset:16384
  v_mfma_f32_16x16x32_bf16 v[188:191], v[92:95], a[76:79], v[188:191]
  ds_read_b64_tr_b16 v[58:59], v11 offset:17408
  buffer_load_dwordx4 a[140:143], v19, s[8:11], s45 offen sc1
  v_mfma_f32_16x16x32_bf16 v[184:187], v[92:95], a[72:75], v[184:187]
  ds_read_b64_tr_b16 v[60:61], v11 offset:18432
  v_mfma_f32_16x16x32_bf16 v[184:187], v[88:91], a[64:67], v[184:187]
  s_waitcnt vmcnt(21) lgkmcnt(11)
  ds_read_b64_tr_b16 v[62:63], v11 offset:19456
  v_mfma_f32_16x16x32_bf16 v[128:131], v[32:35], a[80:83], v[128:131]
  ds_read_b64_tr_b16 v[64:65], v12 offset:16384
  v_mfma_f32_16x16x32_bf16 v[128:131], v[36:39], a[88:91], v[128:131]
  s_add_u32 s36, s39, 30720
  s_add_u32 m0, s43, 32768
  ds_read_b64_tr_b16 v[66:67], v12 offset:17408
  v_mfma_f32_16x16x32_bf16 v[132:135], v[36:39], a[92:95], v[132:135]
  ds_read_b64_tr_b16 v[68:69], v12 offset:18432
  buffer_load_dwordx4 v18, s[52:55], s36 offen offset:2048 lds
  v_mfma_f32_16x16x32_bf16 v[132:135], v[32:35], a[84:87], v[132:135]
  s_waitcnt lgkmcnt(11)
  ds_read_b64_tr_b16 v[70:71], v12 offset:19456
  v_mfma_f32_16x16x32_bf16 v[140:143], v[40:43], a[84:87], v[140:143]
  s_add_u32 s44, s1, 2048
  ds_read_b64_tr_b16 v[72:73], v13 offset:16384
  v_mfma_f32_16x16x32_bf16 v[140:143], v[44:47], a[92:95], v[140:143]
  ds_read_b64_tr_b16 v[74:75], v13 offset:17408
  buffer_load_dwordx4 a[144:147], v19, s[8:11], s44 offen sc1
  v_mfma_f32_16x16x32_bf16 v[136:139], v[44:47], a[88:91], v[136:139]
  ds_read_b64_tr_b16 v[76:77], v13 offset:18432
  v_mfma_f32_16x16x32_bf16 v[136:139], v[40:43], a[80:83], v[136:139]
  s_waitcnt lgkmcnt(11)
  s_add_u32 s37, s39, 46080
  ds_read_b64_tr_b16 v[78:79], v13 offset:19456
  v_mfma_f32_16x16x32_bf16 v[144:147], v[48:51], a[80:83], v[144:147]
  s_add_u32 m0, s43, 32768
  ds_read_b64_tr_b16 v[80:81], v14 offset:16384
  v_mfma_f32_16x16x32_bf16 v[144:147], v[52:55], a[88:91], v[144:147]
  ds_read_b64_tr_b16 v[82:83], v14 offset:17408
  buffer_load_dwordx4 v18, s[52:55], s37 offen offset:3072 lds
  v_mfma_f32_16x16x32_bf16 v[148:151], v[52:55], a[92:95], v[148:151]
  ds_read_b64_tr_b16 v[84:85], v14 offset:18432
  v_mfma_f32_16x16x32_bf16 v[148:151], v[48:51], a[84:87], v[148:151]
  s_waitcnt lgkmcnt(11)
  ds_read_b64_tr_b16 v[86:87], v14 offset:19456
  v_mfma_f32_16x16x32_bf16 v[156:159], v[56:59], a[84:87], v[156:159]
  s_add_u32 s45, s1, 34816
  ds_read_b64_tr_b16 v[88:89], v15 offset:16384
  v_mfma_f32_16x16x32_bf16 v[156:159], v[60:63], a[92:95], v[156:159]
  ds_read_b64_tr_b16 v[90:91], v15 offset:17408
  buffer_load_dwordx4 a[148:151], v19, s[8:11], s45 offen sc1
  v_mfma_f32_16x16x32_bf16 v[152:155], v[60:63], a[88:91], v[152:155]
  ds_read_b64_tr_b16 v[92:93], v15 offset:18432
  v_mfma_f32_16x16x32_bf16 v[152:155], v[56:59], a[80:83], v[152:155]
  s_waitcnt vmcnt(25) lgkmcnt(11)
  ds_read_b64_tr_b16 v[94:95], v15 offset:19456
  v_mfma_f32_16x16x32_bf16 v[160:163], v[64:67], a[80:83], v[160:163]
  s_barrier
  ds_read_b64_tr_b16 v[32:33], v8 offset:32768
  v_mfma_f32_16x16x32_bf16 v[160:163], v[68:71], a[88:91], v[160:163]
  s_add_u32 s34, s39, 65536
  s_add_u32 m0, s43, 49152
  ds_read_b64_tr_b16 v[34:35], v8 offset:33792
  v_mfma_f32_16x16x32_bf16 v[164:167], v[68:71], a[92:95], v[164:167]
  ds_read_b64_tr_b16 v[36:37], v8 offset:34816
  buffer_load_dwordx4 v18, s[52:55], s34 offen offset:0 lds
  v_mfma_f32_16x16x32_bf16 v[164:167], v[64:67], a[84:87], v[164:167]
  s_waitcnt lgkmcnt(11)
  ds_read_b64_tr_b16 v[38:39], v8 offset:35840
  v_mfma_f32_16x16x32_bf16 v[172:175], v[72:75], a[84:87], v[172:175]
  s_add_u32 s44, s1, 3072
  ds_read_b64_tr_b16 v[40:41], v9 offset:32768
  v_mfma_f32_16x16x32_bf16 v[172:175], v[76:79], a[92:95], v[172:175]
  ds_read_b64_tr_b16 v[42:43], v9 offset:33792
  buffer_load_dwordx4 a[152:155], v19, s[8:11], s44 offen sc1
  v_mfma_f32_16x16x32_bf16 v[168:171], v[76:79], a[88:91], v[168:171]
  ds_read_b64_tr_b16 v[44:45], v9 offset:34816
  v_mfma_f32_16x16x32_bf16 v[168:171], v[72:75], a[80:83], v[168:171]
  s_waitcnt lgkmcnt(11)
  s_add_u32 s35, s39, 80896
  ds_read_b64_tr_b16 v[46:47], v9 offset:35840
  v_mfma_f32_16x16x32_bf16 v[176:179], v[80:83], a[80:83], v[176:179]
  s_add_u32 m0, s43, 49152
  ds_read_b64_tr_b16 v[48:49], v10 offset:32768
  v_mfma_f32_16x16x32_bf16 v[176:179], v[84:87], a[88:91], v[176:179]
  ds_read_b64_tr_b16 v[50:51], v10 offset:33792
  buffer_load_dwordx4 v18, s[52:55], s35 offen offset:1024 lds
  v_mfma_f32_16x16x32_bf16 v[180:183], v[84:87], a[92:95], v[180:183]
  ds_read_b64_tr_b16 v[52:53], v10 offset:34816
  v_mfma_f32_16x16x32_bf16 v[180:183], v[80:83], a[84:87], v[180:183]
  s_waitcnt lgkmcnt(11)
  ds_read_b64_tr_b16 v[54:55], v10 offset:35840
  v_mfma_f32_16x16x32_bf16 v[188:191], v[88:91], a[84:87], v[188:191]
  s_add_u32 s45, s1, 35840
  s_waitcnt vmcnt(21)
  ds_read_b64_tr_b16 v[56:57], v11 offset:32768
  v_cmp_eq_u32 s[32:33], s68, v7
  v_mfma_f32_16x16x32_bf16 v[188:191], v[92:95], a[92:95], v[188:191]
  ds_read_b64_tr_b16 v[58:59], v11 offset:33792
  buffer_load_dwordx4 a[156:159], v19, s[8:11], s45 offen sc1
  v_mfma_f32_16x16x32_bf16 v[184:187], v[92:95], a[88:91], v[184:187]
  s_cmp_eq_u64 s[32:33], -1
  s_cbranch_scc0 L_spinM
L_spinM_x:
  ds_read_b64_tr_b16 v[60:61], v11 offset:34816
  v_mfma_f32_16x16x32_bf16 v[184:187], v[88:91], a[80:83], v[184:187]
  s_waitcnt vmcnt(23) lgkmcnt(11)
  ds_read_b64_tr_b16 v[62:63], v11 offset:35840
  v_mfma_f32_16x16x32_bf16 v[128:131], v[32:35], a[96:99], v[128:131]
  ds_read_b64_tr_b16 v[64:65], v12 offset:32768
  v_mfma_f32_16x16x32_bf16 v[128:131], v[36:39], a[104:107], v[128:131]
  s_add_u32 s36, s39, 96256
  s_add_u32 m0, s43, 49152
  ds_read_b64_tr_b16 v[66:67], v12 offset:33792
  v_mfma_f32_16x16x32_bf16 v[132:135], v[36:39], a[108:111], v[132:135]
  ds_read_b64_tr_b16 v[68:69], v12 offset:34816
  buffer_load_dwordx4 v18, s[52:55], s36 offen offset:2048 lds
  v_mfma_f32_16x16x32_bf16 v[132:135], v[32:35], a[100:103], v[132:135]
  s_waitcnt lgkmcnt(11)
  ds_read_b64_tr_b16 v[70:71], v12 offset:35840
  v_mfma_f32_16x16x32_bf16 v[140:143], v[40:43], a[100:103], v[140:143]
  s_add_u32 s1, s1, 4096
  s_cmp_eq_u32 s1, s69
  s_cselect_b32 s44, 4096, 0
  s_add_u32 s1, s1, s44
  s_add_u32 s44, s1, 0
  ds_read_b64_tr_b16 v[72:73], v13 offset:32768
  v_mfma_f32_16x16x32_bf16 v[140:143], v[44:47], a[108:111], v[140:143]
  ds_read_b64_tr_b16 v[74:75], v13 offset:33792
  buffer_load_dwordx4 a[160:163], v19, s[8:11], s44 offen sc1
  v_mfma_f32_16x16x32_bf16 v[136:139], v[44:47], a[104:107], v[136:139]
  s_add_u32 s37, s39, 111616
  ds_read_b64_tr_b16 v[76:77], v13 offset:34816
  v_mfma_f32_16x16x32_bf16 v[136:139], v[40:43], a[96:99], v[136:139]
L_attn_st12:
  s_cbranch_vccnz L_attn_walkdone1
  s_waitcnt lgkmcnt(11)
  s_add_u32 m0, s43, 49152
  ds_read_b64_tr_b16 v[78:79], v13 offset:35840
  v_mfma_f32_16x16x32_bf16 v[144:147], v[48:51], a[96:99], v[144:147]
  ds_read_b64_tr_b16 v[80:81], v14 offset:32768
  buffer_load_dwordx4 v18, s[52:55], s37 offen offset:3072 lds
  v_mfma_f32_16x16x32_bf16 v[144:147], v[52:55], a[104:107], v[144:147]
  ds_read_b64_tr_b16 v[82:83], v14 offset:33792
  v_mfma_f32_16x16x32_bf16 v[148:151], v[52:55], a[108:111], v[148:151]
  s_add_u32 s45, s1, 32768
  ds_read_b64_tr_b16 v[84:85], v14 offset:34816
  v_mfma_f32_16x16x32_bf16 v[148:151], v[48:51], a[100:103], v[148:151]
  s_waitcnt lgkmcnt(11)
  ds_read_b64_tr_b16 v[86:87], v14 offset:35840
  buffer_load_dwordx4 a[164:167], v19, s[8:11], s45 offen sc1
  v_mfma_f32_16x16x32_bf16 v[156:159], v[56:59], a[100:103], v[156:159]
  ds_read_b64_tr_b16 v[88:89], v15 offset:32768
  v_mfma_f32_16x16x32_bf16 v[156:159], v[60:63], a[108:111], v[156:159]
  s_add_u32 s30, s26, 0
  ds_read_b64_tr_b16 v[90:91], v15 offset:33792
  v_mfma_f32_16x16x32_bf16 v[152:155], v[60:63], a[104:107], v[152:155]
  ds_read_b64_tr_b16 v[92:93], v15 offset:34816
  buffer_load_dwordx4 v[192:195], v19, s[20:23], s30 offen offset:0 sc1
  v_mfma_f32_16x16x32_bf16 v[152:155], v[56:59], a[96:99], v[152:155]
  s_waitcnt vmcnt(28) lgkmcnt(11)
  ds_read_b64_tr_b16 v[94:95], v15 offset:35840
  v_mfma_f32_16x16x32_bf16 v[160:163], v[64:67], a[96:99], v[160:163]
  ds_read_b64_tr_b16 v[32:33], v8 offset:49152
  v_mfma_f32_16x16x32_bf16 v[160:163], v[68:71], a[104:107], v[160:163]
  s_add_u32 s39, s39, 0x20000
  s_cmp_eq_u32 s39, s0
  s_cselect_b32 s34, 0x20000, 0
  s_add_u32 s39, s39, s34
  s_add_u32 s34, s39, 0
  s_add_u32 m0, s43, 65536
  ds_read_b64_tr_b16 v[34:35], v8 offset:50176
  v_mfma_f32_16x16x32_bf16 v[164:167], v[68:71], a[108:111], v[164:167]
  ds_read_b64_tr_b16 v[36:37], v8 offset:51200
  buffer_load_dwordx4 v18, s[52:55], s34 offen offset:0 lds
  v_mfma_f32_16x16x32_bf16 v[164:167], v[64:67], a[100:103], v[164:167]
  s_waitcnt lgkmcnt(11)
  ds_read_b64_tr_b16 v[38:39], v8 offset:52224
  v_mfma_f32_16x16x32_bf16 v[172:175], v[72:75], a[100:103], v[172:175]
  s_add_u32 s44, s1, 1024
  ds_read_b64_tr_b16 v[40:41], v9 offset:49152
  v_mfma_f32_16x16x32_bf16 v[172:175], v[76:79], a[108:111], v[172:175]
  ds_read_b64_tr_b16 v[42:43], v9 offset:50176
  buffer_load_dwordx4 a[168:171], v19, s[8:11], s44 offen sc1
  v_mfma_f32_16x16x32_bf16 v[168:171], v[76:79], a[104:107], v[168:171]
  s_add_u32 s35, s39, 15360
  ds_read_b64_tr_b16 v[44:45], v9 offset:51200
  v_mfma_f32_16x16x32_bf16 v[168:171], v[72:75], a[96:99], v[168:171]
  s_waitcnt lgkmcnt(11)
  s_add_u32 m0, s43, 65536
  ds_read_b64_tr_b16 v[46:47], v9 offset:52224
  v_mfma_f32_16x16x32_bf16 v[176:179], v[80:83], a[96:99], v[176:179]
  ds_read_b64_tr_b16 v[48:49], v10 offset:49152
  buffer_load_dwordx4 v18, s[52:55], s35 offen offset:1024 lds
  v_mfma_f32_16x16x32_bf16 v[176:179], v[84:87], a[104:107], v[176:179]
  ds_read_b64_tr_b16 v[50:51], v10 offset:50176
  v_mfma_f32_16x16x32_bf16 v[180:183], v[84:87], a[108:111], v[180:183]
  s_add_u32 s45, s1, 33792
  ds_read_b64_tr_b16 v[52:53], v10 offset:51200
  v_mfma_f32_16x16x32_bf16 v[180:183], v[80:83], a[100:103], v[180:183]
  s_waitcnt lgkmcnt(11)
  ds_read_b64_tr_b16 v[54:55], v10 offset:52224
  buffer_load_dwordx4 a[172:175], v19, s[8:11], s45 offen sc1
  v_mfma_f32_16x16x32_bf16 v[188:191], v[88:91], a[100:103], v[188:191]
  ds_read_b64_tr_b16 v[56:57], v11 offset:49152
  v_mfma_f32_16x16x32_bf16 v[188:191], v[92:95], a[108:111], v[188:191]
  s_add_u32 s30, s26, 0
  ds_read_b64_tr_b16 v[58:59], v11 offset:50176
  v_mfma_f32_16x16x32_bf16 v[184:187], v[92:95], a[104:107], v[184:187]
  ds_read_b64_tr_b16 v[60:61], v11 offset:51200
  buffer_load_dwordx4 v[196:199], v19, s[20:23], s30 offen offset:1024 sc1
  v_mfma_f32_16x16x32_bf16 v[184:187], v[88:91], a[96:99], v[184:187]
  s_waitcnt vmcnt(26) lgkmcnt(11)
  ds_read_b64_tr_b16 v[62:63], v11 offset:52224
  v_mfma_f32_16x16x32_bf16 v[128:131], v[32:35], a[112:115], v[128:131]
  ds_read_b64_tr_b16 v[64:65], v12 offset:49152
  v_mfma_f32_16x16x32_bf16 v[128:131], v[36:39], a[120:123], v[128:131]
  s_add_u32 s36, s39, 30720
  s_add_u32 m0, s43, 65536
  ds_read_b64_tr_b16 v[66:67], v12 offset:50176
  v_mfma_f32_16x16x32_bf16 v[132:135], v[36:39], a[124:127], v[132:135]
  ds_read_b64_tr_b16 v[68:69], v12 offset:51200
  buffer_load_dwordx4 v18, s[52:55], s36 offen offset:2048 lds
  v_mfma_f32_16x16x32_bf16 v[132:135], v[32:35], a[116:119], v[132:135]
  s_waitcnt lgkmcnt(11)
  ds_read_b64_tr_b16 v[70:71], v12 offset:52224
  v_mfma_f32_16x16x32_bf16 v[140:143], v[40:43], a[116:119], v[140:143]
  s_add_u32 s44, s1, 2048
  ds_read_b64_tr_b16 v[72:73], v13 offset:49152
  v_mfma_f32_16x16x32_bf16 v[140:143], v[44:47], a[124:127], v[140:143]
  ds_read_b64_tr_b16 v[74:75], v13 offset:50176
  buffer_load_dwordx4 a[176:179], v19, s[8:11], s44 offen sc1
  v_mfma_f32_16x16x32_bf16 v[136:139], v[44:47], a[120:123], v[136:139]
  s_add_u32 s37, s39, 46080
  ds_read_b64_tr_b16 v[76:77], v13 offset:51200
  v_mfma_f32_16x16x32_bf16 v[136:139], v[40:43], a[112:115], v[136:139]
  s_waitcnt lgkmcnt(11)
  s_add_u32 m0, s43, 65536
  ds_read_b64_tr_b16 v[78:79], v13 offset:52224
  v_mfma_f32_16x16x32_bf16 v[144:147], v[48:51], a[112:115], v[144:147]
  ds_read_b64_tr_b16 v[80:81], v14 offset:49152
  buffer_load_dwordx4 v18, s[52:55], s37 offen offset:3072 lds
  v_mfma_f32_16x16x32_bf16 v[144:147], v[52:55], a[120:123], v[144:147]
  ds_read_b64_tr_b16 v[82:83], v14 offset:50176
  v_mfma_f32_16x16x32_bf16 v[148:151], v[52:55], a[124:127], v[148:151]
  s_add_u32 s45, s1, 34816
  ds_read_b64_tr_b16 v[84:85], v14 offset:51200
  v_mfma_f32_16x16x32_bf16 v[148:151], v[48:51], a[116:119], v[148:151]
  s_waitcnt lgkmcnt(11)
  ds_read_b64_tr_b16 v[86:87], v14 offset:52224
  buffer_load_dwordx4 a[180:183], v19, s[8:11], s45 offen sc1
  v_mfma_f32_16x16x32_bf16 v[156:159], v[56:59], a[116:119], v[156:159]
  ds_read_b64_tr_b16 v[88:89], v15 offset:49152
  v_mfma_f32_16x16x32_bf16 v[156:159], v[60:63], a[124:127], v[156:159]
  s_add_u32 s30, s26, 12288
  ds_read_b64_tr_b16 v[90:91], v15 offset:50176
  v_mfma_f32_16x16x32_bf16 v[152:155], v[60:63], a[120:123], v[152:155]
  ds_read_b64_tr_b16 v[92:93], v15 offset:51200
  buffer_load_dwordx4 v[200:203], v19, s[20:23], s30 offen offset:0 sc1
  v_mfma_f32_16x16x32_bf16 v[152:155], v[56:59], a[112:115], v[152:155]
  s_waitcnt vmcnt(31) lgkmcnt(11)
  ds_read_b64_tr_b16 v[94:95], v15 offset:52224
  v_mfma_f32_16x16x32_bf16 v[160:163], v[64:67], a[112:115], v[160:163]
  s_waitcnt vmcnt(28)
  s_barrier
  ds_read_b64_tr_b16 v[32:33], v20 offset:0
  v_mfma_f32_16x16x32_bf16 v[160:163], v[68:71], a[120:123], v[160:163]
  s_add_u32 s34, s39, 65536
  s_add_u32 m0, s43, 81920
  ds_read_b64_tr_b16 v[34:35], v20 offset:1024
  v_mfma_f32_16x16x32_bf16 v[164:167], v[68:71], a[124:127], v[164:167]
  ds_read_b64_tr_b16 v[36:37], v20 offset:2048
  buffer_load_dwordx4 v18, s[52:55], s34 offen offset:0 lds
  v_mfma_f32_16x16x32_bf16 v[164:167], v[64:67], a[116:119], v[164:167]
  s_waitcnt lgkmcnt(11)
  ds_read_b64_tr_b16 v[38:39], v20 offset:3072
  v_mfma_f32_16x16x32_bf16 v[172:175], v[72:75], a[116:119], v[172:175]
  s_add_u32 s44, s1, 3072
  ds_read_b64_tr_b16 v[40:41], v21 offset:0
  v_mfma_f32_16x16x32_bf16 v[172:175], v[76:79], a[124:127], v[172:175]
  ds_read_b64_tr_b16 v[42:43], v21 offset:1024
  buffer_load_dwordx4 a[184:187], v19, s[8:11], s44 offen sc1
  v_mfma_f32_16x16x32_bf16 v[168:171], v[76:79], a[120:123], v[168:171]
  s_add_u32 s35, s39, 80896
  ds_read_b64_tr_b16 v[44:45], v21 offset:2048
  v_mfma_f32_16x16x32_bf16 v[168:171], v[72:75], a[112:115], v[168:171]
  s_waitcnt lgkmcnt(11)
  s_add_u32 m0, s43, 81920
  ds_read_b64_tr_b16 v[46:47], v21 offset:3072
  v_mfma_f32_16x16x32_bf16 v[176:179], v[80:83], a[112:115], v[176:179]
  ds_read_b64_tr_b16 v[48:49], v22 offset:0
  buffer_load_dwordx4 v18, s[52:55], s35 offen offset:1024 lds
  v_mfma_f32_16x16x32_bf16 v[176:179], v[84:87], a[120:123], v[176:179]
  ds_read_b64_tr_b16 v[50:51], v22 offset:1024
  v_mfma_f32_16x16x32_bf16 v[180:183], v[84:87], a[124:127], v[180:183]
  s_add_u32 s45, s1, 35840
  ds_read_b64_tr_b16 v[52:53], v22 offset:2048
  v_mfma_f32_16x16x32_bf16 v[180:183], v[80:83], a[116:119], v[180:183]
  s_waitcnt lgkmcnt(11)
  ds_read_b64_tr_b16 v[54:55], v22 offset:3072
  buffer_load_dwordx4 a[188:191], v19, s[8:11], s45 offen sc1
  v_mfma_f32_16x16x32_bf16 v[188:191], v[88:91], a[116:119], v[188:191]
  ds_read_b64_tr_b16 v[56:57], v23 offset:0
  v_mfma_f32_16x16x32_bf16 v[188:191], v[92:95], a[124:127], v[188:191]
  s_add_u32 s30, s26, 12288
  ds_read_b64_tr_b16 v[58:59], v23 offset:1024
  v_mfma_f32_16x16x32_bf16 v[184:187], v[92:95], a[120:123], v[184:187]
  ds_read_b64_tr_b16 v[60:61], v23 offset:2048
  buffer_load_dwordx4 v[204:207], v19, s[20:23], s30 offen offset:1024 sc1
  v_mfma_f32_16x16x32_bf16 v[184:187], v[88:91], a[112:115], v[184:187]
  s_waitcnt vmcnt(28) lgkmcnt(11)
  ds_read_b64_tr_b16 v[62:63], v23 offset:3072
  v_mfma_f32_16x16x32_bf16 v[128:131], v[32:35], a[128:131], v[128:131]
  ds_read_b64_tr_b16 v[64:65], v24 offset:0
  v_mfma_f32_16x16x32_bf16 v[128:131], v[36:39], a[136:139], v[128:131]
  s_add_u32 s36, s39, 96256
  s_add_u32 m0, s43, 81920
  ds_read_b64_tr_b16 v[66:67], v24 offset:1024
  v_mfma_f32_16x16x32_bf16 v[132:135], v[36:39], a[140:143], v[132:135]
  ds_read_b64_tr_b16 v[68:69], v24 offset:2048
  buffer_load_dwordx4 v18, s[52:55], s36 offen offset:2048 lds
  v_mfma_f32_16x16x32_bf16 v[132:135], v[32:35], a[132:135], v[132:135]
  s_waitcnt lgkmcnt(11)
  ds_read_b64_tr_b16 v[70:71], v24 offset:3072
  v_mfma_f32_16x16x32_bf16 v[140:143], v[40:43], a[132:135], v[140:143]
  s_add_u32 s1, s1, 4096
  s_cmp_eq_u32 s1, s69
  s_cselect_b32 s44, 4096, 0
  s_add_u32 s1, s1, s44
  s_add_u32 s44, s1, 0
  ds_read_b64_tr_b16 v[72:73], v25 offset:0
  v_mfma_f32_16x16x32_bf16 v[140:143], v[44:47], a[140:143], v[140:143]
  ds_read_b64_tr_b16 v[74:75], v25 offset:1024
  buffer_load_dwordx4 a[192:195], v19, s[8:11], s44 offen sc1
  v_mfma_f32_16x16x32_bf16 v[136:139], v[44:47], a[136:139], v[136:139]
  s_add_u32 s37, s39, 111616
  ds_read_b64_tr_b16 v[76:77], v25 offset:2048
  v_mfma_f32_16x16x32_bf16 v[136:139], v[40:43], a[128:131], v[136:139]
  s_waitcnt lgkmcnt(11)
  s_add_u32 m0, s43, 81920
  ds_read_b64_tr_b16 v[78:79], v25 offset:3072
  v_mfma_f32_16x16x32_bf16 v[144:147], v[48:51], a[128:131], v[144:147]
  ds_read_b64_tr_b16 v[80:81], v26 offset:0
  buffer_load_dwordx4 v18, s[52:55], s37 offen offset:3072 lds
  v_mfma_f32_16x16x32_bf16 v[144:147], v[52:55], a[136:139], v[144:147]
  ds_read_b64_tr_b16 v[82:83], v26 offset:1024
  v_mfma_f32_16x16x32_bf16 v[148:151], v[52:55], a[140:143], v[148:151]
  s_add_u32 s45, s1, 32768
  ds_read_b64_tr_b16 v[84:85], v26 offset:2048
  v_mfma_f32_16x16x32_bf16 v[148:151], v[48:51], a[132:135], v[148:151]
  s_waitcnt lgkmcnt(11)
  ds_read_b64_tr_b16 v[86:87], v26 offset:3072
  buffer_load_dwordx4 a[196:199], v19, s[8:11], s45 offen sc1
  v_mfma_f32_16x16x32_bf16 v[156:159], v[56:59], a[132:135], v[156:159]
  ds_read_b64_tr_b16 v[88:89], v27 offset:0
  v_mfma_f32_16x16x32_bf16 v[156:159], v[60:63], a[140:143], v[156:159]
  s_add_u32 s30, s26, 24576
  ds_read_b64_tr_b16 v[90:91], v27 offset:1024
  v_mfma_f32_16x16x32_bf16 v[152:155], v[60:63], a[136:139], v[152:155]
  ds_read_b64_tr_b16 v[92:93], v27 offset:2048
  buffer_load_dwordx4 v[208:211], v19, s[20:23], s30 offen offset:0 sc1
  v_mfma_f32_16x16x32_bf16 v[152:155], v[56:59], a[128:131], v[152:155]
  s_waitcnt vmcnt(33) lgkmcnt(11)
  ds_read_b64_tr_b16 v[94:95], v27 offset:3072
  v_mfma_f32_16x16x32_bf16 v[160:163], v[64:67], a[128:131], v[160:163]
  ds_read_b64_tr_b16 v[32:33], v20 offset:16384
  v_mfma_f32_16x16x32_bf16 v[160:163], v[68:71], a[136:139], v[160:163]
  s_add_u32 s39, s39, 0x20000
  s_cmp_eq_u32 s39, s0
  s_cselect_b32 s34, 0x20000, 0
  s_add_u32 s39, s39, s34
  s_add_u32 s34, s39, 0
  s_add_u32 m0, s43, 98304
  ds_read_b64_tr_b16 v[34:35], v20 offset:17408
  v_mfma_f32_16x16x32_bf16 v[164:167], v[68:71], a[140:143], v[164:167]
  ds_read_b64_tr_b16 v[36:37], v20 offset:18432
  buffer_load_dwordx4 v18, s[52:55], s34 offen offset:0 lds
  v_mfma_f32_16x16x32_bf16 v[164:167], v[64:67], a[132:135], v[164:167]
  s_waitcnt lgkmcnt(11)
  ds_read_b64_tr_b16 v[38:39], v20 offset:19456
  v_mfma_f32_16x16x32_bf16 v[172:175], v[72:75], a[132:135], v[172:175]
  s_add_u32 s44, s1, 1024
  ds_read_b64_tr_b16 v[40:41], v21 offset:16384
  v_mfma_f32_16x16x32_bf16 v[172:175], v[76:79], a[140:143], v[172:175]
  ds_read_b64_tr_b16 v[42:43], v21 offset:17408
  buffer_load_dwordx4 a[200:203], v19, s[8:11], s44 offen sc1
  v_mfma_f32_16x16x32_bf16 v[168:171], v[76:79], a[136:139], v[168:171]
  s_add_u32 s35, s39, 15360
  ds_read_b64_tr_b16 v[44:45], v21 offset:18432
  v_mfma_f32_16x16x32_bf16 v[168:171], v[72:75], a[128:131], v[168:171]
  s_waitcnt lgkmcnt(11)
  s_add_u32 m0, s43, 98304
  ds_read_b64_tr_b16 v[46:47], v21 offset:19456
  v_mfma_f32_16x16x32_bf16 v[176:179], v[80:83], a[128:131], v[176:179]
  ds_read_b64_tr_b16 v[48:49], v22 offset:16384
  buffer_load_dwordx4 v18, s[52:55], s35 offen offset:1024 lds
  v_mfma_f32_16x16x32_bf16 v[176:179], v[84:87], a[136:139], v[176:179]
  ds_read_b64_tr_b16 v[50:51], v22 offset:17408
  v_mfma_f32_16x16x32_bf16 v[180:183], v[84:87], a[140:143], v[180:183]
  s_add_u32 s45, s1, 33792
  ds_read_b64_tr_b16 v[52:53], v22 offset:18432
  v_mfma_f32_16x16x32_bf16 v[180:183], v[80:83], a[132:135], v[180:183]
  s_waitcnt lgkmcnt(11)
  ds_read_b64_tr_b16 v[54:55], v22 offset:19456
  buffer_load_dwordx4 a[204:207], v19, s[8:11], s45 offen sc1
  v_mfma_f32_16x16x32_bf16 v[188:191], v[88:91], a[132:135], v[188:191]
  ds_read_b64_tr_b16 v[56:57], v23 offset:16384
  v_mfma_f32_16x16x32_bf16 v[188:191], v[92:95], a[140:143], v[188:191]
  s_add_u32 s30, s26, 24576
  ds_read_b64_tr_b16 v[58:59], v23 offset:17408
  v_mfma_f32_16x16x32_bf16 v[184:187], v[92:95], a[136:139], v[184:187]
  ds_read_b64_tr_b16 v[60:61], v23 offset:18432
  buffer_load_dwordx4 v[212:215], v19, s[20:23], s30 offen offset:1024 sc1
  v_mfma_f32_16x16x32_bf16 v[184:187], v[88:91], a[128:131], v[184:187]
  s_waitcnt vmcnt(30) lgkmcnt(11)
  ds_read_b64_tr_b16 v[62:63], v23 offset:19456
  v_mfma_f32_16x16x32_bf16 v[128:131], v[32:35], a[144:147], v[128:131]
  ds_read_b64_tr_b16 v[64:65], v24 offset:16384
  v_mfma_f32_16x16x32_bf16 v[128:131], v[36:39], a[152:155], v[128:131]
  s_add_u32 s36, s39, 30720
  s_add_u32 m0, s43, 98304
  ds_read_b64_tr_b16 v[66:67], v24 offset:17408
  v_mfma_f32_16x16x32_bf16 v[132:135], v[36:39], a[156:159], v[132:135]
  ds_read_b64_tr_b16 v[68:69], v24 offset:18432
  buffer_load_dwordx4 v18, s[52:55], s36 offen offset:2048 lds
  v_mfma_f32_16x16x32_bf16 v[132:135], v[32:35], a[148:151], v[132:135]
  s_waitcnt lgkmcnt(11)
  ds_read_b64_tr_b16 v[70:71], v24 offset:19456
  v_mfma_f32_16x16x32_bf16 v[140:143], v[40:43], a[148:151], v[140:143]
  s_add_u32 s44, s1, 2048
  ds_read_b64_tr_b16 v[72:73], v25 offset:16384
  v_mfma_f32_16x16x32_bf16 v[140:143], v[44:47], a[156:159], v[140:143]
  ds_read_b64_tr_b16 v[74:75], v25 offset:17408
  buffer_load_dwordx4 a[208:211], v19, s[8:11], s44 offen sc1
  v_mfma_f32_16x16x32_bf16 v[136:139], v[44:47], a[152:155], v[136:139]
  s_add_u32 s37, s39, 46080
  ds_read_b64_tr_b16 v[76:77], v25 offset:18432
  v_mfma_f32_16x16x32_bf16 v[136:139], v[40:43], a[144:147], v[136:139]
  s_waitcnt lgkmcnt(11)
  s_add_u32 m0, s43, 98304
  ds_read_b64_tr_b16 v[78:79], v25 offset:19456
  v_mfma_f32_16x16x32_bf16 v[144:147], v[48:51], a[144:147], v[144:147]
  ds_read_b64_tr_b16 v[80:81], v26 offset:16384
  buffer_load_dwordx4 v18, s[52:55], s37 offen offset:3072 lds
  v_mfma_f32_16x16x32_bf16 v[144:147], v[52:55], a[152:155], v[144:147]
  ds_read_b64_tr_b16 v[82:83], v26 offset:17408
  v_mfma_f32_16x16x32_bf16 v[148:151], v[52:55], a[156:159], v[148:151]
  s_add_u32 s45, s1, 34816
  ds_read_b64_tr_b16 v[84:85], v26 offset:18432
  v_mfma_f32_16x16x32_bf16 v[148:151], v[48:51], a[148:151], v[148:151]
  s_waitcnt lgkmcnt(11)
  ds_read_b64_tr_b16 v[86:87], v26 offset:19456
  buffer_load_dwordx4 a[212:215], v19, s[8:11], s45 offen sc1
  v_mfma_f32_16x16x32_bf16 v[156:159], v[56:59], a[148:151], v[156:159]
  ds_read_b64_tr_b16 v[88:89], v27 offset:16384
  v_mfma_f32_16x16x32_bf16 v[156:159], v[60:63], a[156:159], v[156:159]
  s_add_u32 s30, s26, 36864
  ds_read_b64_tr_b16 v[90:91], v27 offset:17408
  v_mfma_f32_16x16x32_bf16 v[152:155], v[60:63], a[152:155], v[152:155]
  ds_read_b64_tr_b16 v[92:93], v27 offset:18432
  buffer_load_dwordx4 v[216:219], v19, s[20:23], s30 offen offset:0 sc1
  v_mfma_f32_16x16x32_bf16 v[152:155], v[56:59], a[144:147], v[152:155]
  s_waitcnt vmcnt(35) lgkmcnt(11)
  ds_read_b64_tr_b16 v[94:95], v27 offset:19456
  v_mfma_f32_16x16x32_bf16 v[160:163], v[64:67], a[144:147], v[160:163]
  s_waitcnt vmcnt(32)
  s_barrier
  ds_read_b64_tr_b16 v[32:33], v20 offset:32768
  v_mfma_f32_16x16x32_bf16 v[160:163], v[68:71], a[152:155], v[160:163]
  s_add_u32 s34, s39, 65536
  s_add_u32 m0, s43, 114688
  ds_read_b64_tr_b16 v[34:35], v20 offset:33792
  v_mfma_f32_16x16x32_bf16 v[164:167], v[68:71], a[156:159], v[164:167]
  ds_read_b64_tr_b16 v[36:37], v20 offset:34816
  buffer_load_dwordx4 v18, s[52:55], s34 offen offset:0 lds
  v_mfma_f32_16x16x32_bf16 v[164:167], v[64:67], a[148:151], v[164:167]
  s_waitcnt lgkmcnt(11)
  ds_read_b64_tr_b16 v[38:39], v20 offset:35840
  v_mfma_f32_16x16x32_bf16 v[172:175], v[72:75], a[148:151], v[172:175]
  s_add_u32 s44, s1, 3072
  ds_read_b64_tr_b16 v[40:41], v21 offset:32768
  v_mfma_f32_16x16x32_bf16 v[172:175], v[76:79], a[156:159], v[172:175]
  ds_read_b64_tr_b16 v[42:43], v21 offset:33792
  buffer_load_dwordx4 a[216:219], v19, s[8:11], s44 offen sc1
  v_mfma_f32_16x16x32_bf16 v[168:171], v[76:79], a[152:155], v[168:171]
  s_add_u32 s35, s39, 80896
  ds_read_b64_tr_b16 v[44:45], v21 offset:34816
  v_mfma_f32_16x16x32_bf16 v[168:171], v[72:75], a[144:147], v[168:171]
  s_waitcnt lgkmcnt(11)
  s_add_u32 m0, s43, 114688
  ds_read_b64_tr_b16 v[46:47], v21 offset:35840
  v_mfma_f32_16x16x32_bf16 v[176:179], v[80:83], a[144:147], v[176:179]
  ds_read_b64_tr_b16 v[48:49], v22 offset:32768
  buffer_load_dwordx4 v18, s[52:55], s35 offen offset:1024 lds
  v_mfma_f32_16x16x32_bf16 v[176:179], v[84:87], a[152:155], v[176:179]
  ds_read_b64_tr_b16 v[50:51], v22 offset:33792
  v_mfma_f32_16x16x32_bf16 v[180:183], v[84:87], a[156:159], v[180:183]
  s_add_u32 s45, s1, 35840
  ds_read_b64_tr_b16 v[52:53], v22 offset:34816
  v_mfma_f32_16x16x32_bf16 v[180:183], v[80:83], a[148:151], v[180:183]
  s_waitcnt lgkmcnt(11)
  ds_read_b64_tr_b16 v[54:55], v22 offset:35840
  buffer_load_dwordx4 a[220:223], v19, s[8:11], s45 offen sc1
  v_mfma_f32_16x16x32_bf16 v[188:191], v[88:91], a[148:151], v[188:191]
  ds_read_b64_tr_b16 v[56:57], v23 offset:32768
  v_mfma_f32_16x16x32_bf16 v[188:191], v[92:95], a[156:159], v[188:191]
  s_add_u32 s30, s26, 36864
  ds_read_b64_tr_b16 v[58:59], v23 offset:33792
  v_mfma_f32_16x16x32_bf16 v[184:187], v[92:95], a[152:155], v[184:187]
  ds_read_b64_tr_b16 v[60:61], v23 offset:34816
  buffer_load_dwordx4 v[220:223], v19, s[20:23], s30 offen offset:1024 sc1
  v_mfma_f32_16x16x32_bf16 v[184:187], v[88:91], a[144:147], v[184:187]
  s_waitcnt vmcnt(31) lgkmcnt(11)
  ds_read_b64_tr_b16 v[62:63], v23 offset:35840
  v_mfma_f32_16x16x32_bf16 v[128:131], v[32:35], a[160:163], v[128:131]
  ds_read_b64_tr_b16 v[64:65], v24 offset:32768
  v_mfma_f32_16x16x32_bf16 v[128:131], v[36:39], a[168:171], v[128:131]
  s_add_u32 s36, s39, 96256
  s_add_u32 m0, s43, 114688
  ds_read_b64_tr_b16 v[66:67], v24 offset:33792
  v_mfma_f32_16x16x32_bf16 v[132:135], v[36:39], a[172:175], v[132:135]
  ds_read_b64_tr_b16 v[68:69], v24 offset:34816
  buffer_load_dwordx4 v18, s[52:55], s36 offen offset:2048 lds
  v_mfma_f32_16x16x32_bf16 v[132:135], v[32:35], a[164:167], v[132:135]
  s_waitcnt lgkmcnt(11)
  ds_read_b64_tr_b16 v[70:71], v24 offset:35840
  v_mfma_f32_16x16x32_bf16 v[140:143], v[40:43], a[164:167], v[140:143]
  s_add_u32 s1, s1, 4096
  s_cmp_eq_u32 s1, s69
  s_cselect_b32 s44, 4096, 0
  s_add_u32 s1, s1, s44
  s_add_u32 s44, s1, 0
  ds_read_b64_tr_b16 v[72:73], v25 offset:32768
  v_mfma_f32_16x16x32_bf16 v[140:143], v[44:47], a[172:175], v[140:143]
  ds_read_b64_tr_b16 v[74:75], v25 offset:33792
  buffer_load_dwordx4 a[224:227], v19, s[8:11], s44 offen sc1
  v_mfma_f32_16x16x32_bf16 v[136:139], v[44:47], a[168:171], v[136:139]
  ds_read_b64_tr_b16 v[76:77], v25 offset:34816
  v_mfma_f32_16x16x32_bf16 v[136:139], v[40:43], a[160:163], v[136:139]
  s_waitcnt lgkmcnt(11)
  s_add_u32 s37, s39, 111616
  ds_read_b64_tr_b16 v[78:79], v25 offset:35840
  v_mfma_f32_16x16x32_bf16 v[144:147], v[48:51], a[160:163], v[144:147]
  s_add_u32 m0, s43, 114688
  ds_read_b64_tr_b16 v[80:81], v26 offset:32768
  v_mfma_f32_16x16x32_bf16 v[144:147], v[52:55], a[168:171], v[144:147]
  ds_read_b64_tr_b16 v[82:83], v26 offset:33792
  buffer_load_dwordx4 v18, s[52:55], s37 offen offset:3072 lds
  v_mfma_f32_16x16x32_bf16 v[148:151], v[52:55], a[172:175], v[148:151]
  ds_read_b64_tr_b16 v[84:85], v26 offset:34816
  v_mfma_f32_16x16x32_bf16 v[148:151], v[48:51], a[164:167], v[148:151]
  s_waitcnt lgkmcnt(11)
  ds_read_b64_tr_b16 v[86:87], v26 offset:35840
  v_mfma_f32_16x16x32_bf16 v[156:159], v[56:59], a[164:167], v[156:159]
  s_add_u32 s45, s1, 32768
  ds_read_b64_tr_b16 v[88:89], v27 offset:32768
  v_mfma_f32_16x16x32_bf16 v[156:159], v[60:63], a[172:175], v[156:159]
  ds_read_b64_tr_b16 v[90:91], v27 offset:33792
  buffer_load_dwordx4 a[228:231], v19, s[8:11], s45 offen sc1
  v_mfma_f32_16x16x32_bf16 v[152:155], v[60:63], a[168:171], v[152:155]
  ds_read_b64_tr_b16 v[92:93], v27 offset:34816
  v_mfma_f32_16x16x32_bf16 v[152:155], v[56:59], a[160:163], v[152:155]
  s_waitcnt vmcnt(35) lgkmcnt(11)
  ds_read_b64_tr_b16 v[94:95], v27 offset:35840
  v_mfma_f32_16x16x32_bf16 v[160:163], v[64:67], a[160:163], v[160:163]
  ds_read_b64_tr_b16 v[32:33], v20 offset:49152
  v_mfma_f32_16x16x32_bf16 v[160:163], v[68:71], a[168:171], v[160:163]
  s_add_u32 s34, s3, 352256
  s_add_u32 m0, s43, 0
  ds_read_b64_tr_b16 v[34:35], v20 offset:50176
  v_mfma_f32_16x16x32_bf16 v[164:167], v[68:71], a[172:175], v[164:167]
  ds_read_b64_tr_b16 v[36:37], v20 offset:51200
  buffer_load_dwordx4 v17, s[56:59], s34 offen offset:0 lds
  v_mfma_f32_16x16x32_bf16 v[164:167], v[64:67], a[164:167], v[164:167]
  s_waitcnt lgkmcnt(11)
  ds_read_b64_tr_b16 v[38:39], v20 offset:52224
  v_mfma_f32_16x16x32_bf16 v[172:175], v[72:75], a[164:167], v[172:175]
  s_add_u32 s44, s1, 1024
  ds_read_b64_tr_b16 v[40:41], v21 offset:49152
  v_mfma_f32_16x16x32_bf16 v[172:175], v[76:79], a[172:175], v[172:175]
  ds_read_b64_tr_b16 v[42:43], v21 offset:50176
  buffer_load_dwordx4 a[232:235], v19, s[8:11], s44 offen sc1
  v_mfma_f32_16x16x32_bf16 v[168:171], v[76:79], a[168:171], v[168:171]
  ds_read_b64_tr_b16 v[44:45], v21 offset:51200
  v_mfma_f32_16x16x32_bf16 v[168:171], v[72:75], a[160:163], v[168:171]
  s_waitcnt lgkmcnt(11)
  s_add_u32 s35, s3, 395264
  ds_read_b64_tr_b16 v[46:47], v21 offset:52224
  v_mfma_f32_16x16x32_bf16 v[176:179], v[80:83], a[160:163], v[176:179]
  s_add_u32 m0, s43, 0
  ds_read_b64_tr_b16 v[48:49], v22 offset:49152
  v_mfma_f32_16x16x32_bf16 v[176:179], v[84:87], a[168:171], v[176:179]
  ds_read_b64_tr_b16 v[50:51], v22 offset:50176
  buffer_load_dwordx4 v17, s[56:59], s35 offen offset:1024 lds
  v_mfma_f32_16x16x32_bf16 v[180:183], v[84:87], a[172:175], v[180:183]
  ds_read_b64_tr_b16 v[52:53], v22 offset:51200
  v_mfma_f32_16x16x32_bf16 v[180:183], v[80:83], a[164:167], v[180:183]
  s_waitcnt lgkmcnt(11)
  ds_read_b64_tr_b16 v[54:55], v22 offset:52224
  v_mfma_f32_16x16x32_bf16 v[188:191], v[88:91], a[164:167], v[188:191]
  s_add_u32 s45, s1, 33792
  ds_read_b64_tr_b16 v[56:57], v23 offset:49152
  v_mfma_f32_16x16x32_bf16 v[188:191], v[92:95], a[172:175], v[188:191]
  ds_read_b64_tr_b16 v[58:59], v23 offset:50176
  buffer_load_dwordx4 a[236:239], v19, s[8:11], s45 offen sc1
  v_mfma_f32_16x16x32_bf16 v[184:187], v[92:95], a[168:171], v[184:187]
  ds_read_b64_tr_b16 v[60:61], v23 offset:51200
  v_mfma_f32_16x16x32_bf16 v[184:187], v[88:91], a[160:163], v[184:187]
  s_waitcnt vmcnt(29) lgkmcnt(11)
  ds_read_b64_tr_b16 v[62:63], v23 offset:52224
  v_mfma_f32_16x16x32_bf16 v[128:131], v[32:35], a[176:179], v[128:131]
  ds_read_b64_tr_b16 v[64:65], v24 offset:49152
  v_mfma_f32_16x16x32_bf16 v[128:131], v[36:39], a[184:187], v[128:131]
  s_add_u32 s36, s3, 438272
  s_add_u32 m0, s43, 0
  ds_read_b64_tr_b16 v[66:67], v24 offset:50176
  v_mfma_f32_16x16x32_bf16 v[132:135], v[36:39], a[188:191], v[132:135]
  ds_read_b64_tr_b16 v[68:69], v24 offset:51200
  buffer_load_dwordx4 v17, s[56:59], s36 offen offset:2048 lds
  v_mfma_f32_16x16x32_bf16 v[132:135], v[32:35], a[180:183], v[132:135]
  s_waitcnt lgkmcnt(11)
  ds_read_b64_tr_b16 v[70:71], v24 offset:52224
  v_mfma_f32_16x16x32_bf16 v[140:143], v[40:43], a[180:183], v[140:143]
  s_add_u32 s44, s1, 2048
  ds_read_b64_tr_b16 v[72:73], v25 offset:49152
  v_mfma_f32_16x16x32_bf16 v[140:143], v[44:47], a[188:191], v[140:143]
  ds_read_b64_tr_b16 v[74:75], v25 offset:50176
  buffer_load_dwordx4 a[240:243], v19, s[8:11], s44 offen sc1
  v_mfma_f32_16x16x32_bf16 v[136:139], v[44:47], a[184:187], v[136:139]
  ds_read_b64_tr_b16 v[76:77], v25 offset:51200
  v_mfma_f32_16x16x32_bf16 v[136:139], v[40:43], a[176:179], v[136:139]
  s_waitcnt lgkmcnt(11)
  s_add_u32 s37, s3, 481280
  ds_read_b64_tr_b16 v[78:79], v25 offset:52224
  v_mfma_f32_16x16x32_bf16 v[144:147], v[48:51], a[176:179], v[144:147]
  s_add_u32 m0, s43, 0
  ds_read_b64_tr_b16 v[80:81], v26 offset:49152
  v_mfma_f32_16x16x32_bf16 v[144:147], v[52:55], a[184:187], v[144:147]
  ds_read_b64_tr_b16 v[82:83], v26 offset:50176
  buffer_load_dwordx4 v17, s[56:59], s37 offen offset:3072 lds
  v_mfma_f32_16x16x32_bf16 v[148:151], v[52:55], a[188:191], v[148:151]
  ds_read_b64_tr_b16 v[84:85], v26 offset:51200
  v_mfma_f32_16x16x32_bf16 v[148:151], v[48:51], a[180:183], v[148:151]
  s_waitcnt lgkmcnt(11)
  ds_read_b64_tr_b16 v[86:87], v26 offset:52224
  v_mfma_f32_16x16x32_bf16 v[156:159], v[56:59], a[180:183], v[156:159]
  s_add_u32 s45, s1, 34816
  ds_read_b64_tr_b16 v[88:89], v27 offset:49152
  v_mfma_f32_16x16x32_bf16 v[156:159], v[60:63], a[188:191], v[156:159]
  ds_read_b64_tr_b16 v[90:91], v27 offset:50176
  buffer_load_dwordx4 a[244:247], v19, s[8:11], s45 offen sc1
  v_mfma_f32_16x16x32_bf16 v[152:155], v[60:63], a[184:187], v[152:155]
  ds_read_b64_tr_b16 v[92:93], v27 offset:51200
  v_mfma_f32_16x16x32_bf16 v[152:155], v[56:59], a[176:179], v[152:155]
  s_waitcnt vmcnt(33) lgkmcnt(11)
  ds_read_b64_tr_b16 v[94:95], v27 offset:52224
  v_mfma_f32_16x16x32_bf16 v[160:163], v[64:67], a[176:179], v[160:163]
  s_waitcnt vmcnt(29)
  s_barrier
  ds_read_b64_tr_b16 v[32:33], v8 offset:0
  v_mfma_f32_16x16x32_bf16 v[160:163], v[68:71], a[184:187], v[160:163]
  s_add_u32 s34, s3, 528384
  s_add_u32 m0, s43, 16384
  ds_read_b64_tr_b16 v[34:35], v8 offset:1024
  v_mfma_f32_16x16x32_bf16 v[164:167], v[68:71], a[188:191], v[164:167]
  ds_read_b64_tr_b16 v[36:37], v8 offset:2048
  buffer_load_dwordx4 v17, s[56:59], s34 offen offset:0 lds
  v_mfma_f32_16x16x32_bf16 v[164:167], v[64:67], a[180:183], v[164:167]
  s_waitcnt lgkmcnt(11)
  ds_read_b64_tr_b16 v[38:39], v8 offset:3072
  v_mfma_f32_16x16x32_bf16 v[172:175], v[72:75], a[180:183], v[172:175]
  s_add_u32 s44, s1, 3072
  ds_read_b64_tr_b16 v[40:41], v9 offset:0
  v_mfma_f32_16x16x32_bf16 v[172:175], v[76:79], a[188:191], v[172:175]
  ds_read_b64_tr_b16 v[42:43], v9 offset:1024
  buffer_load_dwordx4 a[248:251], v19, s[8:11], s44 offen sc1
  v_mfma_f32_16x16x32_bf16 v[168:171], v[76:79], a[184:187], v[168:171]
  ds_read_b64_tr_b16 v[44:45], v9 offset:2048
  v_mfma_f32_16x16x32_bf16 v[168:171], v[72:75], a[176:179], v[168:171]
  s_waitcnt lgkmcnt(11)
  s_add_u32 s35, s3, 571392
  ds_read_b64_tr_b16 v[46:47], v9 offset:3072
  v_mfma_f32_16x16x32_bf16 v[176:179], v[80:83], a[176:179], v[176:179]
L_attn_st13:
  s_cbranch_vccnz L_attn_walkdone1
  s_add_u32 m0, s43, 16384
  ds_read_b64_tr_b16 v[48:49], v10 offset:0
  v_mfma_f32_16x16x32_bf16 v[176:179], v[84:87], a[184:187], v[176:179]
  ds_read_b64_tr_b16 v[50:51], v10 offset:1024
  buffer_load_dwordx4 v17, s[56:59], s35 offen offset:1024 lds
  v_mfma_f32_16x16x32_bf16 v[180:183], v[84:87], a[188:191], v[180:183]
  ds_read_b64_tr_b16 v[52:53], v10 offset:2048
  v_mfma_f32_16x16x32_bf16 v[180:183], v[80:83], a[180:183], v[180:183]
  s_waitcnt lgkmcnt(11)
  ds_read_b64_tr_b16 v[54:55], v10 offset:3072
  v_mfma_f32_16x16x32_bf16 v[188:191], v[88:91], a[180:183], v[188:191]
  s_add_u32 s45, s1, 35840
  ds_read_b64_tr_b16 v[56:57], v11 offset:0
  v_mfma_f32_16x16x32_bf16 v[188:191], v[92:95], a[188:191], v[188:191]
  ds_read_b64_tr_b16 v[58:59], v11 offset:1024
  buffer_load_dwordx4 a[252:255], v19, s[8:11], s45 offen sc1
  v_mfma_f32_16x16x32_bf16 v[184:187], v[92:95], a[184:187], v[184:187]
  ds_read_b64_tr_b16 v[60:61], v11 offset:2048
  v_mfma_f32_16x16x32_bf16 v[184:187], v[88:91], a[176:179], v[184:187]
  s_waitcnt vmcnt(27) lgkmcnt(11)
  ds_read_b64_tr_b16 v[62:63], v11 offset:3072
  v_mfma_f32_16x16x32_bf16 v[128:131], v[32:35], a[192:195], v[128:131]
  ds_read_b64_tr_b16 v[64:65], v12 offset:0
  v_mfma_f32_16x16x32_bf16 v[128:131], v[36:39], a[200:203], v[128:131]
  s_add_u32 s36, s3, 614400
  s_add_u32 m0, s43, 16384
  ds_read_b64_tr_b16 v[66:67], v12 offset:1024
  v_mfma_f32_16x16x32_bf16 v[132:135], v[36:39], a[204:207], v[132:135]
  ds_read_b64_tr_b16 v[68:69], v12 offset:2048
  buffer_load_dwordx4 v17, s[56:59], s36 offen offset:2048 lds
  v_mfma_f32_16x16x32_bf16 v[132:135], v[32:35], a[196:199], v[132:135]
  s_waitcnt lgkmcnt(11)
  ds_read_b64_tr_b16 v[70:71], v12 offset:3072
  v_mfma_f32_16x16x32_bf16 v[140:143], v[40:43], a[196:199], v[140:143]
  ds_read_b64_tr_b16 v[72:73], v13 offset:0
  v_mfma_f32_16x16x32_bf16 v[140:143], v[44:47], a[204:207], v[140:143]
  s_add_u32 s37, s3, 657408
  ds_read_b64_tr_b16 v[74:75], v13 offset:1024
  v_mfma_f32_16x16x32_bf16 v[136:139], v[44:47], a[200:203], v[136:139]
  s_add_u32 m0, s43, 16384
  ds_read_b64_tr_b16 v[76:77], v13 offset:2048
  v_mfma_f32_16x16x32_bf16 v[136:139], v[40:43], a[192:195], v[136:139]
  s_waitcnt lgkmcnt(11)
  ds_read_b64_tr_b16 v[78:79], v13 offset:3072
  buffer_load_dwordx4 v17, s[56:59], s37 offen offset:3072 lds
  v_mfma_f32_16x16x32_bf16 v[144:147], v[48:51], a[192:195], v[144:147]
  ds_read_b64_tr_b16 v[80:81], v14 offset:0
  v_mfma_f32_16x16x32_bf16 v[144:147], v[52:55], a[200:203], v[144:147]
  ds_read_b64_tr_b16 v[82:83], v14 offset:1024
  v_mfma_f32_16x16x32_bf16 v[148:151], v[52:55], a[204:207], v[148:151]
  s_add_u32 s34, s3, 704512
  ds_read_b64_tr_b16 v[84:85], v14 offset:2048
  v_mfma_f32_16x16x32_bf16 v[148:151], v[48:51], a[196:199], v[148:151]
  s_waitcnt lgkmcnt(11)
  s_add_u32 m0, s43, 32768
  ds_read_b64_tr_b16 v[86:87], v14 offset:3072
  v_mfma_f32_16x16x32_bf16 v[156:159], v[56:59], a[196:199], v[156:159]
  ds_read_b64_tr_b16 v[88:89], v15 offset:0
  buffer_load_dwordx4 v17, s[56:59], s34 offen offset:0 lds
  v_mfma_f32_16x16x32_bf16 v[156:159], v[60:63], a[204:207], v[156:159]
  ds_read_b64_tr_b16 v[90:91], v15 offset:1024
  v_mfma_f32_16x16x32_bf16 v[152:155], v[60:63], a[200:203], v[152:155]
  ds_read_b64_tr_b16 v[92:93], v15 offset:2048
  v_mfma_f32_16x16x32_bf16 v[152:155], v[56:59], a[192:195], v[152:155]
  s_waitcnt vmcnt(30) lgkmcnt(11)
  ds_read_b64_tr_b16 v[94:95], v15 offset:3072
  v_mfma_f32_16x16x32_bf16 v[160:163], v[64:67], a[192:195], v[160:163]
  ds_read_b64_tr_b16 v[32:33], v8 offset:16384
  v_mfma_f32_16x16x32_bf16 v[160:163], v[68:71], a[200:203], v[160:163]
  s_add_u32 s35, s3, 747520
  s_add_u32 m0, s43, 32768
  ds_read_b64_tr_b16 v[34:35], v8 offset:17408
  v_mfma_f32_16x16x32_bf16 v[164:167], v[68:71], a[204:207], v[164:167]
  ds_read_b64_tr_b16 v[36:37], v8 offset:18432
  buffer_load_dwordx4 v17, s[56:59], s35 offen offset:1024 lds
  v_mfma_f32_16x16x32_bf16 v[164:167], v[64:67], a[196:199], v[164:167]
  s_waitcnt lgkmcnt(11)
  ds_read_b64_tr_b16 v[38:39], v8 offset:19456
  v_mfma_f32_16x16x32_bf16 v[172:175], v[72:75], a[196:199], v[172:175]
  ds_read_b64_tr_b16 v[40:41], v9 offset:16384
  v_mfma_f32_16x16x32_bf16 v[172:175], v[76:79], a[204:207], v[172:175]
  s_add_u32 s36, s3, 790528
  ds_read_b64_tr_b16 v[42:43], v9 offset:17408
  v_mfma_f32_16x16x32_bf16 v[168:171], v[76:79], a[200:203], v[168:171]
  s_add_u32 m0, s43, 32768
  ds_read_b64_tr_b16 v[44:45], v9 offset:18432
  v_mfma_f32_16x16x32_bf16 v[168:171], v[72:75], a[192:195], v[168:171]
  s_waitcnt lgkmcnt(11)
  ds_read_b64_tr_b16 v[46:47], v9 offset:19456
  buffer_load_dwordx4 v17, s[56:59], s36 offen offset:2048 lds
  v_mfma_f32_16x16x32_bf16 v[176:179], v[80:83], a[192:195], v[176:179]
  ds_read_b64_tr_b16 v[48:49], v10 offset:16384
  v_mfma_f32_16x16x32_bf16 v[176:179], v[84:87], a[200:203], v[176:179]
  ds_read_b64_tr_b16 v[50:51], v10 offset:17408
  v_mfma_f32_16x16x32_bf16 v[180:183], v[84:87], a[204:207], v[180:183]
  s_add_u32 s37, s3, 833536
  ds_read_b64_tr_b16 v[52:53], v10 offset:18432
  v_mfma_f32_16x16x32_bf16 v[180:183], v[80:83], a[196:199], v[180:183]
  s_waitcnt lgkmcnt(11)
  s_add_u32 m0, s43, 32768
  ds_read_b64_tr_b16 v[54:55], v10 offset:19456
  v_mfma_f32_16x16x32_bf16 v[188:191], v[88:91], a[196:199], v[188:191]
  ds_read_b64_tr_b16 v[56:57], v11 offset:16384
  buffer_load_dwordx4 v17, s[56:59], s37 offen offset:3072 lds
  v_mfma_f32_16x16x32_bf16 v[188:191], v[92:95], a[204:207], v[188:191]
  ds_read_b64_tr_b16 v[58:59], v11 offset:17408
  v_mfma_f32_16x16x32_bf16 v[184:187], v[92:95], a[200:203], v[184:187]
  ds_read_b64_tr_b16 v[60:61], v11 offset:18432
  v_mfma_f32_16x16x32_bf16 v[184:187], v[88:91], a[192:195], v[184:187]
  s_waitcnt vmcnt(23) lgkmcnt(11)
  ds_read_b64_tr_b16 v[62:63], v11 offset:19456
  v_mfma_f32_16x16x32_bf16 v[128:131], v[32:35], a[208:211], v[128:131]
  ds_read_b64_tr_b16 v[64:65], v12 offset:16384
  v_mfma_f32_16x16x32_bf16 v[128:131], v[36:39], a[216:219], v[128:131]
  ds_read_b64_tr_b16 v[66:67], v12 offset:17408
  v_mfma_f32_16x16x32_bf16 v[132:135], v[36:39], a[220:223], v[132:135]
  ds_read_b64_tr_b16 v[68:69], v12 offset:18432
  v_mfma_f32_16x16x32_bf16 v[132:135], v[32:35], a[212:215], v[132:135]
  s_waitcnt lgkmcnt(11)
  ds_read_b64_tr_b16 v[70:71], v12 offset:19456
  v_mfma_f32_16x16x32_bf16 v[140:143], v[40:43], a[212:215], v[140:143]
  ds_read_b64_tr_b16 v[72:73], v13 offset:16384
  v_mfma_f32_16x16x32_bf16 v[140:143], v[44:47], a[220:223], v[140:143]
  ds_read_b64_tr_b16 v[74:75], v13 offset:17408
  v_mfma_f32_16x16x32_bf16 v[136:139], v[44:47], a[216:219], v[136:139]
  ds_read_b64_tr_b16 v[76:77], v13 offset:18432
  v_mfma_f32_16x16x32_bf16 v[136:139], v[40:43], a[208:211], v[136:139]
  s_waitcnt lgkmcnt(11)
  ds_read_b64_tr_b16 v[78:79], v13 offset:19456
  v_mfma_f32_16x16x32_bf16 v[144:147], v[48:51], a[208:211], v[144:147]
  ds_read_b64_tr_b16 v[80:81], v14 offset:16384
  v_mfma_f32_16x16x32_bf16 v[144:147], v[52:55], a[216:219], v[144:147]
  ds_read_b64_tr_b16 v[82:83], v14 offset:17408
  v_mfma_f32_16x16x32_bf16 v[148:151], v[52:55], a[220:223], v[148:151]
  ds_read_b64_tr_b16 v[84:85], v14 offset:18432
  v_mfma_f32_16x16x32_bf16 v[148:151], v[48:51], a[212:215], v[148:151]
  s_waitcnt lgkmcnt(11)
  ds_read_b64_tr_b16 v[86:87], v14 offset:19456
  v_mfma_f32_16x16x32_bf16 v[156:159], v[56:59], a[212:215], v[156:159]
  ds_read_b64_tr_b16 v[88:89], v15 offset:16384
  v_mfma_f32_16x16x32_bf16 v[156:159], v[60:63], a[220:223], v[156:159]
  ds_read_b64_tr_b16 v[90:91], v15 offset:17408
  v_mfma_f32_16x16x32_bf16 v[152:155], v[60:63], a[216:219], v[152:155]
  ds_read_b64_tr_b16 v[92:93], v15 offset:18432
  v_mfma_f32_16x16x32_bf16 v[152:155], v[56:59], a[208:211], v[152:155]
  s_waitcnt vmcnt(23) lgkmcnt(11)
  ds_read_b64_tr_b16 v[94:95], v15 offset:19456
  v_mfma_f32_16x16x32_bf16 v[160:163], v[64:67], a[208:211], v[160:163]
  s_waitcnt vmcnt(19)
  s_barrier
  ds_read_b64_tr_b16 v[32:33], v8 offset:32768
  v_mfma_f32_16x16x32_bf16 v[160:163], v[68:71], a[216:219], v[160:163]
  s_add_u32 s34, s3, 880640
  s_add_u32 m0, s43, 49152
  ds_read_b64_tr_b16 v[34:35], v8 offset:33792
  v_mfma_f32_16x16x32_bf16 v[164:167], v[68:71], a[220:223], v[164:167]
  ds_read_b64_tr_b16 v[36:37], v8 offset:34816
  buffer_load_dwordx4 v17, s[56:59], s34 offen offset:0 lds
  v_mfma_f32_16x16x32_bf16 v[164:167], v[64:67], a[212:215], v[164:167]
  s_waitcnt lgkmcnt(11)
  ds_read_b64_tr_b16 v[38:39], v8 offset:35840
  v_mfma_f32_16x16x32_bf16 v[172:175], v[72:75], a[212:215], v[172:175]
  ds_read_b64_tr_b16 v[40:41], v8 offset:49152
  v_mfma_f32_16x16x32_bf16 v[172:175], v[76:79], a[220:223], v[172:175]
  s_add_u32 s35, s3, 923648
  ds_read_b64_tr_b16 v[42:43], v8 offset:50176
  v_mfma_f32_16x16x32_bf16 v[168:171], v[76:79], a[216:219], v[168:171]
  s_add_u32 m0, s43, 49152
  ds_read_b64_tr_b16 v[44:45], v8 offset:51200
  v_mfma_f32_16x16x32_bf16 v[168:171], v[72:75], a[208:211], v[168:171]
  s_waitcnt lgkmcnt(11)
  ds_read_b64_tr_b16 v[46:47], v8 offset:52224
  buffer_load_dwordx4 v17, s[56:59], s35 offen offset:1024 lds
  v_mfma_f32_16x16x32_bf16 v[176:179], v[80:83], a[208:211], v[176:179]
  ds_read_b64_tr_b16 v[48:49], v9 offset:32768
  v_mfma_f32_16x16x32_bf16 v[176:179], v[84:87], a[216:219], v[176:179]
  ds_read_b64_tr_b16 v[50:51], v9 offset:33792
  v_mfma_f32_16x16x32_bf16 v[180:183], v[84:87], a[220:223], v[180:183]
  s_add_u32 s36, s3, 966656
  ds_read_b64_tr_b16 v[52:53], v9 offset:34816
  v_mfma_f32_16x16x32_bf16 v[180:183], v[80:83], a[212:215], v[180:183]
  s_waitcnt lgkmcnt(11)
  s_add_u32 m0, s43, 49152
  ds_read_b64_tr_b16 v[54:55], v9 offset:35840
  v_mfma_f32_16x16x32_bf16 v[188:191], v[88:91], a[212:215], v[188:191]
  ds_read_b64_tr_b16 v[56:57], v9 offset:49152
  buffer_load_dwordx4 v17, s[56:59], s36 offen offset:2048 lds
  v_mfma_f32_16x16x32_bf16 v[188:191], v[92:95], a[220:223], v[188:191]
  ds_read_b64_tr_b16 v[58:59], v9 offset:50176
  v_mfma_f32_16x16x32_bf16 v[184:187], v[92:95], a[216:219], v[184:187]
  ds_read_b64_tr_b16 v[60:61], v9 offset:51200
  v_mfma_f32_16x16x32_bf16 v[184:187], v[88:91], a[208:211], v[184:187]
  s_waitcnt vmcnt(9) lgkmcnt(11)
  ds_read_b64_tr_b16 v[62:63], v9 offset:52224
  v_mfma_f32_16x16x32_bf16 v[128:131], v[32:35], a[224:227], v[128:131]
  ds_read_b64_tr_b16 v[64:65], v10 offset:32768
  v_mfma_f32_16x16x32_bf16 v[128:131], v[36:39], a[232:235], v[128:131]
  s_add_u32 s37, s3, 1009664
  s_add_u32 m0, s43, 49152
  ds_read_b64_tr_b16 v[66:67], v10 offset:33792
  v_mfma_f32_16x16x32_bf16 v[132:135], v[36:39], a[236:239], v[132:135]
  ds_read_b64_tr_b16 v[68:69], v10 offset:34816
  buffer_load_dwordx4 v17, s[56:59], s37 offen offset:3072 lds
  v_mfma_f32_16x16x32_bf16 v[132:135], v[32:35], a[228:231], v[132:135]
  s_waitcnt lgkmcnt(11)
  ds_read_b64_tr_b16 v[70:71], v10 offset:35840
  v_mfma_f32_16x16x32_bf16 v[128:131], v[40:43], a[240:243], v[128:131]
  ds_read_b64_tr_b16 v[72:73], v10 offset:49152
  v_mfma_f32_16x16x32_bf16 v[128:131], v[44:47], a[248:251], v[128:131]
  s_add_u32 s34, s3, 1056768
  s_mov_b32 s45, 16384
  ds_read_b64_tr_b16 v[74:75], v10 offset:50176
  v_mfma_f32_16x16x32_bf16 v[132:135], v[44:47], a[252:255], v[132:135]
  s_add_u32 m0, s43, 65536
  ds_read_b64_tr_b16 v[76:77], v10 offset:51200
  v_mfma_f32_16x16x32_bf16 v[132:135], v[40:43], a[244:247], v[132:135]
  s_waitcnt lgkmcnt(11)
  ds_read_b64_tr_b16 v[78:79], v10 offset:52224
  buffer_load_dwordx4 v17, s[56:59], s34 offen offset:0 lds
  v_mfma_f32_16x16x32_bf16 v[136:139], v[48:51], a[224:227], v[136:139]
  ds_read_b64_tr_b16 v[80:81], v11 offset:32768
  v_mfma_f32_16x16x32_bf16 v[136:139], v[52:55], a[232:235], v[136:139]
  ds_read_b64_tr_b16 v[82:83], v11 offset:33792
  v_mfma_f32_16x16x32_bf16 v[140:143], v[52:55], a[236:239], v[140:143]
  s_add_u32 s35, s3, 1099776
  ds_read_b64_tr_b16 v[84:85], v11 offset:34816
  v_mfma_f32_16x16x32_bf16 v[140:143], v[48:51], a[228:231], v[140:143]
  s_waitcnt lgkmcnt(11)
  s_add_u32 m0, s43, 65536
  ds_read_b64_tr_b16 v[86:87], v11 offset:35840
  v_mfma_f32_16x16x32_bf16 v[136:139], v[56:59], a[240:243], v[136:139]
  ds_read_b64_tr_b16 v[88:89], v11 offset:49152
  buffer_load_dwordx4 v17, s[56:59], s35 offen offset:1024 lds
  v_mfma_f32_16x16x32_bf16 v[136:139], v[60:63], a[248:251], v[136:139]
  ds_read_b64_tr_b16 v[90:91], v11 offset:50176
  v_mfma_f32_16x16x32_bf16 v[140:143], v[60:63], a[252:255], v[140:143]
  ds_read_b64_tr_b16 v[92:93], v11 offset:51200
  v_mfma_f32_16x16x32_bf16 v[140:143], v[56:59], a[244:247], v[140:143]
  s_waitcnt vmcnt(12) lgkmcnt(11)
  ds_read_b64_tr_b16 v[94:95], v11 offset:52224
  v_mfma_f32_16x16x32_bf16 v[144:147], v[64:67], a[224:227], v[144:147]
  s_waitcnt vmcnt(25)
  s_barrier
  ds_read_b64_tr_b16 v[32:33], v12 offset:32768
  v_mfma_f32_16x16x32_bf16 v[144:147], v[68:71], a[232:235], v[144:147]
  s_add_u32 s36, s3, 1142784
  s_add_u32 m0, s43, 65536
  ds_read_b64_tr_b16 v[34:35], v12 offset:33792
  v_mfma_f32_16x16x32_bf16 v[148:151], v[68:71], a[236:239], v[148:151]
  ds_read_b64_tr_b16 v[36:37], v12 offset:34816
  buffer_load_dwordx4 v17, s[56:59], s36 offen offset:2048 lds
  v_mfma_f32_16x16x32_bf16 v[148:151], v[64:67], a[228:231], v[148:151]
  s_waitcnt lgkmcnt(11)
  ds_read_b64_tr_b16 v[38:39], v12 offset:35840
  v_cvt_pk_bf16_f32 v128, v128, v129
  v_mfma_f32_16x16x32_bf16 v[144:147], v[72:75], a[240:243], v[144:147]
  ds_read_b64_tr_b16 v[40:41], v12 offset:49152
  v_cvt_pk_bf16_f32 v129, v130, v131
  v_mfma_f32_16x16x32_bf16 v[144:147], v[76:79], a[248:251], v[144:147]
  s_add_u32 s37, s3, 1185792
  ds_read_b64_tr_b16 v[42:43], v12 offset:50176
  v_cvt_pk_bf16_f32 v130, v136, v137
  v_mfma_f32_16x16x32_bf16 v[148:151], v[76:79], a[252:255], v[148:151]
  s_add_u32 m0, s43, 65536
  ds_read_b64_tr_b16 v[44:45], v12 offset:51200
  v_cvt_pk_bf16_f32 v131, v138, v139
  v_mfma_f32_16x16x32_bf16 v[148:151], v[72:75], a[244:247], v[148:151]
  s_waitcnt lgkmcnt(11)
  ds_read_b64_tr_b16 v[46:47], v12 offset:52224
  buffer_load_dwordx4 v17, s[56:59], s37 offen offset:3072 lds
  v_mfma_f32_16x16x32_bf16 v[152:155], v[80:83], a[224:227], v[152:155]
  ds_read_b64_tr_b16 v[48:49], v13 offset:32768
  buffer_store_dwordx4 v[128:131], v19, s[12:15], 0 offen offset:0 sc1
  v_mfma_f32_16x16x32_bf16 v[152:155], v[84:87], a[232:235], v[152:155]
  ds_read_b64_tr_b16 v[50:51], v13 offset:33792
  v_cvt_pk_bf16_f32 v132, v132, v133
  v_mfma_f32_16x16x32_bf16 v[156:159], v[84:87], a[236:239], v[156:159]
  s_add_u32 s34, s3, 1232896
  ds_read_b64_tr_b16 v[52:53], v13 offset:34816
  v_cvt_pk_bf16_f32 v133, v134, v135
  v_mfma_f32_16x16x32_bf16 v[156:159], v[80:83], a[228:231], v[156:159]
  s_waitcnt lgkmcnt(11)
  s_add_u32 m0, s43, 81920
  ds_read_b64_tr_b16 v[54:55], v13 offset:35840
  v_cvt_pk_bf16_f32 v134, v140, v141
  v_mfma_f32_16x16x32_bf16 v[152:155], v[88:91], a[240:243], v[152:155]
  ds_read_b64_tr_b16 v[56:57], v13 offset:49152
  buffer_load_dwordx4 v17, s[56:59], s34 offen offset:0 lds
  v_cvt_pk_bf16_f32 v135, v142, v143
  v_mfma_f32_16x16x32_bf16 v[152:155], v[92:95], a[248:251], v[152:155]
  ds_read_b64_tr_b16 v[58:59], v13 offset:50176
  v_mfma_f32_16x16x32_bf16 v[156:159], v[92:95], a[252:255], v[156:159]
  ds_read_b64_tr_b16 v[60:61], v13 offset:51200
  buffer_store_dwordx4 v[132:135], v19, s[12:15], s45 offen offset:0 sc1
  v_mfma_f32_16x16x32_bf16 v[156:159], v[88:91], a[244:247], v[156:159]
  s_waitcnt vmcnt(17) lgkmcnt(11)
  ds_read_b64_tr_b16 v[62:63], v13 offset:52224
  v_mfma_f32_16x16x32_bf16 v[160:163], v[32:35], a[224:227], v[160:163]
  ds_read_b64_tr_b16 v[64:65], v14 offset:32768
  v_mfma_f32_16x16x32_bf16 v[160:163], v[36:39], a[232:235], v[160:163]
  s_add_u32 s35, s3, 1275904
  s_add_u32 m0, s43, 81920
  ds_read_b64_tr_b16 v[66:67], v14 offset:33792
  v_mfma_f32_16x16x32_bf16 v[164:167], v[36:39], a[236:239], v[164:167]
  ds_read_b64_tr_b16 v[68:69], v14 offset:34816
  buffer_load_dwordx4 v17, s[56:59], s35 offen offset:1024 lds
  v_mfma_f32_16x16x32_bf16 v[164:167], v[32:35], a[228:231], v[164:167]
  s_waitcnt lgkmcnt(11)
  ds_read_b64_tr_b16 v[70:71], v14 offset:35840
  v_cvt_pk_bf16_f32 v144, v144, v145
  v_mfma_f32_16x16x32_bf16 v[160:163], v[40:43], a[240:243], v[160:163]
  ds_read_b64_tr_b16 v[72:73], v14 offset:49152
  v_cvt_pk_bf16_f32 v145, v146, v147
  v_mfma_f32_16x16x32_bf16 v[160:163], v[44:47], a[248:251], v[160:163]
  s_add_u32 s36, s3, 1318912
  ds_read_b64_tr_b16 v[74:75], v14 offset:50176
  v_cvt_pk_bf16_f32 v146, v152, v153
  v_mfma_f32_16x16x32_bf16 v[164:167], v[44:47], a[252:255], v[164:167]
  s_add_u32 m0, s43, 81920
  ds_read_b64_tr_b16 v[76:77], v14 offset:51200
  v_cvt_pk_bf16_f32 v147, v154, v155
  v_mfma_f32_16x16x32_bf16 v[164:167], v[40:43], a[244:247], v[164:167]
  s_waitcnt lgkmcnt(11)
  ds_read_b64_tr_b16 v[78:79], v14 offset:52224
  buffer_load_dwordx4 v17, s[56:59], s36 offen offset:2048 lds
  v_mfma_f32_16x16x32_bf16 v[168:171], v[48:51], a[224:227], v[168:171]
  ds_read_b64_tr_b16 v[80:81], v15 offset:32768
  buffer_store_dwordx4 v[144:147], v19, s[12:15], 0 offen offset:1024 sc1
  v_mfma_f32_16x16x32_bf16 v[168:171], v[52:55], a[232:235], v[168:171]
  ds_read_b64_tr_b16 v[82:83], v15 offset:33792
  v_cvt_pk_bf16_f32 v148, v148, v149
  v_mfma_f32_16x16x32_bf16 v[172:175], v[52:55], a[236:239], v[172:175]
  s_add_u32 s37, s3, 1361920
  ds_read_b64_tr_b16 v[84:85], v15 offset:34816
  v_cvt_pk_bf16_f32 v149, v150, v151
  v_mfma_f32_16x16x32_bf16 v[172:175], v[48:51], a[228:231], v[172:175]
  s_waitcnt lgkmcnt(11)
  s_add_u32 m0, s43, 81920
  ds_read_b64_tr_b16 v[86:87], v15 offset:35840
  v_cvt_pk_bf16_f32 v150, v156, v157
  v_mfma_f32_16x16x32_bf16 v[168:171], v[56:59], a[240:243], v[168:171]
  ds_read_b64_tr_b16 v[88:89], v15 offset:49152
  buffer_load_dwordx4 v17, s[56:59], s37 offen offset:3072 lds
  v_cvt_pk_bf16_f32 v151, v158, v159
  v_mfma_f32_16x16x32_bf16 v[168:171], v[60:63], a[248:251], v[168:171]
  ds_read_b64_tr_b16 v[90:91], v15 offset:50176
  v_mfma_f32_16x16x32_bf16 v[172:175], v[60:63], a[252:255], v[172:175]
  ds_read_b64_tr_b16 v[92:93], v15 offset:51200
  buffer_store_dwordx4 v[148:151], v19, s[12:15], s45 offen offset:1024 sc1
  v_mfma_f32_16x16x32_bf16 v[172:175], v[56:59], a[244:247], v[172:175]
  s_waitcnt vmcnt(22) lgkmcnt(11)
  ds_read_b64_tr_b16 v[94:95], v15 offset:52224
  v_mfma_f32_16x16x32_bf16 v[176:179], v[64:67], a[224:227], v[176:179]
  v_mfma_f32_16x16x32_bf16 v[176:179], v[68:71], a[232:235], v[176:179]
  v_mfma_f32_16x16x32_bf16 v[180:183], v[68:71], a[236:239], v[180:183]
  v_mfma_f32_16x16x32_bf16 v[180:183], v[64:67], a[228:231], v[180:183]
  s_waitcnt lgkmcnt(8)
  v_cvt_pk_bf16_f32 v160, v160, v161
  v_mfma_f32_16x16x32_bf16 v[176:179], v[72:75], a[240:243], v[176:179]
  v_cvt_pk_bf16_f32 v161, v162, v163
  v_mfma_f32_16x16x32_bf16 v[176:179], v[76:79], a[248:251], v[176:179]
  v_cvt_pk_bf16_f32 v162, v168, v169
  v_mfma_f32_16x16x32_bf16 v[180:183], v[76:79], a[252:255], v[180:183]
  v_cvt_pk_bf16_f32 v163, v170, v171
  v_mfma_f32_16x16x32_bf16 v[180:183], v[72:75], a[244:247], v[180:183]
  s_waitcnt lgkmcnt(4)
  v_mfma_f32_16x16x32_bf16 v[184:187], v[80:83], a[224:227], v[184:187]
  buffer_store_dwordx4 v[160:163], v19, s[12:15], 0 offen offset:2048 sc1
  v_mfma_f32_16x16x32_bf16 v[184:187], v[84:87], a[232:235], v[184:187]
  v_cvt_pk_bf16_f32 v164, v164, v165
  v_mfma_f32_16x16x32_bf16 v[188:191], v[84:87], a[236:239], v[188:191]
  v_cvt_pk_bf16_f32 v165, v166, v167
  v_mfma_f32_16x16x32_bf16 v[188:191], v[80:83], a[228:231], v[188:191]
  s_waitcnt lgkmcnt(0)
  v_cvt_pk_bf16_f32 v166, v172, v173
  v_mfma_f32_16x16x32_bf16 v[184:187], v[88:91], a[240:243], v[184:187]
  v_cvt_pk_bf16_f32 v167, v174, v175
  v_mfma_f32_16x16x32_bf16 v[184:187], v[92:95], a[248:251], v[184:187]
  v_mfma_f32_16x16x32_bf16 v[188:191], v[92:95], a[252:255], v[188:191]
  buffer_store_dwordx4 v[164:167], v19, s[12:15], s45 offen offset:2048 sc1
  v_mfma_f32_16x16x32_bf16 v[188:191], v[88:91], a[244:247], v[188:191]
  s_nop 3
  v_cvt_pk_bf16_f32 v176, v176, v177
  v_cvt_pk_bf16_f32 v177, v178, v179
  v_cvt_pk_bf16_f32 v180, v180, v181
  v_cvt_pk_bf16_f32 v181, v182, v183
  v_cvt_pk_bf16_f32 v178, v184, v185
  v_cvt_pk_bf16_f32 v179, v186, v187
  buffer_store_dwordx4 v[176:179], v19, s[12:15], 0 offen offset:3072 sc1
  v_cvt_pk_bf16_f32 v182, v188, v189
  v_cvt_pk_bf16_f32 v183, v190, v191
  buffer_store_dwordx4 v[180:183], v19, s[12:15], s45 offen offset:3072 sc1
  s_add_u32 s8, s46, 20971520
  s_addc_u32 s9, s47, 0
  s_mov_b32 s10, 8388608
  s_mov_b32 s11, 0x20000
  s_add_u32 s34, s40, 2097152
  s_add_u32 s35, s40, 4194304
  s_add_u32 s36, s40, 6291456
  s_barrier
  s_add_u32 s12, s46, 23068672
  s_addc_u32 s13, s47, 0
  s_mov_b32 s14, 2097152
  s_mov_b32 s15, 0x20000
  s_add_u32 s16, s46, 20971520
  s_addc_u32 s17, s47, 0
  s_mov_b32 s18, 4194304
  s_mov_b32 s19, 0x20000
  s_cmp_eq_u32 s24, 2
  s_cselect_b32 s30, 1.0, 0
  v_mov_b32 v2, s30
  s_add_u32 s30, s26, 110592
  v_add_u32 v3, s30, v19
  s_waitcnt vmcnt(42)
  v_pk_add_f32 v[192:193], v[192:193], v[200:201]
  v_pk_add_f32 v[194:195], v[194:195], v[202:203]
  v_pk_add_f32 v[196:197], v[196:197], v[204:205]
  v_pk_add_f32 v[198:199], v[198:199], v[206:207]
  v_pk_add_f32 v[192:193], v[192:193], v[208:209]
  v_pk_add_f32 v[194:195], v[194:195], v[210:211]
  v_pk_add_f32 v[196:197], v[196:197], v[212:213]
  v_pk_add_f32 v[198:199], v[198:199], v[214:215]
  v_pk_add_f32 v[192:193], v[192:193], v[216:217]
  v_pk_add_f32 v[194:195], v[194:195], v[218:219]
  v_pk_add_f32 v[196:197], v[196:197], v[220:221]
  v_pk_add_f32 v[198:199], v[198:199], v[222:223]
  v_cvt_pk_bf16_f32 v200, v192, v193
  v_cvt_pk_bf16_f32 v201, v194, v195
  v_cvt_pk_bf16_f32 v202, v196, v197
  v_cvt_pk_bf16_f32 v203, v198, v199
  v_lshlrev_b32 v192, 16, v200
  v_and_b32 v193, 0xffff0000, v200
  v_lshlrev_b32 v194, 16, v201
  v_and_b32 v195, 0xffff0000, v201
  v_lshlrev_b32 v196, 16, v202
  v_and_b32 v197, 0xffff0000, v202
  v_lshlrev_b32 v198, 16, v203
  v_and_b32 v199, 0xffff0000, v203
  v_pk_add_f32 v[192:193], v[192:193], v[2:3] op_sel_hi:[1,0]
  v_pk_add_f32 v[194:195], v[194:195], v[2:3] op_sel_hi:[1,0]
  v_pk_add_f32 v[196:197], v[196:197], v[2:3] op_sel_hi:[1,0]
  v_pk_add_f32 v[198:199], v[198:199], v[2:3] op_sel_hi:[1,0]
  v_cvt_pk_bf16_f32 v200, v192, v193
  v_cvt_pk_bf16_f32 v201, v194, v195
  v_cvt_pk_bf16_f32 v202, v196, v197
  v_cvt_pk_bf16_f32 v203, v198, v199
  v_lshlrev_b32 v192, 16, v200
  v_and_b32 v193, 0xffff0000, v200
  v_lshlrev_b32 v194, 16, v201
  v_and_b32 v195, 0xffff0000, v201
  v_lshlrev_b32 v196, 16, v202
  v_and_b32 v197, 0xffff0000, v202
  v_lshlrev_b32 v198, 16, v203
  v_and_b32 v199, 0xffff0000, v203
  s_lshl_b32 s30, s24, 6
  v_xor_b32 v2, s30, v3
  v_xor_b32 v28, 32, v2
  ds_write_b128 v2, v[104:107] offset:8192
  ds_write_b128 v28, v[108:111] offset:9216
  ds_write_b128 v3, v[192:195]
  ds_write_b128 v3, v[196:199] offset:1024
  s_waitcnt lgkmcnt(0)
  s_mov_b64 vcc, -1
  s_cmp_eq_u32 s24, 0
  s_cbranch_scc1 L_attn_st14
  s_cmp_eq_u32 s24, 1
  s_cbranch_scc1 L_attn_st15
  s_cmp_eq_u32 s24, 2
  s_cbranch_scc1 L_attn_st16
  s_cmp_eq_u32 s24, 3
  s_cbranch_scc1 L_attn_walkdone4
L_attn_walkdone4:
  s_mov_b64 vcc, 0
  s_waitcnt vmcnt(0) lgkmcnt(0)
  s_barrier
  s_cmp_lg_u32 s24, 3
  s_cbranch_scc1 L_sync2_a
  v_mov_b32 v6, s68
  s_mov_b64 exec, 1
  s_mov_b32 s30, 32768
  buffer_store_dword v6, v5, s[64:67], s30 offen sc1
  s_mov_b64 exec, -1
L_sync2_a:
  s_mov_b32 s44, 15
  s_mov_b32 s31, 0
  s_mov_b32 s30, 32768
L_s2_poll:
  buffer_load_dword v7, v101, s[64:67], s30 offen sc1
  s_add_u32 s31, s31, 1
  s_waitcnt vmcnt(0)
  v_cmp_eq_u32 s[32:33], s68, v7
  s_cmp_gt_u32 s31, 2097152
  s_cselect_b32 s32, 15, s32
  s_and_b32 s45, s32, s44
  s_bitcmp1_b32 s45, 0
  s_cbranch_scc0 L_s2_n0
  buffer_load_dwordx4 v[32:35], v96, s[8:11], s40 offen offset:0 sc1
  buffer_load_dwordx4 v[36:39], v96, s[8:11], s40 offen offset:2048 sc1
L_s2_n0:
  s_bitcmp1_b32 s45, 1
  s_cbranch_scc0 L_s2_n1
  buffer_load_dwordx4 v[40:43], v96, s[8:11], s34 offen offset:0 sc1
  buffer_load_dwordx4 v[44:47], v96, s[8:11], s34 offen offset:2048 sc1
L_s2_n1:
  s_bitcmp1_b32 s45, 2
  s_cbranch_scc0 L_s2_n2
  buffer_load_dwordx4 v[48:51], v96, s[8:11], s35 offen offset:0 sc1
  buffer_load_dwordx4 v[52:55], v96, s[8:11], s35 offen offset:2048 sc1
L_s2_n2:
  s_bitcmp1_b32 s45, 3
  s_cbranch_scc0 L_s2_n3
  buffer_load_dwordx4 v[56:59], v96, s[8:11], s36 offen offset:0 sc1
  buffer_load_dwordx4 v[60:63], v96, s[8:11], s36 offen offset:2048 sc1
L_s2_n3:
  s_andn2_b32 s44, s44, s45
  s_cbranch_scc1 L_s2_poll
  v_xor_b32 v29, 32, v97
  v_xor_b32 v30, 128, v97
  v_xor_b32 v31, 160, v97
  ds_read_b64 v[104:105], v97
  ds_read_b64 v[106:107], v29
  ds_read_b64 v[108:109], v30
  ds_read_b64 v[110:111], v31
  v_add_u32 v98, 114688, v98
  s_add_u32 s30, s2, 64
  s_bfe_u32 s30, s30, 0x30004
  s_lshl_b32 s30, s30, 8
  s_add_u32 s30, s30, 120832
  v_add_u32 v2, s30, v16
  ds_read_b128 v[112:115], v98 offset:0
  ds_read_b128 v[116:119], v98 offset:64
  ds_read_b128 v[120:123], v98 offset:256
  ds_read_b128 v[124:127], v98 offset:320
  ds_read_b128 v[192:195], v98 offset:2048
  ds_read_b128 v[196:199], v98 offset:2112
  ds_read_b128 v[200:203], v98 offset:2304
  ds_read_b128 v[204:207], v98 offset:2368
  ds_read_b128 v[208:211], v98 offset:4096
  ds_read_b128 v[212:215], v98 offset:4160
  ds_read_b128 v[216:219], v98 offset:4352
  ds_read_b128 v[220:223], v98 offset:4416
  ds_read_b128 v[176:179], v2 offset:0
  ds_read_b128 v[180:183], v2 offset:64
  ds_read_b128 v[184:187], v2 offset:128
  ds_read_b128 v[188:191], v2 offset:192
  s_waitcnt lgkmcnt(15)
  v_lshlrev_b32 v128, 16, v104
  v_and_b32 v129, 0xffff0000, v104
  v_lshlrev_b32 v130, 16, v105
  v_and_b32 v131, 0xffff0000, v105
  v_lshlrev_b32 v132, 16, v106
  v_and_b32 v133, 0xffff0000, v106
  v_lshlrev_b32 v134, 16, v107
  v_and_b32 v135, 0xffff0000, v107
  v_lshlrev_b32 v136, 16, v108
  v_and_b32 v137, 0xffff0000, v108
  v_lshlrev_b32 v138, 16, v109
  v_and_b32 v139, 0xffff0000, v109
  v_lshlrev_b32 v140, 16, v110
  v_and_b32 v141, 0xffff0000, v110
  v_lshlrev_b32 v142, 16, v111
  v_and_b32 v143, 0xffff0000, v111
  s_waitcnt vmcnt(0)
  v_lshlrev_b32 v64, 16, v32
  v_and_b32 v65, 0xffff0000, v32
  v_lshlrev_b32 v66, 16, v33
  v_and_b32 v67, 0xffff0000, v33
  v_lshlrev_b32 v68, 16, v34
  v_and_b32 v69, 0xffff0000, v34
  v_lshlrev_b32 v70, 16, v35
  v_and_b32 v71, 0xffff0000, v35
L_attn_st14:
  s_cbranch_vccnz L_attn_walkdone4
  v_lshlrev_b32 v72, 16, v36
  v_and_b32 v73, 0xffff0000, v36
  v_lshlrev_b32 v74, 16, v37
  v_and_b32 v75, 0xffff0000, v37
  v_lshlrev_b32 v76, 16, v38
  v_and_b32 v77, 0xffff0000, v38
  v_lshlrev_b32 v78, 16, v39
  v_and_b32 v79, 0xffff0000, v39
  v_lshlrev_b32 v80, 16, v40
  v_and_b32 v81, 0xffff0000, v40
  v_pk_add_f32 v[64:65], v[64:65], v[80:81]
  v_lshlrev_b32 v82, 16, v41
  v_and_b32 v83, 0xffff0000, v41
  v_pk_add_f32 v[66:67], v[66:67], v[82:83]
  s_add_u32 m0, s43, 98304
  s_nop 0
  buffer_load_dwordx4 v232, s[60:63], s27 offen offset:0 lds
  v_lshlrev_b32 v80, 16, v42
  v_and_b32 v81, 0xffff0000, v42
  v_pk_add_f32 v[68:69], v[68:69], v[80:81]
  v_lshlrev_b32 v82, 16, v43
  v_and_b32 v83, 0xffff0000, v43
  v_pk_add_f32 v[70:71], v[70:71], v[82:83]
  s_add_u32 m0, s43, 98304
  s_nop 0
  buffer_load_dwordx4 v233, s[60:63], s27 offen offset:1024 lds
  v_lshlrev_b32 v80, 16, v44
  v_and_b32 v81, 0xffff0000, v44
  v_pk_add_f32 v[72:73], v[72:73], v[80:81]
  v_lshlrev_b32 v82, 16, v45
  v_and_b32 v83, 0xffff0000, v45
  v_pk_add_f32 v[74:75], v[74:75], v[82:83]
  s_add_u32 m0, s43, 98304
  s_nop 0
  buffer_load_dwordx4 v234, s[60:63], s27 offen offset:2048 lds
  v_lshlrev_b32 v80, 16, v46
  v_and_b32 v81, 0xffff0000, v46
  v_pk_add_f32 v[76:77], v[76:77], v[80:81]
  v_lshlrev_b32 v82, 16, v47
  v_and_b32 v83, 0xffff0000, v47
  v_pk_add_f32 v[78:79], v[78:79], v[82:83]
  s_add_u32 m0, s43, 98304
  s_nop 0
  buffer_load_dwordx4 v235, s[60:63], s27 offen offset:3072 lds
  v_lshlrev_b32 v80, 16, v48
  v_and_b32 v81, 0xffff0000, v48
  v_pk_add_f32 v[64:65], v[64:65], v[80:81]
  v_lshlrev_b32 v82, 16, v49
  v_and_b32 v83, 0xffff0000, v49
  v_pk_add_f32 v[66:67], v[66:67], v[82:83]
  v_lshlrev_b32 v80, 16, v50
  v_and_b32 v81, 0xffff0000, v50
  v_pk_add_f32 v[68:69], v[68:69], v[80:81]
  v_lshlrev_b32 v82, 16, v51
  v_and_b32 v83, 0xffff0000, v51
  v_pk_add_f32 v[70:71], v[70:71], v[82:83]
  v_lshlrev_b32 v80, 16, v52
  v_and_b32 v81, 0xffff0000, v52
  v_pk_add_f32 v[72:73], v[72:73], v[80:81]
  v_lshlrev_b32 v82, 16, v53
  v_and_b32 v83, 0xffff0000, v53
  v_pk_add_f32 v[74:75], v[74:75], v[82:83]
  v_lshlrev_b32 v80, 16, v54
  v_and_b32 v81, 0xffff0000, v54
  v_pk_add_f32 v[76:77], v[76:77], v[80:81]
  v_lshlrev_b32 v82, 16, v55
  v_and_b32 v83, 0xffff0000, v55
  v_pk_add_f32 v[78:79], v[78:79], v[82:83]
  s_waitcnt vmcnt(4)
  v_lshlrev_b32 v80, 16, v56
  v_and_b32 v81, 0xffff0000, v56
  v_pk_add_f32 v[64:65], v[64:65], v[80:81]
  v_lshlrev_b32 v82, 16, v57
  v_and_b32 v83, 0xffff0000, v57
  v_pk_add_f32 v[66:67], v[66:67], v[82:83]
  v_lshlrev_b32 v80, 16, v58
  v_and_b32 v81, 0xffff0000, v58
  v_pk_add_f32 v[68:69], v[68:69], v[80:81]
  v_lshlrev_b32 v82, 16, v59
  v_and_b32 v83, 0xffff0000, v59
  v_pk_add_f32 v[70:71], v[70:71], v[82:83]
  v_lshlrev_b32 v80, 16, v60
  v_and_b32 v81, 0xffff0000, v60
  v_pk_add_f32 v[72:73], v[72:73], v[80:81]
  v_lshlrev_b32 v82, 16, v61
  v_and_b32 v83, 0xffff0000, v61
  v_pk_add_f32 v[74:75], v[74:75], v[82:83]
  v_lshlrev_b32 v80, 16, v62
  v_and_b32 v81, 0xffff0000, v62
  v_pk_add_f32 v[76:77], v[76:77], v[80:81]
  v_lshlrev_b32 v82, 16, v63
  v_and_b32 v83, 0xffff0000, v63
  v_pk_add_f32 v[78:79], v[78:79], v[82:83]
  s_waitcnt lgkmcnt(0)
  v_pk_fma_f32 v[64:65], v[64:65], v[112:113], v[128:129]
  v_pk_fma_f32 v[66:67], v[66:67], v[114:115], v[130:131]
  v_pk_fma_f32 v[68:69], v[68:69], v[116:117], v[132:133]
  v_pk_fma_f32 v[70:71], v[70:71], v[118:119], v[134:135]
  v_pk_fma_f32 v[72:73], v[72:73], v[120:121], v[136:137]
  v_pk_fma_f32 v[74:75], v[74:75], v[122:123], v[138:139]
  v_pk_fma_f32 v[76:77], v[76:77], v[124:125], v[140:141]
  v_pk_fma_f32 v[78:79], v[78:79], v[126:127], v[142:143]
  v_cvt_pk_bf16_f32 v104, v64, v65
  v_cvt_pk_bf16_f32 v105, v66, v67
  v_cvt_pk_bf16_f32 v106, v68, v69
  v_cvt_pk_bf16_f32 v107, v70, v71
  v_cvt_pk_bf16_f32 v108, v72, v73
  v_cvt_pk_bf16_f32 v109, v74, v75
  v_cvt_pk_bf16_f32 v110, v76, v77
  v_cvt_pk_bf16_f32 v111, v78, v79
  v_lshlrev_b32 v64, 16, v104
  v_and_b32 v65, 0xffff0000, v104
  v_lshlrev_b32 v66, 16, v105
  v_and_b32 v67, 0xffff0000, v105
  v_lshlrev_b32 v68, 16, v106
  v_and_b32 v69, 0xffff0000, v106
  v_lshlrev_b32 v70, 16, v107
  v_and_b32 v71, 0xffff0000, v107
  v_lshlrev_b32 v72, 16, v108
  v_and_b32 v73, 0xffff0000, v108
  v_lshlrev_b32 v74, 16, v109
  v_and_b32 v75, 0xffff0000, v109
  v_lshlrev_b32 v76, 16, v110
  v_and_b32 v77, 0xffff0000, v110
  v_lshlrev_b32 v78, 16, v111
  v_and_b32 v79, 0xffff0000, v111
  buffer_store_dwordx4 v[104:107], v96, s[16:19], s40 offen offset:0 sc1
  buffer_store_dwordx4 v[108:111], v96, s[16:19], s40 offen offset:2048 sc1
  v_pk_add_f32 v[32:33], v[64:65], v[66:67]
  v_pk_add_f32 v[32:33], v[32:33], v[68:69]
  v_pk_add_f32 v[32:33], v[32:33], v[70:71]
  v_pk_add_f32 v[32:33], v[32:33], v[72:73]
  v_pk_add_f32 v[32:33], v[32:33], v[74:75]
  v_pk_add_f32 v[32:33], v[32:33], v[76:77]
  v_pk_add_f32 v[32:33], v[32:33], v[78:79]
  v_add_f32 v32, v32, v33
  s_nop 1
  v_add_f32_dpp v32, v32, v32 row_ror:8 row_mask:0xf bank_mask:0xf
  v_mov_b32 v33, v32
  s_nop 1
  v_permlane32_swap_b32 v32, v33
  v_add_f32 v32, v32, v33
  v_mov_b32 v33, v32
  s_nop 1
  v_permlane16_swap_b32 v32, v33
  v_add_f32 v32, v32, v33
  v_mul_f32 v84, 0x3c000000, v32
  ds_write_b32 v99, v84
  v_pk_add_f32 v[64:65], v[64:65], v[84:85] op_sel_hi:[1,0] neg_lo:[0,1] neg_hi:[0,1]
  v_pk_add_f32 v[66:67], v[66:67], v[84:85] op_sel_hi:[1,0] neg_lo:[0,1] neg_hi:[0,1]
  v_pk_add_f32 v[68:69], v[68:69], v[84:85] op_sel_hi:[1,0] neg_lo:[0,1] neg_hi:[0,1]
  v_pk_add_f32 v[70:71], v[70:71], v[84:85] op_sel_hi:[1,0] neg_lo:[0,1] neg_hi:[0,1]
  v_pk_add_f32 v[72:73], v[72:73], v[84:85] op_sel_hi:[1,0] neg_lo:[0,1] neg_hi:[0,1]
  v_pk_add_f32 v[74:75], v[74:75], v[84:85] op_sel_hi:[1,0] neg_lo:[0,1] neg_hi:[0,1]
  v_pk_add_f32 v[76:77], v[76:77], v[84:85] op_sel_hi:[1,0] neg_lo:[0,1] neg_hi:[0,1]
  v_pk_add_f32 v[78:79], v[78:79], v[84:85] op_sel_hi:[1,0] neg_lo:[0,1] neg_hi:[0,1]
  v_pk_mul_f32 v[32:33], v[64:65], v[64:65]
  v_pk_fma_f32 v[32:33], v[66:67], v[66:67], v[32:33]
  v_pk_fma_f32 v[32:33], v[68:69], v[68:69], v[32:33]
  v_pk_fma_f32 v[32:33], v[70:71], v[70:71], v[32:33]
  v_pk_fma_f32 v[32:33], v[72:73], v[72:73], v[32:33]
  v_pk_fma_f32 v[32:33], v[74:75], v[74:75], v[32:33]
  v_pk_fma_f32 v[32:33], v[76:77], v[76:77], v[32:33]
  v_pk_fma_f32 v[32:33], v[78:79], v[78:79], v[32:33]
  v_add_f32 v32, v32, v33
  s_nop 1
  v_add_f32_dpp v32, v32, v32 row_ror:8 row_mask:0xf bank_mask:0xf
  v_mov_b32 v33, v32
  s_nop 1
  v_permlane32_swap_b32 v32, v33
  v_add_f32 v32, v32, v33
  v_mov_b32 v33, v32
  s_nop 1
  v_permlane16_swap_b32 v32, v33
  v_add_f32 v32, v32, v33
  ds_write_b32 v99, v32 offset:16
  s_waitcnt lgkmcnt(0)
  s_barrier
  ds_read_b128 v[36:39], v100
  ds_read_b128 v[40:43], v100 offset:16
  s_waitcnt lgkmcnt(1)
  v_pk_add_f32 v[32:33], v[36:37], v[38:39]
  v_add_f32 v32, v32, v33
  v_mul_f32 v32, 0x3e800000, v32
  v_pk_add_f32 v[36:37], v[36:37], v[32:33] op_sel_hi:[1,0] neg_lo:[0,1] neg_hi:[0,1]
  v_pk_add_f32 v[38:39], v[38:39], v[32:33] op_sel_hi:[1,0] neg_lo:[0,1] neg_hi:[0,1]
  v_pk_mul_f32 v[36:37], v[36:37], v[36:37]
  v_pk_fma_f32 v[36:37], v[38:39], v[38:39], v[36:37]
  v_cvt_pk_bf16_f32 v34, v32, v32
  v_and_b32 v34, 0xffff0000, v34
  v_add_f32 v36, v36, v37
  v_sub_f32 v34, v84, v34
  s_waitcnt lgkmcnt(0)
  v_pk_add_f32 v[40:41], v[40:41], v[42:43]
  v_mul_f32 v36, 0x3e800000, v36
  v_add_f32 v40, v40, v41
  v_fmac_f32 v36, 0x3b000000, v40
  v_cvt_pk_bf16_f32 v36, v36, v36
  v_and_b32 v36, 0xffff0000, v36
  v_add_f32 v36, 0x3727c5ac, v36
  v_cvt_pk_bf16_f32 v36, v36, v36
  v_and_b32 v36, 0xffff0000, v36
  v_sqrt_f32 v36, v36
  s_nop 0
  v_cvt_pk_bf16_f32 v36, v36, v36
  v_and_b32 v36, 0xffff0000, v36
  v_rcp_f32 v84, v36
  s_nop 0
  v_mul_f32 v85, v34, v84
  v_pk_fma_f32 v[64:65], v[64:65], v[84:85], v[84:85] op_sel:[0,0,1] op_sel_hi:[1,0,1]
  v_pk_fma_f32 v[66:67], v[66:67], v[84:85], v[84:85] op_sel:[0,0,1] op_sel_hi:[1,0,1]
  v_pk_fma_f32 v[68:69], v[68:69], v[84:85], v[84:85] op_sel:[0,0,1] op_sel_hi:[1,0,1]
  v_pk_fma_f32 v[70:71], v[70:71], v[84:85], v[84:85] op_sel:[0,0,1] op_sel_hi:[1,0,1]
  v_pk_fma_f32 v[72:73], v[72:73], v[84:85], v[84:85] op_sel:[0,0,1] op_sel_hi:[1,0,1]
  v_pk_fma_f32 v[74:75], v[74:75], v[84:85], v[84:85] op_sel:[0,0,1] op_sel_hi:[1,0,1]
  v_pk_fma_f32 v[76:77], v[76:77], v[84:85], v[84:85] op_sel:[0,0,1] op_sel_hi:[1,0,1]
  v_pk_fma_f32 v[78:79], v[78:79], v[84:85], v[84:85] op_sel:[0,0,1] op_sel_hi:[1,0,1]
  v_pk_fma_f32 v[64:65], v[64:65], v[208:209], v[192:193]
  v_pk_fma_f32 v[66:67], v[66:67], v[210:211], v[194:195]
  v_pk_fma_f32 v[68:69], v[68:69], v[212:213], v[196:197]
  v_pk_fma_f32 v[70:71], v[70:71], v[214:215], v[198:199]
  v_pk_fma_f32 v[72:73], v[72:73], v[216:217], v[200:201]
  v_pk_fma_f32 v[74:75], v[74:75], v[218:219], v[202:203]
  v_pk_fma_f32 v[76:77], v[76:77], v[220:221], v[204:205]
  v_pk_fma_f32 v[78:79], v[78:79], v[222:223], v[206:207]
  v_cvt_pk_bf16_f32 v88, v64, v65
  v_cvt_pk_bf16_f32 v89, v66, v67
  v_cvt_pk_bf16_f32 v90, v68, v69
  v_cvt_pk_bf16_f32 v91, v70, v71
  v_cvt_pk_bf16_f32 v92, v72, v73
  v_cvt_pk_bf16_f32 v93, v74, v75
  v_cvt_pk_bf16_f32 v94, v76, v77
  v_cvt_pk_bf16_f32 v95, v78, v79
  s_or_b32 s7, s40, s5
  buffer_store_dwordx4 v[88:91], v96, s[12:15], s7 offen offset:0
  s_or_b32 s7, s40, s6
  buffer_store_dwordx4 v[88:91], v96, s[12:15], s7 offen offset:0 sc1
  s_or_b32 s7, s40, s5
  buffer_store_dwordx4 v[92:95], v96, s[12:15], s7 offen offset:2048
  s_or_b32 s7, s40, s6
  buffer_store_dwordx4 v[92:95], v96, s[12:15], s7 offen offset:2048 sc1
  s_add_u32 s26, s40, 2097152
  s_or_b32 s26, s26, s5
  ds_read_b64_tr_b16 v[32:33], v224 offset:0
  ds_read_b64_tr_b16 v[34:35], v224 offset:1024
  ds_read_b64_tr_b16 v[36:37], v224 offset:2048
  ds_read_b64_tr_b16 v[38:39], v224 offset:3072
  ds_read_b64_tr_b16 v[40:41], v225 offset:0
  ds_read_b64_tr_b16 v[42:43], v225 offset:1024
  ds_read_b64_tr_b16 v[44:45], v225 offset:2048
  ds_read_b64_tr_b16 v[46:47], v225 offset:3072
  ds_read_b64_tr_b16 v[48:49], v226 offset:0
  ds_read_b64_tr_b16 v[50:51], v226 offset:1024
  ds_read_b64_tr_b16 v[52:53], v226 offset:2048
  ds_read_b64_tr_b16 v[54:55], v226 offset:3072
  s_lshl_b32 s30, s42, 3
  s_lshl_b32 s31, s24, 1
  s_add_u32 s40, s30, s31
  s_lshl_b32 s30, s40, 14
  s_add_u32 s30, s30, 23068672
  s_add_u32 s8, s46, s30
  s_addc_u32 s9, s47, 0
  s_mov_b32 s10, 32768
  s_mov_b32 s11, 0x20000
  s_mul_i32 s4, s42, 352256
  s_add_u32 s4, s4, 33554432
  s_mul_i32 s30, s24, 88064
  s_mul_i32 s31, s38, 3072
  s_add_u32 s30, s30, s31
  s_add_u32 s30, s30, s4
  s_add_u32 s12, s46, s30
  s_addc_u32 s13, s47, 0
  s_mov_b32 s14, 47104
  s_mov_b32 s15, 0x20000
  s_cmp_eq_u32 s38, 14
  s_cselect_b32 s29, 1, 3
  s_cmp_eq_u32 s38, 15
  s_cselect_b32 s29, 0, s29
  s_lshl_b32 s30, s42, 1
  s_bfe_u32 s31, s2, 0x10003
  s_add_u32 s39, s30, s31
  s_lshl_b32 s40, s39, 2
  s_add_u32 s40, s40, s24
  s_lshl_b32 s40, s40, 14
  s_add_u32 s41, s2, 64
  s_bfe_u32 s41, s41, 0x30004
  s_lshl_b32 s28, s41, 11
  s_add_u32 s28, s28, s40
  v_and_b32 v2, 3, v1
  s_lshl_b32 s30, s24, 2
  v_add_u32 v2, s30, v2
  s_and_b32 s30, s2, 0x87
  v_lshl_or_b32 v2, v2, 3, s30
  v_lshlrev_b32 v2, 7, v2
  s_waitcnt vmcnt(0) lgkmcnt(0)
  s_barrier
  s_cmp_lg_u32 s24, 3
  s_cbranch_scc1 L_sync3_a
  v_mov_b32 v6, s68
  s_mov_b64 exec, 1
  s_mov_b32 s30, 65536
  s_or_b32 s7, s30, s5
  buffer_store_dword v6, v5, s[64:67], s7 offen
  s_or_b32 s30, s30, s6
  buffer_store_dword v6, v5, s[64:67], s30 offen sc1
  s_mov_b64 exec, -1
L_sync3_a:
  s_mov_b32 s31, 0
  s_mov_b32 s30, 65536
L_sync3_poll:
  buffer_load_dword v7, v2, s[64:67], s30 offen sc1
  s_add_u32 s31, s31, 1
  s_waitcnt vmcnt(0)
  v_cmp_eq_u32 s[32:33], s68, v7
  s_cmp_gt_u32 s31, 2097152
  s_cbranch_scc1 L_sync3_x
  s_cmp_eq_u64 s[32:33], -1
  s_cbranch_scc0 L_sync3_poll
L_sync3_x:
  s_mov_b32 s36, 0
  buffer_load_dwordx4 a[0:3], v19, s[8:11], s36 offen sc1
  s_mov_b32 s37, 16384
  buffer_load_dwordx4 a[4:7], v19, s[8:11], s37 offen sc1
  s_mov_b32 s36, 1024
  buffer_load_dwordx4 a[8:11], v19, s[8:11], s36 offen sc1
  s_mov_b32 s37, 17408
  buffer_load_dwordx4 a[12:15], v19, s[8:11], s37 offen sc1
  s_mov_b32 s36, 2048
  buffer_load_dwordx4 a[16:19], v19, s[8:11], s36 offen sc1
  s_mov_b32 s37, 18432
  buffer_load_dwordx4 a[20:23], v19, s[8:11], s37 offen sc1
  s_mov_b32 s36, 3072
  buffer_load_dwordx4 a[24:27], v19, s[8:11], s36 offen sc1
  s_mov_b32 s37, 19456
  buffer_load_dwordx4 a[28:31], v19, s[8:11], s37 offen sc1
  s_mov_b32 s36, 4096
  buffer_load_dwordx4 a[32:35], v19, s[8:11], s36 offen sc1
  s_mov_b32 s37, 20480
  buffer_load_dwordx4 a[36:39], v19, s[8:11], s37 offen sc1
  s_mov_b32 s36, 5120
  buffer_load_dwordx4 a[40:43], v19, s[8:11], s36 offen sc1
  s_mov_b32 s37, 21504
  buffer_load_dwordx4 a[44:47], v19, s[8:11], s37 offen sc1
  s_waitcnt vmcnt(8) lgkmcnt(8)
  v_mfma_f32_16x16x32_bf16 v[128:131], v[32:35], a[0:3], 0
  ds_read_b64_tr_b16 v[64:65], v227 offset:0
  v_mfma_f32_16x16x32_bf16 v[128:131], v[36:39], a[8:11], v[128:131]
  s_mov_b32 s36, 6144
  ds_read_b64_tr_b16 v[66:67], v227 offset:1024
  v_mfma_f32_16x16x32_bf16 v[132:135], v[36:39], a[12:15], 0
  ds_read_b64_tr_b16 v[68:69], v227 offset:2048
  buffer_load_dwordx4 a[48:51], v19, s[8:11], s36 offen sc1
  v_mfma_f32_16x16x32_bf16 v[132:135], v[32:35], a[4:7], v[132:135]
  s_waitcnt lgkmcnt(7)
  s_mov_b32 s37, 22528
  ds_read_b64_tr_b16 v[70:71], v227 offset:3072
  v_mfma_f32_16x16x32_bf16 v[140:143], v[40:43], a[4:7], 0
  ds_read_b64_tr_b16 v[72:73], v228 offset:0
  buffer_load_dwordx4 a[52:55], v19, s[8:11], s37 offen sc1
  v_mfma_f32_16x16x32_bf16 v[140:143], v[44:47], a[12:15], v[140:143]
  ds_read_b64_tr_b16 v[74:75], v228 offset:1024
  v_mfma_f32_16x16x32_bf16 v[136:139], v[44:47], a[8:11], 0
  s_mov_b32 s36, 7168
  ds_read_b64_tr_b16 v[76:77], v228 offset:2048
  v_mfma_f32_16x16x32_bf16 v[136:139], v[40:43], a[0:3], v[136:139]
  s_waitcnt lgkmcnt(7)
  ds_read_b64_tr_b16 v[78:79], v228 offset:3072
  buffer_load_dwordx4 a[56:59], v19, s[8:11], s36 offen sc1
  v_mfma_f32_16x16x32_bf16 v[144:147], v[48:51], a[0:3], 0
  ds_read_b64_tr_b16 v[80:81], v229 offset:0
  v_mfma_f32_16x16x32_bf16 v[144:147], v[52:55], a[8:11], v[144:147]
  s_mov_b32 s37, 23552
  ds_read_b64_tr_b16 v[82:83], v229 offset:1024
  v_mfma_f32_16x16x32_bf16 v[148:151], v[52:55], a[12:15], 0
  ds_read_b64_tr_b16 v[84:85], v229 offset:2048
  buffer_load_dwordx4 a[60:63], v19, s[8:11], s37 offen sc1
  v_mfma_f32_16x16x32_bf16 v[148:151], v[48:51], a[4:7], v[148:151]
  s_waitcnt vmcnt(12) lgkmcnt(7)
  ds_read_b64_tr_b16 v[86:87], v229 offset:3072
  v_mfma_f32_16x16x32_bf16 v[152:155], v[64:67], a[0:3], 0
  ds_read_b64_tr_b16 v[32:33], v224 offset:16384
  v_mfma_f32_16x16x32_bf16 v[152:155], v[68:71], a[8:11], v[152:155]
  s_mov_b32 s36, 8192
  ds_read_b64_tr_b16 v[34:35], v224 offset:17408
  v_mfma_f32_16x16x32_bf16 v[156:159], v[68:71], a[12:15], 0
  ds_read_b64_tr_b16 v[36:37], v224 offset:18432
  buffer_load_dwordx4 a[64:67], v19, s[8:11], s36 offen sc1
  v_mfma_f32_16x16x32_bf16 v[156:159], v[64:67], a[4:7], v[156:159]
  s_waitcnt lgkmcnt(7)
  s_mov_b32 s37, 24576
  ds_read_b64_tr_b16 v[38:39], v224 offset:19456
  v_mfma_f32_16x16x32_bf16 v[164:167], v[72:75], a[4:7], 0
  ds_read_b64_tr_b16 v[40:41], v225 offset:16384
  buffer_load_dwordx4 a[68:71], v19, s[8:11], s37 offen sc1
  v_mfma_f32_16x16x32_bf16 v[164:167], v[76:79], a[12:15], v[164:167]
  ds_read_b64_tr_b16 v[42:43], v225 offset:17408
  v_mfma_f32_16x16x32_bf16 v[160:163], v[76:79], a[8:11], 0
  s_mov_b32 s36, 9216
  ds_read_b64_tr_b16 v[44:45], v225 offset:18432
  v_mfma_f32_16x16x32_bf16 v[160:163], v[72:75], a[0:3], v[160:163]
  s_waitcnt lgkmcnt(7)
  ds_read_b64_tr_b16 v[46:47], v225 offset:19456
  buffer_load_dwordx4 a[72:75], v19, s[8:11], s36 offen sc1
  v_mfma_f32_16x16x32_bf16 v[168:171], v[80:83], a[0:3], 0
  ds_read_b64_tr_b16 v[48:49], v226 offset:16384
  v_mfma_f32_16x16x32_bf16 v[168:171], v[84:87], a[8:11], v[168:171]
  s_mov_b32 s37, 25600
  ds_read_b64_tr_b16 v[50:51], v226 offset:17408
  v_mfma_f32_16x16x32_bf16 v[172:175], v[84:87], a[12:15], 0
  ds_read_b64_tr_b16 v[52:53], v226 offset:18432
  buffer_load_dwordx4 a[76:79], v19, s[8:11], s37 offen sc1
  v_mfma_f32_16x16x32_bf16 v[172:175], v[80:83], a[4:7], v[172:175]
  s_waitcnt vmcnt(12) lgkmcnt(7)
  ds_read_b64_tr_b16 v[54:55], v226 offset:19456
  v_mfma_f32_16x16x32_bf16 v[128:131], v[32:35], a[16:19], v[128:131]
  s_barrier
  ds_read_b64_tr_b16 v[64:65], v227 offset:16384
  v_mfma_f32_16x16x32_bf16 v[128:131], v[36:39], a[24:27], v[128:131]
  s_mov_b32 s36, 10240
  ds_read_b64_tr_b16 v[66:67], v227 offset:17408
  v_mfma_f32_16x16x32_bf16 v[132:135], v[36:39], a[28:31], v[132:135]
  ds_read_b64_tr_b16 v[68:69], v227 offset:18432
  buffer_load_dwordx4 a[80:83], v19, s[8:11], s36 offen sc1
  v_mfma_f32_16x16x32_bf16 v[132:135], v[32:35], a[20:23], v[132:135]
  s_waitcnt lgkmcnt(7)
  s_mov_b32 s37, 26624
  ds_read_b64_tr_b16 v[70:71], v227 offset:19456
  v_mfma_f32_16x16x32_bf16 v[140:143], v[40:43], a[20:23], v[140:143]
  ds_read_b64_tr_b16 v[72:73], v228 offset:16384
  buffer_load_dwordx4 a[84:87], v19, s[8:11], s37 offen sc1
  v_mfma_f32_16x16x32_bf16 v[140:143], v[44:47], a[28:31], v[140:143]
  ds_read_b64_tr_b16 v[74:75], v228 offset:17408
  v_mfma_f32_16x16x32_bf16 v[136:139], v[44:47], a[24:27], v[136:139]
  s_mov_b32 s36, 11264
  ds_read_b64_tr_b16 v[76:77], v228 offset:18432
  v_mfma_f32_16x16x32_bf16 v[136:139], v[40:43], a[16:19], v[136:139]
  s_waitcnt lgkmcnt(7)
  ds_read_b64_tr_b16 v[78:79], v228 offset:19456
  buffer_load_dwordx4 a[88:91], v19, s[8:11], s36 offen sc1
  v_mfma_f32_16x16x32_bf16 v[144:147], v[48:51], a[16:19], v[144:147]
  ds_read_b64_tr_b16 v[80:81], v229 offset:16384
  v_mfma_f32_16x16x32_bf16 v[144:147], v[52:55], a[24:27], v[144:147]
  s_mov_b32 s37, 27648
  ds_read_b64_tr_b16 v[82:83], v229 offset:17408
  v_mfma_f32_16x16x32_bf16 v[148:151], v[52:55], a[28:31], v[148:151]
  ds_read_b64_tr_b16 v[84:85], v229 offset:18432
  buffer_load_dwordx4 a[92:95], v19, s[8:11], s37 offen sc1
  v_mfma_f32_16x16x32_bf16 v[148:151], v[48:51], a[20:23], v[148:151]
  s_waitcnt vmcnt(16) lgkmcnt(7)
  ds_read_b64_tr_b16 v[86:87], v229 offset:19456
  v_mfma_f32_16x16x32_bf16 v[152:155], v[64:67], a[16:19], v[152:155]
  ds_read_b64_tr_b16 v[32:33], v20 offset:0
  v_mfma_f32_16x16x32_bf16 v[152:155], v[68:71], a[24:27], v[152:155]
  s_mov_b32 s36, 12288
  ds_read_b64_tr_b16 v[34:35], v20 offset:1024
  v_mfma_f32_16x16x32_bf16 v[156:159], v[68:71], a[28:31], v[156:159]
  ds_read_b64_tr_b16 v[36:37], v20 offset:2048
  buffer_load_dwordx4 a[96:99], v19, s[8:11], s36 offen sc1
  v_mfma_f32_16x16x32_bf16 v[156:159], v[64:67], a[20:23], v[156:159]
  s_waitcnt lgkmcnt(7)
  s_mov_b32 s37, 28672
  ds_read_b64_tr_b16 v[38:39], v20 offset:3072
  v_mfma_f32_16x16x32_bf16 v[164:167], v[72:75], a[20:23], v[164:167]
  ds_read_b64_tr_b16 v[40:41], v21 offset:0
  buffer_load_dwordx4 a[100:103], v19, s[8:11], s37 offen sc1
  v_mfma_f32_16x16x32_bf16 v[164:167], v[76:79], a[28:31], v[164:167]
  ds_read_b64_tr_b16 v[42:43], v21 offset:1024
  v_mfma_f32_16x16x32_bf16 v[160:163], v[76:79], a[24:27], v[160:163]
  s_mov_b32 s36, 13312
  ds_read_b64_tr_b16 v[44:45], v21 offset:2048
  v_mfma_f32_16x16x32_bf16 v[160:163], v[72:75], a[16:19], v[160:163]
  s_waitcnt lgkmcnt(7)
  ds_read_b64_tr_b16 v[46:47], v21 offset:3072
  buffer_load_dwordx4 a[104:107], v19, s[8:11], s36 offen sc1
  v_mfma_f32_16x16x32_bf16 v[168:171], v[80:83], a[16:19], v[168:171]
  ds_read_b64_tr_b16 v[48:49], v22 offset:0
  v_mfma_f32_16x16x32_bf16 v[168:171], v[84:87], a[24:27], v[168:171]
  s_mov_b32 s37, 29696
  ds_read_b64_tr_b16 v[50:51], v22 offset:1024
  v_mfma_f32_16x16x32_bf16 v[172:175], v[84:87], a[28:31], v[172:175]
  ds_read_b64_tr_b16 v[52:53], v22 offset:2048
  buffer_load_dwordx4 a[108:111], v19, s[8:11], s37 offen sc1
  v_mfma_f32_16x16x32_bf16 v[172:175], v[80:83], a[20:23], v[172:175]
  s_waitcnt vmcnt(16) lgkmcnt(7)
  ds_read_b64_tr_b16 v[54:55], v22 offset:3072
  v_mfma_f32_16x16x32_bf16 v[128:131], v[32:35], a[32:35], v[128:131]
  s_barrier
  ds_read_b64_tr_b16 v[64:65], v23 offset:0
  v_mfma_f32_16x16x32_bf16 v[128:131], v[36:39], a[40:43], v[128:131]
  s_mov_b32 s36, 14336
  ds_read_b64_tr_b16 v[66:67], v23 offset:1024
  v_mfma_f32_16x16x32_bf16 v[132:135], v[36:39], a[44:47], v[132:135]
  ds_read_b64_tr_b16 v[68:69], v23 offset:2048
  buffer_load_dwordx4 a[112:115], v19, s[8:11], s36 offen sc1
  v_mfma_f32_16x16x32_bf16 v[132:135], v[32:35], a[36:39], v[132:135]
  s_waitcnt lgkmcnt(7)
  s_mov_b32 s37, 30720
  ds_read_b64_tr_b16 v[70:71], v23 offset:3072
  v_mfma_f32_16x16x32_bf16 v[140:143], v[40:43], a[36:39], v[140:143]
  ds_read_b64_tr_b16 v[72:73], v24 offset:0
  buffer_load_dwordx4 a[116:119], v19, s[8:11], s37 offen sc1
  v_mfma_f32_16x16x32_bf16 v[140:143], v[44:47], a[44:47], v[140:143]
  ds_read_b64_tr_b16 v[74:75], v24 offset:1024
  v_mfma_f32_16x16x32_bf16 v[136:139], v[44:47], a[40:43], v[136:139]
  s_mov_b32 s36, 15360
  ds_read_b64_tr_b16 v[76:77], v24 offset:2048
  v_mfma_f32_16x16x32_bf16 v[136:139], v[40:43], a[32:35], v[136:139]
  s_waitcnt lgkmcnt(7)
  ds_read_b64_tr_b16 v[78:79], v24 offset:3072
  buffer_load_dwordx4 a[120:123], v19, s[8:11], s36 offen sc1
  v_mfma_f32_16x16x32_bf16 v[144:147], v[48:51], a[32:35], v[144:147]
  ds_read_b64_tr_b16 v[80:81], v25 offset:0
  v_mfma_f32_16x16x32_bf16 v[144:147], v[52:55], a[40:43], v[144:147]
  s_mov_b32 s37, 31744
  ds_read_b64_tr_b16 v[82:83], v25 offset:1024
  v_mfma_f32_16x16x32_bf16 v[148:151], v[52:55], a[44:47], v[148:151]
  ds_read_b64_tr_b16 v[84:85], v25 offset:2048
  buffer_load_dwordx4 a[124:127], v19, s[8:11], s37 offen sc1
  v_mfma_f32_16x16x32_bf16 v[148:151], v[48:51], a[36:39], v[148:151]
  s_waitcnt vmcnt(20) lgkmcnt(7)
  ds_read_b64_tr_b16 v[86:87], v25 offset:3072
  v_mfma_f32_16x16x32_bf16 v[152:155], v[64:67], a[32:35], v[152:155]
  ds_read_b64_tr_b16 v[32:33], v20 offset:16384
  v_mfma_f32_16x16x32_bf16 v[152:155], v[68:71], a[40:43], v[152:155]
  s_add_u32 s27, s27, 131072
  s_cmp_ge_u32 s27, s25
  s_cselect_b32 s34, 1441792, 0
  s_sub_u32 s27, s27, s34
  s_add_u32 m0, s43, 114688
  ds_read_b64_tr_b16 v[34:35], v20 offset:17408
  v_mfma_f32_16x16x32_bf16 v[156:159], v[68:71], a[44:47], v[156:159]
  ds_read_b64_tr_b16 v[36:37], v20 offset:18432
  buffer_load_dwordx4 v232, s[60:63], s27 offen offset:0 lds
  v_mfma_f32_16x16x32_bf16 v[156:159], v[64:67], a[36:39], v[156:159]
  s_waitcnt lgkmcnt(7)
  ds_read_b64_tr_b16 v[38:39], v20 offset:19456
  v_mfma_f32_16x16x32_bf16 v[164:167], v[72:75], a[36:39], v[164:167]
  s_add_u32 m0, s43, 114688
  ds_read_b64_tr_b16 v[40:41], v21 offset:16384
  v_mfma_f32_16x16x32_bf16 v[164:167], v[76:79], a[44:47], v[164:167]
  ds_read_b64_tr_b16 v[42:43], v21 offset:17408
  buffer_load_dwordx4 v233, s[60:63], s27 offen offset:1024 lds
  v_mfma_f32_16x16x32_bf16 v[160:163], v[76:79], a[40:43], v[160:163]
  ds_read_b64_tr_b16 v[44:45], v21 offset:18432
  v_mfma_f32_16x16x32_bf16 v[160:163], v[72:75], a[32:35], v[160:163]
  s_waitcnt lgkmcnt(7)
  ds_read_b64_tr_b16 v[46:47], v21 offset:19456
  v_mfma_f32_16x16x32_bf16 v[168:171], v[80:83], a[32:35], v[168:171]
  s_add_u32 m0, s43, 114688
  ds_read_b64_tr_b16 v[48:49], v22 offset:16384
  v_mfma_f32_16x16x32_bf16 v[168:171], v[84:87], a[40:43], v[168:171]
  ds_read_b64_tr_b16 v[50:51], v22 offset:17408
  buffer_load_dwordx4 v234, s[60:63], s27 offen offset:2048 lds
  v_mfma_f32_16x16x32_bf16 v[172:175], v[84:87], a[44:47], v[172:175]
  ds_read_b64_tr_b16 v[52:53], v22 offset:18432
  v_mfma_f32_16x16x32_bf16 v[172:175], v[80:83], a[36:39], v[172:175]
  s_waitcnt vmcnt(19) lgkmcnt(7)
  ds_read_b64_tr_b16 v[54:55], v22 offset:19456
  v_mfma_f32_16x16x32_bf16 v[128:131], v[32:35], a[48:51], v[128:131]
  s_barrier
  ds_read_b64_tr_b16 v[64:65], v23 offset:16384
  v_mfma_f32_16x16x32_bf16 v[128:131], v[36:39], a[56:59], v[128:131]
  s_add_u32 m0, s43, 114688
  ds_read_b64_tr_b16 v[66:67], v23 offset:17408
  v_mfma_f32_16x16x32_bf16 v[132:135], v[36:39], a[60:63], v[132:135]
  ds_read_b64_tr_b16 v[68:69], v23 offset:18432
  buffer_load_dwordx4 v235, s[60:63], s27 offen offset:3072 lds
  v_mfma_f32_16x16x32_bf16 v[132:135], v[32:35], a[52:55], v[132:135]
  s_waitcnt lgkmcnt(7)
  s_add_u32 s27, s27, 131072
  s_cmp_ge_u32 s27, s25
  s_cselect_b32 s34, 1441792, 0
  s_sub_u32 s27, s27, s34
  ds_read_b64_tr_b16 v[70:71], v23 offset:19456
  v_mfma_f32_16x16x32_bf16 v[140:143], v[40:43], a[52:55], v[140:143]
  s_add_u32 m0, s43, 131072
  ds_read_b64_tr_b16 v[72:73], v24 offset:16384
  v_mfma_f32_16x16x32_bf16 v[140:143], v[44:47], a[60:63], v[140:143]
  ds_read_b64_tr_b16 v[74:75], v24 offset:17408
  buffer_load_dwordx4 v232, s[60:63], s27 offen offset:0 lds
  v_mfma_f32_16x16x32_bf16 v[136:139], v[44:47], a[56:59], v[136:139]
  ds_read_b64_tr_b16 v[76:77], v24 offset:18432
  v_mfma_f32_16x16x32_bf16 v[136:139], v[40:43], a[48:51], v[136:139]
  s_waitcnt lgkmcnt(7)
  ds_read_b64_tr_b16 v[78:79], v24 offset:19456
  v_mfma_f32_16x16x32_bf16 v[144:147], v[48:51], a[48:51], v[144:147]
  s_add_u32 m0, s43, 131072
  ds_read_b64_tr_b16 v[80:81], v25 offset:16384
  v_mfma_f32_16x16x32_bf16 v[144:147], v[52:55], a[56:59], v[144:147]
  ds_read_b64_tr_b16 v[82:83], v25 offset:17408
  buffer_load_dwordx4 v233, s[60:63], s27 offen offset:1024 lds
  v_mfma_f32_16x16x32_bf16 v[148:151], v[52:55], a[60:63], v[148:151]
L_attn_st15:
  s_cbranch_vccnz L_attn_walkdone4
  ds_read_b64_tr_b16 v[84:85], v25 offset:18432
  v_mfma_f32_16x16x32_bf16 v[148:151], v[48:51], a[52:55], v[148:151]
  s_waitcnt vmcnt(22) lgkmcnt(7)
  ds_read_b64_tr_b16 v[86:87], v25 offset:19456
  v_mfma_f32_16x16x32_bf16 v[152:155], v[64:67], a[48:51], v[152:155]
  ds_read_b64_tr_b16 v[32:33], v20 offset:32768
  v_mfma_f32_16x16x32_bf16 v[152:155], v[68:71], a[56:59], v[152:155]
  s_add_u32 m0, s43, 131072
  ds_read_b64_tr_b16 v[34:35], v20 offset:33792
  v_mfma_f32_16x16x32_bf16 v[156:159], v[68:71], a[60:63], v[156:159]
  ds_read_b64_tr_b16 v[36:37], v20 offset:34816
  buffer_load_dwordx4 v234, s[60:63], s27 offen offset:2048 lds
  v_mfma_f32_16x16x32_bf16 v[156:159], v[64:67], a[52:55], v[156:159]
  s_waitcnt lgkmcnt(7)
  ds_read_b64_tr_b16 v[38:39], v20 offset:35840
  v_mfma_f32_16x16x32_bf16 v[164:167], v[72:75], a[52:55], v[164:167]
  s_add_u32 m0, s43, 131072
  ds_read_b64_tr_b16 v[40:41], v21 offset:32768
  v_mfma_f32_16x16x32_bf16 v[164:167], v[76:79], a[60:63], v[164:167]
  ds_read_b64_tr_b16 v[42:43], v21 offset:33792
  buffer_load_dwordx4 v235, s[60:63], s27 offen offset:3072 lds
  v_mfma_f32_16x16x32_bf16 v[160:163], v[76:79], a[56:59], v[160:163]
  ds_read_b64_tr_b16 v[44:45], v21 offset:34816
  v_mfma_f32_16x16x32_bf16 v[160:163], v[72:75], a[48:51], v[160:163]
  s_waitcnt lgkmcnt(7)
  s_add_u32 s27, s27, 131072
  s_cmp_ge_u32 s27, s25
  s_cselect_b32 s34, 1441792, 0
  s_sub_u32 s27, s27, s34
  ds_read_b64_tr_b16 v[46:47], v21 offset:35840
  v_mfma_f32_16x16x32_bf16 v[168:171], v[80:83], a[48:51], v[168:171]
  s_add_u32 m0, s43, 147456
  ds_read_b64_tr_b16 v[48:49], v22 offset:32768
  v_mfma_f32_16x16x32_bf16 v[168:171], v[84:87], a[56:59], v[168:171]
  ds_read_b64_tr_b16 v[50:51], v22 offset:33792
  buffer_load_dwordx4 v232, s[60:63], s27 offen offset:0 lds
  v_mfma_f32_16x16x32_bf16 v[172:175], v[84:87], a[60:63], v[172:175]
  ds_read_b64_tr_b16 v[52:53], v22 offset:34816
  v_mfma_f32_16x16x32_bf16 v[172:175], v[80:83], a[52:55], v[172:175]
  s_waitcnt vmcnt(21) lgkmcnt(7)
  ds_read_b64_tr_b16 v[54:55], v22 offset:35840
  v_mfma_f32_16x16x32_bf16 v[128:131], v[32:35], a[64:67], v[128:131]
  s_barrier
  ds_read_b64_tr_b16 v[64:65], v23 offset:32768
  v_mfma_f32_16x16x32_bf16 v[128:131], v[36:39], a[72:75], v[128:131]
  s_add_u32 m0, s43, 147456
  ds_read_b64_tr_b16 v[66:67], v23 offset:33792
  v_mfma_f32_16x16x32_bf16 v[132:135], v[36:39], a[76:79], v[132:135]
  ds_read_b64_tr_b16 v[68:69], v23 offset:34816
  buffer_load_dwordx4 v233, s[60:63], s27 offen offset:1024 lds
  v_mfma_f32_16x16x32_bf16 v[132:135], v[32:35], a[68:71], v[132:135]
  s_waitcnt lgkmcnt(7)
  ds_read_b64_tr_b16 v[70:71], v23 offset:35840
  v_mfma_f32_16x16x32_bf16 v[140:143], v[40:43], a[68:71], v[140:143]
  s_add_u32 m0, s43, 147456
  ds_read_b64_tr_b16 v[72:73], v24 offset:32768
  v_mfma_f32_16x16x32_bf16 v[140:143], v[44:47], a[76:79], v[140:143]
  ds_read_b64_tr_b16 v[74:75], v24 offset:33792
  buffer_load_dwordx4 v234, s[60:63], s27 offen offset:2048 lds
  v_mfma_f32_16x16x32_bf16 v[136:139], v[44:47], a[72:75], v[136:139]
  ds_read_b64_tr_b16 v[76:77], v24 offset:34816
  v_mfma_f32_16x16x32_bf16 v[136:139], v[40:43], a[64:67], v[136:139]
  s_waitcnt lgkmcnt(7)
  ds_read_b64_tr_b16 v[78:79], v24 offset:35840
  v_mfma_f32_16x16x32_bf16 v[144:147], v[48:51], a[64:67], v[144:147]
  s_add_u32 m0, s43, 147456
  ds_read_b64_tr_b16 v[80:81], v25 offset:32768
  v_mfma_f32_16x16x32_bf16 v[144:147], v[52:55], a[72:75], v[144:147]
  ds_read_b64_tr_b16 v[82:83], v25 offset:33792
  buffer_load_dwordx4 v235, s[60:63], s27 offen offset:3072 lds
  v_mfma_f32_16x16x32_bf16 v[148:151], v[52:55], a[76:79], v[148:151]
  ds_read_b64_tr_b16 v[84:85], v25 offset:34816
  v_mfma_f32_16x16x32_bf16 v[148:151], v[48:51], a[68:71], v[148:151]
  s_waitcnt vmcnt(24) lgkmcnt(7)
  ds_read_b64_tr_b16 v[86:87], v25 offset:35840
  v_mfma_f32_16x16x32_bf16 v[152:155], v[64:67], a[64:67], v[152:155]
  ds_read_b64_tr_b16 v[32:33], v20 offset:49152
  v_mfma_f32_16x16x32_bf16 v[152:155], v[68:71], a[72:75], v[152:155]
  s_add_u32 s27, s27, 131072
  s_cmp_ge_u32 s27, s25
  s_cselect_b32 s34, 1441792, 0
  s_sub_u32 s27, s27, s34
  s_add_u32 m0, s43, 0
  ds_read_b64_tr_b16 v[34:35], v20 offset:50176
  v_mfma_f32_16x16x32_bf16 v[156:159], v[68:71], a[76:79], v[156:159]
  ds_read_b64_tr_b16 v[36:37], v20 offset:51200
  buffer_load_dwordx4 v232, s[60:63], s27 offen offset:0 lds
  v_mfma_f32_16x16x32_bf16 v[156:159], v[64:67], a[68:71], v[156:159]
  s_waitcnt lgkmcnt(7)
  ds_read_b64_tr_b16 v[38:39], v20 offset:52224
  v_mfma_f32_16x16x32_bf16 v[164:167], v[72:75], a[68:71], v[164:167]
  s_add_u32 m0, s43, 0
  ds_read_b64_tr_b16 v[40:41], v21 offset:49152
  v_mfma_f32_16x16x32_bf16 v[164:167], v[76:79], a[76:79], v[164:167]
  ds_read_b64_tr_b16 v[42:43], v21 offset:50176
  buffer_load_dwordx4 v233, s[60:63], s27 offen offset:1024 lds
  v_mfma_f32_16x16x32_bf16 v[160:163], v[76:79], a[72:75], v[160:163]
  ds_read_b64_tr_b16 v[44:45], v21 offset:51200
  v_mfma_f32_16x16x32_bf16 v[160:163], v[72:75], a[64:67], v[160:163]
  s_waitcnt lgkmcnt(7)
  ds_read_b64_tr_b16 v[46:47], v21 offset:52224
  v_mfma_f32_16x16x32_bf16 v[168:171], v[80:83], a[64:67], v[168:171]
  s_add_u32 m0, s43, 0
  ds_read_b64_tr_b16 v[48:49], v22 offset:49152
  v_mfma_f32_16x16x32_bf16 v[168:171], v[84:87], a[72:75], v[168:171]
  ds_read_b64_tr_b16 v[50:51], v22 offset:50176
  buffer_load_dwordx4 v234, s[60:63], s27 offen offset:2048 lds
  v_mfma_f32_16x16x32_bf16 v[172:175], v[84:87], a[76:79], v[172:175]
  ds_read_b64_tr_b16 v[52:53], v22 offset:51200
  v_mfma_f32_16x16x32_bf16 v[172:175], v[80:83], a[68:71], v[172:175]
  s_waitcnt vmcnt(23) lgkmcnt(7)
  ds_read_b64_tr_b16 v[54:55], v22 offset:52224
  v_mfma_f32_16x16x32_bf16 v[128:131], v[32:35], a[80:83], v[128:131]
  s_barrier
  ds_read_b64_tr_b16 v[64:65], v23 offset:49152
  v_mfma_f32_16x16x32_bf16 v[128:131], v[36:39], a[88:91], v[128:131]
  s_add_u32 m0, s43, 0
  ds_read_b64_tr_b16 v[66:67], v23 offset:50176
  v_mfma_f32_16x16x32_bf16 v[132:135], v[36:39], a[92:95], v[132:135]
  ds_read_b64_tr_b16 v[68:69], v23 offset:51200
  buffer_load_dwordx4 v235, s[60:63], s27 offen offset:3072 lds
  v_mfma_f32_16x16x32_bf16 v[132:135], v[32:35], a[84:87], v[132:135]
  s_waitcnt lgkmcnt(7)
  s_add_u32 s27, s27, 131072
  s_cmp_ge_u32 s27, s25
  s_cselect_b32 s34, 1441792, 0
  s_sub_u32 s27, s27, s34
  ds_read_b64_tr_b16 v[70:71], v23 offset:52224
  v_mfma_f32_16x16x32_bf16 v[140:143], v[40:43], a[84:87], v[140:143]
  s_add_u32 m0, s43, 16384
  ds_read_b64_tr_b16 v[72:73], v24 offset:49152
  v_mfma_f32_16x16x32_bf16 v[140:143], v[44:47], a[92:95], v[140:143]
  ds_read_b64_tr_b16 v[74:75], v24 offset:50176
  buffer_load_dwordx4 v232, s[60:63], s27 offen offset:0 lds
  v_mfma_f32_16x16x32_bf16 v[136:139], v[44:47], a[88:91], v[136:139]
  ds_read_b64_tr_b16 v[76:77], v24 offset:51200
  v_mfma_f32_16x16x32_bf16 v[136:139], v[40:43], a[80:83], v[136:139]
  s_waitcnt lgkmcnt(7)
  ds_read_b64_tr_b16 v[78:79], v24 offset:52224
  v_mfma_f32_16x16x32_bf16 v[144:147], v[48:51], a[80:83], v[144:147]
  s_add_u32 m0, s43, 16384
  ds_read_b64_tr_b16 v[80:81], v25 offset:49152
  v_mfma_f32_16x16x32_bf16 v[144:147], v[52:55], a[88:91], v[144:147]
  ds_read_b64_tr_b16 v[82:83], v25 offset:50176
  buffer_load_dwordx4 v233, s[60:63], s27 offen offset:1024 lds
  v_mfma_f32_16x16x32_bf16 v[148:151], v[52:55], a[92:95], v[148:151]
  ds_read_b64_tr_b16 v[84:85], v25 offset:51200
  v_mfma_f32_16x16x32_bf16 v[148:151], v[48:51], a[84:87], v[148:151]
  s_waitcnt vmcnt(26) lgkmcnt(7)
  ds_read_b64_tr_b16 v[86:87], v25 offset:52224
  v_mfma_f32_16x16x32_bf16 v[152:155], v[64:67], a[80:83], v[152:155]
  ds_read_b64_tr_b16 v[32:33], v8 offset:0
  v_mfma_f32_16x16x32_bf16 v[152:155], v[68:71], a[88:91], v[152:155]
  s_add_u32 m0, s43, 16384
  ds_read_b64_tr_b16 v[34:35], v8 offset:1024
  v_mfma_f32_16x16x32_bf16 v[156:159], v[68:71], a[92:95], v[156:159]
  ds_read_b64_tr_b16 v[36:37], v8 offset:2048
  buffer_load_dwordx4 v234, s[60:63], s27 offen offset:2048 lds
  v_mfma_f32_16x16x32_bf16 v[156:159], v[64:67], a[84:87], v[156:159]
  s_waitcnt lgkmcnt(7)
  ds_read_b64_tr_b16 v[38:39], v8 offset:3072
  v_mfma_f32_16x16x32_bf16 v[164:167], v[72:75], a[84:87], v[164:167]
  s_add_u32 m0, s43, 16384
  ds_read_b64_tr_b16 v[40:41], v9 offset:0
  v_mfma_f32_16x16x32_bf16 v[164:167], v[76:79], a[92:95], v[164:167]
  ds_read_b64_tr_b16 v[42:43], v9 offset:1024
  buffer_load_dwordx4 v235, s[60:63], s27 offen offset:3072 lds
  v_mfma_f32_16x16x32_bf16 v[160:163], v[76:79], a[88:91], v[160:163]
  ds_read_b64_tr_b16 v[44:45], v9 offset:2048
  v_mfma_f32_16x16x32_bf16 v[160:163], v[72:75], a[80:83], v[160:163]
  s_waitcnt lgkmcnt(7)
  s_add_u32 s27, s27, 131072
  s_cmp_ge_u32 s27, s25
  s_cselect_b32 s34, 1441792, 0
  s_sub_u32 s27, s27, s34
  ds_read_b64_tr_b16 v[46:47], v9 offset:3072
  v_mfma_f32_16x16x32_bf16 v[168:171], v[80:83], a[80:83], v[168:171]
  s_add_u32 m0, s43, 32768
  ds_read_b64_tr_b16 v[48:49], v10 offset:0
  v_mfma_f32_16x16x32_bf16 v[168:171], v[84:87], a[88:91], v[168:171]
  ds_read_b64_tr_b16 v[50:51], v10 offset:1024
  buffer_load_dwordx4 v232, s[60:63], s27 offen offset:0 lds
  v_mfma_f32_16x16x32_bf16 v[172:175], v[84:87], a[92:95], v[172:175]
  ds_read_b64_tr_b16 v[52:53], v10 offset:2048
  v_mfma_f32_16x16x32_bf16 v[172:175], v[80:83], a[84:87], v[172:175]
  s_waitcnt vmcnt(25) lgkmcnt(7)
  ds_read_b64_tr_b16 v[54:55], v10 offset:3072
  v_mfma_f32_16x16x32_bf16 v[128:131], v[32:35], a[96:99], v[128:131]
  s_barrier
  ds_read_b64_tr_b16 v[64:65], v11 offset:0
  v_mfma_f32_16x16x32_bf16 v[128:131], v[36:39], a[104:107], v[128:131]
  s_add_u32 m0, s43, 32768
  ds_read_b64_tr_b16 v[66:67], v11 offset:1024
  v_mfma_f32_16x16x32_bf16 v[132:135], v[36:39], a[108:111], v[132:135]
  ds_read_b64_tr_b16 v[68:69], v11 offset:2048
  buffer_load_dwordx4 v233, s[60:63], s27 offen offset:1024 lds
  v_mfma_f32_16x16x32_bf16 v[132:135], v[32:35], a[100:103], v[132:135]
  s_waitcnt lgkmcnt(7)
  ds_read_b64_tr_b16 v[70:71], v11 offset:3072
  v_mfma_f32_16x16x32_bf16 v[140:143], v[40:43], a[100:103], v[140:143]
  s_add_u32 m0, s43, 32768
  ds_read_b64_tr_b16 v[72:73], v12 offset:0
  v_mfma_f32_16x16x32_bf16 v[140:143], v[44:47], a[108:111], v[140:143]
  ds_read_b64_tr_b16 v[74:75], v12 offset:1024
  buffer_load_dwordx4 v234, s[60:63], s27 offen offset:2048 lds
  v_mfma_f32_16x16x32_bf16 v[136:139], v[44:47], a[104:107], v[136:139]
  ds_read_b64_tr_b16 v[76:77], v12 offset:2048
  v_mfma_f32_16x16x32_bf16 v[136:139], v[40:43], a[96:99], v[136:139]
  s_waitcnt lgkmcnt(7)
  ds_read_b64_tr_b16 v[78:79], v12 offset:3072
  v_mfma_f32_16x16x32_bf16 v[144:147], v[48:51], a[96:99], v[144:147]
  s_add_u32 m0, s43, 32768
  ds_read_b64_tr_b16 v[80:81], v13 offset:0
  v_mfma_f32_16x16x32_bf16 v[144:147], v[52:55], a[104:107], v[144:147]
  ds_read_b64_tr_b16 v[82:83], v13 offset:1024
  buffer_load_dwordx4 v235, s[60:63], s27 offen offset:3072 lds
  v_mfma_f32_16x16x32_bf16 v[148:151], v[52:55], a[108:111], v[148:151]
  ds_read_b64_tr_b16 v[84:85], v13 offset:2048
  v_mfma_f32_16x16x32_bf16 v[148:151], v[48:51], a[100:103], v[148:151]
  s_waitcnt vmcnt(28) lgkmcnt(7)
  ds_read_b64_tr_b16 v[86:87], v13 offset:3072
  v_mfma_f32_16x16x32_bf16 v[152:155], v[64:67], a[96:99], v[152:155]
  ds_read_b64_tr_b16 v[32:33], v8 offset:16384
  v_mfma_f32_16x16x32_bf16 v[152:155], v[68:71], a[104:107], v[152:155]
  s_add_u32 s27, s27, 131072
  s_cmp_ge_u32 s27, s25
  s_cselect_b32 s34, 1441792, 0
  s_sub_u32 s27, s27, s34
  s_add_u32 m0, s43, 49152
  ds_read_b64_tr_b16 v[34:35], v8 offset:17408
  v_mfma_f32_16x16x32_bf16 v[156:159], v[68:71], a[108:111], v[156:159]
  ds_read_b64_tr_b16 v[36:37], v8 offset:18432
  buffer_load_dwordx4 v232, s[60:63], s27 offen offset:0 lds
  v_mfma_f32_16x16x32_bf16 v[156:159], v[64:67], a[100:103], v[156:159]
  s_waitcnt lgkmcnt(7)
  ds_read_b64_tr_b16 v[38:39], v8 offset:19456
  v_mfma_f32_16x16x32_bf16 v[164:167], v[72:75], a[100:103], v[164:167]
  s_add_u32 m0, s43, 49152
  ds_read_b64_tr_b16 v[40:41], v9 offset:16384
  v_mfma_f32_16x16x32_bf16 v[164:167], v[76:79], a[108:111], v[164:167]
  ds_read_b64_tr_b16 v[42:43], v9 offset:17408
  buffer_load_dwordx4 v233, s[60:63], s27 offen offset:1024 lds
  v_mfma_f32_16x16x32_bf16 v[160:163], v[76:79], a[104:107], v[160:163]
  ds_read_b64_tr_b16 v[44:45], v9 offset:18432
  v_mfma_f32_16x16x32_bf16 v[160:163], v[72:75], a[96:99], v[160:163]
  s_waitcnt lgkmcnt(7)
  ds_read_b64_tr_b16 v[46:47], v9 offset:19456
  v_mfma_f32_16x16x32_bf16 v[168:171], v[80:83], a[96:99], v[168:171]
  s_add_u32 m0, s43, 49152
  ds_read_b64_tr_b16 v[48:49], v10 offset:16384
  v_mfma_f32_16x16x32_bf16 v[168:171], v[84:87], a[104:107], v[168:171]
  ds_read_b64_tr_b16 v[50:51], v10 offset:17408
  buffer_load_dwordx4 v234, s[60:63], s27 offen offset:2048 lds
  v_mfma_f32_16x16x32_bf16 v[172:175], v[84:87], a[108:111], v[172:175]
  ds_read_b64_tr_b16 v[52:53], v10 offset:18432
  v_mfma_f32_16x16x32_bf16 v[172:175], v[80:83], a[100:103], v[172:175]
  s_waitcnt vmcnt(27) lgkmcnt(7)
  ds_read_b64_tr_b16 v[54:55], v10 offset:19456
  v_mfma_f32_16x16x32_bf16 v[128:131], v[32:35], a[112:115], v[128:131]
  s_barrier
  ds_read_b64_tr_b16 v[64:65], v11 offset:16384
  v_mfma_f32_16x16x32_bf16 v[128:131], v[36:39], a[120:123], v[128:131]
  s_add_u32 m0, s43, 49152
  ds_read_b64_tr_b16 v[66:67], v11 offset:17408
  v_mfma_f32_16x16x32_bf16 v[132:135], v[36:39], a[124:127], v[132:135]
  ds_read_b64_tr_b16 v[68:69], v11 offset:18432
  buffer_load_dwordx4 v235, s[60:63], s27 offen offset:3072 lds
  v_mfma_f32_16x16x32_bf16 v[132:135], v[32:35], a[116:119], v[132:135]
  s_waitcnt lgkmcnt(7)
  s_add_u32 s27, s27, 131072
  s_cmp_ge_u32 s27, s25
  s_cselect_b32 s34, 1441792, 0
  s_sub_u32 s27, s27, s34
  s_add_u32 m0, s43, 65536
  ds_read_b64_tr_b16 v[70:71], v11 offset:19456
  v_mfma_f32_16x16x32_bf16 v[140:143], v[40:43], a[116:119], v[140:143]
  ds_read_b64_tr_b16 v[72:73], v12 offset:16384
  buffer_load_dwordx4 v232, s[60:63], s27 offen offset:0 lds
  v_mfma_f32_16x16x32_bf16 v[140:143], v[44:47], a[124:127], v[140:143]
  ds_read_b64_tr_b16 v[74:75], v12 offset:17408
  v_mfma_f32_16x16x32_bf16 v[136:139], v[44:47], a[120:123], v[136:139]
  s_add_u32 m0, s43, 65536
  ds_read_b64_tr_b16 v[76:77], v12 offset:18432
  v_mfma_f32_16x16x32_bf16 v[136:139], v[40:43], a[112:115], v[136:139]
  s_waitcnt lgkmcnt(7)
  ds_read_b64_tr_b16 v[78:79], v12 offset:19456
  buffer_load_dwordx4 v233, s[60:63], s27 offen offset:1024 lds
  v_mfma_f32_16x16x32_bf16 v[144:147], v[48:51], a[112:115], v[144:147]
  ds_read_b64_tr_b16 v[80:81], v13 offset:16384
  v_mfma_f32_16x16x32_bf16 v[144:147], v[52:55], a[120:123], v[144:147]
  s_add_u32 m0, s43, 65536
  ds_read_b64_tr_b16 v[82:83], v13 offset:17408
  v_mfma_f32_16x16x32_bf16 v[148:151], v[52:55], a[124:127], v[148:151]
  ds_read_b64_tr_b16 v[84:85], v13 offset:18432
  buffer_load_dwordx4 v234, s[60:63], s27 offen offset:2048 lds
  v_mfma_f32_16x16x32_bf16 v[148:151], v[48:51], a[116:119], v[148:151]
  s_waitcnt vmcnt(31) lgkmcnt(7)
  ds_read_b64_tr_b16 v[86:87], v13 offset:19456
  v_mfma_f32_16x16x32_bf16 v[152:155], v[64:67], a[112:115], v[152:155]
  v_mfma_f32_16x16x32_bf16 v[152:155], v[68:71], a[120:123], v[152:155]
  s_add_u32 m0, s43, 65536
  v_mfma_f32_16x16x32_bf16 v[156:159], v[68:71], a[124:127], v[156:159]
  buffer_load_dwordx4 v235, s[60:63], s27 offen offset:3072 lds
  v_mfma_f32_16x16x32_bf16 v[156:159], v[64:67], a[116:119], v[156:159]
  s_waitcnt lgkmcnt(4)
  v_mfma_f32_16x16x32_bf16 v[164:167], v[72:75], a[116:119], v[164:167]
  v_mfma_f32_16x16x32_bf16 v[164:167], v[76:79], a[124:127], v[164:167]
  v_mfma_f32_16x16x32_bf16 v[160:163], v[76:79], a[120:123], v[160:163]
  v_mfma_f32_16x16x32_bf16 v[160:163], v[72:75], a[112:115], v[160:163]
  s_waitcnt lgkmcnt(0)
  v_mfma_f32_16x16x32_bf16 v[168:171], v[80:83], a[112:115], v[168:171]
  v_mfma_f32_16x16x32_bf16 v[168:171], v[84:87], a[120:123], v[168:171]
  v_mfma_f32_16x16x32_bf16 v[172:175], v[84:87], a[124:127], v[172:175]
  v_mfma_f32_16x16x32_bf16 v[172:175], v[80:83], a[116:119], v[172:175]
  s_barrier
  v_mov_b32 v2, 0xbfb8aa3b
  v_mov_b32 v3, 1.0
  s_add_u32 s27, s27, 131072
  s_cmp_ge_u32 s27, s25
  s_cselect_b32 s34, 1441792, 0
  s_sub_u32 s27, s27, s34
  s_add_u32 m0, s43, 81920
  s_nop 0
  buffer_load_dwordx4 v232, s[60:63], s27 offen offset:0 lds
  buffer_load_dwordx4 v233, s[60:63], s27 offen offset:1024 lds
  buffer_load_dwordx4 v234, s[60:63], s27 offen offset:2048 lds
  buffer_load_dwordx4 v235, s[60:63], s27 offen offset:3072 lds
  v_pk_mul_f32 v[104:105], v[128:129], v[2:3] op_sel_hi:[1,0]
  v_pk_mul_f32 v[106:107], v[130:131], v[2:3] op_sel_hi:[1,0]
  v_pk_mul_f32 v[108:109], v[136:137], v[2:3] op_sel_hi:[1,0]
  v_pk_mul_f32 v[110:111], v[138:139], v[2:3] op_sel_hi:[1,0]
  buffer_load_dwordx4 v[192:195], v19, s[16:19], s28 offen sc1
  buffer_load_dwordx4 v[196:199], v19, s[16:19], s28 offen offset:1024 sc1
  v_exp_f32 v104, v104
  v_exp_f32 v105, v105
  v_exp_f32 v106, v106
  v_exp_f32 v107, v107
  v_exp_f32 v108, v108
  v_exp_f32 v109, v109
  v_exp_f32 v110, v110
  v_exp_f32 v111, v111
  s_nop 0
  v_pk_add_f32 v[104:105], v[104:105], v[2:3] op_sel:[0,1] op_sel_hi:[1,1]
  v_pk_add_f32 v[106:107], v[106:107], v[2:3] op_sel:[0,1] op_sel_hi:[1,1]
  v_pk_add_f32 v[108:109], v[108:109], v[2:3] op_sel:[0,1] op_sel_hi:[1,1]
  v_pk_add_f32 v[110:111], v[110:111], v[2:3] op_sel:[0,1] op_sel_hi:[1,1]
  v_rcp_f32 v104, v104
  v_rcp_f32 v105, v105
  v_rcp_f32 v106, v106
  v_rcp_f32 v107, v107
  v_rcp_f32 v108, v108
  v_rcp_f32 v109, v109
  v_rcp_f32 v110, v110
  v_rcp_f32 v111, v111
  s_cmp_gt_u32 s29, 0
  s_cselect_b32 s44, 0, 2.0
  v_pk_mul_f32 v[104:105], v[104:105], v[128:129]
  v_pk_mul_f32 v[106:107], v[106:107], v[130:131]
  v_pk_mul_f32 v[108:109], v[108:109], v[136:137]
  v_pk_mul_f32 v[110:111], v[110:111], v[138:139]
  v_cvt_pk_bf16_f32 v200, v104, v105
  v_cvt_pk_bf16_f32 v201, v106, v107
  v_cvt_pk_bf16_f32 v202, v108, v109
  v_cvt_pk_bf16_f32 v203, v110, v111
  buffer_store_dwordx4 v[200:203], v19, s[12:15], s44 offen offset:0 sc1
  v_pk_mul_f32 v[112:113], v[132:133], v[2:3] op_sel_hi:[1,0]
  v_pk_mul_f32 v[114:115], v[134:135], v[2:3] op_sel_hi:[1,0]
  v_pk_mul_f32 v[116:117], v[140:141], v[2:3] op_sel_hi:[1,0]
  v_pk_mul_f32 v[118:119], v[142:143], v[2:3] op_sel_hi:[1,0]
  v_exp_f32 v112, v112
  v_exp_f32 v113, v113
  v_exp_f32 v114, v114
  v_exp_f32 v115, v115
  v_exp_f32 v116, v116
  v_exp_f32 v117, v117
  v_exp_f32 v118, v118
  v_exp_f32 v119, v119
  s_nop 0
  v_pk_add_f32 v[112:113], v[112:113], v[2:3] op_sel:[0,1] op_sel_hi:[1,1]
  v_pk_add_f32 v[114:115], v[114:115], v[2:3] op_sel:[0,1] op_sel_hi:[1,1]
  v_pk_add_f32 v[116:117], v[116:117], v[2:3] op_sel:[0,1] op_sel_hi:[1,1]
  v_pk_add_f32 v[118:119], v[118:119], v[2:3] op_sel:[0,1] op_sel_hi:[1,1]
  v_rcp_f32 v112, v112
  v_rcp_f32 v113, v113
  v_rcp_f32 v114, v114
  v_rcp_f32 v115, v115
  v_rcp_f32 v116, v116
  v_rcp_f32 v117, v117
  v_rcp_f32 v118, v118
  v_rcp_f32 v119, v119
  s_cmp_gt_u32 s29, 0
  s_cselect_b32 s44, 44032, 2.0
  v_pk_mul_f32 v[112:113], v[112:113], v[132:133]
  v_pk_mul_f32 v[114:115], v[114:115], v[134:135]
  v_pk_mul_f32 v[116:117], v[116:117], v[140:141]
  v_pk_mul_f32 v[118:119], v[118:119], v[142:143]
  v_cvt_pk_bf16_f32 v204, v112, v113
  v_cvt_pk_bf16_f32 v205, v114, v115
  v_cvt_pk_bf16_f32 v206, v116, v117
  v_cvt_pk_bf16_f32 v207, v118, v119
  buffer_store_dwordx4 v[204:207], v19, s[12:15], s44 offen offset:0 sc1
  s_cmp_le_u32 s29, 1
  s_cbranch_scc1 L_p3_few
  v_pk_mul_f32 v[104:105], v[144:145], v[2:3] op_sel_hi:[1,0]
  v_pk_mul_f32 v[106:107], v[146:147], v[2:3] op_sel_hi:[1,0]
  v_pk_mul_f32 v[108:109], v[152:153], v[2:3] op_sel_hi:[1,0]
  v_pk_mul_f32 v[110:111], v[154:155], v[2:3] op_sel_hi:[1,0]
  v_exp_f32 v104, v104
  v_exp_f32 v105, v105
  v_exp_f32 v106, v106
  v_exp_f32 v107, v107
  v_exp_f32 v108, v108
  v_exp_f32 v109, v109
  v_exp_f32 v110, v110
  v_exp_f32 v111, v111
  s_nop 0
  v_pk_add_f32 v[104:105], v[104:105], v[2:3] op_sel:[0,1] op_sel_hi:[1,1]
  v_pk_add_f32 v[106:107], v[106:107], v[2:3] op_sel:[0,1] op_sel_hi:[1,1]
  v_pk_add_f32 v[108:109], v[108:109], v[2:3] op_sel:[0,1] op_sel_hi:[1,1]
  v_pk_add_f32 v[110:111], v[110:111], v[2:3] op_sel:[0,1] op_sel_hi:[1,1]
  v_rcp_f32 v104, v104
  v_rcp_f32 v105, v105
  v_rcp_f32 v106, v106
  v_rcp_f32 v107, v107
  v_rcp_f32 v108, v108
  v_rcp_f32 v109, v109
  v_rcp_f32 v110, v110
  v_rcp_f32 v111, v111
  s_cmp_gt_u32 s29, 1
  s_cselect_b32 s44, 0, 2.0
  v_pk_mul_f32 v[104:105], v[104:105], v[144:145]
  v_pk_mul_f32 v[106:107], v[106:107], v[146:147]
  v_pk_mul_f32 v[108:109], v[108:109], v[152:153]
  v_pk_mul_f32 v[110:111], v[110:111], v[154:155]
  v_cvt_pk_bf16_f32 v208, v104, v105
  v_cvt_pk_bf16_f32 v209, v106, v107
  v_cvt_pk_bf16_f32 v210, v108, v109
  v_cvt_pk_bf16_f32 v211, v110, v111
  buffer_store_dwordx4 v[208:211], v19, s[12:15], s44 offen offset:1024 sc1
  v_pk_mul_f32 v[112:113], v[148:149], v[2:3] op_sel_hi:[1,0]
  v_pk_mul_f32 v[114:115], v[150:151], v[2:3] op_sel_hi:[1,0]
  v_pk_mul_f32 v[116:117], v[156:157], v[2:3] op_sel_hi:[1,0]
  v_pk_mul_f32 v[118:119], v[158:159], v[2:3] op_sel_hi:[1,0]
  v_exp_f32 v112, v112
  v_exp_f32 v113, v113
  v_exp_f32 v114, v114
  v_exp_f32 v115, v115
  v_exp_f32 v116, v116
  v_exp_f32 v117, v117
  v_exp_f32 v118, v118
  v_exp_f32 v119, v119
  s_nop 0
  v_pk_add_f32 v[112:113], v[112:113], v[2:3] op_sel:[0,1] op_sel_hi:[1,1]
  v_pk_add_f32 v[114:115], v[114:115], v[2:3] op_sel:[0,1] op_sel_hi:[1,1]
  v_pk_add_f32 v[116:117], v[116:117], v[2:3] op_sel:[0,1] op_sel_hi:[1,1]
  v_pk_add_f32 v[118:119], v[118:119], v[2:3] op_sel:[0,1] op_sel_hi:[1,1]
  v_rcp_f32 v112, v112
  v_rcp_f32 v113, v113
  v_rcp_f32 v114, v114
  v_rcp_f32 v115, v115
  v_rcp_f32 v116, v116
  v_rcp_f32 v117, v117
  v_rcp_f32 v118, v118
  v_rcp_f32 v119, v119
  s_cmp_gt_u32 s29, 1
  s_cselect_b32 s44, 44032, 2.0
  v_pk_mul_f32 v[112:113], v[112:113], v[148:149]
  v_pk_mul_f32 v[114:115], v[114:115], v[150:151]
  v_pk_mul_f32 v[116:117], v[116:117], v[156:157]
  v_pk_mul_f32 v[118:119], v[118:119], v[158:159]
  v_cvt_pk_bf16_f32 v212, v112, v113
  v_cvt_pk_bf16_f32 v213, v114, v115
  v_cvt_pk_bf16_f32 v214, v116, v117
  v_cvt_pk_bf16_f32 v215, v118, v119
  buffer_store_dwordx4 v[212:215], v19, s[12:15], s44 offen offset:1024 sc1
  v_pk_mul_f32 v[104:105], v[160:161], v[2:3] op_sel_hi:[1,0]
  v_pk_mul_f32 v[106:107], v[162:163], v[2:3] op_sel_hi:[1,0]
  v_pk_mul_f32 v[108:109], v[168:169], v[2:3] op_sel_hi:[1,0]
  v_pk_mul_f32 v[110:111], v[170:171], v[2:3] op_sel_hi:[1,0]
  v_exp_f32 v104, v104
  v_exp_f32 v105, v105
  v_exp_f32 v106, v106
  v_exp_f32 v107, v107
  v_exp_f32 v108, v108
  v_exp_f32 v109, v109
  v_exp_f32 v110, v110
  v_exp_f32 v111, v111
  s_nop 0
  v_pk_add_f32 v[104:105], v[104:105], v[2:3] op_sel:[0,1] op_sel_hi:[1,1]
  v_pk_add_f32 v[106:107], v[106:107], v[2:3] op_sel:[0,1] op_sel_hi:[1,1]
  v_pk_add_f32 v[108:109], v[108:109], v[2:3] op_sel:[0,1] op_sel_hi:[1,1]
  v_pk_add_f32 v[110:111], v[110:111], v[2:3] op_sel:[0,1] op_sel_hi:[1,1]
  v_rcp_f32 v104, v104
  v_rcp_f32 v105, v105
  v_rcp_f32 v106, v106
  v_rcp_f32 v107, v107
  v_rcp_f32 v108, v108
  v_rcp_f32 v109, v109
  v_rcp_f32 v110, v110
  v_rcp_f32 v111, v111
  s_cmp_gt_u32 s29, 2
  s_cselect_b32 s44, 0, 2.0
  v_pk_mul_f32 v[104:105], v[104:105], v[160:161]
  v_pk_mul_f32 v[106:107], v[106:107], v[162:163]
  v_pk_mul_f32 v[108:109], v[108:109], v[168:169]
  v_pk_mul_f32 v[110:111], v[110:111], v[170:171]
  v_cvt_pk_bf16_f32 v216, v104, v105
  v_cvt_pk_bf16_f32 v217, v106, v107
  v_cvt_pk_bf16_f32 v218, v108, v109
  v_cvt_pk_bf16_f32 v219, v110, v111
  buffer_store_dwordx4 v[216:219], v19, s[12:15], s44 offen offset:2048 sc1
  v_pk_mul_f32 v[112:113], v[164:165], v[2:3] op_sel_hi:[1,0]
  v_pk_mul_f32 v[114:115], v[166:167], v[2:3] op_sel_hi:[1,0]
  v_pk_mul_f32 v[116:117], v[172:173], v[2:3] op_sel_hi:[1,0]
  v_pk_mul_f32 v[118:119], v[174:175], v[2:3] op_sel_hi:[1,0]
  v_exp_f32 v112, v112
  v_exp_f32 v113, v113
  v_exp_f32 v114, v114
  v_exp_f32 v115, v115
  v_exp_f32 v116, v116
  v_exp_f32 v117, v117
  v_exp_f32 v118, v118
  v_exp_f32 v119, v119
  s_nop 0
  v_pk_add_f32 v[112:113], v[112:113], v[2:3] op_sel:[0,1] op_sel_hi:[1,1]
  v_pk_add_f32 v[114:115], v[114:115], v[2:3] op_sel:[0,1] op_sel_hi:[1,1]
  v_pk_add_f32 v[116:117], v[116:117], v[2:3] op_sel:[0,1] op_sel_hi:[1,1]
  v_pk_add_f32 v[118:119], v[118:119], v[2:3] op_sel:[0,1] op_sel_hi:[1,1]
  v_rcp_f32 v112, v112
  v_rcp_f32 v113, v113
  v_rcp_f32 v114, v114
  v_rcp_f32 v115, v115
  v_rcp_f32 v116, v116
  v_rcp_f32 v117, v117
  v_rcp_f32 v118, v118
  v_rcp_f32 v119, v119
  s_cmp_gt_u32 s29, 2
  s_cselect_b32 s44, 44032, 2.0
  v_pk_mul_f32 v[112:113], v[112:113], v[164:165]
  v_pk_mul_f32 v[114:115], v[114:115], v[166:167]
  v_pk_mul_f32 v[116:117], v[116:117], v[172:173]
  v_pk_mul_f32 v[118:119], v[118:119], v[174:175]
  v_cvt_pk_bf16_f32 v220, v112, v113
  v_cvt_pk_bf16_f32 v221, v114, v115
  v_cvt_pk_bf16_f32 v222, v116, v117
  v_cvt_pk_bf16_f32 v223, v118, v119
  buffer_store_dwordx4 v[220:223], v19, s[12:15], s44 offen offset:2048 sc1
  s_waitcnt vmcnt(6)
L_p3_done:
  ds_read_b64_tr_b16 v[32:33], v240 offset:32768
  ds_read_b64_tr_b16 v[34:35], v240 offset:34816
  ds_read_b64_tr_b16 v[36:37], v241 offset:32768
  ds_read_b64_tr_b16 v[38:39], v241 offset:34816
  ds_read_b64_tr_b16 v[40:41], v242 offset:32768
  ds_read_b64_tr_b16 v[42:43], v242 offset:34816
  ds_read_b64_tr_b16 v[44:45], v243 offset:32768
  ds_read_b64_tr_b16 v[46:47], v243 offset:34816
  s_and_b32 s30, s39, 1
  s_mul_i32 s30, s30, 176128
  s_add_u32 s30, s30, s4
  s_add_u32 s8, s46, s30
  s_addc_u32 s9, s47, 0
  s_mov_b32 s10, 176128
  s_mov_b32 s11, 0x20000
  s_mov_b32 s20, s50
  s_mov_b32 s21, s51
  s_mov_b32 s22, 2097152
  s_mov_b32 s23, 0x20000
  s_lshl_b32 s39, s24, 10
  s_add_u32 s45, s39, 45056
  s_add_u32 s30, s24, 0
  s_and_b32 s30, s30, 3
  s_mul_i32 s0, s30, 44032
  s_add_u32 s30, s24, 1
  s_and_b32 s30, s30, 3
  s_mul_i32 s1, s30, 44032
  s_add_u32 s30, s24, 2
  s_and_b32 s30, s30, 3
  s_mul_i32 s3, s30, 44032
  s_add_u32 s30, s24, 3
  s_and_b32 s30, s30, 3
  s_mul_i32 s69, s30, 44032
  v_add_u32 v28, s43, v19
  s_sub_u32 s30, s24, 1
  s_and_b32 s30, s30, 3
  s_lshl_b32 s30, s30, 12
  v_add_u32 v29, s30, v19
  s_sub_u32 s30, s24, 2
  s_and_b32 s30, s30, 3
  s_lshl_b32 s30, s30, 12
  v_add_u32 v30, s30, v19
  s_sub_u32 s30, s24, 3
  s_and_b32 s30, s30, 3
  s_lshl_b32 s30, s30, 12
  v_add_u32 v31, s30, v19
  v_and_b32 v2, 15, v1
  v_lshlrev_b32 v2, 10, v2
  v_add_u32 v2, v2, v16
  v_lshlrev_b32 v128, 16, v192
  v_and_b32 v129, 0xffff0000, v192
  v_lshlrev_b32 v130, 16, v193
  v_and_b32 v131, 0xffff0000, v193
  v_lshlrev_b32 v132, 16, v194
  v_and_b32 v133, 0xffff0000, v194
  v_lshlrev_b32 v134, 16, v195
  v_and_b32 v135, 0xffff0000, v195
  v_lshlrev_b32 v136, 16, v196
  v_and_b32 v137, 0xffff0000, v196
  v_lshlrev_b32 v138, 16, v197
  v_and_b32 v139, 0xffff0000, v197
  v_lshlrev_b32 v140, 16, v198
  v_and_b32 v141, 0xffff0000, v198
L_attn_st16:
  s_cbranch_vccnz L_attn_walkdone4
  v_lshlrev_b32 v142, 16, v199
  v_and_b32 v143, 0xffff0000, v199
  s_lshr_b32 s30, s2, 7
  s_lshl_b32 s30, s30, 1
  s_bfe_u32 s31, s2, 0x10003
  s_add_u32 s30, s30, s31
  s_mul_i32 s30, s30, 3
  s_add_u32 s31, s2, 64
  s_bfe_u32 s31, s31, 0x30004
  s_and_b32 s31, s31, 7
  s_mul_i32 s31, s31, 0
  s_add_u32 s30, s30, s31
  s_mul_i32 s31, s30, 373
  s_lshr_b32 s31, s31, 12
  s_mul_i32 s31, s31, 11
  s_sub_u32 s30, s30, s31
  s_lshl_b32 s30, s30, 12
  s_add_u32 s39, s39, s30
  s_lshl_b32 s30, s41, 7
  s_add_u32 s40, s40, s30
  s_waitcnt vmcnt(0) lgkmcnt(0)
  s_barrier
  s_cmp_lg_u32 s24, 3
  s_cbranch_scc1 L_sync4_a
  v_mov_b32 v6, s68
  s_mov_b64 exec, 1
  s_mov_b32 s30, 98304
  s_or_b32 s7, s30, s5
  buffer_store_dword v6, v5, s[64:67], s7 offen
  s_or_b32 s30, s30, s6
  buffer_store_dword v6, v5, s[64:67], s30 offen sc1
  s_mov_b64 exec, -1
L_sync4_a:
  s_cmp_lg_u32 s24, 3
  s_cbranch_scc1 L_sync4_b
  s_mov_b32 s31, 0
  s_mov_b32 s30, 98304
L_sync4_poll:
  buffer_load_dword v7, v102, s[64:67], s30 offen sc1
  s_add_u32 s31, s31, 1
  s_waitcnt vmcnt(0)
  v_cmp_eq_u32 s[32:33], s68, v7
  s_cmp_gt_u32 s31, 2097152
  s_cbranch_scc1 L_sync4_x
  s_cmp_eq_u64 s[32:33], -1
  s_cbranch_scc0 L_sync4_poll
L_sync4_x:
L_sync4_b:
  s_barrier
  s_cmp_eq_u32 s39, 44032
  s_cselect_b32 s44, 2.0, s39
  s_add_u32 s35, s44, s0
  buffer_load_dwordx4 a[0:3], v19, s[8:11], s35 offen sc1
  s_add_u32 s36, s44, s1
  buffer_load_dwordx4 a[4:7], v19, s[8:11], s36 offen sc1
  s_add_u32 s37, s44, s3
  buffer_load_dwordx4 a[8:11], v19, s[8:11], s37 offen sc1
  s_add_u32 s38, s44, s69
  buffer_load_dwordx4 a[12:15], v19, s[8:11], s38 offen sc1
  s_add_u32 s39, s39, 4096
  s_cmp_ge_u32 s39, s45
  s_cselect_b32 s44, 45056, 0
  s_sub_u32 s39, s39, s44
  s_cmp_eq_u32 s39, 44032
  s_cselect_b32 s44, 2.0, s39
  s_add_u32 s35, s44, s0
  buffer_load_dwordx4 a[16:19], v19, s[8:11], s35 offen sc1
  s_add_u32 s36, s44, s1
  buffer_load_dwordx4 a[20:23], v19, s[8:11], s36 offen sc1
  s_add_u32 s37, s44, s3
  buffer_load_dwordx4 a[24:27], v19, s[8:11], s37 offen sc1
  s_add_u32 s38, s44, s69
  buffer_load_dwordx4 a[28:31], v19, s[8:11], s38 offen sc1
  s_waitcnt vmcnt(4) lgkmcnt(0)
  v_mfma_f32_16x16x32_bf16 v[64:67], v[32:35], a[0:3], 0
  s_add_u32 s39, s39, 4096
  s_cmp_ge_u32 s39, s45
  s_cselect_b32 s44, 45056, 0
  s_sub_u32 s39, s39, s44
  s_cmp_eq_u32 s39, 44032
  s_cselect_b32 s44, 2.0, s39
  s_add_u32 s35, s44, s0
  ds_read_b64_tr_b16 v[48:49], v240 offset:49152
  v_mfma_f32_16x16x32_bf16 v[80:83], v[32:35], a[4:7], 0
  ds_read_b64_tr_b16 v[50:51], v240 offset:51200
  buffer_load_dwordx4 a[32:35], v19, s[8:11], s35 offen sc1
  v_mfma_f32_16x16x32_bf16 v[96:99], v[32:35], a[8:11], 0
  s_add_u32 s36, s44, s1
  ds_read_b64_tr_b16 v[52:53], v241 offset:49152
  v_mfma_f32_16x16x32_bf16 v[112:115], v[32:35], a[12:15], 0
  buffer_load_dwordx4 a[36:39], v19, s[8:11], s36 offen sc1
  v_mfma_f32_16x16x32_bf16 v[116:119], v[36:39], a[12:15], 0
  s_add_u32 s37, s44, s3
  ds_read_b64_tr_b16 v[54:55], v241 offset:51200
  v_mfma_f32_16x16x32_bf16 v[100:103], v[36:39], a[8:11], 0
  ds_read_b64_tr_b16 v[56:57], v242 offset:49152
  buffer_load_dwordx4 a[40:43], v19, s[8:11], s37 offen sc1
  v_mfma_f32_16x16x32_bf16 v[84:87], v[36:39], a[4:7], 0
  s_add_u32 s38, s44, s69
  ds_read_b64_tr_b16 v[58:59], v242 offset:51200
  v_mfma_f32_16x16x32_bf16 v[68:71], v[36:39], a[0:3], 0
  buffer_load_dwordx4 a[44:47], v19, s[8:11], s38 offen sc1
  v_mfma_f32_16x16x32_bf16 v[72:75], v[40:43], a[0:3], 0
  s_add_u32 s39, s39, 4096
  s_cmp_ge_u32 s39, s45
  s_cselect_b32 s44, 45056, 0
  s_sub_u32 s39, s39, s44
  s_cmp_eq_u32 s39, 44032
  s_cselect_b32 s44, 2.0, s39
  s_add_u32 s35, s44, s0
  ds_read_b64_tr_b16 v[60:61], v243 offset:49152
  v_mfma_f32_16x16x32_bf16 v[88:91], v[40:43], a[4:7], 0
  ds_read_b64_tr_b16 v[62:63], v243 offset:51200
  buffer_load_dwordx4 a[48:51], v19, s[8:11], s35 offen sc1
  v_mfma_f32_16x16x32_bf16 v[104:107], v[40:43], a[8:11], 0
  s_add_u32 s36, s44, s1
  v_mfma_f32_16x16x32_bf16 v[120:123], v[40:43], a[12:15], 0
  buffer_load_dwordx4 a[52:55], v19, s[8:11], s36 offen sc1
  v_mfma_f32_16x16x32_bf16 v[124:127], v[44:47], a[12:15], 0
  s_add_u32 s37, s44, s3
  v_mfma_f32_16x16x32_bf16 v[108:111], v[44:47], a[8:11], 0
  buffer_load_dwordx4 a[56:59], v19, s[8:11], s37 offen sc1
  v_mfma_f32_16x16x32_bf16 v[92:95], v[44:47], a[4:7], 0
  s_add_u32 s38, s44, s69
  v_mfma_f32_16x16x32_bf16 v[76:79], v[44:47], a[0:3], 0
  s_waitcnt vmcnt(7) lgkmcnt(0)
  buffer_load_dwordx4 a[60:63], v19, s[8:11], s38 offen sc1
  v_mfma_f32_16x16x32_bf16 v[64:67], v[48:51], a[16:19], v[64:67]
  ds_read_b64_tr_b16 v[32:33], v244 offset:0
  v_mfma_f32_16x16x32_bf16 v[80:83], v[48:51], a[20:23], v[80:83]
  ds_read_b64_tr_b16 v[34:35], v244 offset:2048
  v_mfma_f32_16x16x32_bf16 v[96:99], v[48:51], a[24:27], v[96:99]
  s_add_u32 s39, s39, 4096
  s_cmp_ge_u32 s39, s45
  s_cselect_b32 s44, 45056, 0
  s_sub_u32 s39, s39, s44
  s_cmp_eq_u32 s39, 44032
  s_cselect_b32 s44, 2.0, s39
  s_add_u32 s35, s44, s0
  ds_read_b64_tr_b16 v[36:37], v245 offset:0
  v_mfma_f32_16x16x32_bf16 v[112:115], v[48:51], a[28:31], v[112:115]
  buffer_load_dwordx4 a[64:67], v19, s[8:11], s35 offen sc1
  v_mfma_f32_16x16x32_bf16 v[116:119], v[52:55], a[28:31], v[116:119]
  ds_read_b64_tr_b16 v[38:39], v245 offset:2048
  v_mfma_f32_16x16x32_bf16 v[100:103], v[52:55], a[24:27], v[100:103]
  ds_read_b64_tr_b16 v[40:41], v246 offset:0
  v_mfma_f32_16x16x32_bf16 v[84:87], v[52:55], a[20:23], v[84:87]
  s_add_u32 s36, s44, s1
  ds_read_b64_tr_b16 v[42:43], v246 offset:2048
  v_mfma_f32_16x16x32_bf16 v[68:71], v[52:55], a[16:19], v[68:71]
  buffer_load_dwordx4 a[68:71], v19, s[8:11], s36 offen sc1
  v_mfma_f32_16x16x32_bf16 v[72:75], v[56:59], a[16:19], v[72:75]
  ds_read_b64_tr_b16 v[44:45], v247 offset:0
  v_mfma_f32_16x16x32_bf16 v[88:91], v[56:59], a[20:23], v[88:91]
  ds_read_b64_tr_b16 v[46:47], v247 offset:2048
  v_mfma_f32_16x16x32_bf16 v[104:107], v[56:59], a[24:27], v[104:107]
  s_add_u32 s37, s44, s3
  v_mfma_f32_16x16x32_bf16 v[120:123], v[56:59], a[28:31], v[120:123]
  buffer_load_dwordx4 a[72:75], v19, s[8:11], s37 offen sc1
  v_mfma_f32_16x16x32_bf16 v[124:127], v[60:63], a[28:31], v[124:127]
  v_mfma_f32_16x16x32_bf16 v[108:111], v[60:63], a[24:27], v[108:111]
  v_mfma_f32_16x16x32_bf16 v[92:95], v[60:63], a[20:23], v[92:95]
  s_add_u32 s38, s44, s69
  v_mfma_f32_16x16x32_bf16 v[76:79], v[60:63], a[16:19], v[76:79]
  s_waitcnt vmcnt(7) lgkmcnt(0)
  buffer_load_dwordx4 a[76:79], v19, s[8:11], s38 offen sc1
  v_mfma_f32_16x16x32_bf16 v[64:67], v[32:35], a[32:35], v[64:67]
  ds_read_b64_tr_b16 v[48:49], v244 offset:16384
  v_mfma_f32_16x16x32_bf16 v[80:83], v[32:35], a[36:39], v[80:83]
  ds_read_b64_tr_b16 v[50:51], v244 offset:18432
  v_mfma_f32_16x16x32_bf16 v[96:99], v[32:35], a[40:43], v[96:99]
  s_add_u32 s39, s39, 4096
  s_cmp_ge_u32 s39, s45
  s_cselect_b32 s44, 45056, 0
  s_sub_u32 s39, s39, s44
  s_cmp_eq_u32 s39, 44032
  s_cselect_b32 s44, 2.0, s39
  s_add_u32 s35, s44, s0
  ds_read_b64_tr_b16 v[52:53], v245 offset:16384
  v_mfma_f32_16x16x32_bf16 v[112:115], v[32:35], a[44:47], v[112:115]
  buffer_load_dwordx4 a[80:83], v19, s[8:11], s35 offen sc1
  v_mfma_f32_16x16x32_bf16 v[116:119], v[36:39], a[44:47], v[116:119]
  ds_read_b64_tr_b16 v[54:55], v245 offset:18432
  v_mfma_f32_16x16x32_bf16 v[100:103], v[36:39], a[40:43], v[100:103]
  ds_read_b64_tr_b16 v[56:57], v246 offset:16384
  v_mfma_f32_16x16x32_bf16 v[84:87], v[36:39], a[36:39], v[84:87]
  s_add_u32 s36, s44, s1
  ds_read_b64_tr_b16 v[58:59], v246 offset:18432
  v_mfma_f32_16x16x32_bf16 v[68:71], v[36:39], a[32:35], v[68:71]
  buffer_load_dwordx4 a[84:87], v19, s[8:11], s36 offen sc1
  v_mfma_f32_16x16x32_bf16 v[72:75], v[40:43], a[32:35], v[72:75]
  ds_read_b64_tr_b16 v[60:61], v247 offset:16384
  v_mfma_f32_16x16x32_bf16 v[88:91], v[40:43], a[36:39], v[88:91]
  ds_read_b64_tr_b16 v[62:63], v247 offset:18432
  v_mfma_f32_16x16x32_bf16 v[104:107], v[40:43], a[40:43], v[104:107]
  s_add_u32 s37, s44, s3
  v_mfma_f32_16x16x32_bf16 v[120:123], v[40:43], a[44:47], v[120:123]
  buffer_load_dwordx4 a[88:91], v19, s[8:11], s37 offen sc1
  v_mfma_f32_16x16x32_bf16 v[124:127], v[44:47], a[44:47], v[124:127]
  s_add_u32 s27, s27, 131072
  s_cmp_ge_u32 s27, s25
  s_cselect_b32 s34, 1441792, 0
  s_sub_u32 s27, s27, s34
  s_add_u32 m0, s43, 98304
  v_mfma_f32_16x16x32_bf16 v[108:111], v[44:47], a[40:43], v[108:111]
  buffer_load_dwordx4 v232, s[60:63], s27 offen offset:0 lds
  v_mfma_f32_16x16x32_bf16 v[92:95], v[44:47], a[36:39], v[92:95]
  s_add_u32 s38, s44, s69
  v_mfma_f32_16x16x32_bf16 v[76:79], v[44:47], a[32:35], v[76:79]
  s_waitcnt vmcnt(8) lgkmcnt(0)
  buffer_load_dwordx4 a[92:95], v19, s[8:11], s38 offen sc1
  v_mfma_f32_16x16x32_bf16 v[64:67], v[48:51], a[48:51], v[64:67]
  ds_read_b64_tr_b16 v[32:33], v236 offset:0
  v_mfma_f32_16x16x32_bf16 v[80:83], v[48:51], a[52:55], v[80:83]
  ds_read_b64_tr_b16 v[34:35], v236 offset:2048
  v_mfma_f32_16x16x32_bf16 v[96:99], v[48:51], a[56:59], v[96:99]
  s_add_u32 s39, s39, 4096
  s_cmp_ge_u32 s39, s45
  s_cselect_b32 s44, 45056, 0
  s_sub_u32 s39, s39, s44
  s_cmp_eq_u32 s39, 44032
  s_cselect_b32 s44, 2.0, s39
  s_add_u32 s35, s44, s0
  ds_read_b64_tr_b16 v[36:37], v237 offset:0
  v_mfma_f32_16x16x32_bf16 v[112:115], v[48:51], a[60:63], v[112:115]
  buffer_load_dwordx4 a[96:99], v19, s[8:11], s35 offen sc1
  v_mfma_f32_16x16x32_bf16 v[116:119], v[52:55], a[60:63], v[116:119]
  ds_read_b64_tr_b16 v[38:39], v237 offset:2048
  v_mfma_f32_16x16x32_bf16 v[100:103], v[52:55], a[56:59], v[100:103]
  ds_read_b64_tr_b16 v[40:41], v238 offset:0
  v_mfma_f32_16x16x32_bf16 v[84:87], v[52:55], a[52:55], v[84:87]
  s_add_u32 s36, s44, s1
  ds_read_b64_tr_b16 v[42:43], v238 offset:2048
  v_mfma_f32_16x16x32_bf16 v[68:71], v[52:55], a[48:51], v[68:71]
  buffer_load_dwordx4 a[100:103], v19, s[8:11], s36 offen sc1
  v_mfma_f32_16x16x32_bf16 v[72:75], v[56:59], a[48:51], v[72:75]
  ds_read_b64_tr_b16 v[44:45], v239 offset:0
  v_mfma_f32_16x16x32_bf16 v[88:91], v[56:59], a[52:55], v[88:91]
  ds_read_b64_tr_b16 v[46:47], v239 offset:2048
  v_mfma_f32_16x16x32_bf16 v[104:107], v[56:59], a[56:59], v[104:107]
  s_add_u32 s37, s44, s3
  v_mfma_f32_16x16x32_bf16 v[120:123], v[56:59], a[60:63], v[120:123]
  buffer_load_dwordx4 a[104:107], v19, s[8:11], s37 offen sc1
  v_mfma_f32_16x16x32_bf16 v[124:127], v[60:63], a[60:63], v[124:127]
  s_add_u32 m0, s43, 98304
  v_mfma_f32_16x16x32_bf16 v[108:111], v[60:63], a[56:59], v[108:111]
  buffer_load_dwordx4 v233, s[60:63], s27 offen offset:1024 lds
  v_mfma_f32_16x16x32_bf16 v[92:95], v[60:63], a[52:55], v[92:95]
  s_add_u32 s38, s44, s69
  v_mfma_f32_16x16x32_bf16 v[76:79], v[60:63], a[48:51], v[76:79]
  s_waitcnt vmcnt(9) lgkmcnt(0)
  buffer_load_dwordx4 a[108:111], v19, s[8:11], s38 offen sc1
  v_mfma_f32_16x16x32_bf16 v[64:67], v[32:35], a[64:67], v[64:67]
  ds_read_b64_tr_b16 v[48:49], v236 offset:16384
  v_mfma_f32_16x16x32_bf16 v[80:83], v[32:35], a[68:71], v[80:83]
  ds_read_b64_tr_b16 v[50:51], v236 offset:18432
  v_mfma_f32_16x16x32_bf16 v[96:99], v[32:35], a[72:75], v[96:99]
  s_add_u32 s39, s39, 4096
  s_cmp_ge_u32 s39, s45
  s_cselect_b32 s44, 45056, 0
  s_sub_u32 s39, s39, s44
  s_cmp_eq_u32 s39, 44032
  s_cselect_b32 s44, 2.0, s39
  s_add_u32 s35, s44, s0
  ds_read_b64_tr_b16 v[52:53], v237 offset:16384
  v_mfma_f32_16x16x32_bf16 v[112:115], v[32:35], a[76:79], v[112:115]
  buffer_load_dwordx4 a[112:115], v19, s[8:11], s35 offen sc1
  v_mfma_f32_16x16x32_bf16 v[116:119], v[36:39], a[76:79], v[116:119]
  ds_read_b64_tr_b16 v[54:55], v237 offset:18432
  v_mfma_f32_16x16x32_bf16 v[100:103], v[36:39], a[72:75], v[100:103]
  ds_read_b64_tr_b16 v[56:57], v238 offset:16384
  v_mfma_f32_16x16x32_bf16 v[84:87], v[36:39], a[68:71], v[84:87]
  s_add_u32 s36, s44, s1
  ds_read_b64_tr_b16 v[58:59], v238 offset:18432
  v_mfma_f32_16x16x32_bf16 v[68:71], v[36:39], a[64:67], v[68:71]
  buffer_load_dwordx4 a[116:119], v19, s[8:11], s36 offen sc1
  v_mfma_f32_16x16x32_bf16 v[72:75], v[40:43], a[64:67], v[72:75]
  ds_read_b64_tr_b16 v[60:61], v239 offset:16384
  v_mfma_f32_16x16x32_bf16 v[88:91], v[40:43], a[68:71], v[88:91]
  ds_read_b64_tr_b16 v[62:63], v239 offset:18432
  v_mfma_f32_16x16x32_bf16 v[104:107], v[40:43], a[72:75], v[104:107]
  s_add_u32 s37, s44, s3
  v_mfma_f32_16x16x32_bf16 v[120:123], v[40:43], a[76:79], v[120:123]
  buffer_load_dwordx4 a[120:123], v19, s[8:11], s37 offen sc1
  v_mfma_f32_16x16x32_bf16 v[124:127], v[44:47], a[76:79], v[124:127]
  s_add_u32 m0, s43, 98304
  v_mfma_f32_16x16x32_bf16 v[108:111], v[44:47], a[72:75], v[108:111]
  buffer_load_dwordx4 v234, s[60:63], s27 offen offset:2048 lds
  v_mfma_f32_16x16x32_bf16 v[92:95], v[44:47], a[68:71], v[92:95]
  s_add_u32 s38, s44, s69
  v_mfma_f32_16x16x32_bf16 v[76:79], v[44:47], a[64:67], v[76:79]
  s_waitcnt vmcnt(9) lgkmcnt(0)
  buffer_load_dwordx4 a[124:127], v19, s[8:11], s38 offen sc1
  v_mfma_f32_16x16x32_bf16 v[64:67], v[48:51], a[80:83], v[64:67]
  ds_read_b64_tr_b16 v[32:33], v236 offset:32768
  v_mfma_f32_16x16x32_bf16 v[80:83], v[48:51], a[84:87], v[80:83]
  ds_read_b64_tr_b16 v[34:35], v236 offset:34816
  v_mfma_f32_16x16x32_bf16 v[96:99], v[48:51], a[88:91], v[96:99]
  s_add_u32 s39, s39, 4096
  s_cmp_ge_u32 s39, s45
  s_cselect_b32 s44, 45056, 0
  s_sub_u32 s39, s39, s44
  s_cmp_eq_u32 s39, 44032
  s_cselect_b32 s44, 2.0, s39
  s_add_u32 s35, s44, s0
  ds_read_b64_tr_b16 v[36:37], v237 offset:32768
  v_mfma_f32_16x16x32_bf16 v[112:115], v[48:51], a[92:95], v[112:115]
  buffer_load_dwordx4 a[128:131], v19, s[8:11], s35 offen sc1
  v_mfma_f32_16x16x32_bf16 v[116:119], v[52:55], a[92:95], v[116:119]
  ds_read_b64_tr_b16 v[38:39], v237 offset:34816
  v_mfma_f32_16x16x32_bf16 v[100:103], v[52:55], a[88:91], v[100:103]
  ds_read_b64_tr_b16 v[40:41], v238 offset:32768
  v_mfma_f32_16x16x32_bf16 v[84:87], v[52:55], a[84:87], v[84:87]
  s_add_u32 s36, s44, s1
  ds_read_b64_tr_b16 v[42:43], v238 offset:34816
  v_mfma_f32_16x16x32_bf16 v[68:71], v[52:55], a[80:83], v[68:71]
  buffer_load_dwordx4 a[132:135], v19, s[8:11], s36 offen sc1
  v_mfma_f32_16x16x32_bf16 v[72:75], v[56:59], a[80:83], v[72:75]
  ds_read_b64_tr_b16 v[44:45], v239 offset:32768
  v_mfma_f32_16x16x32_bf16 v[88:91], v[56:59], a[84:87], v[88:91]
  ds_read_b64_tr_b16 v[46:47], v239 offset:34816
  v_mfma_f32_16x16x32_bf16 v[104:107], v[56:59], a[88:91], v[104:107]
  s_add_u32 s37, s44, s3
  v_mfma_f32_16x16x32_bf16 v[120:123], v[56:59], a[92:95], v[120:123]
  buffer_load_dwordx4 a[136:139], v19, s[8:11], s37 offen sc1
  v_mfma_f32_16x16x32_bf16 v[124:127], v[60:63], a[92:95], v[124:127]
  s_add_u32 m0, s43, 98304
  v_mfma_f32_16x16x32_bf16 v[108:111], v[60:63], a[88:91], v[108:111]
  buffer_load_dwordx4 v235, s[60:63], s27 offen offset:3072 lds
  v_mfma_f32_16x16x32_bf16 v[92:95], v[60:63], a[84:87], v[92:95]
  s_add_u32 s38, s44, s69
  v_mfma_f32_16x16x32_bf16 v[76:79], v[60:63], a[80:83], v[76:79]
  s_waitcnt vmcnt(9) lgkmcnt(0)
  buffer_load_dwordx4 a[140:143], v19, s[8:11], s38 offen sc1
  v_mfma_f32_16x16x32_bf16 v[64:67], v[32:35], a[96:99], v[64:67]
  ds_read_b64_tr_b16 v[48:49], v236 offset:49152
  v_mfma_f32_16x16x32_bf16 v[80:83], v[32:35], a[100:103], v[80:83]
  ds_read_b64_tr_b16 v[50:51], v236 offset:51200
  v_mfma_f32_16x16x32_bf16 v[96:99], v[32:35], a[104:107], v[96:99]
  s_add_u32 s39, s39, 4096
  s_cmp_ge_u32 s39, s45
  s_cselect_b32 s44, 45056, 0
  s_sub_u32 s39, s39, s44
  s_cmp_eq_u32 s39, 44032
  s_cselect_b32 s44, 2.0, s39
  s_add_u32 s35, s44, s0
  ds_read_b64_tr_b16 v[52:53], v237 offset:49152
  v_mfma_f32_16x16x32_bf16 v[112:115], v[32:35], a[108:111], v[112:115]
  buffer_load_dwordx4 a[144:147], v19, s[8:11], s35 offen sc1
  v_mfma_f32_16x16x32_bf16 v[116:119], v[36:39], a[108:111], v[116:119]
  ds_read_b64_tr_b16 v[54:55], v237 offset:51200
  v_mfma_f32_16x16x32_bf16 v[100:103], v[36:39], a[104:107], v[100:103]
  ds_read_b64_tr_b16 v[56:57], v238 offset:49152
  v_mfma_f32_16x16x32_bf16 v[84:87], v[36:39], a[100:103], v[84:87]
  s_add_u32 s36, s44, s1
  ds_read_b64_tr_b16 v[58:59], v238 offset:51200
  v_mfma_f32_16x16x32_bf16 v[68:71], v[36:39], a[96:99], v[68:71]
  buffer_load_dwordx4 a[148:151], v19, s[8:11], s36 offen sc1
  v_mfma_f32_16x16x32_bf16 v[72:75], v[40:43], a[96:99], v[72:75]
  ds_read_b64_tr_b16 v[60:61], v239 offset:49152
  v_mfma_f32_16x16x32_bf16 v[88:91], v[40:43], a[100:103], v[88:91]
  ds_read_b64_tr_b16 v[62:63], v239 offset:51200
  v_mfma_f32_16x16x32_bf16 v[104:107], v[40:43], a[104:107], v[104:107]
  s_add_u32 s37, s44, s3
  v_mfma_f32_16x16x32_bf16 v[120:123], v[40:43], a[108:111], v[120:123]
  buffer_load_dwordx4 a[152:155], v19, s[8:11], s37 offen sc1
  v_mfma_f32_16x16x32_bf16 v[124:127], v[44:47], a[108:111], v[124:127]
  v_mfma_f32_16x16x32_bf16 v[108:111], v[44:47], a[104:107], v[108:111]
  v_mfma_f32_16x16x32_bf16 v[92:95], v[44:47], a[100:103], v[92:95]
  s_add_u32 s38, s44, s69
  v_mfma_f32_16x16x32_bf16 v[76:79], v[44:47], a[96:99], v[76:79]
  s_waitcnt vmcnt(8) lgkmcnt(0)
  buffer_load_dwordx4 a[156:159], v19, s[8:11], s38 offen sc1
  v_mfma_f32_16x16x32_bf16 v[64:67], v[48:51], a[112:115], v[64:67]
  ds_read_b64_tr_b16 v[32:33], v240 offset:0
  v_mfma_f32_16x16x32_bf16 v[80:83], v[48:51], a[116:119], v[80:83]
  ds_read_b64_tr_b16 v[34:35], v240 offset:2048
  v_mfma_f32_16x16x32_bf16 v[96:99], v[48:51], a[120:123], v[96:99]
  s_add_u32 s39, s39, 4096
  s_cmp_ge_u32 s39, s45
  s_cselect_b32 s44, 45056, 0
  s_sub_u32 s39, s39, s44
  s_cmp_eq_u32 s39, 44032
  s_cselect_b32 s44, 2.0, s39
  s_add_u32 s35, s44, s0
  ds_read_b64_tr_b16 v[36:37], v241 offset:0
  v_mfma_f32_16x16x32_bf16 v[112:115], v[48:51], a[124:127], v[112:115]
  buffer_load_dwordx4 a[160:163], v19, s[8:11], s35 offen sc1
  v_mfma_f32_16x16x32_bf16 v[116:119], v[52:55], a[124:127], v[116:119]
  ds_read_b64_tr_b16 v[38:39], v241 offset:2048
  v_mfma_f32_16x16x32_bf16 v[100:103], v[52:55], a[120:123], v[100:103]
  ds_read_b64_tr_b16 v[40:41], v242 offset:0
  v_mfma_f32_16x16x32_bf16 v[84:87], v[52:55], a[116:119], v[84:87]
  s_add_u32 s36, s44, s1
  ds_read_b64_tr_b16 v[42:43], v242 offset:2048
  v_mfma_f32_16x16x32_bf16 v[68:71], v[52:55], a[112:115], v[68:71]
  buffer_load_dwordx4 a[164:167], v19, s[8:11], s36 offen sc1
  v_mfma_f32_16x16x32_bf16 v[72:75], v[56:59], a[112:115], v[72:75]
  ds_read_b64_tr_b16 v[44:45], v243 offset:0
  v_mfma_f32_16x16x32_bf16 v[88:91], v[56:59], a[116:119], v[88:91]
  ds_read_b64_tr_b16 v[46:47], v243 offset:2048
  v_mfma_f32_16x16x32_bf16 v[104:107], v[56:59], a[120:123], v[104:107]
  s_add_u32 s37, s44, s3
  v_mfma_f32_16x16x32_bf16 v[120:123], v[56:59], a[124:127], v[120:123]
  buffer_load_dwordx4 a[168:171], v19, s[8:11], s37 offen sc1
  v_mfma_f32_16x16x32_bf16 v[124:127], v[60:63], a[124:127], v[124:127]
  v_mfma_f32_16x16x32_bf16 v[108:111], v[60:63], a[120:123], v[108:111]
  v_mfma_f32_16x16x32_bf16 v[92:95], v[60:63], a[116:119], v[92:95]
  s_add_u32 s38, s44, s69
  v_mfma_f32_16x16x32_bf16 v[76:79], v[60:63], a[112:115], v[76:79]
  s_waitcnt vmcnt(7) lgkmcnt(0)
  buffer_load_dwordx4 a[172:175], v19, s[8:11], s38 offen sc1
  v_mfma_f32_16x16x32_bf16 v[64:67], v[32:35], a[128:131], v[64:67]
  ds_read_b64_tr_b16 v[48:49], v240 offset:16384
  v_mfma_f32_16x16x32_bf16 v[80:83], v[32:35], a[132:135], v[80:83]
  ds_read_b64_tr_b16 v[50:51], v240 offset:18432
  v_mfma_f32_16x16x32_bf16 v[96:99], v[32:35], a[136:139], v[96:99]
  ds_read_b64_tr_b16 v[52:53], v241 offset:16384
  v_mfma_f32_16x16x32_bf16 v[112:115], v[32:35], a[140:143], v[112:115]
  v_mfma_f32_16x16x32_bf16 v[116:119], v[36:39], a[140:143], v[116:119]
  ds_read_b64_tr_b16 v[54:55], v241 offset:18432
  v_mfma_f32_16x16x32_bf16 v[100:103], v[36:39], a[136:139], v[100:103]
  ds_read_b64_tr_b16 v[56:57], v242 offset:16384
  v_mfma_f32_16x16x32_bf16 v[84:87], v[36:39], a[132:135], v[84:87]
  ds_read_b64_tr_b16 v[58:59], v242 offset:18432
  v_mfma_f32_16x16x32_bf16 v[68:71], v[36:39], a[128:131], v[68:71]
  v_mfma_f32_16x16x32_bf16 v[72:75], v[40:43], a[128:131], v[72:75]
  ds_read_b64_tr_b16 v[60:61], v243 offset:16384
  v_mfma_f32_16x16x32_bf16 v[88:91], v[40:43], a[132:135], v[88:91]
  ds_read_b64_tr_b16 v[62:63], v243 offset:18432
  v_mfma_f32_16x16x32_bf16 v[104:107], v[40:43], a[136:139], v[104:107]
  v_mfma_f32_16x16x32_bf16 v[120:123], v[40:43], a[140:143], v[120:123]
  v_mfma_f32_16x16x32_bf16 v[124:127], v[44:47], a[140:143], v[124:127]
  v_mfma_f32_16x16x32_bf16 v[108:111], v[44:47], a[136:139], v[108:111]
  v_mfma_f32_16x16x32_bf16 v[92:95], v[44:47], a[132:135], v[92:95]
  v_mfma_f32_16x16x32_bf16 v[76:79], v[44:47], a[128:131], v[76:79]
  s_waitcnt vmcnt(4) lgkmcnt(0)
  v_mfma_f32_16x16x32_bf16 v[64:67], v[48:51], a[144:147], v[64:67]
  ds_read_b64_tr_b16 v[32:33], v240 offset:32768
  v_mfma_f32_16x16x32_bf16 v[80:83], v[48:51], a[148:151], v[80:83]
  ds_read_b64_tr_b16 v[34:35], v240 offset:34816
  v_mfma_f32_16x16x32_bf16 v[96:99], v[48:51], a[152:155], v[96:99]
  ds_read_b64_tr_b16 v[36:37], v241 offset:32768
  v_mfma_f32_16x16x32_bf16 v[112:115], v[48:51], a[156:159], v[112:115]
  v_mfma_f32_16x16x32_bf16 v[116:119], v[52:55], a[156:159], v[116:119]
  ds_read_b64_tr_b16 v[38:39], v241 offset:34816
  v_mfma_f32_16x16x32_bf16 v[100:103], v[52:55], a[152:155], v[100:103]
  ds_read_b64_tr_b16 v[40:41], v242 offset:32768
  v_mfma_f32_16x16x32_bf16 v[84:87], v[52:55], a[148:151], v[84:87]
  ds_read_b64_tr_b16 v[42:43], v242 offset:34816
  v_mfma_f32_16x16x32_bf16 v[68:71], v[52:55], a[144:147], v[68:71]
  v_mfma_f32_16x16x32_bf16 v[72:75], v[56:59], a[144:147], v[72:75]
  ds_read_b64_tr_b16 v[44:45], v243 offset:32768
  v_mfma_f32_16x16x32_bf16 v[88:91], v[56:59], a[148:151], v[88:91]
  ds_read_b64_tr_b16 v[46:47], v243 offset:34816
  v_mfma_f32_16x16x32_bf16 v[104:107], v[56:59], a[152:155], v[104:107]
  v_mfma_f32_16x16x32_bf16 v[120:123], v[56:59], a[156:159], v[120:123]
  v_mfma_f32_16x16x32_bf16 v[124:127], v[60:63], a[156:159], v[124:127]
  v_mfma_f32_16x16x32_bf16 v[108:111], v[60:63], a[152:155], v[108:111]
  v_mfma_f32_16x16x32_bf16 v[92:95], v[60:63], a[148:151], v[92:95]
  v_mfma_f32_16x16x32_bf16 v[76:79], v[60:63], a[144:147], v[76:79]
  s_waitcnt vmcnt(0) lgkmcnt(0)
  v_mfma_f32_16x16x32_bf16 v[80:83], v[32:35], a[164:167], v[80:83]
  v_mfma_f32_16x16x32_bf16 v[84:87], v[36:39], a[164:167], v[84:87]
  v_mfma_f32_16x16x32_bf16 v[88:91], v[40:43], a[164:167], v[88:91]
  v_mfma_f32_16x16x32_bf16 v[92:95], v[44:47], a[164:167], v[92:95]
  v_mfma_f32_16x16x32_bf16 v[96:99], v[32:35], a[168:171], v[96:99]
  v_mfma_f32_16x16x32_bf16 v[100:103], v[36:39], a[168:171], v[100:103]
  v_mfma_f32_16x16x32_bf16 v[104:107], v[40:43], a[168:171], v[104:107]
  v_mfma_f32_16x16x32_bf16 v[108:111], v[44:47], a[168:171], v[108:111]
  v_mfma_f32_16x16x32_bf16 v[112:115], v[32:35], a[172:175], v[112:115]
  v_mfma_f32_16x16x32_bf16 v[116:119], v[36:39], a[172:175], v[116:119]
  ds_write_b128 v28, v[80:83] offset:0
  v_mfma_f32_16x16x32_bf16 v[120:123], v[40:43], a[172:175], v[120:123]
  ds_write_b128 v28, v[84:87] offset:1024
  v_mfma_f32_16x16x32_bf16 v[124:127], v[44:47], a[172:175], v[124:127]
  ds_write_b128 v28, v[88:91] offset:2048
  v_mfma_f32_16x16x32_bf16 v[64:67], v[32:35], a[160:163], v[64:67]
  ds_write_b128 v28, v[92:95] offset:3072
  v_mfma_f32_16x16x32_bf16 v[68:71], v[36:39], a[160:163], v[68:71]
  ds_write_b128 v28, v[96:99] offset:16384
  v_mfma_f32_16x16x32_bf16 v[72:75], v[40:43], a[160:163], v[72:75]
  ds_write_b128 v28, v[100:103] offset:17408
  v_mfma_f32_16x16x32_bf16 v[76:79], v[44:47], a[160:163], v[76:79]
  ds_write_b128 v28, v[104:107] offset:18432
  ds_write_b128 v28, v[108:111] offset:19456
  ds_write_b128 v28, v[112:115] offset:32768
  ds_write_b128 v28, v[116:119] offset:33792
  ds_write_b128 v28, v[120:123] offset:34816
  ds_write_b128 v28, v[124:127] offset:35840
  s_waitcnt lgkmcnt(0)
  s_barrier
  ds_read_b128 v[80:83], v29 offset:0
  ds_read_b128 v[84:87], v29 offset:1024
  ds_read_b128 v[88:91], v29 offset:2048
  ds_read_b128 v[92:95], v29 offset:3072
  ds_read_b128 v[96:99], v30 offset:16384
  ds_read_b128 v[100:103], v30 offset:17408
  ds_read_b128 v[104:107], v30 offset:18432
  ds_read_b128 v[108:111], v30 offset:19456
  ds_read_b128 v[112:115], v31 offset:32768
  ds_read_b128 v[116:119], v31 offset:33792
  ds_read_b128 v[120:123], v31 offset:34816
  ds_read_b128 v[124:127], v31 offset:35840
  s_waitcnt lgkmcnt(8)
  v_pk_add_f32 v[64:65], v[64:65], v[80:81]
  v_pk_add_f32 v[66:67], v[66:67], v[82:83]
  v_pk_add_f32 v[68:69], v[68:69], v[84:85]
  v_pk_add_f32 v[70:71], v[70:71], v[86:87]
  v_pk_add_f32 v[72:73], v[72:73], v[88:89]
  v_pk_add_f32 v[74:75], v[74:75], v[90:91]
  v_pk_add_f32 v[76:77], v[76:77], v[92:93]
  v_pk_add_f32 v[78:79], v[78:79], v[94:95]
  s_waitcnt lgkmcnt(4)
  v_pk_add_f32 v[64:65], v[64:65], v[96:97]
  v_pk_add_f32 v[66:67], v[66:67], v[98:99]
  v_pk_add_f32 v[68:69], v[68:69], v[100:101]
  v_pk_add_f32 v[70:71], v[70:71], v[102:103]
  v_pk_add_f32 v[72:73], v[72:73], v[104:105]
  v_pk_add_f32 v[74:75], v[74:75], v[106:107]
  v_pk_add_f32 v[76:77], v[76:77], v[108:109]
  v_pk_add_f32 v[78:79], v[78:79], v[110:111]
  s_waitcnt lgkmcnt(0)
  v_pk_add_f32 v[64:65], v[64:65], v[112:113]
  v_pk_add_f32 v[66:67], v[66:67], v[114:115]
  v_pk_add_f32 v[68:69], v[68:69], v[116:117]
  v_pk_add_f32 v[70:71], v[70:71], v[118:119]
  v_pk_add_f32 v[72:73], v[72:73], v[120:121]
  v_pk_add_f32 v[74:75], v[74:75], v[122:123]
  v_pk_add_f32 v[76:77], v[76:77], v[124:125]
  v_pk_add_f32 v[78:79], v[78:79], v[126:127]
  v_pk_fma_f32 v[64:65], v[64:65], v[176:177], v[128:129]
  v_pk_fma_f32 v[66:67], v[66:67], v[178:179], v[130:131]
  v_pk_fma_f32 v[68:69], v[68:69], v[180:181], v[132:133]
  v_pk_fma_f32 v[70:71], v[70:71], v[182:183], v[134:135]
  v_pk_fma_f32 v[72:73], v[72:73], v[184:185], v[136:137]
  v_pk_fma_f32 v[74:75], v[74:75], v[186:187], v[138:139]
  v_pk_fma_f32 v[76:77], v[76:77], v[188:189], v[140:141]
  v_pk_fma_f32 v[78:79], v[78:79], v[190:191], v[142:143]
  v_cvt_pk_bf16_f32 v40, v64, v65
  v_cvt_pk_bf16_f32 v41, v66, v67
  v_cvt_pk_bf16_f32 v42, v68, v69
  v_cvt_pk_bf16_f32 v43, v70, v71
  v_cvt_pk_bf16_f32 v44, v72, v73
  v_cvt_pk_bf16_f32 v45, v74, v75
  v_cvt_pk_bf16_f32 v46, v76, v77
  v_cvt_pk_bf16_f32 v47, v78, v79
  s_nop 1
  v_permlane32_swap_b32 v40, v42
  v_permlane32_swap_b32 v41, v43
  v_permlane32_swap_b32 v44, v46
  v_permlane32_swap_b32 v45, v47
  v_permlane16_swap_b32 v40, v42
  v_permlane16_swap_b32 v41, v43
  v_permlane16_swap_b32 v44, v46
  v_permlane16_swap_b32 v45, v47
  buffer_store_dwordx4 v[40:43], v2, s[20:23], s40 offen offset:0 nt
  buffer_store_dwordx4 v[44:47], v2, s[20:23], s40 offen offset:64 nt
L_attn_end:
  s_endpgm
L_f_far:
  s_waitcnt vmcnt(16)
  s_nop 0
  v_mfma_f32_16x16x32_bf16 v[228:231], v[224:227], v[192:195], v[228:231]
  ds_read_b64_tr_b16 a[192:193], v12 offset:49152
  ds_read_b64_tr_b16 a[194:195], v12 offset:50176
  v_mfma_f32_16x16x32_bf16 v[228:231], v[224:227], v[208:211], v[228:231]
  ds_read_b64_tr_b16 a[196:197], v12 offset:51200
  ds_read_b64_tr_b16 a[198:199], v12 offset:52224
  v_mfma_f32_16x16x32_bf16 v[232:235], v[224:227], v[196:199], v[232:235]
  ds_read_b64_tr_b16 a[200:201], v13 offset:49152
  ds_read_b64_tr_b16 a[202:203], v13 offset:50176
  v_mfma_f32_16x16x32_bf16 v[232:235], v[224:227], v[212:215], v[232:235]
  ds_read_b64_tr_b16 a[204:205], v13 offset:51200
  ds_read_b64_tr_b16 a[206:207], v13 offset:52224
  v_mfma_f32_16x16x32_bf16 v[236:239], v[224:227], v[200:203], v[236:239]
  ds_read_b64_tr_b16 a[208:209], v14 offset:49152
  ds_read_b64_tr_b16 a[210:211], v14 offset:50176
  v_mfma_f32_16x16x32_bf16 v[236:239], v[224:227], v[216:219], v[236:239]
  ds_read_b64_tr_b16 a[212:213], v14 offset:51200
  ds_read_b64_tr_b16 a[214:215], v14 offset:52224
  v_mfma_f32_16x16x32_bf16 v[240:243], v[224:227], v[204:207], v[240:243]
  ds_read_b64_tr_b16 a[216:217], v15 offset:49152
  ds_read_b64_tr_b16 a[218:219], v15 offset:50176
  v_mfma_f32_16x16x32_bf16 v[240:243], v[224:227], v[220:223], v[240:243]
  ds_read_b64_tr_b16 a[220:221], v15 offset:51200
  ds_read_b64_tr_b16 a[222:223], v15 offset:52224
  v_mfma_f32_16x16x32_bf16 a[0:3], a[224:227], v[192:195], a[0:3]
  v_mfma_f32_16x16x32_bf16 a[0:3], a[228:231], v[208:211], a[0:3]
  v_mfma_f32_16x16x32_bf16 a[16:19], a[232:235], v[192:195], a[16:19]
  v_mfma_f32_16x16x32_bf16 a[16:19], a[236:239], v[208:211], a[16:19]
  v_mfma_f32_16x16x32_bf16 a[4:7], a[224:227], v[196:199], a[4:7]
  v_mfma_f32_16x16x32_bf16 a[4:7], a[228:231], v[212:215], a[4:7]
  v_mfma_f32_16x16x32_bf16 a[20:23], a[232:235], v[196:199], a[20:23]
  v_mfma_f32_16x16x32_bf16 a[20:23], a[236:239], v[212:215], a[20:23]
  v_mfma_f32_16x16x32_bf16 a[8:11], a[224:227], v[200:203], a[8:11]
  v_rcp_f32 v32, v228
  v_rcp_f32 v33, v232
  v_rcp_f32 v34, v236
  v_rcp_f32 v35, v240
  v_mfma_f32_16x16x32_bf16 a[8:11], a[228:231], v[216:219], a[8:11]
  v_add_f32 v28, v228, v232
  v_add_f32 v29, v236, v240
  v_add_f32 v28, v28, v29
  v_mov_b32 v29, 0x53800000
  v_mfma_f32_16x16x32_bf16 a[24:27], a[232:235], v[200:203], a[24:27]
  v_cmp_nlt_f32 s[32:33], v28, v29
  s_cmp_lg_u64 s[32:33], 0
  s_cselect_b32 s31, 1, 0
  s_lshl_b32 s32, s24, 2
  s_add_u32 s32, s32, 131296
  v_mov_b32 v28, s32
  v_mov_b32 v29, s31
  v_mov_b32 v30, 131296
  v_mfma_f32_16x16x32_bf16 a[24:27], a[236:239], v[216:219], a[24:27]
  ds_write_b32 v28, v29
  v_mfma_f32_16x16x32_bf16 a[12:15], a[224:227], v[204:207], a[12:15]
  s_xor_b32 s32, s40, 0
  v_accvgpr_read_b32 v128, a0
  v_accvgpr_read_b32 v129, a1
  v_mfma_f32_16x16x32_bf16 a[12:15], a[228:231], v[220:223], a[12:15]
  v_accvgpr_read_b32 v130, a2
  v_accvgpr_read_b32 v131, a3
  v_mfma_f32_16x16x32_bf16 a[28:31], a[232:235], v[204:207], a[28:31]
  v_accvgpr_read_b32 v132, a16
  v_accvgpr_read_b32 v133, a17
  v_mfma_f32_16x16x32_bf16 a[28:31], a[236:239], v[220:223], a[28:31]
  v_accvgpr_read_b32 v134, a18
  v_accvgpr_read_b32 v135, a19
  v_mfma_f32_16x16x32_bf16 a[32:35], a[240:243], v[192:195], a[32:35]
  v_mul_f32 v128, v128, v32
  v_mul_f32 v129, v129, v32
  v_mfma_f32_16x16x32_bf16 a[32:35], a[244:247], v[208:211], a[32:35]
  v_mul_f32 v130, v130, v32
  v_mul_f32 v131, v131, v32
  v_mfma_f32_16x16x32_bf16 a[48:51], a[248:251], v[192:195], a[48:51]
  v_mul_f32 v132, v132, v32
  v_mul_f32 v133, v133, v32
  v_mfma_f32_16x16x32_bf16 a[48:51], a[252:255], v[208:211], a[48:51]
  v_mul_f32 v134, v134, v32
  v_mul_f32 v135, v135, v32
  v_mfma_f32_16x16x32_bf16 a[36:39], a[240:243], v[196:199], a[36:39]
  v_cvt_pk_bf16_f32 v128, v128, v129
  v_cvt_pk_bf16_f32 v129, v130, v131
  v_mfma_f32_16x16x32_bf16 a[36:39], a[244:247], v[212:215], a[36:39]
  v_cvt_pk_bf16_f32 v130, v132, v133
  v_cvt_pk_bf16_f32 v131, v134, v135
  v_mfma_f32_16x16x32_bf16 a[52:55], a[248:251], v[196:199], a[52:55]
  buffer_store_dwordx4 v[128:131], v19, s[20:23], s32 offen offset:0 sc1
  v_mfma_f32_16x16x32_bf16 a[52:55], a[252:255], v[212:215], a[52:55]
  v_accvgpr_write_b32 a128, v128
  v_accvgpr_write_b32 a129, v129
  v_mfma_f32_16x16x32_bf16 a[40:43], a[240:243], v[200:203], a[40:43]
  v_accvgpr_write_b32 a130, v130
  v_accvgpr_write_b32 a131, v131
  v_mfma_f32_16x16x32_bf16 a[40:43], a[244:247], v[216:219], a[40:43]
  s_xor_b32 s32, s40, 32768
  s_mov_b32 s39, s81
  s_add_u32 s39, s39, 0x20000
  s_cmp_eq_u32 s39, s0
  s_cselect_b32 s34, 0x20000, 0
  s_add_u32 s39, s39, s34
  s_add_u32 s34, s39, 0
  s_add_u32 m0, s43, 98304
  v_accvgpr_read_b32 v136, a4
  buffer_load_dwordx4 v18, s[52:55], s34 offen offset:0 lds
  v_mfma_f32_16x16x32_bf16 a[56:59], a[248:251], v[200:203], a[56:59]
  v_accvgpr_read_b32 v137, a5
  v_accvgpr_read_b32 v138, a6
  v_mfma_f32_16x16x32_bf16 a[56:59], a[252:255], v[216:219], a[56:59]
  v_accvgpr_read_b32 v139, a7
  v_accvgpr_read_b32 v140, a20
  v_mfma_f32_16x16x32_bf16 a[44:47], a[240:243], v[204:207], a[44:47]
  v_accvgpr_read_b32 v141, a21
  v_accvgpr_read_b32 v142, a22
  v_mfma_f32_16x16x32_bf16 a[44:47], a[244:247], v[220:223], a[44:47]
  v_accvgpr_read_b32 v143, a23
  v_mul_f32 v136, v136, v33
  v_mfma_f32_16x16x32_bf16 a[60:63], a[248:251], v[204:207], a[60:63]
  v_mul_f32 v137, v137, v33
  v_mul_f32 v138, v138, v33
  v_mfma_f32_16x16x32_bf16 a[60:63], a[252:255], v[220:223], a[60:63]
  v_mul_f32 v139, v139, v33
  v_mul_f32 v140, v140, v33
  s_waitcnt lgkmcnt(0)
  v_mfma_f32_16x16x32_bf16 a[64:67], a[192:195], v[192:195], a[64:67]
  v_mul_f32 v141, v141, v33
  v_mul_f32 v142, v142, v33
  v_mfma_f32_16x16x32_bf16 a[64:67], a[196:199], v[208:211], a[64:67]
  v_mul_f32 v143, v143, v33
  v_cvt_pk_bf16_f32 v136, v136, v137
  v_mfma_f32_16x16x32_bf16 a[80:83], a[200:203], v[192:195], a[80:83]
  v_cvt_pk_bf16_f32 v137, v138, v139
  v_cvt_pk_bf16_f32 v138, v140, v141
  v_mfma_f32_16x16x32_bf16 a[80:83], a[204:207], v[208:211], a[80:83]
  v_cvt_pk_bf16_f32 v139, v142, v143
  buffer_store_dwordx4 v[136:139], v19, s[20:23], s32 offen offset:0 sc1
  v_mfma_f32_16x16x32_bf16 a[68:71], a[192:195], v[196:199], a[68:71]
  v_accvgpr_write_b32 a132, v136
  v_accvgpr_write_b32 a133, v137
  v_mfma_f32_16x16x32_bf16 a[68:71], a[196:199], v[212:215], a[68:71]
  v_accvgpr_write_b32 a134, v138
  v_accvgpr_write_b32 a135, v139
  v_mfma_f32_16x16x32_bf16 a[84:87], a[200:203], v[196:199], a[84:87]
  s_xor_b32 s32, s40, 65536
  v_accvgpr_read_b32 v144, a8
  v_accvgpr_read_b32 v145, a9
  v_mfma_f32_16x16x32_bf16 a[84:87], a[204:207], v[212:215], a[84:87]
  v_accvgpr_read_b32 v146, a10
  v_accvgpr_read_b32 v147, a11
  v_mfma_f32_16x16x32_bf16 a[72:75], a[192:195], v[200:203], a[72:75]
  v_accvgpr_read_b32 v148, a24
  v_accvgpr_read_b32 v149, a25
  v_mfma_f32_16x16x32_bf16 a[72:75], a[196:199], v[216:219], a[72:75]
  v_accvgpr_read_b32 v150, a26
  v_accvgpr_read_b32 v151, a27
  v_mfma_f32_16x16x32_bf16 a[88:91], a[200:203], v[200:203], a[88:91]
  v_mul_f32 v144, v144, v34
  v_mul_f32 v145, v145, v34
  v_mfma_f32_16x16x32_bf16 a[88:91], a[204:207], v[216:219], a[88:91]
  v_mul_f32 v146, v146, v34
  v_mul_f32 v147, v147, v34
  v_mfma_f32_16x16x32_bf16 a[76:79], a[192:195], v[204:207], a[76:79]
  v_mul_f32 v148, v148, v34
  v_mul_f32 v149, v149, v34
  v_mfma_f32_16x16x32_bf16 a[76:79], a[196:199], v[220:223], a[76:79]
  v_mul_f32 v150, v150, v34
  v_mul_f32 v151, v151, v34
  v_mfma_f32_16x16x32_bf16 a[92:95], a[200:203], v[204:207], a[92:95]
  v_cvt_pk_bf16_f32 v144, v144, v145
  v_cvt_pk_bf16_f32 v145, v146, v147
  v_mfma_f32_16x16x32_bf16 a[92:95], a[204:207], v[220:223], a[92:95]
  v_cvt_pk_bf16_f32 v146, v148, v149
  v_cvt_pk_bf16_f32 v147, v150, v151
  v_mfma_f32_16x16x32_bf16 a[96:99], a[208:211], v[192:195], a[96:99]
  buffer_store_dwordx4 v[144:147], v19, s[20:23], s32 offen offset:0 sc1
  v_mfma_f32_16x16x32_bf16 a[96:99], a[212:215], v[208:211], a[96:99]
  s_xor_b32 s32, s40, 98304
  s_add_u32 s35, s39, 15360
  s_add_u32 m0, s43, 98304
  v_accvgpr_read_b32 v152, a12
  buffer_load_dwordx4 v18, s[52:55], s35 offen offset:1024 lds
  v_mfma_f32_16x16x32_bf16 a[112:115], a[216:219], v[192:195], a[112:115]
  v_accvgpr_read_b32 v153, a13
  v_accvgpr_read_b32 v154, a14
  v_mfma_f32_16x16x32_bf16 a[112:115], a[220:223], v[208:211], a[112:115]
  v_accvgpr_read_b32 v155, a15
  v_accvgpr_read_b32 v156, a28
  v_mfma_f32_16x16x32_bf16 a[100:103], a[208:211], v[196:199], a[100:103]
  v_accvgpr_read_b32 v157, a29
  v_accvgpr_read_b32 v158, a30
  v_mfma_f32_16x16x32_bf16 a[100:103], a[212:215], v[212:215], a[100:103]
  v_accvgpr_read_b32 v159, a31
  v_mul_f32 v152, v152, v35
  v_mfma_f32_16x16x32_bf16 a[116:119], a[216:219], v[196:199], a[116:119]
  v_mul_f32 v153, v153, v35
  v_mul_f32 v154, v154, v35
  v_mfma_f32_16x16x32_bf16 a[116:119], a[220:223], v[212:215], a[116:119]
  v_mul_f32 v155, v155, v35
  v_mul_f32 v156, v156, v35
  v_mfma_f32_16x16x32_bf16 a[104:107], a[208:211], v[200:203], a[104:107]
  v_mul_f32 v157, v157, v35
  v_mul_f32 v158, v158, v35
  v_mfma_f32_16x16x32_bf16 a[104:107], a[212:215], v[216:219], a[104:107]
  v_mul_f32 v159, v159, v35
  v_cvt_pk_bf16_f32 v152, v152, v153
  v_mfma_f32_16x16x32_bf16 a[120:123], a[216:219], v[200:203], a[120:123]
  v_cvt_pk_bf16_f32 v153, v154, v155
  v_cvt_pk_bf16_f32 v154, v156, v157
  v_mfma_f32_16x16x32_bf16 a[120:123], a[220:223], v[216:219], a[120:123]
  v_cvt_pk_bf16_f32 v155, v158, v159
  buffer_store_dwordx4 v[152:155], v19, s[20:23], s32 offen offset:0 sc1
  v_mfma_f32_16x16x32_bf16 a[108:111], a[208:211], v[204:207], a[108:111]
  s_xor_b32 s32, s40, 0
  v_accvgpr_read_b32 v160, a32
  v_accvgpr_read_b32 v161, a33
  v_mfma_f32_16x16x32_bf16 a[108:111], a[212:215], v[220:223], a[108:111]
  v_accvgpr_read_b32 v162, a34
  v_accvgpr_read_b32 v163, a35
  v_mfma_f32_16x16x32_bf16 a[124:127], a[216:219], v[204:207], a[124:127]
  v_accvgpr_read_b32 v164, a48
  v_accvgpr_read_b32 v165, a49
  v_mfma_f32_16x16x32_bf16 a[124:127], a[220:223], v[220:223], a[124:127]
  v_accvgpr_read_b32 v166, a50
  v_accvgpr_read_b32 v167, a51
  v_pk_mul_f32 v[160:161], v[160:161], v[32:33] op_sel:[0,0] op_sel_hi:[1,0]
  v_pk_mul_f32 v[162:163], v[162:163], v[32:33] op_sel:[0,0] op_sel_hi:[1,0]
  v_pk_mul_f32 v[164:165], v[164:165], v[32:33] op_sel:[0,0] op_sel_hi:[1,0]
  v_pk_mul_f32 v[166:167], v[166:167], v[32:33] op_sel:[0,0] op_sel_hi:[1,0]
  v_cvt_pk_bf16_f32 v160, v160, v161
  v_cvt_pk_bf16_f32 v161, v162, v163
  v_cvt_pk_bf16_f32 v162, v164, v165
  v_cvt_pk_bf16_f32 v163, v166, v167
  buffer_store_dwordx4 v[160:163], v19, s[20:23], s32 offen offset:1024 sc1
  v_accvgpr_write_b32 a136, v160
  v_accvgpr_write_b32 a137, v161
  v_accvgpr_write_b32 a138, v162
  v_accvgpr_write_b32 a139, v163
  s_xor_b32 s32, s40, 32768
  s_add_u32 s36, s39, 30720
  s_add_u32 m0, s43, 98304
  v_accvgpr_read_b32 v168, a36
  buffer_load_dwordx4 v18, s[52:55], s36 offen offset:2048 lds
  v_accvgpr_read_b32 v169, a37
  v_accvgpr_read_b32 v170, a38
  v_accvgpr_read_b32 v171, a39
  v_accvgpr_read_b32 v172, a52
  v_accvgpr_read_b32 v173, a53
  v_accvgpr_read_b32 v174, a54
  v_accvgpr_read_b32 v175, a55
  v_pk_mul_f32 v[168:169], v[168:169], v[32:33] op_sel:[0,1] op_sel_hi:[1,1]
  v_pk_mul_f32 v[170:171], v[170:171], v[32:33] op_sel:[0,1] op_sel_hi:[1,1]
  v_pk_mul_f32 v[172:173], v[172:173], v[32:33] op_sel:[0,1] op_sel_hi:[1,1]
  v_pk_mul_f32 v[174:175], v[174:175], v[32:33] op_sel:[0,1] op_sel_hi:[1,1]
  v_cvt_pk_bf16_f32 v168, v168, v169
  v_cvt_pk_bf16_f32 v169, v170, v171
  v_cvt_pk_bf16_f32 v170, v172, v173
  v_cvt_pk_bf16_f32 v171, v174, v175
  buffer_store_dwordx4 v[168:171], v19, s[20:23], s32 offen offset:1024 sc1
  v_accvgpr_write_b32 a140, v168
  v_accvgpr_write_b32 a141, v169
  v_accvgpr_write_b32 a142, v170
  v_accvgpr_write_b32 a143, v171
  s_xor_b32 s32, s40, 65536
  s_add_u32 s37, s39, 46080
  s_add_u32 m0, s43, 98304
  v_accvgpr_read_b32 v176, a40
  buffer_load_dwordx4 v18, s[52:55], s37 offen offset:3072 lds
  v_accvgpr_read_b32 v177, a41
  v_accvgpr_read_b32 v178, a42
  v_accvgpr_read_b32 v179, a43
  v_accvgpr_read_b32 v180, a56
  v_accvgpr_read_b32 v181, a57
  v_accvgpr_read_b32 v182, a58
  v_accvgpr_read_b32 v183, a59
  v_pk_mul_f32 v[176:177], v[176:177], v[34:35] op_sel:[0,0] op_sel_hi:[1,0]
  v_pk_mul_f32 v[178:179], v[178:179], v[34:35] op_sel:[0,0] op_sel_hi:[1,0]
  v_pk_mul_f32 v[180:181], v[180:181], v[34:35] op_sel:[0,0] op_sel_hi:[1,0]
  v_pk_mul_f32 v[182:183], v[182:183], v[34:35] op_sel:[0,0] op_sel_hi:[1,0]
  v_cvt_pk_bf16_f32 v176, v176, v177
  v_cvt_pk_bf16_f32 v177, v178, v179
  v_cvt_pk_bf16_f32 v178, v180, v181
  v_cvt_pk_bf16_f32 v179, v182, v183
  buffer_store_dwordx4 v[176:179], v19, s[20:23], s32 offen offset:1024 sc1
  s_waitcnt vmcnt(11) lgkmcnt(0)
  s_barrier
  ds_read_b128 v[36:39], v30
  s_xor_b32 s32, s40, 98304
  v_accvgpr_read_b32 v184, a44
  v_accvgpr_read_b32 v185, a45
  v_accvgpr_read_b32 v186, a46
  v_accvgpr_read_b32 v187, a47
  v_accvgpr_read_b32 v188, a60
  v_accvgpr_read_b32 v189, a61
  v_accvgpr_read_b32 v190, a62
  v_accvgpr_read_b32 v191, a63
  v_pk_mul_f32 v[184:185], v[184:185], v[34:35] op_sel:[0,1] op_sel_hi:[1,1]
  v_pk_mul_f32 v[186:187], v[186:187], v[34:35] op_sel:[0,1] op_sel_hi:[1,1]
  v_pk_mul_f32 v[188:189], v[188:189], v[34:35] op_sel:[0,1] op_sel_hi:[1,1]
  v_pk_mul_f32 v[190:191], v[190:191], v[34:35] op_sel:[0,1] op_sel_hi:[1,1]
  v_cvt_pk_bf16_f32 v184, v184, v185
  v_cvt_pk_bf16_f32 v185, v186, v187
  v_cvt_pk_bf16_f32 v186, v188, v189
  v_cvt_pk_bf16_f32 v187, v190, v191
  buffer_store_dwordx4 v[184:187], v19, s[20:23], s32 offen offset:1024 sc1
  s_waitcnt lgkmcnt(0)
  v_or_b32 v36, v36, v37
  v_or3_b32 v36, v36, v38, v39
  s_nop 0
  v_readfirstlane_b32 s31, v36
  s_nop 3
  s_andn2_b32 s31, s31, s29
  s_cbranch_scc1 L_attn_fallback
  s_xor_b32 s32, s40, 0
  s_add_u32 s34, s39, 65536
  s_add_u32 m0, s43, 114688
  v_accvgpr_read_b32 v128, a64
  buffer_load_dwordx4 v18, s[52:55], s34 offen offset:0 lds
  v_accvgpr_read_b32 v129, a65
  v_accvgpr_read_b32 v130, a66
  v_accvgpr_read_b32 v131, a67
  v_accvgpr_read_b32 v132, a80
  v_accvgpr_read_b32 v133, a81
  v_accvgpr_read_b32 v134, a82
  v_accvgpr_read_b32 v135, a83
  v_pk_mul_f32 v[128:129], v[128:129], v[32:33] op_sel:[0,0] op_sel_hi:[1,0]
  v_pk_mul_f32 v[130:131], v[130:131], v[32:33] op_sel:[0,0] op_sel_hi:[1,0]
  v_pk_mul_f32 v[132:133], v[132:133], v[32:33] op_sel:[0,0] op_sel_hi:[1,0]
  v_pk_mul_f32 v[134:135], v[134:135], v[32:33] op_sel:[0,0] op_sel_hi:[1,0]
  v_cvt_pk_bf16_f32 v128, v128, v129
  v_cvt_pk_bf16_f32 v129, v130, v131
  v_cvt_pk_bf16_f32 v130, v132, v133
  v_cvt_pk_bf16_f32 v131, v134, v135
  buffer_store_dwordx4 v[128:131], v19, s[20:23], s32 offen offset:2048 sc1
  v_accvgpr_write_b32 a144, v128
  v_accvgpr_write_b32 a145, v129
  v_accvgpr_write_b32 a146, v130
  v_accvgpr_write_b32 a147, v131
  s_xor_b32 s32, s40, 32768
  v_accvgpr_read_b32 v136, a68
  v_accvgpr_read_b32 v137, a69
  v_accvgpr_read_b32 v138, a70
  v_accvgpr_read_b32 v139, a71
  v_accvgpr_read_b32 v140, a84
  v_accvgpr_read_b32 v141, a85
  v_accvgpr_read_b32 v142, a86
  v_accvgpr_read_b32 v143, a87
  v_pk_mul_f32 v[136:137], v[136:137], v[32:33] op_sel:[0,1] op_sel_hi:[1,1]
  v_pk_mul_f32 v[138:139], v[138:139], v[32:33] op_sel:[0,1] op_sel_hi:[1,1]
  v_pk_mul_f32 v[140:141], v[140:141], v[32:33] op_sel:[0,1] op_sel_hi:[1,1]
  v_pk_mul_f32 v[142:143], v[142:143], v[32:33] op_sel:[0,1] op_sel_hi:[1,1]
  v_cvt_pk_bf16_f32 v136, v136, v137
  v_cvt_pk_bf16_f32 v137, v138, v139
  v_cvt_pk_bf16_f32 v138, v140, v141
  v_cvt_pk_bf16_f32 v139, v142, v143
  buffer_store_dwordx4 v[136:139], v19, s[20:23], s32 offen offset:2048 sc1
  v_accvgpr_write_b32 a148, v136
  v_accvgpr_write_b32 a149, v137
  v_accvgpr_write_b32 a150, v138
  v_accvgpr_write_b32 a151, v139
  s_xor_b32 s32, s40, 65536
  s_add_u32 s35, s39, 80896
  s_add_u32 m0, s43, 114688
  v_accvgpr_read_b32 v144, a72
  buffer_load_dwordx4 v18, s[52:55], s35 offen offset:1024 lds
  v_accvgpr_read_b32 v145, a73
  v_accvgpr_read_b32 v146, a74
  v_accvgpr_read_b32 v147, a75
  v_accvgpr_read_b32 v148, a88
  v_accvgpr_read_b32 v149, a89
  v_accvgpr_read_b32 v150, a90
  v_accvgpr_read_b32 v151, a91
  v_pk_mul_f32 v[144:145], v[144:145], v[34:35] op_sel:[0,0] op_sel_hi:[1,0]
  v_pk_mul_f32 v[146:147], v[146:147], v[34:35] op_sel:[0,0] op_sel_hi:[1,0]
  v_pk_mul_f32 v[148:149], v[148:149], v[34:35] op_sel:[0,0] op_sel_hi:[1,0]
  v_pk_mul_f32 v[150:151], v[150:151], v[34:35] op_sel:[0,0] op_sel_hi:[1,0]
  v_cvt_pk_bf16_f32 v144, v144, v145
  v_cvt_pk_bf16_f32 v145, v146, v147
  v_cvt_pk_bf16_f32 v146, v148, v149
  v_cvt_pk_bf16_f32 v147, v150, v151
  buffer_store_dwordx4 v[144:147], v19, s[20:23], s32 offen offset:2048 sc1
  s_xor_b32 s32, s40, 98304
  v_accvgpr_read_b32 v152, a76
  v_accvgpr_read_b32 v153, a77
  v_accvgpr_read_b32 v154, a78
  v_accvgpr_read_b32 v155, a79
  v_accvgpr_read_b32 v156, a92
  v_accvgpr_read_b32 v157, a93
  v_accvgpr_read_b32 v158, a94
  v_accvgpr_read_b32 v159, a95
  v_pk_mul_f32 v[152:153], v[152:153], v[34:35] op_sel:[0,1] op_sel_hi:[1,1]
  v_pk_mul_f32 v[154:155], v[154:155], v[34:35] op_sel:[0,1] op_sel_hi:[1,1]
  v_pk_mul_f32 v[156:157], v[156:157], v[34:35] op_sel:[0,1] op_sel_hi:[1,1]
  v_pk_mul_f32 v[158:159], v[158:159], v[34:35] op_sel:[0,1] op_sel_hi:[1,1]
  v_cvt_pk_bf16_f32 v152, v152, v153
  v_cvt_pk_bf16_f32 v153, v154, v155
  v_cvt_pk_bf16_f32 v154, v156, v157
  v_cvt_pk_bf16_f32 v155, v158, v159
  buffer_store_dwordx4 v[152:155], v19, s[20:23], s32 offen offset:2048 sc1
  s_xor_b32 s32, s40, 0
  s_add_u32 s36, s39, 96256
  s_add_u32 m0, s43, 114688
  v_accvgpr_read_b32 v160, a96
  buffer_load_dwordx4 v18, s[52:55], s36 offen offset:2048 lds
  v_accvgpr_read_b32 v161, a97
  v_accvgpr_read_b32 v162, a98
  v_accvgpr_read_b32 v163, a99
  v_accvgpr_read_b32 v164, a112
  v_accvgpr_read_b32 v165, a113
  v_accvgpr_read_b32 v166, a114
  v_accvgpr_read_b32 v167, a115
  v_pk_mul_f32 v[160:161], v[160:161], v[32:33] op_sel:[0,0] op_sel_hi:[1,0]
  v_pk_mul_f32 v[162:163], v[162:163], v[32:33] op_sel:[0,0] op_sel_hi:[1,0]
  v_pk_mul_f32 v[164:165], v[164:165], v[32:33] op_sel:[0,0] op_sel_hi:[1,0]
  v_pk_mul_f32 v[166:167], v[166:167], v[32:33] op_sel:[0,0] op_sel_hi:[1,0]
  v_cvt_pk_bf16_f32 v160, v160, v161
  v_cvt_pk_bf16_f32 v161, v162, v163
  v_cvt_pk_bf16_f32 v162, v164, v165
  v_cvt_pk_bf16_f32 v163, v166, v167
  buffer_store_dwordx4 v[160:163], v19, s[20:23], s32 offen offset:3072 sc1
  v_accvgpr_write_b32 a152, v160
  v_accvgpr_write_b32 a153, v161
  v_accvgpr_write_b32 a154, v162
  v_accvgpr_write_b32 a155, v163
  s_xor_b32 s32, s40, 32768
  s_add_u32 s37, s39, 111616
  s_add_u32 m0, s43, 114688
  v_accvgpr_read_b32 v168, a100
  buffer_load_dwordx4 v18, s[52:55], s37 offen offset:3072 lds
  v_accvgpr_read_b32 v169, a101
  v_accvgpr_read_b32 v170, a102
  v_accvgpr_read_b32 v171, a103
  v_accvgpr_read_b32 v172, a116
  v_accvgpr_read_b32 v173, a117
  v_accvgpr_read_b32 v174, a118
  v_accvgpr_read_b32 v175, a119
  v_pk_mul_f32 v[168:169], v[168:169], v[32:33] op_sel:[0,1] op_sel_hi:[1,1]
  v_pk_mul_f32 v[170:171], v[170:171], v[32:33] op_sel:[0,1] op_sel_hi:[1,1]
  v_pk_mul_f32 v[172:173], v[172:173], v[32:33] op_sel:[0,1] op_sel_hi:[1,1]
  v_pk_mul_f32 v[174:175], v[174:175], v[32:33] op_sel:[0,1] op_sel_hi:[1,1]
  v_cvt_pk_bf16_f32 v168, v168, v169
  v_cvt_pk_bf16_f32 v169, v170, v171
  v_cvt_pk_bf16_f32 v170, v172, v173
  v_cvt_pk_bf16_f32 v171, v174, v175
  buffer_store_dwordx4 v[168:171], v19, s[20:23], s32 offen offset:3072 sc1
  v_accvgpr_write_b32 a156, v168
  v_accvgpr_write_b32 a157, v169
  v_accvgpr_write_b32 a158, v170
  v_accvgpr_write_b32 a159, v171
  s_xor_b32 s32, s40, 65536
  v_accvgpr_read_b32 v176, a104
  v_accvgpr_read_b32 v177, a105
  v_accvgpr_read_b32 v178, a106
  v_accvgpr_read_b32 v179, a107
  v_accvgpr_read_b32 v180, a120
  v_accvgpr_read_b32 v181, a121
  v_accvgpr_read_b32 v182, a122
  v_accvgpr_read_b32 v183, a123
  v_pk_mul_f32 v[176:177], v[176:177], v[34:35] op_sel:[0,0] op_sel_hi:[1,0]
  v_pk_mul_f32 v[178:179], v[178:179], v[34:35] op_sel:[0,0] op_sel_hi:[1,0]
  v_pk_mul_f32 v[180:181], v[180:181], v[34:35] op_sel:[0,0] op_sel_hi:[1,0]
  v_pk_mul_f32 v[182:183], v[182:183], v[34:35] op_sel:[0,0] op_sel_hi:[1,0]
  v_cvt_pk_bf16_f32 v176, v176, v177
  v_cvt_pk_bf16_f32 v177, v178, v179
  v_cvt_pk_bf16_f32 v178, v180, v181
  v_cvt_pk_bf16_f32 v179, v182, v183
  buffer_store_dwordx4 v[176:179], v19, s[20:23], s32 offen offset:3072 sc1
  s_xor_b32 s32, s40, 98304
  v_accvgpr_read_b32 v184, a108
  v_accvgpr_read_b32 v185, a109
  v_accvgpr_read_b32 v186, a110
  v_accvgpr_read_b32 v187, a111
  v_accvgpr_read_b32 v188, a124
  v_accvgpr_read_b32 v189, a125
  v_accvgpr_read_b32 v190, a126
  v_accvgpr_read_b32 v191, a127
  v_pk_mul_f32 v[184:185], v[184:185], v[34:35] op_sel:[0,1] op_sel_hi:[1,1]
  v_pk_mul_f32 v[186:187], v[186:187], v[34:35] op_sel:[0,1] op_sel_hi:[1,1]
  v_pk_mul_f32 v[188:189], v[188:189], v[34:35] op_sel:[0,1] op_sel_hi:[1,1]
  v_pk_mul_f32 v[190:191], v[190:191], v[34:35] op_sel:[0,1] op_sel_hi:[1,1]
  v_cvt_pk_bf16_f32 v184, v184, v185
  v_cvt_pk_bf16_f32 v185, v186, v187
  v_cvt_pk_bf16_f32 v186, v188, v189
  v_cvt_pk_bf16_f32 v187, v190, v191
  buffer_store_dwordx4 v[184:187], v19, s[20:23], s32 offen offset:3072 sc1
  s_branch L_f_done
L_p3_few:
  s_waitcnt vmcnt(2)
  s_branch L_p3_done
L_spinM:
  s_mov_b32 s31, 0
  s_mov_b32 s30, 131072
L_spinM2_poll:
  buffer_load_dword v7, v103, s[64:67], s30 offen sc1
  s_add_u32 s31, s31, 1
  s_waitcnt vmcnt(0)
  v_cmp_eq_u32 s[32:33], s68, v7
  s_cmp_gt_u32 s31, 2097152
  s_cbranch_scc1 L_spinM2_x
  s_cmp_eq_u64 s[32:33], -1
  s_cbranch_scc0 L_spinM2_poll
L_spinM2_x:
  s_branch L_spinM_x
L_attn_fallback:
  s_mov_b32 s29, 1
  s_waitcnt vmcnt(0)
  s_nop 7
  v_lshrrev_b32 v28, 4, v19
  v_and_b32 v29, 15, v28
  v_lshrrev_b32 v28, 4, v28
  v_lshlrev_b32 v29, 8, v29
  v_lshl_add_u32 v28, v28, 4, v29
  s_mov_b32 s30, 0
  v_mov_b32 v24, 0xff7fffff
  v_mov_b32 v25, 0xff7fffff
  v_mov_b32 v26, 0xff7fffff
  v_mov_b32 v27, 0xff7fffff
  v_accvgpr_write_b32 a0, 0
  v_accvgpr_write_b32 a1, 0
  v_accvgpr_write_b32 a2, 0
  v_accvgpr_write_b32 a3, 0
  v_accvgpr_write_b32 a4, 0
  v_accvgpr_write_b32 a5, 0
  v_accvgpr_write_b32 a6, 0
  v_accvgpr_write_b32 a7, 0
  v_accvgpr_write_b32 a8, 0
  v_accvgpr_write_b32 a9, 0
  v_accvgpr_write_b32 a10, 0
  v_accvgpr_write_b32 a11, 0
  v_accvgpr_write_b32 a12, 0
  v_accvgpr_write_b32 a13, 0
  v_accvgpr_write_b32 a14, 0
  v_accvgpr_write_b32 a15, 0
  v_accvgpr_write_b32 a16, 0
  v_accvgpr_write_b32 a17, 0
  v_accvgpr_write_b32 a18, 0
  v_accvgpr_write_b32 a19, 0
  v_accvgpr_write_b32 a20, 0
  v_accvgpr_write_b32 a21, 0
  v_accvgpr_write_b32 a22, 0
  v_accvgpr_write_b32 a23, 0
  v_accvgpr_write_b32 a24, 0
  v_accvgpr_write_b32 a25, 0
  v_accvgpr_write_b32 a26, 0
  v_accvgpr_write_b32 a27, 0
  v_accvgpr_write_b32 a28, 0
  v_accvgpr_write_b32 a29, 0
  v_accvgpr_write_b32 a30, 0
  v_accvgpr_write_b32 a31, 0
  v_accvgpr_write_b32 a32, 0
  v_accvgpr_write_b32 a33, 0
  v_accvgpr_write_b32 a34, 0
  v_accvgpr_write_b32 a35, 0
  v_accvgpr_write_b32 a36, 0
  v_accvgpr_write_b32 a37, 0
  v_accvgpr_write_b32 a38, 0
  v_accvgpr_write_b32 a39, 0
  v_accvgpr_write_b32 a40, 0
  v_accvgpr_write_b32 a41, 0
  v_accvgpr_write_b32 a42, 0
  v_accvgpr_write_b32 a43, 0
  v_accvgpr_write_b32 a44, 0
  v_accvgpr_write_b32 a45, 0
  v_accvgpr_write_b32 a46, 0
  v_accvgpr_write_b32 a47, 0
  v_accvgpr_write_b32 a48, 0
  v_accvgpr_write_b32 a49, 0
  v_accvgpr_write_b32 a50, 0
  v_accvgpr_write_b32 a51, 0
  v_accvgpr_write_b32 a52, 0
  v_accvgpr_write_b32 a53, 0
  v_accvgpr_write_b32 a54, 0
  v_accvgpr_write_b32 a55, 0
  v_accvgpr_write_b32 a56, 0
  v_accvgpr_write_b32 a57, 0
  v_accvgpr_write_b32 a58, 0
  v_accvgpr_write_b32 a59, 0
  v_accvgpr_write_b32 a60, 0
  v_accvgpr_write_b32 a61, 0
  v_accvgpr_write_b32 a62, 0
  v_accvgpr_write_b32 a63, 0
  v_accvgpr_write_b32 a64, 0
  v_accvgpr_write_b32 a65, 0
  v_accvgpr_write_b32 a66, 0
  v_accvgpr_write_b32 a67, 0
  v_accvgpr_write_b32 a68, 0
  v_accvgpr_write_b32 a69, 0
  v_accvgpr_write_b32 a70, 0
  v_accvgpr_write_b32 a71, 0
  v_accvgpr_write_b32 a72, 0
  v_accvgpr_write_b32 a73, 0
  v_accvgpr_write_b32 a74, 0
  v_accvgpr_write_b32 a75, 0
  v_accvgpr_write_b32 a76, 0
  v_accvgpr_write_b32 a77, 0
  v_accvgpr_write_b32 a78, 0
  v_accvgpr_write_b32 a79, 0
  v_accvgpr_write_b32 a80, 0
  v_accvgpr_write_b32 a81, 0
  v_accvgpr_write_b32 a82, 0
  v_accvgpr_write_b32 a83, 0
  v_accvgpr_write_b32 a84, 0
  v_accvgpr_write_b32 a85, 0
  v_accvgpr_write_b32 a86, 0
  v_accvgpr_write_b32 a87, 0
  v_accvgpr_write_b32 a88, 0
  v_accvgpr_write_b32 a89, 0
  v_accvgpr_write_b32 a90, 0
  v_accvgpr_write_b32 a91, 0
  v_accvgpr_write_b32 a92, 0
  v_accvgpr_write_b32 a93, 0
  v_accvgpr_write_b32 a94, 0
  v_accvgpr_write_b32 a95, 0
  v_accvgpr_write_b32 a96, 0
  v_accvgpr_write_b32 a97, 0
  v_accvgpr_write_b32 a98, 0
  v_accvgpr_write_b32 a99, 0
  v_accvgpr_write_b32 a100, 0
  v_accvgpr_write_b32 a101, 0
  v_accvgpr_write_b32 a102, 0
  v_accvgpr_write_b32 a103, 0
  v_accvgpr_write_b32 a104, 0
  v_accvgpr_write_b32 a105, 0
  v_accvgpr_write_b32 a106, 0
  v_accvgpr_write_b32 a107, 0
  v_accvgpr_write_b32 a108, 0
  v_accvgpr_write_b32 a109, 0
  v_accvgpr_write_b32 a110, 0
  v_accvgpr_write_b32 a111, 0
  v_accvgpr_write_b32 a112, 0
  v_accvgpr_write_b32 a113, 0
  v_accvgpr_write_b32 a114, 0
  v_accvgpr_write_b32 a115, 0
  v_accvgpr_write_b32 a116, 0
  v_accvgpr_write_b32 a117, 0
  v_accvgpr_write_b32 a118, 0
  v_accvgpr_write_b32 a119, 0
  v_accvgpr_write_b32 a120, 0
  v_accvgpr_write_b32 a121, 0
  v_accvgpr_write_b32 a122, 0
  v_accvgpr_write_b32 a123, 0
  v_accvgpr_write_b32 a124, 0
  v_accvgpr_write_b32 a125, 0
  v_accvgpr_write_b32 a126, 0
  v_accvgpr_write_b32 a127, 0
L_attn_maxloop:
  s_add_u32 s31, s30, 4096
  buffer_load_dwordx4 a[128:131], v28, s[4:7], s30 offen offset:0
  buffer_load_dwordx4 a[132:135], v28, s[4:7], s30 offen offset:64
  buffer_load_dwordx4 a[136:139], v28, s[4:7], s30 offen offset:128
  buffer_load_dwordx4 a[140:143], v28, s[4:7], s30 offen offset:192
  buffer_load_dwordx4 a[144:147], v28, s[4:7], s31 offen offset:0
  buffer_load_dwordx4 a[148:151], v28, s[4:7], s31 offen offset:64
  buffer_load_dwordx4 a[152:155], v28, s[4:7], s31 offen offset:128
  buffer_load_dwordx4 a[156:159], v28, s[4:7], s31 offen offset:192
  s_waitcnt vmcnt(0)
  v_mfma_f32_16x16x32_bf16 v[128:131], a[128:131], v[64:67], 0
  v_mfma_f32_16x16x32_bf16 v[128:131], a[132:135], v[68:71], v[128:131]
  v_mfma_f32_16x16x32_bf16 v[128:131], a[136:139], v[72:75], v[128:131]
  v_mfma_f32_16x16x32_bf16 v[128:131], a[140:143], v[76:79], v[128:131]
  v_mfma_f32_16x16x32_bf16 v[132:135], a[156:159], v[76:79], 0
  v_mfma_f32_16x16x32_bf16 v[132:135], a[152:155], v[72:75], v[132:135]
  v_mfma_f32_16x16x32_bf16 v[132:135], a[148:151], v[68:71], v[132:135]
  v_mfma_f32_16x16x32_bf16 v[132:135], a[144:147], v[64:67], v[132:135]
  v_mfma_f32_16x16x32_bf16 v[136:139], a[128:131], v[80:83], 0
  v_mfma_f32_16x16x32_bf16 v[136:139], a[132:135], v[84:87], v[136:139]
  v_mfma_f32_16x16x32_bf16 v[136:139], a[136:139], v[88:91], v[136:139]
  v_mfma_f32_16x16x32_bf16 v[136:139], a[140:143], v[92:95], v[136:139]
  v_mfma_f32_16x16x32_bf16 v[140:143], a[156:159], v[92:95], 0
  v_mfma_f32_16x16x32_bf16 v[140:143], a[152:155], v[88:91], v[140:143]
  v_mfma_f32_16x16x32_bf16 v[140:143], a[148:151], v[84:87], v[140:143]
  v_mfma_f32_16x16x32_bf16 v[140:143], a[144:147], v[80:83], v[140:143]
  v_mfma_f32_16x16x32_bf16 v[144:147], a[128:131], v[96:99], 0
  v_mfma_f32_16x16x32_bf16 v[144:147], a[132:135], v[100:103], v[144:147]
  v_mfma_f32_16x16x32_bf16 v[144:147], a[136:139], v[104:107], v[144:147]
  v_mfma_f32_16x16x32_bf16 v[144:147], a[140:143], v[108:111], v[144:147]
  v_mfma_f32_16x16x32_bf16 v[148:151], a[156:159], v[108:111], 0
  v_mfma_f32_16x16x32_bf16 v[148:151], a[152:155], v[104:107], v[148:151]
  v_mfma_f32_16x16x32_bf16 v[148:151], a[148:151], v[100:103], v[148:151]
  v_mfma_f32_16x16x32_bf16 v[148:151], a[144:147], v[96:99], v[148:151]
  v_mfma_f32_16x16x32_bf16 v[152:155], a[128:131], v[112:115], 0
  v_mfma_f32_16x16x32_bf16 v[152:155], a[132:135], v[116:119], v[152:155]
  v_mfma_f32_16x16x32_bf16 v[152:155], a[136:139], v[120:123], v[152:155]
  v_mfma_f32_16x16x32_bf16 v[152:155], a[140:143], v[124:127], v[152:155]
  v_mfma_f32_16x16x32_bf16 v[156:159], a[156:159], v[124:127], 0
  v_mfma_f32_16x16x32_bf16 v[156:159], a[152:155], v[120:123], v[156:159]
  v_mfma_f32_16x16x32_bf16 v[156:159], a[148:151], v[116:119], v[156:159]
  v_mfma_f32_16x16x32_bf16 v[156:159], a[144:147], v[112:115], v[156:159]
  s_nop 7
  v_max3_f32 v24, v24, v128, v129
  v_max3_f32 v25, v25, v136, v137
  v_max3_f32 v26, v26, v144, v145
  v_max3_f32 v27, v27, v152, v153
  v_max3_f32 v24, v24, v130, v131
  v_max3_f32 v25, v25, v138, v139
  v_max3_f32 v26, v26, v146, v147
  v_max3_f32 v27, v27, v154, v155
  v_max3_f32 v24, v24, v132, v133
  v_max3_f32 v25, v25, v140, v141
  v_max3_f32 v26, v26, v148, v149
  v_max3_f32 v27, v27, v156, v157
  v_max3_f32 v24, v24, v134, v135
  v_max3_f32 v25, v25, v142, v143
  v_max3_f32 v26, v26, v150, v151
  v_max3_f32 v27, v27, v158, v159
  s_add_u32 s30, s30, 8192
  s_cmp_lt_u32 s30, 524288
  s_cbranch_scc1 L_attn_maxloop
  s_barrier
  s_mov_b32 s38, 0
  s_add_u32 m0, s43, 0
  s_nop 0
  buffer_load_dwordx4 v16, s[4:7], s38 offen offset:0 lds
  s_mov_b32 s38, 0
  buffer_load_dwordx4 v16, s[4:7], s38 offen offset:1024 lds
  s_mov_b32 s38, 0
  buffer_load_dwordx4 v16, s[4:7], s38 offen offset:2048 lds
  s_mov_b32 s38, 0
  buffer_load_dwordx4 v16, s[4:7], s38 offen offset:3072 lds
  s_mov_b32 s38, 16384
  s_add_u32 m0, s43, 16384
  s_nop 0
  buffer_load_dwordx4 v16, s[4:7], s38 offen offset:0 lds
  s_mov_b32 s38, 16384
  buffer_load_dwordx4 v16, s[4:7], s38 offen offset:1024 lds
  s_mov_b32 s38, 16384
  buffer_load_dwordx4 v16, s[4:7], s38 offen offset:2048 lds
  s_mov_b32 s38, 16384
  buffer_load_dwordx4 v16, s[4:7], s38 offen offset:3072 lds
  s_mov_b32 s38, 0
  s_add_u32 m0, s26, 0
  s_nop 0
  buffer_load_dwordx4 v17, s[8:11], s38 offen offset:0 lds
  s_mov_b32 s38, 0
  buffer_load_dwordx4 v17, s[8:11], s38 offen offset:1024 lds
  s_mov_b32 s38, 0
  buffer_load_dwordx4 v17, s[8:11], s38 offen offset:2048 lds
  s_mov_b32 s38, 0
  buffer_load_dwordx4 v17, s[8:11], s38 offen offset:3072 lds
  s_mov_b32 s38, 32768
  s_add_u32 m0, s43, 32768
  s_nop 0
  buffer_load_dwordx4 v16, s[4:7], s38 offen offset:0 lds
  s_mov_b32 s38, 32768
  buffer_load_dwordx4 v16, s[4:7], s38 offen offset:1024 lds
  s_mov_b32 s38, 32768
  buffer_load_dwordx4 v16, s[4:7], s38 offen offset:2048 lds
  s_mov_b32 s38, 32768
  buffer_load_dwordx4 v16, s[4:7], s38 offen offset:3072 lds
  s_mov_b32 s38, 16384
  s_add_u32 m0, s26, 16384
  s_nop 0
  buffer_load_dwordx4 v17, s[8:11], s38 offen offset:0 lds
  s_mov_b32 s38, 16384
  buffer_load_dwordx4 v17, s[8:11], s38 offen offset:1024 lds
  s_mov_b32 s38, 16384
  buffer_load_dwordx4 v17, s[8:11], s38 offen offset:2048 lds
  s_mov_b32 s38, 16384
  buffer_load_dwordx4 v17, s[8:11], s38 offen offset:3072 lds
  s_mov_b32 s38, 49152
  s_add_u32 m0, s43, 49152
  s_nop 0
  buffer_load_dwordx4 v16, s[4:7], s38 offen offset:0 lds
  s_mov_b32 s38, 49152
  buffer_load_dwordx4 v16, s[4:7], s38 offen offset:1024 lds
  s_mov_b32 s38, 49152
  buffer_load_dwordx4 v16, s[4:7], s38 offen offset:2048 lds
  s_mov_b32 s38, 49152
  buffer_load_dwordx4 v16, s[4:7], s38 offen offset:3072 lds
  s_waitcnt vmcnt(20)
  s_barrier
  ds_read_b128 a[128:131], v4 offset:0
  ds_read_b128 a[132:135], v5 offset:0
  ds_read_b128 a[136:139], v6 offset:0
  ds_read_b128 a[140:143], v7 offset:0
  ds_read_b128 a[144:147], v4 offset:1024
  ds_read_b128 a[148:151], v5 offset:1024
  ds_read_b128 a[152:155], v6 offset:1024
  ds_read_b128 a[156:159], v7 offset:1024
  ds_read_b128 a[160:163], v4 offset:2048
  ds_read_b128 a[164:167], v5 offset:2048
  ds_read_b128 a[168:171], v6 offset:2048
  ds_read_b128 a[172:175], v7 offset:2048
  ds_read_b128 a[176:179], v4 offset:3072
  ds_read_b128 a[180:183], v5 offset:3072
  ds_read_b128 a[184:187], v6 offset:3072
  ds_read_b128 a[188:191], v7 offset:3072
  s_branch L_attn_restart
  s_endpgm
  s_endpgm
  s_endpgm
  s_endpgm
  s_endpgm
  s_endpgm
  s_endpgm
  s_endpgm
  s_endpgm
  s_endpgm
  s_endpgm
  s_endpgm
  s_endpgm
  s_endpgm
  s_endpgm
  s_endpgm
  s_endpgm
  s_endpgm
  s_endpgm
  s_endpgm
  s_endpgm
  s_endpgm
  s_endpgm
  s_endpgm
  s_endpgm
  s_endpgm
  s_endpgm
  s_endpgm
  s_endpgm
  s_endpgm
  s_endpgm
  s_endpgm
  s_endpgm
  s_endpgm
  s_endpgm
  s_endpgm
  s_endpgm
  s_endpgm
  s_endpgm
  s_endpgm
  s_endpgm
  s_endpgm
  s_endpgm
  s_endpgm
  s_endpgm
  s_endpgm
  s_endpgm
  s_endpgm
  s_endpgm
  s_endpgm
  s_endpgm
  s_endpgm
  s_endpgm
  s_endpgm
  s_endpgm
  s_endpgm
  s_endpgm
  s_endpgm
  s_endpgm
  s_endpgm
  s_endpgm
  s_endpgm
  s_endpgm
  s_endpgm
.section .rodata,"a"
.p2align 6
.amdhsa_kernel adaLN_cond__gqa_block_cached__dense_activation_silu__prompt_kernel
  .amdhsa_next_free_vgpr 512
  .amdhsa_next_free_sgpr 82
  .amdhsa_accum_offset 256
  .amdhsa_group_segment_fixed_size 0
  .amdhsa_kernarg_size 104
  .amdhsa_user_sgpr_count 2
  .amdhsa_user_sgpr_kernarg_segment_ptr 1
  .amdhsa_system_sgpr_workgroup_id_x 1
.end_amdhsa_kernel
```
